```python
import torch

def _softmax(x, axis=-1):
    return torch.softmax(x, dim=axis)
def _gelu(x):
    return torch.nn.functional.gelu(x, approximate="tanh")
def _silu(x):
    return torch.nn.functional.silu(x)
def _sigmoid(x):
    return torch.sigmoid(x)
def _layernorm(x, axis=-1, eps=1e-5):
    m = x.mean(dim=axis, keepdim=True)
    v = x.var(dim=axis, keepdim=True, unbiased=False)
    return (x - m) / torch.sqrt(v + eps)
def _scatter_add(tgt, idx, src, axis=0):
    return tgt.clone().index_add_(axis, idx, src)
def _segment_sum(src, seg, n):
    out = torch.zeros((n,) + src.shape[1:], dtype=src.dtype)
    return out.index_add_(0, seg, src)
def _pad(x, pw):
    flat = tuple(v for pair in reversed(pw) for v in pair)
    return torch.nn.functional.pad(x, flat)

kernel_name = 'standalone__window_attn_swin__vision'

def setup_inputs():

    _w = (lambda a: (lambda t: t.to(torch.bfloat16) if t.is_floating_point() else t)(torch.as_tensor(a)))
    H = W = 256
    C = 384
    ws = 8
    nh = 4
    shift = ws // 2
    coords = torch.stack(torch.meshgrid(torch.arange(ws), torch.arange(ws), indexing='ij'), 0).reshape(2, -1)
    rel = coords[:, :, None] - coords[:, None, :]
    rel[0] += ws - 1
    rel[1] += ws - 1
    rel[0] *= 2 * ws - 1
    rp_idx = rel.sum(0).to(torch.int64)
    img_mask = torch.zeros((1, H, W, 1), dtype=float)
    cnt = 0
    for hs in (slice(0, H - ws), slice(H - ws, H - shift), slice(H - shift, H)):
        for vs in (slice(0, W - ws), slice(W - ws, W - shift), slice(W - shift, W)):
            img_mask[:, hs, vs, :] = cnt
            cnt += 1
    mw = img_mask.reshape(1, H // ws, ws, W // ws, ws, 1).permute(0, 1, 3, 2, 4, 5).reshape(-1, ws * ws)
    am = mw[:, :, None] - mw[:, None, :]
    attn_mask = torch.where(am != 0, -100.0, 0.0).to(float)
    return {
        "x": _w((lambda *s: torch.randn(*s, dtype=torch.bfloat16) * 1.6)(1, H, W, C)),
        "wqkv": _w((lambda *s: torch.randn(*s, dtype=torch.bfloat16) * 1.6)(C, 3 * C) * 0.02),
        "wo": _w((lambda *s: torch.randn(*s, dtype=torch.bfloat16) * 0.05)(C, C) * 0.02),
        "rpb": _w((lambda *s: torch.randn(*s, dtype=torch.bfloat16) * 0.2)((2 * ws - 1) * (2 * ws - 1), nh)),
        "rp_idx": _w(rp_idx),
        "attn_mask": _w(attn_mask),
    }

def reference(x, wqkv, wo, rpb, rp_idx, attn_mask):
    B, H, W, C = x.shape
    N = rp_idx.shape[0]
    ws = int(round(N ** 0.5))
    nh = rpb.shape[-1]
    hd = C // nh
    shift = ws // 2
    xs = torch.roll(x, (-shift, -shift), (1, 2))
    nWh = H // ws
    nWw = W // ws
    xw = (lambda x, *d: x.permute(*d))(xs.reshape(B, nWh, ws, nWw, ws, C), 0, 1, 3, 2, 4, 5).reshape(B * nWh * nWw, N, C)
    qkv = (lambda x, *d: x.permute(*d))(torch.einsum('wnc,cd->wnd', xw, wqkv).reshape(-1, N, 3, nh, hd), 2, 0, 3, 1, 4)
    q, k, v = qkv[0], qkv[1], qkv[2]
    attn = torch.einsum('whid,whjd->whij', q, k) * (hd ** -0.5)
    bias = (lambda x, *d: x.permute(*d))(rpb[rp_idx.reshape(-1)].reshape(N, N, nh), 2, 0, 1)
    attn = attn + bias[None, :, :, :]
    attn = (attn.reshape(B, nWh * nWw, nh, N, N) + attn_mask[None, :, None, :, :]).reshape(-1, nh, N, N)
    attn = _softmax(attn, axis=-1)
    out = (lambda x, *d: x.permute(*d))(torch.einsum('whij,whjd->whid', attn, v), 0, 2, 1, 3).reshape(-1, N, C)
    out = torch.einsum('wnc,cd->wnd', out, wo)
    out = (lambda x, *d: x.permute(*d))(out.reshape(B, nWh, nWw, ws, ws, C), 0, 1, 3, 2, 4, 5).reshape(B, H, W, C)
    return torch.roll(out, (shift, shift), (1, 2))
```

```asm
; @launch grid=(256,1,1) block=(256,1,1) lds=163840
.amdgcn_target "amdgcn-amd-amdhsa--gfx950"
.text
.globl standalone__window_attn_swin__vision_kernel
.p2align 8
.type standalone__window_attn_swin__vision_kernel,@function
standalone__window_attn_swin__vision_kernel:
s_load_dwordx4 s[4:7], s[0:1], 0
s_load_dwordx4 s[8:11], s[0:1], 16
s_load_dwordx2 s[12:13], s[0:1], 48
s_cmp_ge_u32 s2, 256
s_cbranch_scc1 L_done
v_and_b32 v1, 63, v0
v_lshrrev_b32 v32, 6, v0
s_lshr_b32 s45, s2, 3
s_getpc_b64 s[48:49]
L_pc:
v_min_u32 v62, 5, v1
v_lshlrev_b32 v62, 7, v62
v_mul_u32_u24 v63, 768, v32
s_mul_i32 s41, s45, 3072
v_add3_u32 v62, v62, v63, s41
v_min_u32 v62, L_end-L_pc-4, v62
s_mov_b32 m0, 163072
v_readfirstlane_b32 s36, v32
global_load_lds_dword v62, s[48:49]
v_lshrrev_b32 v56, 3, v1
v_and_b32 v57, 6, v56
v_and_b32 v58, 7, v1
v_xor_b32 v57, v57, v58
s_lshl_b32 s14, s2, 2
s_add_u32 s14, s14, s36
s_lshr_b32 s15, s14, 5
s_and_b32 s14, s14, 31
s_lshl_b32 s42, s14, 3
s_add_u32 s42, s42, 4
v_add_u32 v59, s42, v56
v_and_b32 v59, 255, v59
v_mul_u32_u24 v59, 768, v59
v_lshl_add_u32 v24, v57, 4, v59
s_lshl_b32 s41, s15, 3
s_add_u32 s41, s41, 4
s_add_u32 s42, s41, 0
s_and_b32 s42, s42, 255
s_mul_i32 s50, s42, 196608
s_add_u32 s42, s41, 1
s_and_b32 s42, s42, 255
s_mul_i32 s51, s42, 196608
s_add_u32 s42, s41, 2
s_and_b32 s42, s42, 255
s_mul_i32 s52, s42, 196608
s_add_u32 s42, s41, 3
s_and_b32 s42, s42, 255
s_mul_i32 s53, s42, 196608
s_add_u32 s42, s41, 4
s_and_b32 s42, s42, 255
s_mul_i32 s54, s42, 196608
s_add_u32 s42, s41, 5
s_and_b32 s42, s42, 255
s_mul_i32 s55, s42, 196608
s_add_u32 s42, s41, 6
s_and_b32 s42, s42, 255
s_mul_i32 s56, s42, 196608
s_add_u32 s42, s41, 7
s_and_b32 s42, s42, 255
s_mul_i32 s57, s42, 196608
v_bfe_u32 v53, v1, 4, 1
s_and_b32 s41, s36, 1
s_lshl_b32 s41, s41, 1
v_or_b32 v53, s41, v53
v_lshlrev_b32 v53, 1, v53
v_xor_b32 v54, v58, v53
v_lshrrev_b32 v12, 2, v54
v_and_b32 v54, 3, v54
v_mul_u32_u24 v52, 2304, v56
v_lshl_add_u32 v52, v54, 4, v52
v_lshl_add_u32 v8, v12, 6, v52
s_mul_i32 s37, s36, 18432
s_mul_i32 s39, s36, 12288
s_waitcnt lgkmcnt(0)
s_mov_b32 s16, s4
s_and_b32 s17, s5, 0xffff
s_mov_b32 s18, 50331648
s_mov_b32 s19, 0x20000
s_sub_u32 s20, s6, 3072
s_subb_u32 s21, s7, 0
s_and_b32 s21, s21, 0xffff
s_mov_b32 s22, 887808
s_mov_b32 s23, 0x20000
s_add_u32 m0, s39, 49152
s_add_u32 s42, s50, 0
buffer_load_dwordx4 v24, s[16:19], s42 offen nt lds
s_add_u32 m0, s39, 50176
s_add_u32 s43, s51, 0
buffer_load_dwordx4 v24, s[16:19], s43 offen nt lds
s_add_u32 m0, s39, 51200
s_add_u32 s42, s52, 0
buffer_load_dwordx4 v24, s[16:19], s42 offen nt lds
s_add_u32 m0, s39, 52224
s_add_u32 s43, s53, 0
buffer_load_dwordx4 v24, s[16:19], s43 offen nt lds
s_add_u32 m0, s39, 53248
s_add_u32 s42, s54, 0
buffer_load_dwordx4 v24, s[16:19], s42 offen nt lds
s_add_u32 m0, s39, 54272
s_add_u32 s43, s55, 0
buffer_load_dwordx4 v24, s[16:19], s43 offen nt lds
s_add_u32 m0, s39, 55296
s_add_u32 s42, s56, 0
buffer_load_dwordx4 v24, s[16:19], s42 offen nt lds
s_add_u32 m0, s39, 56320
s_add_u32 s43, s57, 0
buffer_load_dwordx4 v24, s[16:19], s43 offen nt lds
s_add_u32 m0, s39, 0
s_add_u32 s42, s37, 3072
buffer_load_dwordx4 v8, s[20:23], s42 offen offset:0 lds
s_add_u32 s43, s37, 75776
buffer_load_dwordx4 v8, s[20:23], s43 offen offset:1024 lds
s_add_u32 s42, s37, 1792
buffer_load_dwordx4 v8, s[20:23], s42 offen offset:2048 lds
s_add_u32 s43, s37, 74496
buffer_load_dwordx4 v8, s[20:23], s43 offen offset:3072 lds
s_add_u32 m0, s39, 4096
s_add_u32 s42, s37, 4608
buffer_load_dwordx4 v8, s[20:23], s42 offen offset:0 lds
s_add_u32 s43, s37, 77312
buffer_load_dwordx4 v8, s[20:23], s43 offen offset:1024 lds
s_sub_u32 s24, s8, 3072
s_subb_u32 s25, s9, 0
s_and_b32 s25, s25, 0xffff
s_mov_b32 s26, 297984
s_mov_b32 s27, 0x20000
s_mov_b32 s28, s10
s_and_b32 s29, s11, 0xffff
s_mov_b32 s30, 1800
s_mov_b32 s31, 0x20000
s_mov_b32 s32, s12
s_and_b32 s33, s13, 0xffff
s_mov_b32 s34, 50331648
s_mov_b32 s35, 0x20000
v_and_b32 v43, 15, v1
v_lshrrev_b32 v44, 4, v1
v_lshrrev_b32 v46, 3, v43
s_lshr_b32 s45, s2, 3
s_lshl_b32 s45, s45, 2
s_add_u32 s45, s45, s36
v_min_u32 v60, 23, v1
v_lshrrev_b32 v61, 3, v60
v_and_b32 v60, 7, v60
v_mul_u32_u24 v62, 43, v60
v_lshrrev_b32 v62, 7, v62
v_mul_u32_u24 v62, 3, v62
v_add_u32 v60, v60, v62
v_lshlrev_b32 v60, 7, v60
v_mul_u32_u24 v61, 2304, v61
v_add_u32 v60, v60, v61
s_mul_i32 s38, s36, 6144
s_mov_b32 s40, 0x3e16c740
v_min_u32 v48, 179, v0
v_mul_u32_u24 v49, 21846, v48
v_lshrrev_b32 v49, 18, v49
v_mul_u32_u24 v50, 12, v49
v_sub_u32 v50, v48, v50
v_mul_u32_u24 v51, 15, v49
v_add_u32 v51, 11, v51
v_sub_u32 v51, v51, v50
v_lshlrev_b32 v2, 3, v51
v_mul_u32_u24 v51, 48, v49
v_lshl_add_u32 v51, v50, 2, v51
v_add_u32 v3, 147456, v51
v_bfe_u32 v52, v1, 2, 2
v_and_b32 v53, 3, v1
v_lshlrev_b32 v54, 7, v52
v_lshl_add_u32 v54, v53, 3, v54
v_and_b32 v55, 1, v44
v_lshrrev_b32 v56, 1, v44
v_lshrrev_b32 v57, 1, v52
v_lshl_add_u32 v57, v55, 1, v57
v_lshl_add_u32 v54, v57, 5, v54
v_mul_u32_u24 v57, 12288, v44
v_add_u32 v6, v54, v57
v_xor_b32 v7, 32, v6
v_xor_b32 v17, 64, v6
v_xor_b32 v18, 96, v6
v_add_u32 v19, 98304, v6
v_add_u32 v20, 98304, v7
v_add_u32 v21, 98304, v17
v_add_u32 v22, 98304, v18
v_and_b32 v58, 7, v43
v_and_b32 v57, 6, v43
v_xor_b32 v57, v57, v44
v_lshlrev_b32 v57, 4, v57
v_lshl_add_u32 v57, v58, 7, v57
v_lshl_add_u32 v57, v46, 10, v57
s_add_u32 s41, s39, 49152
v_add_u32 v25, s41, v57
v_xor_b32 v26, 64, v25
v_lshlrev_b32 v15, 4, v1
s_add_u32 s41, s39, 98304
v_add_u32 v10, s41, v15
v_and_b32 v57, 7, v43
v_sub_u32 v57, 7, v57
v_lshl_add_u32 v57, v55, 2, v57
v_and_b32 v58, 3, v57
v_sub_u32 v57, v57, v58
v_mul_u32_u24 v58, 720, v58
v_lshl_add_u32 v58, v57, 2, v58
v_sub_u32 v59, v46, v56
v_add_u32 v59, 1, v59
v_mul_u32_u24 v59, 48, v59
v_add_u32 v58, v58, v59
v_add_u32 v9, 147456, v58
v_bfe_u32 v57, v43, 2, 1
v_xor_b32 v57, v57, v55
s_cmp_eq_u32 s14, 31
s_cselect_b32 s41, 1, 0
v_and_b32 v57, s41, v57
v_cvt_f32_u32 v58, v57
v_mul_f32 v11, 0xc474f2f0, v58
v_mul_f32 v13, 0xc31044fe, v58
s_cmp_eq_u32 s15, 31
s_cselect_b32 s41, 1, 0
v_or_b32 v57, s41, v57
v_cvt_f32_u32 v58, v57
v_mul_f32 v23, 0xc474f2f0, v58
v_mul_f32 v14, 0xc31044fe, v58
s_mov_b32 s3, 0x411cc471
buffer_load_dwordx2 v[32:33], v2, s[28:31], 0 offen offset:24
buffer_load_dwordx2 v[34:35], v2, s[28:31], 0 offen offset:16
buffer_load_dwordx2 v[36:37], v2, s[28:31], 0 offen offset:8
buffer_load_dwordx2 v[38:39], v2, s[28:31], 0 offen offset:0
s_mov_b32 m0, 163072
s_mul_i32 s41, s45, 6912
s_add_u32 s41, s41, 3072
buffer_load_dword v60, s[20:23], s41 offen lds
s_add_u32 m0, s39, 57344
s_add_u32 s42, s50, 128
buffer_load_dwordx4 v24, s[16:19], s42 offen nt lds
s_add_u32 m0, s39, 58368
s_add_u32 s43, s51, 128
buffer_load_dwordx4 v24, s[16:19], s43 offen nt lds
s_add_u32 m0, s39, 59392
s_add_u32 s42, s52, 128
buffer_load_dwordx4 v24, s[16:19], s42 offen nt lds
s_add_u32 m0, s39, 60416
s_add_u32 s43, s53, 128
buffer_load_dwordx4 v24, s[16:19], s43 offen nt lds
s_add_u32 m0, s39, 104448
s_add_u32 s42, s54, 128
buffer_load_dwordx4 v24, s[16:19], s42 offen nt lds
s_add_u32 m0, s39, 105472
s_add_u32 s43, s55, 128
buffer_load_dwordx4 v24, s[16:19], s43 offen nt lds
s_add_u32 m0, s39, 106496
s_add_u32 s42, s56, 128
buffer_load_dwordx4 v24, s[16:19], s42 offen nt lds
s_add_u32 m0, s39, 107520
s_add_u32 s43, s57, 128
buffer_load_dwordx4 v24, s[16:19], s43 offen nt lds
s_add_u32 m0, s39, 6144
s_add_u32 s42, s37, 150528
buffer_load_dwordx4 v8, s[20:23], s42 offen offset:0 lds
s_add_u32 s43, s37, 223232
buffer_load_dwordx4 v8, s[20:23], s43 offen offset:1024 lds
s_add_u32 s42, s37, 149248
buffer_load_dwordx4 v8, s[20:23], s42 offen offset:2048 lds
s_add_u32 s43, s37, 221952
buffer_load_dwordx4 v8, s[20:23], s43 offen offset:3072 lds
s_add_u32 m0, s39, 10240
s_add_u32 s42, s37, 152064
buffer_load_dwordx4 v8, s[20:23], s42 offen offset:0 lds
s_add_u32 s43, s37, 224768
buffer_load_dwordx4 v8, s[20:23], s43 offen offset:1024 lds
s_waitcnt vmcnt(31)
ds_read_b128 a[0:3], v25 offset:0
ds_read_b128 a[4:7], v26 offset:0
s_waitcnt vmcnt(29)
ds_read_b128 a[48:51], v25 offset:2048
ds_read_b128 a[52:55], v26 offset:2048
s_waitcnt vmcnt(27)
ds_read_b128 a[96:99], v25 offset:4096
ds_read_b128 a[100:103], v26 offset:4096
s_waitcnt vmcnt(25)
ds_read_b128 a[144:147], v25 offset:6144
ds_read_b128 a[148:151], v26 offset:6144
s_waitcnt vmcnt(19)
s_barrier
s_waitcnt lgkmcnt(0)
ds_read_b64_tr_b16 a[192:193], v6 offset:0
ds_read_b64_tr_b16 a[194:195], v6 offset:512
ds_read_b64_tr_b16 a[196:197], v6 offset:1024
ds_read_b64_tr_b16 a[198:199], v6 offset:1536
s_waitcnt lgkmcnt(0)
v_mfma_f32_16x16x32_bf16 v[40:43], a[192:195], a[0:3], 0
ds_read_b64_tr_b16 a[200:201], v7 offset:0
ds_read_b64_tr_b16 a[204:205], v17 offset:0
v_mfma_f32_16x16x32_bf16 v[40:43], a[196:199], a[4:7], v[40:43]
ds_read_b64_tr_b16 a[202:203], v7 offset:512
s_waitcnt vmcnt(18)
v_lshlrev_b32 v4, 16, v32
v_mfma_f32_16x16x32_bf16 v[44:47], a[192:195], a[48:51], 0
ds_read_b64_tr_b16 a[206:207], v17 offset:512
v_mul_f32 v4, s3, v4
v_mfma_f32_16x16x32_bf16 v[44:47], a[196:199], a[52:55], v[44:47]
ds_read_b64_tr_b16 a[208:209], v7 offset:1024
ds_write_b32 v3, v4 offset:0
v_mfma_f32_16x16x32_bf16 v[48:51], a[192:195], a[96:99], 0
ds_read_b64_tr_b16 a[212:213], v17 offset:1024
v_and_b32 v5, 0xffff0000, v32
v_mfma_f32_16x16x32_bf16 v[48:51], a[196:199], a[100:103], v[48:51]
ds_read_b64_tr_b16 a[210:211], v7 offset:1536
s_add_u32 m0, s39, 49152
v_mfma_f32_16x16x32_bf16 v[52:55], a[192:195], a[144:147], 0
ds_read_b64_tr_b16 a[214:215], v17 offset:1536
s_add_u32 s42, s50, 256
v_mfma_f32_16x16x32_bf16 v[52:55], a[196:199], a[148:151], v[52:55]
buffer_load_dwordx4 v24, s[16:19], s42 offen nt lds
s_waitcnt lgkmcnt(1)
v_mfma_f32_16x16x32_bf16 v[56:59], a[200:203], a[0:3], 0
ds_read_b64_tr_b16 a[216:217], v18 offset:0
v_mul_f32 v5, s3, v5
v_mfma_f32_16x16x32_bf16 v[56:59], a[208:211], a[4:7], v[56:59]
ds_write_b32 v3, v5 offset:2880
v_lshlrev_b32 v27, 16, v33
v_mfma_f32_16x16x32_bf16 v[60:63], a[200:203], a[48:51], 0
ds_read_b64_tr_b16 a[218:219], v18 offset:512
v_mul_f32 v27, s3, v27
v_mfma_f32_16x16x32_bf16 v[60:63], a[208:211], a[52:55], v[60:63]
ds_write_b32 v3, v27 offset:5760
s_add_u32 m0, s39, 50176
v_mfma_f32_16x16x32_bf16 v[64:67], a[200:203], a[96:99], 0
ds_read_b64_tr_b16 a[220:221], v18 offset:1024
s_add_u32 s43, s51, 256
v_mfma_f32_16x16x32_bf16 v[64:67], a[208:211], a[100:103], v[64:67]
buffer_load_dwordx4 v24, s[16:19], s43 offen nt lds
v_and_b32 v28, 0xffff0000, v33
v_mfma_f32_16x16x32_bf16 v[68:71], a[200:203], a[144:147], 0
ds_read_b64_tr_b16 a[222:223], v18 offset:1536
v_mul_f32 v28, s3, v28
v_mfma_f32_16x16x32_bf16 v[68:71], a[208:211], a[148:151], v[68:71]
ds_write_b32 v3, v28 offset:8640
s_waitcnt lgkmcnt(7)
v_mfma_f32_16x16x32_bf16 v[72:75], a[204:207], a[0:3], 0
ds_read_b64_tr_b16 a[224:225], v6 offset:2048
s_waitcnt vmcnt(19)
v_lshlrev_b32 v29, 16, v34
v_mfma_f32_16x16x32_bf16 v[72:75], a[212:215], a[4:7], v[72:75]
v_mul_f32 v29, s3, v29
s_add_u32 m0, s39, 98304
v_mfma_f32_16x16x32_bf16 v[76:79], a[204:207], a[48:51], 0
ds_read_b64_tr_b16 a[226:227], v6 offset:2560
s_add_u32 s42, s37, 297984
v_mfma_f32_16x16x32_bf16 v[76:79], a[212:215], a[52:55], v[76:79]
buffer_load_dwordx4 v8, s[20:23], s42 offen offset:0 lds
ds_write_b32 v3, v29 offset:720
v_mfma_f32_16x16x32_bf16 v[80:83], a[204:207], a[96:99], 0
ds_read_b64_tr_b16 a[228:229], v6 offset:3072
v_and_b32 v30, 0xffff0000, v34
v_mfma_f32_16x16x32_bf16 v[80:83], a[212:215], a[100:103], v[80:83]
v_mul_f32 v30, s3, v30
ds_write_b32 v3, v30 offset:3600
v_mfma_f32_16x16x32_bf16 v[84:87], a[204:207], a[144:147], 0
ds_read_b64_tr_b16 a[230:231], v6 offset:3584
v_lshlrev_b32 v31, 16, v35
v_mfma_f32_16x16x32_bf16 v[84:87], a[212:215], a[148:151], v[84:87]
s_add_u32 m0, s39, 51200
s_waitcnt lgkmcnt(7)
v_mfma_f32_16x16x32_bf16 v[88:91], a[216:219], a[0:3], 0
ds_read_b64_tr_b16 a[232:233], v7 offset:2048
s_add_u32 s43, s52, 256
v_mfma_f32_16x16x32_bf16 v[88:91], a[220:223], a[4:7], v[88:91]
buffer_load_dwordx4 v24, s[16:19], s43 offen nt lds
v_mul_f32 v31, s3, v31
v_mfma_f32_16x16x32_bf16 v[92:95], a[216:219], a[48:51], 0
ds_read_b64_tr_b16 a[234:235], v7 offset:2560
ds_write_b32 v3, v31 offset:6480
v_mfma_f32_16x16x32_bf16 v[92:95], a[220:223], a[52:55], v[92:95]
v_and_b32 v2, 0xffff0000, v35
v_mul_f32 v2, s3, v2
v_mfma_f32_16x16x32_bf16 v[96:99], a[216:219], a[96:99], 0
ds_read_b64_tr_b16 a[236:237], v7 offset:3072
ds_write_b32 v3, v2 offset:9360
v_mfma_f32_16x16x32_bf16 v[96:99], a[220:223], a[100:103], v[96:99]
s_add_u32 m0, s39, 52224
s_add_u32 s42, s53, 256
v_mfma_f32_16x16x32_bf16 v[100:103], a[216:219], a[144:147], 0
ds_read_b64_tr_b16 a[238:239], v7 offset:3584
buffer_load_dwordx4 v24, s[16:19], s42 offen nt lds
v_mfma_f32_16x16x32_bf16 v[100:103], a[220:223], a[148:151], v[100:103]
s_waitcnt vmcnt(21)
v_lshlrev_b32 v16, 16, v36
s_waitcnt lgkmcnt(6)
v_mfma_f32_16x16x32_bf16 v[104:107], a[224:227], a[0:3], 0
ds_read_b64_tr_b16 a[240:241], v17 offset:2048
v_mul_f32 v16, s3, v16
v_mfma_f32_16x16x32_bf16 v[104:107], a[228:231], a[4:7], v[104:107]
ds_write_b32 v3, v16 offset:1440
v_and_b32 v15, 0xffff0000, v36
v_mfma_f32_16x16x32_bf16 v[108:111], a[224:227], a[48:51], 0
ds_read_b64_tr_b16 a[242:243], v17 offset:2560
v_mul_f32 v15, s3, v15
v_mfma_f32_16x16x32_bf16 v[108:111], a[228:231], a[52:55], v[108:111]
s_add_u32 m0, s39, 99328
s_add_u32 s43, s37, 371712
v_mfma_f32_16x16x32_bf16 v[112:115], a[224:227], a[96:99], 0
ds_read_b64_tr_b16 a[244:245], v17 offset:3072
buffer_load_dwordx4 v8, s[20:23], s43 offen offset:0 lds
v_mfma_f32_16x16x32_bf16 v[112:115], a[228:231], a[100:103], v[112:115]
ds_write_b32 v3, v15 offset:4320
v_lshlrev_b32 v4, 16, v37
v_mfma_f32_16x16x32_bf16 v[116:119], a[224:227], a[144:147], 0
ds_read_b64_tr_b16 a[246:247], v17 offset:3584
v_mul_f32 v4, s3, v4
v_mfma_f32_16x16x32_bf16 v[116:119], a[228:231], a[148:151], v[116:119]
ds_write_b32 v3, v4 offset:7200
s_waitcnt lgkmcnt(7)
v_mfma_f32_16x16x32_bf16 v[120:123], a[232:235], a[0:3], 0
ds_read_b64_tr_b16 a[248:249], v18 offset:2048
v_and_b32 v5, 0xffff0000, v37
v_mfma_f32_16x16x32_bf16 v[120:123], a[236:239], a[4:7], v[120:123]
s_add_u32 m0, s39, 53248
s_add_u32 s42, s54, 256
v_mfma_f32_16x16x32_bf16 v[124:127], a[232:235], a[48:51], 0
ds_read_b64_tr_b16 a[250:251], v18 offset:2560
buffer_load_dwordx4 v24, s[16:19], s42 offen nt lds
v_mfma_f32_16x16x32_bf16 v[124:127], a[236:239], a[52:55], v[124:127]
v_mul_f32 v5, s3, v5
ds_write_b32 v3, v5 offset:10080
v_mfma_f32_16x16x32_bf16 v[128:131], a[232:235], a[96:99], 0
ds_read_b64_tr_b16 a[252:253], v18 offset:3072
s_waitcnt vmcnt(22)
v_lshlrev_b32 v27, 16, v38
v_mfma_f32_16x16x32_bf16 v[128:131], a[236:239], a[100:103], v[128:131]
v_mul_f32 v27, s3, v27
ds_write_b32 v3, v27 offset:2160
v_mfma_f32_16x16x32_bf16 v[132:135], a[232:235], a[144:147], 0
ds_read_b64_tr_b16 a[254:255], v18 offset:3584
s_add_u32 m0, s39, 100352
v_mfma_f32_16x16x32_bf16 v[132:135], a[236:239], a[148:151], v[132:135]
s_add_u32 s43, s37, 298752
s_waitcnt lgkmcnt(7)
v_mfma_f32_16x16x32_bf16 v[136:139], a[240:243], a[0:3], 0
ds_read_b64_tr_b16 a[192:193], v6 offset:4096
buffer_load_dwordx4 v8, s[20:23], s43 offen offset:0 lds
v_mfma_f32_16x16x32_bf16 v[136:139], a[244:247], a[4:7], v[136:139]
v_and_b32 v28, 0xffff0000, v38
v_mul_f32 v28, s3, v28
v_mfma_f32_16x16x32_bf16 v[140:143], a[240:243], a[48:51], 0
ds_read_b64_tr_b16 a[194:195], v6 offset:4608
ds_write_b32 v3, v28 offset:5040
v_mfma_f32_16x16x32_bf16 v[140:143], a[244:247], a[52:55], v[140:143]
v_lshlrev_b32 v29, 16, v39
v_mul_f32 v29, s3, v29
v_mfma_f32_16x16x32_bf16 v[144:147], a[240:243], a[96:99], 0
ds_read_b64_tr_b16 a[196:197], v6 offset:5120
s_add_u32 m0, s39, 54272
v_mfma_f32_16x16x32_bf16 v[144:147], a[244:247], a[100:103], v[144:147]
s_add_u32 s42, s55, 256
buffer_load_dwordx4 v24, s[16:19], s42 offen nt lds
v_mfma_f32_16x16x32_bf16 v[148:151], a[240:243], a[144:147], 0
ds_read_b64_tr_b16 a[198:199], v6 offset:5632
ds_write_b32 v3, v29 offset:7920
v_mfma_f32_16x16x32_bf16 v[148:151], a[244:247], a[148:151], v[148:151]
v_and_b32 v30, 0xffff0000, v39
s_waitcnt lgkmcnt(6)
v_mfma_f32_16x16x32_bf16 v[152:155], a[248:251], a[0:3], 0
ds_read_b64_tr_b16 a[200:201], v7 offset:4096
v_mul_f32 v30, s3, v30
v_mfma_f32_16x16x32_bf16 v[152:155], a[252:255], a[4:7], v[152:155]
ds_write_b32 v3, v30 offset:10800
s_add_u32 m0, s39, 101376
v_mfma_f32_16x16x32_bf16 v[156:159], a[248:251], a[48:51], 0
ds_read_b64_tr_b16 a[202:203], v7 offset:4608
s_add_u32 s43, s37, 372480
v_mfma_f32_16x16x32_bf16 v[156:159], a[252:255], a[52:55], v[156:159]
buffer_load_dwordx4 v8, s[20:23], s43 offen offset:0 lds
s_add_u32 m0, s39, 55296
v_mfma_f32_16x16x32_bf16 v[160:163], a[248:251], a[96:99], 0
ds_read_b64_tr_b16 a[208:209], v7 offset:5120
s_add_u32 s42, s56, 256
v_mfma_f32_16x16x32_bf16 v[160:163], a[252:255], a[100:103], v[160:163]
buffer_load_dwordx4 v24, s[16:19], s42 offen nt lds
s_add_u32 m0, s39, 102400
v_mfma_f32_16x16x32_bf16 v[164:167], a[248:251], a[144:147], 0
ds_read_b64_tr_b16 a[210:211], v7 offset:5632
s_add_u32 s43, s37, 299520
v_mfma_f32_16x16x32_bf16 v[164:167], a[252:255], a[148:151], v[164:167]
buffer_load_dwordx4 v8, s[20:23], s43 offen offset:0 lds
s_waitcnt lgkmcnt(6)
v_mfma_f32_16x16x32_bf16 v[168:171], a[0:3], a[192:195], 0
ds_read_b64_tr_b16 a[204:205], v17 offset:4096
s_add_u32 m0, s39, 56320
v_mfma_f32_16x16x32_bf16 v[168:171], a[4:7], a[196:199], v[168:171]
s_add_u32 s42, s57, 256
buffer_load_dwordx4 v24, s[16:19], s42 offen nt lds
v_mfma_f32_16x16x32_bf16 v[172:175], a[48:51], a[192:195], 0
ds_read_b64_tr_b16 a[206:207], v17 offset:4608
v_mfma_f32_16x16x32_bf16 v[172:175], a[52:55], a[196:199], v[172:175]
s_add_u32 m0, s39, 103424
v_mfma_f32_16x16x32_bf16 v[176:179], a[96:99], a[192:195], 0
ds_read_b64_tr_b16 a[212:213], v17 offset:5120
s_add_u32 s43, s37, 373248
v_mfma_f32_16x16x32_bf16 v[176:179], a[100:103], a[196:199], v[176:179]
buffer_load_dwordx4 v8, s[20:23], s43 offen offset:0 lds
v_mfma_f32_16x16x32_bf16 v[180:183], a[144:147], a[192:195], 0
ds_read_b64_tr_b16 a[214:215], v17 offset:5632
v_mfma_f32_16x16x32_bf16 v[180:183], a[148:151], a[196:199], v[180:183]
s_waitcnt lgkmcnt(4)
v_mfma_f32_16x16x32_bf16 v[184:187], a[0:3], a[200:203], 0
ds_read_b64_tr_b16 a[216:217], v18 offset:4096
s_waitcnt vmcnt(26)
ds_read_b128 a[8:11], v25 offset:8192
v_mfma_f32_16x16x32_bf16 v[184:187], a[4:7], a[208:211], v[184:187]
ds_read_b128 a[12:15], v26 offset:8192
v_mfma_f32_16x16x32_bf16 v[188:191], a[48:51], a[200:203], 0
ds_read_b64_tr_b16 a[218:219], v18 offset:4608
s_waitcnt vmcnt(24)
ds_read_b128 a[56:59], v25 offset:10240
v_mfma_f32_16x16x32_bf16 v[188:191], a[52:55], a[208:211], v[188:191]
ds_read_b128 a[60:63], v26 offset:10240
v_mfma_f32_16x16x32_bf16 v[192:195], a[96:99], a[200:203], 0
ds_read_b64_tr_b16 a[220:221], v18 offset:5120
s_waitcnt vmcnt(22)
ds_read_b128 a[104:107], v25 offset:55296
v_mfma_f32_16x16x32_bf16 v[192:195], a[100:103], a[208:211], v[192:195]
ds_read_b128 a[108:111], v26 offset:55296
v_mfma_f32_16x16x32_bf16 v[196:199], a[144:147], a[200:203], 0
ds_read_b64_tr_b16 a[222:223], v18 offset:5632
s_waitcnt vmcnt(20)
ds_read_b128 a[152:155], v25 offset:57344
v_mfma_f32_16x16x32_bf16 v[196:199], a[148:151], a[208:211], v[196:199]
ds_read_b128 a[156:159], v26 offset:57344
s_waitcnt lgkmcnt(12)
v_mfma_f32_16x16x32_bf16 v[200:203], a[0:3], a[204:207], 0
v_mfma_f32_16x16x32_bf16 v[200:203], a[4:7], a[212:215], v[200:203]
v_mfma_f32_16x16x32_bf16 v[204:207], a[48:51], a[204:207], 0
v_mfma_f32_16x16x32_bf16 v[204:207], a[52:55], a[212:215], v[204:207]
s_waitcnt vmcnt(14) lgkmcnt(2)
s_barrier
v_mfma_f32_16x16x32_bf16 v[208:211], a[96:99], a[204:207], 0
ds_read_b64_tr_b16 a[224:225], v6 offset:6144
v_mfma_f32_16x16x32_bf16 v[208:211], a[100:103], a[212:215], v[208:211]
ds_read_b64_tr_b16 a[226:227], v6 offset:6656
v_mfma_f32_16x16x32_bf16 v[212:215], a[144:147], a[204:207], 0
s_add_u32 m0, s39, 57344
v_mfma_f32_16x16x32_bf16 v[212:215], a[148:151], a[212:215], v[212:215]
ds_read_b64_tr_b16 a[228:229], v6 offset:7168
v_mfma_f32_16x16x32_bf16 v[216:219], a[0:3], a[216:219], 0
ds_read_b64_tr_b16 a[232:233], v7 offset:6144
s_add_u32 s42, s50, 384
v_mfma_f32_16x16x32_bf16 v[216:219], a[4:7], a[220:223], v[216:219]
ds_read_b64_tr_b16 a[230:231], v6 offset:7680
buffer_load_dwordx4 v24, s[16:19], s42 offen nt lds
v_mfma_f32_16x16x32_bf16 v[220:223], a[48:51], a[216:219], 0
ds_read_b64_tr_b16 a[234:235], v7 offset:6656
v_mfma_f32_16x16x32_bf16 v[220:223], a[52:55], a[220:223], v[220:223]
s_add_u32 m0, s39, 58368
v_mfma_f32_16x16x32_bf16 v[224:227], a[96:99], a[216:219], 0
ds_read_b64_tr_b16 a[236:237], v7 offset:7168
s_add_u32 s43, s51, 384
v_mfma_f32_16x16x32_bf16 v[224:227], a[100:103], a[220:223], v[224:227]
buffer_load_dwordx4 v24, s[16:19], s43 offen nt lds
v_mfma_f32_16x16x32_bf16 v[228:231], a[144:147], a[216:219], 0
ds_read_b64_tr_b16 a[238:239], v7 offset:7680
v_mfma_f32_16x16x32_bf16 v[228:231], a[148:151], a[220:223], v[228:231]
s_waitcnt lgkmcnt(8)
s_waitcnt lgkmcnt(3)
v_mfma_f32_16x16x32_bf16 v[40:43], a[224:227], a[8:11], v[40:43]
ds_read_b64_tr_b16 a[240:241], v17 offset:6144
v_mfma_f32_16x16x32_bf16 v[40:43], a[228:231], a[12:15], v[40:43]
s_add_u32 m0, s39, 0
s_add_u32 s42, s37, 445440
v_mfma_f32_16x16x32_bf16 v[44:47], a[224:227], a[56:59], v[44:47]
ds_read_b64_tr_b16 a[242:243], v17 offset:6656
buffer_load_dwordx4 v8, s[20:23], s42 offen offset:0 lds
v_mfma_f32_16x16x32_bf16 v[44:47], a[228:231], a[60:63], v[44:47]
s_add_u32 m0, s39, 59392
v_mfma_f32_16x16x32_bf16 v[48:51], a[224:227], a[104:107], v[48:51]
ds_read_b64_tr_b16 a[244:245], v17 offset:7168
v_mfma_f32_16x16x32_bf16 v[48:51], a[228:231], a[108:111], v[48:51]
s_add_u32 s43, s52, 384
v_mfma_f32_16x16x32_bf16 v[52:55], a[224:227], a[152:155], v[52:55]
ds_read_b64_tr_b16 a[246:247], v17 offset:7680
buffer_load_dwordx4 v24, s[16:19], s43 offen nt lds
v_mfma_f32_16x16x32_bf16 v[52:55], a[228:231], a[156:159], v[52:55]
s_waitcnt lgkmcnt(4)
v_mfma_f32_16x16x32_bf16 v[56:59], a[232:235], a[8:11], v[56:59]
ds_read_b64_tr_b16 a[248:249], v18 offset:6144
v_mfma_f32_16x16x32_bf16 v[56:59], a[236:239], a[12:15], v[56:59]
s_add_u32 m0, s39, 60416
v_mfma_f32_16x16x32_bf16 v[60:63], a[232:235], a[56:59], v[60:63]
ds_read_b64_tr_b16 a[250:251], v18 offset:6656
v_mfma_f32_16x16x32_bf16 v[60:63], a[236:239], a[60:63], v[60:63]
s_add_u32 s42, s53, 384
buffer_load_dwordx4 v24, s[16:19], s42 offen nt lds
v_mfma_f32_16x16x32_bf16 v[64:67], a[232:235], a[104:107], v[64:67]
ds_read_b64_tr_b16 a[252:253], v18 offset:7168
v_mfma_f32_16x16x32_bf16 v[64:67], a[236:239], a[108:111], v[64:67]
s_add_u32 m0, s39, 1024
v_mfma_f32_16x16x32_bf16 v[68:71], a[232:235], a[152:155], v[68:71]
ds_read_b64_tr_b16 a[254:255], v18 offset:7680
v_mfma_f32_16x16x32_bf16 v[68:71], a[236:239], a[156:159], v[68:71]
s_waitcnt lgkmcnt(4)
v_mfma_f32_16x16x32_bf16 v[72:75], a[240:243], a[8:11], v[72:75]
ds_read_b64_tr_b16 a[192:193], v6 offset:8192
s_add_u32 s43, s37, 519168
v_mfma_f32_16x16x32_bf16 v[72:75], a[244:247], a[12:15], v[72:75]
buffer_load_dwordx4 v8, s[20:23], s43 offen offset:0 lds
v_mfma_f32_16x16x32_bf16 v[76:79], a[240:243], a[56:59], v[76:79]
ds_read_b64_tr_b16 a[194:195], v6 offset:8704
v_mfma_f32_16x16x32_bf16 v[76:79], a[244:247], a[60:63], v[76:79]
s_add_u32 m0, s39, 104448
v_mfma_f32_16x16x32_bf16 v[80:83], a[240:243], a[104:107], v[80:83]
ds_read_b64_tr_b16 a[196:197], v6 offset:9216
v_mfma_f32_16x16x32_bf16 v[80:83], a[244:247], a[108:111], v[80:83]
s_add_u32 s42, s54, 384
buffer_load_dwordx4 v24, s[16:19], s42 offen nt lds
v_mfma_f32_16x16x32_bf16 v[84:87], a[240:243], a[152:155], v[84:87]
ds_read_b64_tr_b16 a[198:199], v6 offset:9728
v_mfma_f32_16x16x32_bf16 v[84:87], a[244:247], a[156:159], v[84:87]
s_waitcnt lgkmcnt(4)
v_mfma_f32_16x16x32_bf16 v[88:91], a[248:251], a[8:11], v[88:91]
ds_read_b64_tr_b16 a[200:201], v7 offset:8192
v_mfma_f32_16x16x32_bf16 v[88:91], a[252:255], a[12:15], v[88:91]
s_add_u32 m0, s39, 2048
v_mfma_f32_16x16x32_bf16 v[92:95], a[248:251], a[56:59], v[92:95]
ds_read_b64_tr_b16 a[202:203], v7 offset:8704
s_add_u32 s43, s37, 446208
v_mfma_f32_16x16x32_bf16 v[92:95], a[252:255], a[60:63], v[92:95]
buffer_load_dwordx4 v8, s[20:23], s43 offen offset:0 lds
v_mfma_f32_16x16x32_bf16 v[96:99], a[248:251], a[104:107], v[96:99]
ds_read_b64_tr_b16 a[208:209], v7 offset:9216
v_mfma_f32_16x16x32_bf16 v[96:99], a[252:255], a[108:111], v[96:99]
s_add_u32 m0, s39, 105472
v_mfma_f32_16x16x32_bf16 v[100:103], a[248:251], a[152:155], v[100:103]
ds_read_b64_tr_b16 a[210:211], v7 offset:9728
v_mfma_f32_16x16x32_bf16 v[100:103], a[252:255], a[156:159], v[100:103]
s_add_u32 s42, s55, 384
s_waitcnt lgkmcnt(4)
v_mfma_f32_16x16x32_bf16 v[104:107], a[192:195], a[8:11], v[104:107]
ds_read_b64_tr_b16 a[204:205], v17 offset:8192
buffer_load_dwordx4 v24, s[16:19], s42 offen nt lds
v_mfma_f32_16x16x32_bf16 v[104:107], a[196:199], a[12:15], v[104:107]
s_add_u32 m0, s39, 3072
v_mfma_f32_16x16x32_bf16 v[108:111], a[192:195], a[56:59], v[108:111]
ds_read_b64_tr_b16 a[206:207], v17 offset:8704
v_mfma_f32_16x16x32_bf16 v[108:111], a[196:199], a[60:63], v[108:111]
s_add_u32 s43, s37, 519936
v_mfma_f32_16x16x32_bf16 v[112:115], a[192:195], a[104:107], v[112:115]
ds_read_b64_tr_b16 a[212:213], v17 offset:9216
buffer_load_dwordx4 v8, s[20:23], s43 offen offset:0 lds
v_mfma_f32_16x16x32_bf16 v[112:115], a[196:199], a[108:111], v[112:115]
v_mfma_f32_16x16x32_bf16 v[116:119], a[192:195], a[152:155], v[116:119]
ds_read_b64_tr_b16 a[214:215], v17 offset:9728
v_mfma_f32_16x16x32_bf16 v[116:119], a[196:199], a[156:159], v[116:119]
s_waitcnt lgkmcnt(4)
v_mfma_f32_16x16x32_bf16 v[120:123], a[200:203], a[8:11], v[120:123]
ds_read_b64_tr_b16 a[216:217], v18 offset:8192
v_mfma_f32_16x16x32_bf16 v[120:123], a[208:211], a[12:15], v[120:123]
s_add_u32 m0, s39, 106496
s_add_u32 s42, s56, 384
v_mfma_f32_16x16x32_bf16 v[124:127], a[200:203], a[56:59], v[124:127]
ds_read_b64_tr_b16 a[218:219], v18 offset:8704
buffer_load_dwordx4 v24, s[16:19], s42 offen nt lds
v_mfma_f32_16x16x32_bf16 v[124:127], a[208:211], a[60:63], v[124:127]
s_add_u32 m0, s39, 4096
v_mfma_f32_16x16x32_bf16 v[128:131], a[200:203], a[104:107], v[128:131]
ds_read_b64_tr_b16 a[220:221], v18 offset:9216
v_mfma_f32_16x16x32_bf16 v[128:131], a[208:211], a[108:111], v[128:131]
s_add_u32 s43, s37, 446976
v_mfma_f32_16x16x32_bf16 v[132:135], a[200:203], a[152:155], v[132:135]
ds_read_b64_tr_b16 a[222:223], v18 offset:9728
buffer_load_dwordx4 v8, s[20:23], s43 offen offset:0 lds
v_mfma_f32_16x16x32_bf16 v[132:135], a[208:211], a[156:159], v[132:135]
s_waitcnt lgkmcnt(4)
v_mfma_f32_16x16x32_bf16 v[136:139], a[204:207], a[8:11], v[136:139]
ds_read_b64_tr_b16 a[224:225], v6 offset:10240
v_mfma_f32_16x16x32_bf16 v[136:139], a[212:215], a[12:15], v[136:139]
s_add_u32 m0, s39, 107520
v_mfma_f32_16x16x32_bf16 v[140:143], a[204:207], a[56:59], v[140:143]
ds_read_b64_tr_b16 a[226:227], v6 offset:10752
v_mfma_f32_16x16x32_bf16 v[140:143], a[212:215], a[60:63], v[140:143]
s_add_u32 s42, s57, 384
buffer_load_dwordx4 v24, s[16:19], s42 offen nt lds
v_mfma_f32_16x16x32_bf16 v[144:147], a[204:207], a[104:107], v[144:147]
ds_read_b64_tr_b16 a[228:229], v6 offset:11264
v_mfma_f32_16x16x32_bf16 v[144:147], a[212:215], a[108:111], v[144:147]
s_add_u32 m0, s39, 5120
v_mfma_f32_16x16x32_bf16 v[148:151], a[204:207], a[152:155], v[148:151]
ds_read_b64_tr_b16 a[230:231], v6 offset:11776
v_mfma_f32_16x16x32_bf16 v[148:151], a[212:215], a[156:159], v[148:151]
s_waitcnt lgkmcnt(4)
v_mfma_f32_16x16x32_bf16 v[152:155], a[216:219], a[8:11], v[152:155]
ds_read_b64_tr_b16 a[232:233], v7 offset:10240
s_add_u32 s43, s37, 520704
v_mfma_f32_16x16x32_bf16 v[152:155], a[220:223], a[12:15], v[152:155]
buffer_load_dwordx4 v8, s[20:23], s43 offen offset:0 lds
v_mfma_f32_16x16x32_bf16 v[156:159], a[216:219], a[56:59], v[156:159]
ds_read_b64_tr_b16 a[234:235], v7 offset:10752
v_mfma_f32_16x16x32_bf16 v[156:159], a[220:223], a[60:63], v[156:159]
v_mfma_f32_16x16x32_bf16 v[160:163], a[216:219], a[104:107], v[160:163]
ds_read_b64_tr_b16 a[236:237], v7 offset:11264
s_waitcnt vmcnt(26)
ds_read_b128 a[16:19], v25 offset:0
v_mfma_f32_16x16x32_bf16 v[160:163], a[220:223], a[108:111], v[160:163]
ds_read_b128 a[20:23], v26 offset:0
v_mfma_f32_16x16x32_bf16 v[164:167], a[216:219], a[152:155], v[164:167]
ds_read_b64_tr_b16 a[238:239], v7 offset:11776
s_waitcnt vmcnt(23)
ds_read_b128 a[64:67], v25 offset:2048
v_mfma_f32_16x16x32_bf16 v[164:167], a[220:223], a[156:159], v[164:167]
ds_read_b128 a[68:71], v26 offset:2048
s_waitcnt lgkmcnt(8)
v_mfma_f32_16x16x32_bf16 v[168:171], a[8:11], a[224:227], v[168:171]
ds_read_b64_tr_b16 a[240:241], v17 offset:10240
s_waitcnt vmcnt(19)
ds_read_b128 a[112:115], v25 offset:4096
v_mfma_f32_16x16x32_bf16 v[168:171], a[12:15], a[228:231], v[168:171]
ds_read_b128 a[116:119], v26 offset:4096
v_mfma_f32_16x16x32_bf16 v[172:175], a[56:59], a[224:227], v[172:175]
ds_read_b64_tr_b16 a[242:243], v17 offset:10752
s_waitcnt vmcnt(15)
ds_read_b128 a[160:163], v25 offset:6144
v_mfma_f32_16x16x32_bf16 v[172:175], a[60:63], a[228:231], v[172:175]
ds_read_b128 a[164:167], v26 offset:6144
v_mfma_f32_16x16x32_bf16 v[176:179], a[104:107], a[224:227], v[176:179]
ds_read_b64_tr_b16 a[244:245], v17 offset:11264
v_mfma_f32_16x16x32_bf16 v[176:179], a[108:111], a[228:231], v[176:179]
v_mfma_f32_16x16x32_bf16 v[180:183], a[152:155], a[224:227], v[180:183]
ds_read_b64_tr_b16 a[246:247], v17 offset:11776
v_mfma_f32_16x16x32_bf16 v[180:183], a[156:159], a[228:231], v[180:183]
s_waitcnt lgkmcnt(10)
v_mfma_f32_16x16x32_bf16 v[184:187], a[8:11], a[232:235], v[184:187]
ds_read_b64_tr_b16 a[248:249], v18 offset:10240
v_mfma_f32_16x16x32_bf16 v[184:187], a[12:15], a[236:239], v[184:187]
v_mfma_f32_16x16x32_bf16 v[188:191], a[56:59], a[232:235], v[188:191]
ds_read_b64_tr_b16 a[250:251], v18 offset:10752
v_mfma_f32_16x16x32_bf16 v[188:191], a[60:63], a[236:239], v[188:191]
v_mfma_f32_16x16x32_bf16 v[192:195], a[104:107], a[232:235], v[192:195]
ds_read_b64_tr_b16 a[252:253], v18 offset:11264
v_mfma_f32_16x16x32_bf16 v[192:195], a[108:111], a[236:239], v[192:195]
v_mfma_f32_16x16x32_bf16 v[196:199], a[152:155], a[232:235], v[196:199]
ds_read_b64_tr_b16 a[254:255], v18 offset:11776
v_mfma_f32_16x16x32_bf16 v[196:199], a[156:159], a[236:239], v[196:199]
s_waitcnt lgkmcnt(4)
v_mfma_f32_16x16x32_bf16 v[200:203], a[8:11], a[240:243], v[200:203]
v_mfma_f32_16x16x32_bf16 v[200:203], a[12:15], a[244:247], v[200:203]
v_mfma_f32_16x16x32_bf16 v[204:207], a[56:59], a[240:243], v[204:207]
v_mfma_f32_16x16x32_bf16 v[204:207], a[60:63], a[244:247], v[204:207]
s_waitcnt vmcnt(14) lgkmcnt(0)
s_barrier
v_mfma_f32_16x16x32_bf16 v[208:211], a[104:107], a[240:243], v[208:211]
ds_read_b64_tr_b16 a[192:193], v19 offset:0
v_mfma_f32_16x16x32_bf16 v[208:211], a[108:111], a[244:247], v[208:211]
ds_read_b64_tr_b16 a[194:195], v19 offset:512
v_mfma_f32_16x16x32_bf16 v[212:215], a[152:155], a[240:243], v[212:215]
s_add_u32 m0, s39, 49152
v_mfma_f32_16x16x32_bf16 v[212:215], a[156:159], a[244:247], v[212:215]
ds_read_b64_tr_b16 a[196:197], v19 offset:1024
v_mfma_f32_16x16x32_bf16 v[216:219], a[8:11], a[248:251], v[216:219]
ds_read_b64_tr_b16 a[200:201], v20 offset:0
s_add_u32 s42, s50, 512
v_mfma_f32_16x16x32_bf16 v[216:219], a[12:15], a[252:255], v[216:219]
ds_read_b64_tr_b16 a[198:199], v19 offset:1536
buffer_load_dwordx4 v24, s[16:19], s42 offen nt lds
v_mfma_f32_16x16x32_bf16 v[220:223], a[56:59], a[248:251], v[220:223]
ds_read_b64_tr_b16 a[202:203], v20 offset:512
v_mfma_f32_16x16x32_bf16 v[220:223], a[60:63], a[252:255], v[220:223]
s_add_u32 m0, s39, 50176
v_mfma_f32_16x16x32_bf16 v[224:227], a[104:107], a[248:251], v[224:227]
ds_read_b64_tr_b16 a[208:209], v20 offset:1024
s_add_u32 s43, s51, 512
v_mfma_f32_16x16x32_bf16 v[224:227], a[108:111], a[252:255], v[224:227]
buffer_load_dwordx4 v24, s[16:19], s43 offen nt lds
v_mfma_f32_16x16x32_bf16 v[228:231], a[152:155], a[248:251], v[228:231]
ds_read_b64_tr_b16 a[210:211], v20 offset:1536
v_mfma_f32_16x16x32_bf16 v[228:231], a[156:159], a[252:255], v[228:231]
s_waitcnt lgkmcnt(3)
v_mfma_f32_16x16x32_bf16 v[40:43], a[192:195], a[16:19], v[40:43]
ds_read_b64_tr_b16 a[204:205], v21 offset:0
v_mfma_f32_16x16x32_bf16 v[40:43], a[196:199], a[20:23], v[40:43]
s_add_u32 m0, s39, 6144
s_add_u32 s42, s37, 592896
v_mfma_f32_16x16x32_bf16 v[44:47], a[192:195], a[64:67], v[44:47]
ds_read_b64_tr_b16 a[206:207], v21 offset:512
buffer_load_dwordx4 v8, s[20:23], s42 offen offset:0 lds
v_mfma_f32_16x16x32_bf16 v[44:47], a[196:199], a[68:71], v[44:47]
s_add_u32 m0, s39, 51200
v_mfma_f32_16x16x32_bf16 v[48:51], a[192:195], a[112:115], v[48:51]
ds_read_b64_tr_b16 a[212:213], v21 offset:1024
v_mfma_f32_16x16x32_bf16 v[48:51], a[196:199], a[116:119], v[48:51]
s_add_u32 s43, s52, 512
v_mfma_f32_16x16x32_bf16 v[52:55], a[192:195], a[160:163], v[52:55]
ds_read_b64_tr_b16 a[214:215], v21 offset:1536
buffer_load_dwordx4 v24, s[16:19], s43 offen nt lds
v_mfma_f32_16x16x32_bf16 v[52:55], a[196:199], a[164:167], v[52:55]
s_waitcnt lgkmcnt(4)
v_mfma_f32_16x16x32_bf16 v[56:59], a[200:203], a[16:19], v[56:59]
ds_read_b64_tr_b16 a[216:217], v22 offset:0
v_mfma_f32_16x16x32_bf16 v[56:59], a[208:211], a[20:23], v[56:59]
s_add_u32 m0, s39, 52224
v_mfma_f32_16x16x32_bf16 v[60:63], a[200:203], a[64:67], v[60:63]
ds_read_b64_tr_b16 a[218:219], v22 offset:512
v_mfma_f32_16x16x32_bf16 v[60:63], a[208:211], a[68:71], v[60:63]
s_add_u32 s42, s53, 512
buffer_load_dwordx4 v24, s[16:19], s42 offen nt lds
v_mfma_f32_16x16x32_bf16 v[64:67], a[200:203], a[112:115], v[64:67]
ds_read_b64_tr_b16 a[220:221], v22 offset:1024
v_mfma_f32_16x16x32_bf16 v[64:67], a[208:211], a[116:119], v[64:67]
s_add_u32 m0, s39, 7168
v_mfma_f32_16x16x32_bf16 v[68:71], a[200:203], a[160:163], v[68:71]
ds_read_b64_tr_b16 a[222:223], v22 offset:1536
v_mfma_f32_16x16x32_bf16 v[68:71], a[208:211], a[164:167], v[68:71]
s_waitcnt lgkmcnt(4)
v_mfma_f32_16x16x32_bf16 v[72:75], a[204:207], a[16:19], v[72:75]
ds_read_b64_tr_b16 a[224:225], v19 offset:2048
s_add_u32 s43, s37, 666624
v_mfma_f32_16x16x32_bf16 v[72:75], a[212:215], a[20:23], v[72:75]
buffer_load_dwordx4 v8, s[20:23], s43 offen offset:0 lds
v_mfma_f32_16x16x32_bf16 v[76:79], a[204:207], a[64:67], v[76:79]
ds_read_b64_tr_b16 a[226:227], v19 offset:2560
v_mfma_f32_16x16x32_bf16 v[76:79], a[212:215], a[68:71], v[76:79]
s_add_u32 m0, s39, 53248
v_mfma_f32_16x16x32_bf16 v[80:83], a[204:207], a[112:115], v[80:83]
ds_read_b64_tr_b16 a[228:229], v19 offset:3072
v_mfma_f32_16x16x32_bf16 v[80:83], a[212:215], a[116:119], v[80:83]
s_add_u32 s42, s54, 512
buffer_load_dwordx4 v24, s[16:19], s42 offen nt lds
v_mfma_f32_16x16x32_bf16 v[84:87], a[204:207], a[160:163], v[84:87]
ds_read_b64_tr_b16 a[230:231], v19 offset:3584
v_mfma_f32_16x16x32_bf16 v[84:87], a[212:215], a[164:167], v[84:87]
s_waitcnt lgkmcnt(4)
v_mfma_f32_16x16x32_bf16 v[88:91], a[216:219], a[16:19], v[88:91]
ds_read_b64_tr_b16 a[232:233], v20 offset:2048
v_mfma_f32_16x16x32_bf16 v[88:91], a[220:223], a[20:23], v[88:91]
s_add_u32 m0, s39, 8192
v_mfma_f32_16x16x32_bf16 v[92:95], a[216:219], a[64:67], v[92:95]
ds_read_b64_tr_b16 a[234:235], v20 offset:2560
s_add_u32 s43, s37, 593664
v_mfma_f32_16x16x32_bf16 v[92:95], a[220:223], a[68:71], v[92:95]
buffer_load_dwordx4 v8, s[20:23], s43 offen offset:0 lds
v_mfma_f32_16x16x32_bf16 v[96:99], a[216:219], a[112:115], v[96:99]
ds_read_b64_tr_b16 a[236:237], v20 offset:3072
v_mfma_f32_16x16x32_bf16 v[96:99], a[220:223], a[116:119], v[96:99]
s_add_u32 m0, s39, 54272
v_mfma_f32_16x16x32_bf16 v[100:103], a[216:219], a[160:163], v[100:103]
ds_read_b64_tr_b16 a[238:239], v20 offset:3584
v_mfma_f32_16x16x32_bf16 v[100:103], a[220:223], a[164:167], v[100:103]
s_add_u32 s42, s55, 512
s_waitcnt lgkmcnt(4)
v_mfma_f32_16x16x32_bf16 v[104:107], a[224:227], a[16:19], v[104:107]
ds_read_b64_tr_b16 a[240:241], v21 offset:2048
buffer_load_dwordx4 v24, s[16:19], s42 offen nt lds
v_mfma_f32_16x16x32_bf16 v[104:107], a[228:231], a[20:23], v[104:107]
s_add_u32 m0, s39, 9216
v_mfma_f32_16x16x32_bf16 v[108:111], a[224:227], a[64:67], v[108:111]
ds_read_b64_tr_b16 a[242:243], v21 offset:2560
v_mfma_f32_16x16x32_bf16 v[108:111], a[228:231], a[68:71], v[108:111]
s_add_u32 s43, s37, 667392
v_mfma_f32_16x16x32_bf16 v[112:115], a[224:227], a[112:115], v[112:115]
ds_read_b64_tr_b16 a[244:245], v21 offset:3072
buffer_load_dwordx4 v8, s[20:23], s43 offen offset:0 lds
v_mfma_f32_16x16x32_bf16 v[112:115], a[228:231], a[116:119], v[112:115]
v_mfma_f32_16x16x32_bf16 v[116:119], a[224:227], a[160:163], v[116:119]
ds_read_b64_tr_b16 a[246:247], v21 offset:3584
v_mfma_f32_16x16x32_bf16 v[116:119], a[228:231], a[164:167], v[116:119]
s_waitcnt lgkmcnt(4)
v_mfma_f32_16x16x32_bf16 v[120:123], a[232:235], a[16:19], v[120:123]
ds_read_b64_tr_b16 a[248:249], v22 offset:2048
v_mfma_f32_16x16x32_bf16 v[120:123], a[236:239], a[20:23], v[120:123]
s_add_u32 m0, s39, 55296
s_add_u32 s42, s56, 512
v_mfma_f32_16x16x32_bf16 v[124:127], a[232:235], a[64:67], v[124:127]
ds_read_b64_tr_b16 a[250:251], v22 offset:2560
buffer_load_dwordx4 v24, s[16:19], s42 offen nt lds
v_mfma_f32_16x16x32_bf16 v[124:127], a[236:239], a[68:71], v[124:127]
s_add_u32 m0, s39, 10240
v_mfma_f32_16x16x32_bf16 v[128:131], a[232:235], a[112:115], v[128:131]
ds_read_b64_tr_b16 a[252:253], v22 offset:3072
v_mfma_f32_16x16x32_bf16 v[128:131], a[236:239], a[116:119], v[128:131]
s_add_u32 s43, s37, 594432
v_mfma_f32_16x16x32_bf16 v[132:135], a[232:235], a[160:163], v[132:135]
ds_read_b64_tr_b16 a[254:255], v22 offset:3584
buffer_load_dwordx4 v8, s[20:23], s43 offen offset:0 lds
v_mfma_f32_16x16x32_bf16 v[132:135], a[236:239], a[164:167], v[132:135]
s_waitcnt lgkmcnt(4)
v_mfma_f32_16x16x32_bf16 v[136:139], a[240:243], a[16:19], v[136:139]
ds_read_b64_tr_b16 a[192:193], v19 offset:4096
v_mfma_f32_16x16x32_bf16 v[136:139], a[244:247], a[20:23], v[136:139]
s_add_u32 m0, s39, 56320
v_mfma_f32_16x16x32_bf16 v[140:143], a[240:243], a[64:67], v[140:143]
ds_read_b64_tr_b16 a[194:195], v19 offset:4608
v_mfma_f32_16x16x32_bf16 v[140:143], a[244:247], a[68:71], v[140:143]
s_add_u32 s42, s57, 512
buffer_load_dwordx4 v24, s[16:19], s42 offen nt lds
v_mfma_f32_16x16x32_bf16 v[144:147], a[240:243], a[112:115], v[144:147]
ds_read_b64_tr_b16 a[196:197], v19 offset:5120
v_mfma_f32_16x16x32_bf16 v[144:147], a[244:247], a[116:119], v[144:147]
s_add_u32 m0, s39, 11264
v_mfma_f32_16x16x32_bf16 v[148:151], a[240:243], a[160:163], v[148:151]
ds_read_b64_tr_b16 a[198:199], v19 offset:5632
v_mfma_f32_16x16x32_bf16 v[148:151], a[244:247], a[164:167], v[148:151]
s_waitcnt lgkmcnt(4)
v_mfma_f32_16x16x32_bf16 v[152:155], a[248:251], a[16:19], v[152:155]
ds_read_b64_tr_b16 a[200:201], v20 offset:4096
s_add_u32 s43, s37, 668160
v_mfma_f32_16x16x32_bf16 v[152:155], a[252:255], a[20:23], v[152:155]
buffer_load_dwordx4 v8, s[20:23], s43 offen offset:0 lds
v_mfma_f32_16x16x32_bf16 v[156:159], a[248:251], a[64:67], v[156:159]
ds_read_b64_tr_b16 a[202:203], v20 offset:4608
v_mfma_f32_16x16x32_bf16 v[156:159], a[252:255], a[68:71], v[156:159]
v_mfma_f32_16x16x32_bf16 v[160:163], a[248:251], a[112:115], v[160:163]
ds_read_b64_tr_b16 a[208:209], v20 offset:5120
s_waitcnt vmcnt(26)
ds_read_b128 a[24:27], v25 offset:8192
v_mfma_f32_16x16x32_bf16 v[160:163], a[252:255], a[116:119], v[160:163]
ds_read_b128 a[28:31], v26 offset:8192
v_mfma_f32_16x16x32_bf16 v[164:167], a[248:251], a[160:163], v[164:167]
ds_read_b64_tr_b16 a[210:211], v20 offset:5632
s_waitcnt vmcnt(23)
ds_read_b128 a[72:75], v25 offset:10240
v_mfma_f32_16x16x32_bf16 v[164:167], a[252:255], a[164:167], v[164:167]
ds_read_b128 a[76:79], v26 offset:10240
s_waitcnt lgkmcnt(8)
v_mfma_f32_16x16x32_bf16 v[168:171], a[16:19], a[192:195], v[168:171]
ds_read_b64_tr_b16 a[204:205], v21 offset:4096
s_waitcnt vmcnt(19)
ds_read_b128 a[120:123], v25 offset:55296
v_mfma_f32_16x16x32_bf16 v[168:171], a[20:23], a[196:199], v[168:171]
ds_read_b128 a[124:127], v26 offset:55296
v_mfma_f32_16x16x32_bf16 v[172:175], a[64:67], a[192:195], v[172:175]
ds_read_b64_tr_b16 a[206:207], v21 offset:4608
s_waitcnt vmcnt(15)
ds_read_b128 a[168:171], v25 offset:57344
v_mfma_f32_16x16x32_bf16 v[172:175], a[68:71], a[196:199], v[172:175]
ds_read_b128 a[172:175], v26 offset:57344
v_mfma_f32_16x16x32_bf16 v[176:179], a[112:115], a[192:195], v[176:179]
ds_read_b64_tr_b16 a[212:213], v21 offset:5120
v_mfma_f32_16x16x32_bf16 v[176:179], a[116:119], a[196:199], v[176:179]
v_mfma_f32_16x16x32_bf16 v[180:183], a[160:163], a[192:195], v[180:183]
ds_read_b64_tr_b16 a[214:215], v21 offset:5632
v_mfma_f32_16x16x32_bf16 v[180:183], a[164:167], a[196:199], v[180:183]
s_waitcnt lgkmcnt(10)
v_mfma_f32_16x16x32_bf16 v[184:187], a[16:19], a[200:203], v[184:187]
ds_read_b64_tr_b16 a[216:217], v22 offset:4096
v_mfma_f32_16x16x32_bf16 v[184:187], a[20:23], a[208:211], v[184:187]
v_mfma_f32_16x16x32_bf16 v[188:191], a[64:67], a[200:203], v[188:191]
ds_read_b64_tr_b16 a[218:219], v22 offset:4608
v_mfma_f32_16x16x32_bf16 v[188:191], a[68:71], a[208:211], v[188:191]
v_mfma_f32_16x16x32_bf16 v[192:195], a[112:115], a[200:203], v[192:195]
ds_read_b64_tr_b16 a[220:221], v22 offset:5120
v_mfma_f32_16x16x32_bf16 v[192:195], a[116:119], a[208:211], v[192:195]
v_mfma_f32_16x16x32_bf16 v[196:199], a[160:163], a[200:203], v[196:199]
ds_read_b64_tr_b16 a[222:223], v22 offset:5632
v_mfma_f32_16x16x32_bf16 v[196:199], a[164:167], a[208:211], v[196:199]
s_waitcnt lgkmcnt(4)
v_mfma_f32_16x16x32_bf16 v[200:203], a[16:19], a[204:207], v[200:203]
v_mfma_f32_16x16x32_bf16 v[200:203], a[20:23], a[212:215], v[200:203]
v_mfma_f32_16x16x32_bf16 v[204:207], a[64:67], a[204:207], v[204:207]
v_mfma_f32_16x16x32_bf16 v[204:207], a[68:71], a[212:215], v[204:207]
s_waitcnt vmcnt(14) lgkmcnt(0)
s_barrier
v_mfma_f32_16x16x32_bf16 v[208:211], a[112:115], a[204:207], v[208:211]
ds_read_b64_tr_b16 a[224:225], v6 offset:0
v_mfma_f32_16x16x32_bf16 v[208:211], a[116:119], a[212:215], v[208:211]
ds_read_b64_tr_b16 a[226:227], v6 offset:512
v_mfma_f32_16x16x32_bf16 v[212:215], a[160:163], a[204:207], v[212:215]
s_add_u32 m0, s39, 57344
v_mfma_f32_16x16x32_bf16 v[212:215], a[164:167], a[212:215], v[212:215]
ds_read_b64_tr_b16 a[228:229], v6 offset:1024
v_mfma_f32_16x16x32_bf16 v[216:219], a[16:19], a[216:219], v[216:219]
ds_read_b64_tr_b16 a[232:233], v7 offset:0
s_add_u32 s42, s50, 640
v_mfma_f32_16x16x32_bf16 v[216:219], a[20:23], a[220:223], v[216:219]
ds_read_b64_tr_b16 a[230:231], v6 offset:1536
buffer_load_dwordx4 v24, s[16:19], s42 offen nt lds
v_mfma_f32_16x16x32_bf16 v[220:223], a[64:67], a[216:219], v[220:223]
ds_read_b64_tr_b16 a[234:235], v7 offset:512
v_mfma_f32_16x16x32_bf16 v[220:223], a[68:71], a[220:223], v[220:223]
s_add_u32 m0, s39, 58368
v_mfma_f32_16x16x32_bf16 v[224:227], a[112:115], a[216:219], v[224:227]
ds_read_b64_tr_b16 a[236:237], v7 offset:1024
s_add_u32 s43, s51, 640
v_mfma_f32_16x16x32_bf16 v[224:227], a[116:119], a[220:223], v[224:227]
buffer_load_dwordx4 v24, s[16:19], s43 offen nt lds
v_mfma_f32_16x16x32_bf16 v[228:231], a[160:163], a[216:219], v[228:231]
ds_read_b64_tr_b16 a[238:239], v7 offset:1536
v_mfma_f32_16x16x32_bf16 v[228:231], a[164:167], a[220:223], v[228:231]
s_waitcnt lgkmcnt(3)
v_mfma_f32_16x16x32_bf16 v[40:43], a[224:227], a[24:27], v[40:43]
ds_read_b64_tr_b16 a[240:241], v17 offset:0
v_mfma_f32_16x16x32_bf16 v[40:43], a[228:231], a[28:31], v[40:43]
s_add_u32 m0, s39, 98304
s_add_u32 s42, s37, 740352
v_mfma_f32_16x16x32_bf16 v[44:47], a[224:227], a[72:75], v[44:47]
ds_read_b64_tr_b16 a[242:243], v17 offset:512
buffer_load_dwordx4 v8, s[20:23], s42 offen offset:0 lds
v_mfma_f32_16x16x32_bf16 v[44:47], a[228:231], a[76:79], v[44:47]
s_add_u32 m0, s39, 59392
v_mfma_f32_16x16x32_bf16 v[48:51], a[224:227], a[120:123], v[48:51]
ds_read_b64_tr_b16 a[244:245], v17 offset:1024
v_mfma_f32_16x16x32_bf16 v[48:51], a[228:231], a[124:127], v[48:51]
s_add_u32 s43, s52, 640
v_mfma_f32_16x16x32_bf16 v[52:55], a[224:227], a[168:171], v[52:55]
ds_read_b64_tr_b16 a[246:247], v17 offset:1536
buffer_load_dwordx4 v24, s[16:19], s43 offen nt lds
v_mfma_f32_16x16x32_bf16 v[52:55], a[228:231], a[172:175], v[52:55]
s_waitcnt lgkmcnt(4)
v_mfma_f32_16x16x32_bf16 v[56:59], a[232:235], a[24:27], v[56:59]
ds_read_b64_tr_b16 a[248:249], v18 offset:0
v_mfma_f32_16x16x32_bf16 v[56:59], a[236:239], a[28:31], v[56:59]
s_add_u32 m0, s39, 60416
v_mfma_f32_16x16x32_bf16 v[60:63], a[232:235], a[72:75], v[60:63]
ds_read_b64_tr_b16 a[250:251], v18 offset:512
v_mfma_f32_16x16x32_bf16 v[60:63], a[236:239], a[76:79], v[60:63]
s_add_u32 s42, s53, 640
buffer_load_dwordx4 v24, s[16:19], s42 offen nt lds
v_mfma_f32_16x16x32_bf16 v[64:67], a[232:235], a[120:123], v[64:67]
ds_read_b64_tr_b16 a[252:253], v18 offset:1024
v_mfma_f32_16x16x32_bf16 v[64:67], a[236:239], a[124:127], v[64:67]
s_add_u32 m0, s39, 99328
v_mfma_f32_16x16x32_bf16 v[68:71], a[232:235], a[168:171], v[68:71]
ds_read_b64_tr_b16 a[254:255], v18 offset:1536
v_mfma_f32_16x16x32_bf16 v[68:71], a[236:239], a[172:175], v[68:71]
s_waitcnt lgkmcnt(4)
v_mfma_f32_16x16x32_bf16 v[72:75], a[240:243], a[24:27], v[72:75]
ds_read_b64_tr_b16 a[192:193], v6 offset:2048
s_add_u32 s43, s37, 814080
v_mfma_f32_16x16x32_bf16 v[72:75], a[244:247], a[28:31], v[72:75]
buffer_load_dwordx4 v8, s[20:23], s43 offen offset:0 lds
v_mfma_f32_16x16x32_bf16 v[76:79], a[240:243], a[72:75], v[76:79]
ds_read_b64_tr_b16 a[194:195], v6 offset:2560
v_mfma_f32_16x16x32_bf16 v[76:79], a[244:247], a[76:79], v[76:79]
s_add_u32 m0, s39, 104448
v_mfma_f32_16x16x32_bf16 v[80:83], a[240:243], a[120:123], v[80:83]
ds_read_b64_tr_b16 a[196:197], v6 offset:3072
v_mfma_f32_16x16x32_bf16 v[80:83], a[244:247], a[124:127], v[80:83]
s_add_u32 s42, s54, 640
buffer_load_dwordx4 v24, s[16:19], s42 offen nt lds
v_mfma_f32_16x16x32_bf16 v[84:87], a[240:243], a[168:171], v[84:87]
ds_read_b64_tr_b16 a[198:199], v6 offset:3584
v_mfma_f32_16x16x32_bf16 v[84:87], a[244:247], a[172:175], v[84:87]
s_waitcnt lgkmcnt(4)
v_mfma_f32_16x16x32_bf16 v[88:91], a[248:251], a[24:27], v[88:91]
ds_read_b64_tr_b16 a[200:201], v7 offset:2048
v_mfma_f32_16x16x32_bf16 v[88:91], a[252:255], a[28:31], v[88:91]
s_add_u32 m0, s39, 100352
v_mfma_f32_16x16x32_bf16 v[92:95], a[248:251], a[72:75], v[92:95]
ds_read_b64_tr_b16 a[202:203], v7 offset:2560
s_add_u32 s43, s37, 741120
v_mfma_f32_16x16x32_bf16 v[92:95], a[252:255], a[76:79], v[92:95]
buffer_load_dwordx4 v8, s[20:23], s43 offen offset:0 lds
v_mfma_f32_16x16x32_bf16 v[96:99], a[248:251], a[120:123], v[96:99]
ds_read_b64_tr_b16 a[208:209], v7 offset:3072
v_mfma_f32_16x16x32_bf16 v[96:99], a[252:255], a[124:127], v[96:99]
s_add_u32 m0, s39, 105472
v_mfma_f32_16x16x32_bf16 v[100:103], a[248:251], a[168:171], v[100:103]
ds_read_b64_tr_b16 a[210:211], v7 offset:3584
v_mfma_f32_16x16x32_bf16 v[100:103], a[252:255], a[172:175], v[100:103]
s_add_u32 s42, s55, 640
s_waitcnt lgkmcnt(4)
v_mfma_f32_16x16x32_bf16 v[104:107], a[192:195], a[24:27], v[104:107]
ds_read_b64_tr_b16 a[204:205], v17 offset:2048
buffer_load_dwordx4 v24, s[16:19], s42 offen nt lds
v_mfma_f32_16x16x32_bf16 v[104:107], a[196:199], a[28:31], v[104:107]
s_add_u32 m0, s39, 101376
v_mfma_f32_16x16x32_bf16 v[108:111], a[192:195], a[72:75], v[108:111]
ds_read_b64_tr_b16 a[206:207], v17 offset:2560
v_mfma_f32_16x16x32_bf16 v[108:111], a[196:199], a[76:79], v[108:111]
s_add_u32 s43, s37, 814848
v_mfma_f32_16x16x32_bf16 v[112:115], a[192:195], a[120:123], v[112:115]
ds_read_b64_tr_b16 a[212:213], v17 offset:3072
buffer_load_dwordx4 v8, s[20:23], s43 offen offset:0 lds
v_mfma_f32_16x16x32_bf16 v[112:115], a[196:199], a[124:127], v[112:115]
v_mfma_f32_16x16x32_bf16 v[116:119], a[192:195], a[168:171], v[116:119]
ds_read_b64_tr_b16 a[214:215], v17 offset:3584
v_mfma_f32_16x16x32_bf16 v[116:119], a[196:199], a[172:175], v[116:119]
s_waitcnt lgkmcnt(4)
v_mfma_f32_16x16x32_bf16 v[120:123], a[200:203], a[24:27], v[120:123]
ds_read_b64_tr_b16 a[216:217], v18 offset:2048
v_mfma_f32_16x16x32_bf16 v[120:123], a[208:211], a[28:31], v[120:123]
s_add_u32 m0, s39, 106496
s_add_u32 s42, s56, 640
v_mfma_f32_16x16x32_bf16 v[124:127], a[200:203], a[72:75], v[124:127]
ds_read_b64_tr_b16 a[218:219], v18 offset:2560
buffer_load_dwordx4 v24, s[16:19], s42 offen nt lds
v_mfma_f32_16x16x32_bf16 v[124:127], a[208:211], a[76:79], v[124:127]
s_add_u32 m0, s39, 102400
v_mfma_f32_16x16x32_bf16 v[128:131], a[200:203], a[120:123], v[128:131]
ds_read_b64_tr_b16 a[220:221], v18 offset:3072
v_mfma_f32_16x16x32_bf16 v[128:131], a[208:211], a[124:127], v[128:131]
s_add_u32 s43, s37, 741888
v_mfma_f32_16x16x32_bf16 v[132:135], a[200:203], a[168:171], v[132:135]
ds_read_b64_tr_b16 a[222:223], v18 offset:3584
buffer_load_dwordx4 v8, s[20:23], s43 offen offset:0 lds
v_mfma_f32_16x16x32_bf16 v[132:135], a[208:211], a[172:175], v[132:135]
s_waitcnt lgkmcnt(4)
v_mfma_f32_16x16x32_bf16 v[136:139], a[204:207], a[24:27], v[136:139]
ds_read_b64_tr_b16 a[224:225], v6 offset:4096
v_mfma_f32_16x16x32_bf16 v[136:139], a[212:215], a[28:31], v[136:139]
s_add_u32 m0, s39, 107520
v_mfma_f32_16x16x32_bf16 v[140:143], a[204:207], a[72:75], v[140:143]
ds_read_b64_tr_b16 a[226:227], v6 offset:4608
v_mfma_f32_16x16x32_bf16 v[140:143], a[212:215], a[76:79], v[140:143]
s_add_u32 s42, s57, 640
buffer_load_dwordx4 v24, s[16:19], s42 offen nt lds
v_mfma_f32_16x16x32_bf16 v[144:147], a[204:207], a[120:123], v[144:147]
ds_read_b64_tr_b16 a[228:229], v6 offset:5120
v_mfma_f32_16x16x32_bf16 v[144:147], a[212:215], a[124:127], v[144:147]
s_add_u32 m0, s39, 103424
v_mfma_f32_16x16x32_bf16 v[148:151], a[204:207], a[168:171], v[148:151]
ds_read_b64_tr_b16 a[230:231], v6 offset:5632
v_mfma_f32_16x16x32_bf16 v[148:151], a[212:215], a[172:175], v[148:151]
s_waitcnt lgkmcnt(4)
v_mfma_f32_16x16x32_bf16 v[152:155], a[216:219], a[24:27], v[152:155]
ds_read_b64_tr_b16 a[232:233], v7 offset:4096
s_add_u32 s43, s37, 815616
v_mfma_f32_16x16x32_bf16 v[152:155], a[220:223], a[28:31], v[152:155]
buffer_load_dwordx4 v8, s[20:23], s43 offen offset:0 lds
v_mfma_f32_16x16x32_bf16 v[156:159], a[216:219], a[72:75], v[156:159]
ds_read_b64_tr_b16 a[234:235], v7 offset:4608
v_mfma_f32_16x16x32_bf16 v[156:159], a[220:223], a[76:79], v[156:159]
v_mfma_f32_16x16x32_bf16 v[160:163], a[216:219], a[120:123], v[160:163]
ds_read_b64_tr_b16 a[236:237], v7 offset:5120
s_waitcnt vmcnt(26)
ds_read_b128 a[32:35], v25 offset:0
v_mfma_f32_16x16x32_bf16 v[160:163], a[220:223], a[124:127], v[160:163]
ds_read_b128 a[36:39], v26 offset:0
v_mfma_f32_16x16x32_bf16 v[164:167], a[216:219], a[168:171], v[164:167]
ds_read_b64_tr_b16 a[238:239], v7 offset:5632
s_waitcnt vmcnt(23)
ds_read_b128 a[80:83], v25 offset:2048
v_mfma_f32_16x16x32_bf16 v[164:167], a[220:223], a[172:175], v[164:167]
ds_read_b128 a[84:87], v26 offset:2048
s_waitcnt lgkmcnt(8)
v_mfma_f32_16x16x32_bf16 v[168:171], a[24:27], a[224:227], v[168:171]
ds_read_b64_tr_b16 a[240:241], v17 offset:4096
s_waitcnt vmcnt(19)
ds_read_b128 a[128:131], v25 offset:4096
v_mfma_f32_16x16x32_bf16 v[168:171], a[28:31], a[228:231], v[168:171]
ds_read_b128 a[132:135], v26 offset:4096
v_mfma_f32_16x16x32_bf16 v[172:175], a[72:75], a[224:227], v[172:175]
ds_read_b64_tr_b16 a[242:243], v17 offset:4608
s_waitcnt vmcnt(15)
ds_read_b128 a[176:179], v25 offset:6144
v_mfma_f32_16x16x32_bf16 v[172:175], a[76:79], a[228:231], v[172:175]
ds_read_b128 a[180:183], v26 offset:6144
v_mfma_f32_16x16x32_bf16 v[176:179], a[120:123], a[224:227], v[176:179]
ds_read_b64_tr_b16 a[244:245], v17 offset:5120
v_mfma_f32_16x16x32_bf16 v[176:179], a[124:127], a[228:231], v[176:179]
v_mfma_f32_16x16x32_bf16 v[180:183], a[168:171], a[224:227], v[180:183]
ds_read_b64_tr_b16 a[246:247], v17 offset:5632
v_mfma_f32_16x16x32_bf16 v[180:183], a[172:175], a[228:231], v[180:183]
s_waitcnt lgkmcnt(10)
v_mfma_f32_16x16x32_bf16 v[184:187], a[24:27], a[232:235], v[184:187]
ds_read_b64_tr_b16 a[248:249], v18 offset:4096
v_mfma_f32_16x16x32_bf16 v[184:187], a[28:31], a[236:239], v[184:187]
v_mfma_f32_16x16x32_bf16 v[188:191], a[72:75], a[232:235], v[188:191]
ds_read_b64_tr_b16 a[250:251], v18 offset:4608
v_mfma_f32_16x16x32_bf16 v[188:191], a[76:79], a[236:239], v[188:191]
v_mfma_f32_16x16x32_bf16 v[192:195], a[120:123], a[232:235], v[192:195]
ds_read_b64_tr_b16 a[252:253], v18 offset:5120
v_mfma_f32_16x16x32_bf16 v[192:195], a[124:127], a[236:239], v[192:195]
v_mfma_f32_16x16x32_bf16 v[196:199], a[168:171], a[232:235], v[196:199]
ds_read_b64_tr_b16 a[254:255], v18 offset:5632
v_mfma_f32_16x16x32_bf16 v[196:199], a[172:175], a[236:239], v[196:199]
s_waitcnt lgkmcnt(4)
v_mfma_f32_16x16x32_bf16 v[200:203], a[24:27], a[240:243], v[200:203]
v_mfma_f32_16x16x32_bf16 v[200:203], a[28:31], a[244:247], v[200:203]
v_mfma_f32_16x16x32_bf16 v[204:207], a[72:75], a[240:243], v[204:207]
v_mfma_f32_16x16x32_bf16 v[204:207], a[76:79], a[244:247], v[204:207]
s_waitcnt vmcnt(14) lgkmcnt(0)
s_barrier
v_mfma_f32_16x16x32_bf16 v[208:211], a[120:123], a[240:243], v[208:211]
ds_read_b64_tr_b16 a[192:193], v6 offset:6144
v_mfma_f32_16x16x32_bf16 v[208:211], a[124:127], a[244:247], v[208:211]
ds_read_b64_tr_b16 a[194:195], v6 offset:6656
v_mfma_f32_16x16x32_bf16 v[212:215], a[168:171], a[240:243], v[212:215]
v_mfma_f32_16x16x32_bf16 v[212:215], a[172:175], a[244:247], v[212:215]
ds_read_b64_tr_b16 a[196:197], v6 offset:7168
v_mfma_f32_16x16x32_bf16 v[216:219], a[24:27], a[248:251], v[216:219]
ds_read_b64_tr_b16 a[200:201], v7 offset:6144
v_mfma_f32_16x16x32_bf16 v[216:219], a[28:31], a[252:255], v[216:219]
ds_read_b64_tr_b16 a[198:199], v6 offset:7680
v_mfma_f32_16x16x32_bf16 v[220:223], a[72:75], a[248:251], v[220:223]
ds_read_b64_tr_b16 a[202:203], v7 offset:6656
v_mfma_f32_16x16x32_bf16 v[220:223], a[76:79], a[252:255], v[220:223]
s_mov_b32 s44, 704
v_mfma_f32_16x16x32_bf16 v[224:227], a[120:123], a[248:251], v[224:227]
ds_read_b64_tr_b16 a[208:209], v7 offset:7168
v_mfma_f32_16x16x32_bf16 v[224:227], a[124:127], a[252:255], v[224:227]
v_mad_i32_i24 v8, v12, s44, v8
v_mfma_f32_16x16x32_bf16 v[228:231], a[168:171], a[248:251], v[228:231]
ds_read_b64_tr_b16 a[210:211], v7 offset:7680
v_mfma_f32_16x16x32_bf16 v[228:231], a[172:175], a[252:255], v[228:231]
s_waitcnt lgkmcnt(3)
v_mfma_f32_16x16x32_bf16 v[40:43], a[192:195], a[32:35], v[40:43]
ds_read_b64_tr_b16 a[204:205], v17 offset:6144
v_mfma_f32_16x16x32_bf16 v[40:43], a[196:199], a[36:39], v[40:43]
s_add_u32 m0, s39, 0
v_mfma_f32_16x16x32_bf16 v[44:47], a[192:195], a[80:83], v[44:47]
ds_read_b64_tr_b16 a[206:207], v17 offset:6656
v_mfma_f32_16x16x32_bf16 v[44:47], a[196:199], a[84:87], v[44:47]
s_add_u32 s42, s37, 3200
v_mfma_f32_16x16x32_bf16 v[48:51], a[192:195], a[128:131], v[48:51]
ds_read_b64_tr_b16 a[212:213], v17 offset:7168
buffer_load_dwordx4 v8, s[20:23], s42 offen offset:0 lds
v_mfma_f32_16x16x32_bf16 v[48:51], a[196:199], a[132:135], v[48:51]
s_add_u32 s43, s37, 75904
v_mfma_f32_16x16x32_bf16 v[52:55], a[192:195], a[176:179], v[52:55]
ds_read_b64_tr_b16 a[214:215], v17 offset:7680
v_mfma_f32_16x16x32_bf16 v[52:55], a[196:199], a[180:183], v[52:55]
s_waitcnt lgkmcnt(4)
v_mfma_f32_16x16x32_bf16 v[56:59], a[200:203], a[32:35], v[56:59]
ds_read_b64_tr_b16 a[216:217], v18 offset:6144
v_mfma_f32_16x16x32_bf16 v[56:59], a[208:211], a[36:39], v[56:59]
buffer_load_dwordx4 v8, s[20:23], s43 offen offset:1024 lds
v_mfma_f32_16x16x32_bf16 v[60:63], a[200:203], a[80:83], v[60:63]
ds_read_b64_tr_b16 a[218:219], v18 offset:6656
v_mfma_f32_16x16x32_bf16 v[60:63], a[208:211], a[84:87], v[60:63]
s_add_u32 s42, s37, 148608
v_mfma_f32_16x16x32_bf16 v[64:67], a[200:203], a[128:131], v[64:67]
ds_read_b64_tr_b16 a[220:221], v18 offset:7168
v_mfma_f32_16x16x32_bf16 v[64:67], a[208:211], a[132:135], v[64:67]
buffer_load_dwordx4 v8, s[20:23], s42 offen offset:2048 lds
v_mfma_f32_16x16x32_bf16 v[68:71], a[200:203], a[176:179], v[68:71]
ds_read_b64_tr_b16 a[222:223], v18 offset:7680
v_mfma_f32_16x16x32_bf16 v[68:71], a[208:211], a[180:183], v[68:71]
s_waitcnt lgkmcnt(4)
v_mfma_f32_16x16x32_bf16 v[72:75], a[204:207], a[32:35], v[72:75]
ds_read_b64_tr_b16 a[224:225], v6 offset:8192
v_mfma_f32_16x16x32_bf16 v[72:75], a[212:215], a[36:39], v[72:75]
s_add_u32 s43, s37, 221312
v_mfma_f32_16x16x32_bf16 v[76:79], a[204:207], a[80:83], v[76:79]
ds_read_b64_tr_b16 a[226:227], v6 offset:8704
v_mfma_f32_16x16x32_bf16 v[76:79], a[212:215], a[84:87], v[76:79]
buffer_load_dwordx4 v8, s[20:23], s43 offen offset:3072 lds
v_mfma_f32_16x16x32_bf16 v[80:83], a[204:207], a[128:131], v[80:83]
ds_read_b64_tr_b16 a[228:229], v6 offset:9216
v_mfma_f32_16x16x32_bf16 v[80:83], a[212:215], a[132:135], v[80:83]
s_add_u32 m0, s39, 4096
v_mfma_f32_16x16x32_bf16 v[84:87], a[204:207], a[176:179], v[84:87]
ds_read_b64_tr_b16 a[230:231], v6 offset:9728
v_mfma_f32_16x16x32_bf16 v[84:87], a[212:215], a[180:183], v[84:87]
s_waitcnt lgkmcnt(4)
v_mfma_f32_16x16x32_bf16 v[88:91], a[216:219], a[32:35], v[88:91]
ds_read_b64_tr_b16 a[232:233], v7 offset:8192
v_mfma_f32_16x16x32_bf16 v[88:91], a[220:223], a[36:39], v[88:91]
s_add_u32 s42, s37, 298112
v_mfma_f32_16x16x32_bf16 v[92:95], a[216:219], a[80:83], v[92:95]
ds_read_b64_tr_b16 a[234:235], v7 offset:8704
v_mfma_f32_16x16x32_bf16 v[92:95], a[220:223], a[84:87], v[92:95]
buffer_load_dwordx4 v8, s[20:23], s42 offen offset:0 lds
v_mfma_f32_16x16x32_bf16 v[96:99], a[216:219], a[128:131], v[96:99]
ds_read_b64_tr_b16 a[236:237], v7 offset:9216
v_mfma_f32_16x16x32_bf16 v[96:99], a[220:223], a[132:135], v[96:99]
s_add_u32 s43, s37, 370816
v_mfma_f32_16x16x32_bf16 v[100:103], a[216:219], a[176:179], v[100:103]
ds_read_b64_tr_b16 a[238:239], v7 offset:9728
v_mfma_f32_16x16x32_bf16 v[100:103], a[220:223], a[180:183], v[100:103]
s_waitcnt lgkmcnt(4)
v_mfma_f32_16x16x32_bf16 v[104:107], a[224:227], a[32:35], v[104:107]
ds_read_b64_tr_b16 a[240:241], v17 offset:8192
v_mfma_f32_16x16x32_bf16 v[104:107], a[228:231], a[36:39], v[104:107]
buffer_load_dwordx4 v8, s[20:23], s43 offen offset:1024 lds
v_mfma_f32_16x16x32_bf16 v[108:111], a[224:227], a[80:83], v[108:111]
ds_read_b64_tr_b16 a[242:243], v17 offset:8704
v_mfma_f32_16x16x32_bf16 v[108:111], a[228:231], a[84:87], v[108:111]
v_mfma_f32_16x16x32_bf16 v[112:115], a[224:227], a[128:131], v[112:115]
ds_read_b64_tr_b16 a[244:245], v17 offset:9216
v_mfma_f32_16x16x32_bf16 v[112:115], a[228:231], a[132:135], v[112:115]
v_mfma_f32_16x16x32_bf16 v[116:119], a[224:227], a[176:179], v[116:119]
ds_read_b64_tr_b16 a[246:247], v17 offset:9728
v_mfma_f32_16x16x32_bf16 v[116:119], a[228:231], a[180:183], v[116:119]
s_waitcnt lgkmcnt(4)
v_mfma_f32_16x16x32_bf16 v[120:123], a[232:235], a[32:35], v[120:123]
ds_read_b64_tr_b16 a[248:249], v18 offset:8192
v_mfma_f32_16x16x32_bf16 v[120:123], a[236:239], a[36:39], v[120:123]
v_mfma_f32_16x16x32_bf16 v[124:127], a[232:235], a[80:83], v[124:127]
ds_read_b64_tr_b16 a[250:251], v18 offset:8704
v_mfma_f32_16x16x32_bf16 v[124:127], a[236:239], a[84:87], v[124:127]
v_mfma_f32_16x16x32_bf16 v[128:131], a[232:235], a[128:131], v[128:131]
ds_read_b64_tr_b16 a[252:253], v18 offset:9216
v_mfma_f32_16x16x32_bf16 v[128:131], a[236:239], a[132:135], v[128:131]
v_mfma_f32_16x16x32_bf16 v[132:135], a[232:235], a[176:179], v[132:135]
ds_read_b64_tr_b16 a[254:255], v18 offset:9728
v_mfma_f32_16x16x32_bf16 v[132:135], a[236:239], a[180:183], v[132:135]
s_waitcnt lgkmcnt(4)
v_mfma_f32_16x16x32_bf16 v[136:139], a[240:243], a[32:35], v[136:139]
ds_read_b64_tr_b16 a[192:193], v6 offset:10240
v_mfma_f32_16x16x32_bf16 v[136:139], a[244:247], a[36:39], v[136:139]
v_mfma_f32_16x16x32_bf16 v[140:143], a[240:243], a[80:83], v[140:143]
ds_read_b64_tr_b16 a[194:195], v6 offset:10752
v_mfma_f32_16x16x32_bf16 v[140:143], a[244:247], a[84:87], v[140:143]
v_mfma_f32_16x16x32_bf16 v[144:147], a[240:243], a[128:131], v[144:147]
ds_read_b64_tr_b16 a[196:197], v6 offset:11264
v_mfma_f32_16x16x32_bf16 v[144:147], a[244:247], a[132:135], v[144:147]
v_mfma_f32_16x16x32_bf16 v[148:151], a[240:243], a[176:179], v[148:151]
ds_read_b64_tr_b16 a[198:199], v6 offset:11776
v_mfma_f32_16x16x32_bf16 v[148:151], a[244:247], a[180:183], v[148:151]
s_waitcnt lgkmcnt(4)
v_mfma_f32_16x16x32_bf16 v[152:155], a[248:251], a[32:35], v[152:155]
ds_read_b64_tr_b16 a[200:201], v7 offset:10240
v_mfma_f32_16x16x32_bf16 v[152:155], a[252:255], a[36:39], v[152:155]
v_mfma_f32_16x16x32_bf16 v[156:159], a[248:251], a[80:83], v[156:159]
ds_read_b64_tr_b16 a[202:203], v7 offset:10752
v_mfma_f32_16x16x32_bf16 v[156:159], a[252:255], a[84:87], v[156:159]
v_mfma_f32_16x16x32_bf16 v[160:163], a[248:251], a[128:131], v[160:163]
ds_read_b64_tr_b16 a[208:209], v7 offset:11264
s_waitcnt vmcnt(18)
ds_read_b128 a[40:43], v25 offset:8192
v_mfma_f32_16x16x32_bf16 v[160:163], a[252:255], a[132:135], v[160:163]
ds_read_b128 a[44:47], v26 offset:8192
v_mfma_f32_16x16x32_bf16 v[164:167], a[248:251], a[176:179], v[164:167]
ds_read_b64_tr_b16 a[210:211], v7 offset:11776
s_waitcnt vmcnt(15)
ds_read_b128 a[88:91], v25 offset:10240
v_mfma_f32_16x16x32_bf16 v[164:167], a[252:255], a[180:183], v[164:167]
ds_read_b128 a[92:95], v26 offset:10240
s_waitcnt lgkmcnt(8)
v_mfma_f32_16x16x32_bf16 v[168:171], a[32:35], a[192:195], v[168:171]
ds_read_b64_tr_b16 a[204:205], v17 offset:10240
s_waitcnt vmcnt(11)
ds_read_b128 a[136:139], v25 offset:55296
v_mfma_f32_16x16x32_bf16 v[168:171], a[36:39], a[196:199], v[168:171]
ds_read_b128 a[140:143], v26 offset:55296
v_mfma_f32_16x16x32_bf16 v[172:175], a[80:83], a[192:195], v[172:175]
ds_read_b64_tr_b16 a[206:207], v17 offset:10752
s_waitcnt vmcnt(7)
ds_read_b128 a[184:187], v25 offset:57344
v_mfma_f32_16x16x32_bf16 v[172:175], a[84:87], a[196:199], v[172:175]
ds_read_b128 a[188:191], v26 offset:57344
v_mfma_f32_16x16x32_bf16 v[176:179], a[128:131], a[192:195], v[176:179]
ds_read_b64_tr_b16 a[212:213], v17 offset:11264
v_mfma_f32_16x16x32_bf16 v[176:179], a[132:135], a[196:199], v[176:179]
v_mfma_f32_16x16x32_bf16 v[180:183], a[176:179], a[192:195], v[180:183]
ds_read_b64_tr_b16 a[214:215], v17 offset:11776
v_mfma_f32_16x16x32_bf16 v[180:183], a[180:183], a[196:199], v[180:183]
s_waitcnt lgkmcnt(10)
v_mfma_f32_16x16x32_bf16 v[184:187], a[32:35], a[200:203], v[184:187]
ds_read_b64_tr_b16 a[216:217], v18 offset:10240
v_mfma_f32_16x16x32_bf16 v[184:187], a[36:39], a[208:211], v[184:187]
s_add_u32 m0, s39, 55296
v_mfma_f32_16x16x32_bf16 v[188:191], a[80:83], a[200:203], v[188:191]
ds_read_b64_tr_b16 a[218:219], v18 offset:10752
v_mfma_f32_16x16x32_bf16 v[188:191], a[84:87], a[208:211], v[188:191]
s_add_u32 s42, s37, 445568
v_mfma_f32_16x16x32_bf16 v[192:195], a[128:131], a[200:203], v[192:195]
ds_read_b64_tr_b16 a[220:221], v18 offset:11264
v_mfma_f32_16x16x32_bf16 v[192:195], a[132:135], a[208:211], v[192:195]
s_waitcnt lgkmcnt(5)
buffer_load_dwordx4 v8, s[20:23], s42 offen offset:0 lds
v_mfma_f32_16x16x32_bf16 v[196:199], a[176:179], a[200:203], v[196:199]
ds_read_b64_tr_b16 a[222:223], v18 offset:11776
v_mfma_f32_16x16x32_bf16 v[196:199], a[180:183], a[208:211], v[196:199]
s_waitcnt lgkmcnt(4)
v_mfma_f32_16x16x32_bf16 v[200:203], a[32:35], a[204:207], v[200:203]
s_add_u32 s43, s37, 518272
v_mfma_f32_16x16x32_bf16 v[200:203], a[36:39], a[212:215], v[200:203]
buffer_load_dwordx4 v8, s[20:23], s43 offen offset:1024 lds
v_mfma_f32_16x16x32_bf16 v[204:207], a[80:83], a[204:207], v[204:207]
v_mfma_f32_16x16x32_bf16 v[204:207], a[84:87], a[212:215], v[204:207]
s_waitcnt vmcnt(8) lgkmcnt(0)
s_barrier
v_mfma_f32_16x16x32_bf16 v[208:211], a[128:131], a[204:207], v[208:211]
ds_read_b64_tr_b16 a[224:225], v19 offset:0
v_mfma_f32_16x16x32_bf16 v[208:211], a[132:135], a[212:215], v[208:211]
ds_read_b64_tr_b16 a[226:227], v19 offset:512
v_mfma_f32_16x16x32_bf16 v[212:215], a[176:179], a[204:207], v[212:215]
s_add_u32 s42, s37, 590976
v_mfma_f32_16x16x32_bf16 v[212:215], a[180:183], a[212:215], v[212:215]
ds_read_b64_tr_b16 a[228:229], v19 offset:1024
v_mfma_f32_16x16x32_bf16 v[216:219], a[32:35], a[216:219], v[216:219]
ds_read_b64_tr_b16 a[232:233], v20 offset:0
v_mfma_f32_16x16x32_bf16 v[216:219], a[36:39], a[220:223], v[216:219]
ds_read_b64_tr_b16 a[230:231], v19 offset:1536
v_mfma_f32_16x16x32_bf16 v[220:223], a[80:83], a[216:219], v[220:223]
ds_read_b64_tr_b16 a[234:235], v20 offset:512
v_mfma_f32_16x16x32_bf16 v[220:223], a[84:87], a[220:223], v[220:223]
buffer_load_dwordx4 v8, s[20:23], s42 offen offset:2048 lds
v_mfma_f32_16x16x32_bf16 v[224:227], a[128:131], a[216:219], v[224:227]
ds_read_b64_tr_b16 a[236:237], v20 offset:1024
v_mfma_f32_16x16x32_bf16 v[224:227], a[132:135], a[220:223], v[224:227]
s_add_u32 s43, s37, 663680
v_mfma_f32_16x16x32_bf16 v[228:231], a[176:179], a[216:219], v[228:231]
ds_read_b64_tr_b16 a[238:239], v20 offset:1536
v_mfma_f32_16x16x32_bf16 v[228:231], a[180:183], a[220:223], v[228:231]
s_waitcnt lgkmcnt(3)
v_mfma_f32_16x16x32_bf16 v[40:43], a[224:227], a[40:43], v[40:43]
ds_read_b64_tr_b16 a[240:241], v21 offset:0
v_mfma_f32_16x16x32_bf16 v[40:43], a[228:231], a[44:47], v[40:43]
buffer_load_dwordx4 v8, s[20:23], s43 offen offset:3072 lds
v_mfma_f32_16x16x32_bf16 v[44:47], a[224:227], a[88:91], v[44:47]
ds_read_b64_tr_b16 a[242:243], v21 offset:512
v_mfma_f32_16x16x32_bf16 v[44:47], a[228:231], a[92:95], v[44:47]
s_add_u32 m0, s39, 59392
v_mfma_f32_16x16x32_bf16 v[48:51], a[224:227], a[136:139], v[48:51]
ds_read_b64_tr_b16 a[244:245], v21 offset:1024
v_mfma_f32_16x16x32_bf16 v[48:51], a[228:231], a[140:143], v[48:51]
s_add_u32 s42, s37, 740480
v_mfma_f32_16x16x32_bf16 v[52:55], a[224:227], a[184:187], v[52:55]
ds_read_b64_tr_b16 a[246:247], v21 offset:1536
v_mfma_f32_16x16x32_bf16 v[52:55], a[228:231], a[188:191], v[52:55]
s_waitcnt lgkmcnt(4)
v_mfma_f32_16x16x32_bf16 v[56:59], a[232:235], a[40:43], v[56:59]
ds_read_b64_tr_b16 a[248:249], v22 offset:0
v_mfma_f32_16x16x32_bf16 v[56:59], a[236:239], a[44:47], v[56:59]
buffer_load_dwordx4 v8, s[20:23], s42 offen offset:0 lds
v_mfma_f32_16x16x32_bf16 v[60:63], a[232:235], a[88:91], v[60:63]
ds_read_b64_tr_b16 a[250:251], v22 offset:512
s_add_u32 s43, s37, 813184
v_mfma_f32_16x16x32_bf16 v[60:63], a[236:239], a[92:95], v[60:63]
buffer_load_dwordx4 v8, s[20:23], s43 offen offset:1024 lds
v_mfma_f32_16x16x32_bf16 v[64:67], a[232:235], a[136:139], v[64:67]
ds_read_b64_tr_b16 a[252:253], v22 offset:1024
v_cvt_pk_bf16_f32 v232, v40, v41
v_mfma_f32_16x16x32_bf16 v[64:67], a[236:239], a[140:143], v[64:67]
v_cvt_pk_bf16_f32 v233, v42, v43
v_mfma_f32_16x16x32_bf16 v[68:71], a[232:235], a[184:187], v[68:71]
ds_read_b64_tr_b16 a[254:255], v22 offset:1536
v_cvt_pk_bf16_f32 v236, v44, v45
v_mfma_f32_16x16x32_bf16 v[68:71], a[236:239], a[188:191], v[68:71]
v_cvt_pk_bf16_f32 v237, v46, v47
s_waitcnt lgkmcnt(4)
v_mfma_f32_16x16x32_bf16 v[72:75], a[240:243], a[40:43], v[72:75]
ds_read_b64_tr_b16 a[192:193], v19 offset:2048
v_cvt_pk_bf16_f32 v240, v48, v49
v_mfma_f32_16x16x32_bf16 v[72:75], a[244:247], a[44:47], v[72:75]
v_cvt_pk_bf16_f32 v241, v50, v51
v_mfma_f32_16x16x32_bf16 v[76:79], a[240:243], a[88:91], v[76:79]
ds_read_b64_tr_b16 a[194:195], v19 offset:2560
v_cvt_pk_bf16_f32 v244, v52, v53
v_mfma_f32_16x16x32_bf16 v[76:79], a[244:247], a[92:95], v[76:79]
v_cvt_pk_bf16_f32 v245, v54, v55
v_mfma_f32_16x16x32_bf16 v[80:83], a[240:243], a[136:139], v[80:83]
ds_read_b64_tr_b16 a[196:197], v19 offset:3072
v_cvt_pk_bf16_f32 v234, v56, v57
v_mfma_f32_16x16x32_bf16 v[80:83], a[244:247], a[140:143], v[80:83]
v_cvt_pk_bf16_f32 v235, v58, v59
v_mfma_f32_16x16x32_bf16 v[84:87], a[240:243], a[184:187], v[84:87]
ds_read_b64_tr_b16 a[198:199], v19 offset:3584
v_cvt_pk_bf16_f32 v238, v60, v61
v_mfma_f32_16x16x32_bf16 v[84:87], a[244:247], a[188:191], v[84:87]
v_cvt_pk_bf16_f32 v239, v62, v63
s_waitcnt lgkmcnt(4)
v_mfma_f32_16x16x32_bf16 v[88:91], a[248:251], a[40:43], v[88:91]
ds_read_b64_tr_b16 a[200:201], v20 offset:2048
v_cvt_pk_bf16_f32 v242, v64, v65
v_mfma_f32_16x16x32_bf16 v[88:91], a[252:255], a[44:47], v[88:91]
v_cvt_pk_bf16_f32 v243, v66, v67
v_mfma_f32_16x16x32_bf16 v[92:95], a[248:251], a[88:91], v[92:95]
ds_read_b64_tr_b16 a[202:203], v20 offset:2560
v_cvt_pk_bf16_f32 v246, v68, v69
v_mfma_f32_16x16x32_bf16 v[92:95], a[252:255], a[92:95], v[92:95]
v_cvt_pk_bf16_f32 v247, v70, v71
v_mfma_f32_16x16x32_bf16 v[96:99], a[248:251], a[136:139], v[96:99]
ds_read_b64_tr_b16 a[208:209], v20 offset:3072
v_cvt_pk_bf16_f32 v248, v72, v73
v_mfma_f32_16x16x32_bf16 v[96:99], a[252:255], a[140:143], v[96:99]
v_cvt_pk_bf16_f32 v249, v74, v75
v_mfma_f32_16x16x32_bf16 v[100:103], a[248:251], a[184:187], v[100:103]
ds_read_b64_tr_b16 a[210:211], v20 offset:3584
v_cvt_pk_bf16_f32 v252, v76, v77
v_mfma_f32_16x16x32_bf16 v[100:103], a[252:255], a[188:191], v[100:103]
v_cvt_pk_bf16_f32 v253, v78, v79
s_waitcnt lgkmcnt(4)
v_mfma_f32_16x16x32_bf16 v[104:107], a[192:195], a[40:43], v[104:107]
ds_read_b64_tr_b16 a[204:205], v21 offset:2048
v_cvt_pk_bf16_f32 v32, v80, v81
v_mfma_f32_16x16x32_bf16 v[104:107], a[196:199], a[44:47], v[104:107]
v_cvt_pk_bf16_f32 v33, v82, v83
v_mfma_f32_16x16x32_bf16 v[108:111], a[192:195], a[88:91], v[108:111]
ds_read_b64_tr_b16 a[206:207], v21 offset:2560
v_cvt_pk_bf16_f32 v36, v84, v85
v_mfma_f32_16x16x32_bf16 v[108:111], a[196:199], a[92:95], v[108:111]
v_cvt_pk_bf16_f32 v37, v86, v87
v_mfma_f32_16x16x32_bf16 v[112:115], a[192:195], a[136:139], v[112:115]
ds_read_b64_tr_b16 a[212:213], v21 offset:3072
v_cvt_pk_bf16_f32 v250, v88, v89
v_mfma_f32_16x16x32_bf16 v[112:115], a[196:199], a[140:143], v[112:115]
v_cvt_pk_bf16_f32 v251, v90, v91
v_mfma_f32_16x16x32_bf16 v[116:119], a[192:195], a[184:187], v[116:119]
ds_read_b64_tr_b16 a[214:215], v21 offset:3584
v_cvt_pk_bf16_f32 v254, v92, v93
v_mfma_f32_16x16x32_bf16 v[116:119], a[196:199], a[188:191], v[116:119]
v_cvt_pk_bf16_f32 v255, v94, v95
s_waitcnt lgkmcnt(4)
v_mfma_f32_16x16x32_bf16 v[120:123], a[200:203], a[40:43], v[120:123]
ds_read_b64_tr_b16 a[216:217], v22 offset:2048
v_cvt_pk_bf16_f32 v34, v96, v97
v_mfma_f32_16x16x32_bf16 v[120:123], a[208:211], a[44:47], v[120:123]
v_cvt_pk_bf16_f32 v35, v98, v99
v_mfma_f32_16x16x32_bf16 v[124:127], a[200:203], a[88:91], v[124:127]
ds_read_b64_tr_b16 a[218:219], v22 offset:2560
v_cvt_pk_bf16_f32 v38, v100, v101
v_mfma_f32_16x16x32_bf16 v[124:127], a[208:211], a[92:95], v[124:127]
v_cvt_pk_bf16_f32 v39, v102, v103
v_mfma_f32_16x16x32_bf16 v[128:131], a[200:203], a[136:139], v[128:131]
ds_read_b64_tr_b16 a[220:221], v22 offset:3072
v_cvt_pk_bf16_f32 v40, v104, v105
v_mfma_f32_16x16x32_bf16 v[128:131], a[208:211], a[140:143], v[128:131]
v_cvt_pk_bf16_f32 v41, v106, v107
v_mfma_f32_16x16x32_bf16 v[132:135], a[200:203], a[184:187], v[132:135]
ds_read_b64_tr_b16 a[222:223], v22 offset:3584
v_cvt_pk_bf16_f32 v44, v108, v109
v_mfma_f32_16x16x32_bf16 v[132:135], a[208:211], a[188:191], v[132:135]
v_cvt_pk_bf16_f32 v45, v110, v111
s_waitcnt lgkmcnt(4)
v_mfma_f32_16x16x32_bf16 v[136:139], a[204:207], a[40:43], v[136:139]
ds_read_b64_tr_b16 a[224:225], v19 offset:4096
v_cvt_pk_bf16_f32 v48, v112, v113
v_mfma_f32_16x16x32_bf16 v[136:139], a[212:215], a[44:47], v[136:139]
v_cvt_pk_bf16_f32 v49, v114, v115
v_mfma_f32_16x16x32_bf16 v[140:143], a[204:207], a[88:91], v[140:143]
ds_read_b64_tr_b16 a[226:227], v19 offset:4608
v_cvt_pk_bf16_f32 v52, v116, v117
v_mfma_f32_16x16x32_bf16 v[140:143], a[212:215], a[92:95], v[140:143]
ds_read_b128 v[56:59], v9 offset:288
v_cvt_pk_bf16_f32 v53, v118, v119
v_mfma_f32_16x16x32_bf16 v[144:147], a[204:207], a[136:139], v[144:147]
ds_read_b64_tr_b16 a[228:229], v19 offset:5120
v_cvt_pk_bf16_f32 v42, v120, v121
v_mfma_f32_16x16x32_bf16 v[144:147], a[212:215], a[140:143], v[144:147]
ds_read_b128 v[60:63], v9 offset:384
v_cvt_pk_bf16_f32 v43, v122, v123
v_mfma_f32_16x16x32_bf16 v[148:151], a[204:207], a[184:187], v[148:151]
ds_read_b64_tr_b16 a[230:231], v19 offset:5632
v_cvt_pk_bf16_f32 v46, v124, v125
v_mfma_f32_16x16x32_bf16 v[148:151], a[212:215], a[188:191], v[148:151]
ds_read_b128 v[64:67], v9 offset:480
s_waitcnt lgkmcnt(7)
v_mfma_f32_16x16x32_bf16 v[152:155], a[216:219], a[40:43], v[152:155]
ds_read_b64_tr_b16 a[232:233], v20 offset:4096
v_cvt_pk_bf16_f32 v47, v126, v127
v_mfma_f32_16x16x32_bf16 v[152:155], a[220:223], a[44:47], v[152:155]
ds_read_b128 v[68:71], v9 offset:576
v_cvt_pk_bf16_f32 v50, v128, v129
v_mfma_f32_16x16x32_bf16 v[156:159], a[216:219], a[88:91], v[156:159]
ds_read_b64_tr_b16 a[234:235], v20 offset:4608
v_cvt_pk_bf16_f32 v51, v130, v131
v_mfma_f32_16x16x32_bf16 v[156:159], a[220:223], a[92:95], v[156:159]
ds_read_b128 v[72:75], v9 offset:192
v_cvt_pk_bf16_f32 v54, v132, v133
v_mfma_f32_16x16x32_bf16 v[160:163], a[216:219], a[136:139], v[160:163]
ds_read_b64_tr_b16 a[236:237], v20 offset:5120
v_cvt_pk_bf16_f32 v55, v134, v135
v_mfma_f32_16x16x32_bf16 v[160:163], a[220:223], a[140:143], v[160:163]
ds_read_b128 v[76:79], v9 offset:288
v_cvt_pk_bf16_f32 v80, v136, v137
v_mfma_f32_16x16x32_bf16 v[164:167], a[216:219], a[184:187], v[164:167]
ds_read_b64_tr_b16 a[238:239], v20 offset:5632
v_cvt_pk_bf16_f32 v81, v138, v139
v_mfma_f32_16x16x32_bf16 v[164:167], a[220:223], a[188:191], v[164:167]
ds_read_b128 v[84:87], v9 offset:384
s_waitcnt lgkmcnt(9)
v_mfma_f32_16x16x32_bf16 v[168:171], a[40:43], a[224:227], v[168:171]
ds_read_b64_tr_b16 a[240:241], v21 offset:4096
v_cvt_pk_bf16_f32 v88, v140, v141
v_mfma_f32_16x16x32_bf16 v[168:171], a[44:47], a[228:231], v[168:171]
ds_read_b128 v[92:95], v9 offset:480
v_cvt_pk_bf16_f32 v89, v142, v143
v_mfma_f32_16x16x32_bf16 v[172:175], a[88:91], a[224:227], v[172:175]
ds_read_b64_tr_b16 a[242:243], v21 offset:4608
v_cvt_pk_bf16_f32 v96, v144, v145
v_mfma_f32_16x16x32_bf16 v[172:175], a[92:95], a[228:231], v[172:175]
ds_read_b128 v[100:103], v9 offset:96
v_cvt_pk_bf16_f32 v97, v146, v147
v_mfma_f32_16x16x32_bf16 v[176:179], a[136:139], a[224:227], v[176:179]
ds_read_b64_tr_b16 a[244:245], v21 offset:5120
v_cvt_pk_bf16_f32 v104, v148, v149
v_mfma_f32_16x16x32_bf16 v[176:179], a[140:143], a[228:231], v[176:179]
ds_read_b128 v[108:111], v9 offset:192
v_cvt_pk_bf16_f32 v105, v150, v151
v_mfma_f32_16x16x32_bf16 v[180:183], a[184:187], a[224:227], v[180:183]
ds_read_b64_tr_b16 a[246:247], v21 offset:5632
v_cvt_pk_bf16_f32 v82, v152, v153
v_mfma_f32_16x16x32_bf16 v[180:183], a[188:191], a[228:231], v[180:183]
ds_read_b128 v[112:115], v9 offset:288
v_cvt_pk_bf16_f32 v83, v154, v155
v_mfma_f32_16x16x32_bf16 v[56:59], v[40:43], v[232:235], v[56:59]
v_cvt_pk_bf16_f32 v90, v156, v157
v_cvt_pk_bf16_f32 v91, v158, v159
v_mfma_f32_16x16x32_bf16 v[60:63], v[40:43], v[236:239], v[60:63]
ds_read_b128 v[116:119], v9 offset:384
v_cvt_pk_bf16_f32 v98, v160, v161
s_waitcnt lgkmcnt(15)
v_mfma_f32_16x16x32_bf16 v[64:67], v[40:43], v[240:243], v[64:67]
v_cvt_pk_bf16_f32 v99, v162, v163
v_cvt_pk_bf16_f32 v106, v164, v165
v_mfma_f32_16x16x32_bf16 v[68:71], v[40:43], v[244:247], v[68:71]
ds_read_b128 v[120:123], v9 offset:0
v_cvt_pk_bf16_f32 v107, v166, v167
s_waitcnt lgkmcnt(14)
v_mfma_f32_16x16x32_bf16 v[72:75], v[44:47], v[232:235], v[72:75]
v_cvt_pk_bf16_f32 v124, v168, v169
v_cvt_pk_bf16_f32 v125, v170, v171
s_waitcnt lgkmcnt(12)
v_mfma_f32_16x16x32_bf16 v[76:79], v[44:47], v[236:239], v[76:79]
ds_read_b128 v[128:131], v9 offset:96
s_waitcnt lgkmcnt(11)
v_mfma_f32_16x16x32_bf16 v[84:87], v[44:47], v[240:243], v[84:87]
v_cvt_pk_bf16_f32 v126, v172, v173
v_cvt_pk_bf16_f32 v127, v174, v175
s_waitcnt lgkmcnt(9)
v_mfma_f32_16x16x32_bf16 v[92:95], v[44:47], v[244:247], v[92:95]
ds_read_b128 v[132:135], v9 offset:192
s_waitcnt lgkmcnt(8)
v_mfma_f32_16x16x32_bf16 v[100:103], v[48:51], v[232:235], v[100:103]
v_cvt_pk_bf16_f32 v136, v176, v177
s_waitcnt lgkmcnt(6)
v_mfma_f32_16x16x32_bf16 v[108:111], v[48:51], v[236:239], v[108:111]
ds_read_b128 v[140:143], v9 offset:288
s_waitcnt lgkmcnt(5)
v_mfma_f32_16x16x32_bf16 v[112:115], v[48:51], v[240:243], v[112:115]
v_cvt_pk_bf16_f32 v137, v178, v179
s_waitcnt lgkmcnt(4)
v_mfma_f32_16x16x32_bf16 v[116:119], v[48:51], v[244:247], v[116:119]
v_cvt_pk_bf16_f32 v138, v180, v181
s_waitcnt lgkmcnt(3)
v_mfma_f32_16x16x32_bf16 v[120:123], v[52:55], v[232:235], v[120:123]
v_cvt_pk_bf16_f32 v139, v182, v183
s_waitcnt lgkmcnt(2)
v_mfma_f32_16x16x32_bf16 v[128:131], v[52:55], v[236:239], v[128:131]
s_waitcnt lgkmcnt(1)
v_mfma_f32_16x16x32_bf16 v[132:135], v[52:55], v[240:243], v[132:135]
s_waitcnt lgkmcnt(0)
v_mfma_f32_16x16x32_bf16 v[140:143], v[52:55], v[244:247], v[140:143]
v_mfma_f32_16x16x32_bf16 v[56:59], v[80:83], v[248:251], v[56:59]
v_mfma_f32_16x16x32_bf16 v[60:63], v[80:83], v[252:255], v[60:63]
v_mfma_f32_16x16x32_bf16 v[64:67], v[80:83], v[32:35], v[64:67]
v_mfma_f32_16x16x32_bf16 v[68:71], v[80:83], v[36:39], v[68:71]
v_mfma_f32_16x16x32_bf16 v[72:75], v[88:91], v[248:251], v[72:75]
v_mfma_f32_16x16x32_bf16 v[76:79], v[88:91], v[252:255], v[76:79]
v_mfma_f32_16x16x32_bf16 v[84:87], v[88:91], v[32:35], v[84:87]
v_mfma_f32_16x16x32_bf16 v[92:95], v[88:91], v[36:39], v[92:95]
v_mfma_f32_16x16x32_bf16 v[100:103], v[96:99], v[248:251], v[100:103]
v_mfma_f32_16x16x32_bf16 v[108:111], v[96:99], v[252:255], v[108:111]
v_mfma_f32_16x16x32_bf16 v[112:115], v[96:99], v[32:35], v[112:115]
v_mfma_f32_16x16x32_bf16 v[116:119], v[96:99], v[36:39], v[116:119]
v_mfma_f32_16x16x32_bf16 v[120:123], v[104:107], v[248:251], v[120:123]
v_mfma_f32_16x16x32_bf16 v[128:131], v[104:107], v[252:255], v[128:131]
v_mfma_f32_16x16x32_bf16 v[132:135], v[104:107], v[32:35], v[132:135]
v_mfma_f32_16x16x32_bf16 v[140:143], v[104:107], v[36:39], v[140:143]
v_mfma_f32_16x16x32_bf16 v[184:187], a[40:43], a[232:235], v[184:187]
ds_read_b64_tr_b16 a[248:249], v22 offset:4096
v_mfma_f32_16x16x32_bf16 v[184:187], a[44:47], a[236:239], v[184:187]
v_mfma_f32_16x16x32_bf16 v[188:191], a[88:91], a[232:235], v[188:191]
ds_read_b64_tr_b16 a[250:251], v22 offset:4608
v_mfma_f32_16x16x32_bf16 v[188:191], a[92:95], a[236:239], v[188:191]
v_mfma_f32_16x16x32_bf16 v[192:195], a[136:139], a[232:235], v[192:195]
ds_read_b64_tr_b16 a[252:253], v22 offset:5120
v_mfma_f32_16x16x32_bf16 v[192:195], a[140:143], a[236:239], v[192:195]
v_mfma_f32_16x16x32_bf16 v[196:199], a[184:187], a[232:235], v[196:199]
ds_read_b64_tr_b16 a[254:255], v22 offset:5632
v_mfma_f32_16x16x32_bf16 v[196:199], a[188:191], a[236:239], v[196:199]
v_mfma_f32_16x16x32_bf16 v[200:203], a[40:43], a[240:243], v[200:203]
v_cvt_pk_bf16_f32 v144, v184, v185
v_mfma_f32_16x16x32_bf16 v[200:203], a[44:47], a[244:247], v[200:203]
v_cvt_pk_bf16_f32 v145, v186, v187
v_mfma_f32_16x16x32_bf16 v[204:207], a[88:91], a[240:243], v[204:207]
v_cvt_pk_bf16_f32 v146, v188, v189
v_mfma_f32_16x16x32_bf16 v[204:207], a[92:95], a[244:247], v[204:207]
s_waitcnt vmcnt(0) lgkmcnt(0)
s_barrier
v_mfma_f32_16x16x32_bf16 v[208:211], a[136:139], a[240:243], v[208:211]
ds_read_b64_tr_b16 a[192:193], v6 offset:0
s_mov_b32 s44, 704
v_mfma_f32_16x16x32_bf16 v[208:211], a[140:143], a[244:247], v[208:211]
ds_read_b64_tr_b16 a[194:195], v6 offset:512
v_mad_i32_i24 v8, v12, s44, v8
v_mfma_f32_16x16x32_bf16 v[212:215], a[184:187], a[240:243], v[212:215]
s_add_u32 m0, s39, 49152
s_add_u32 s42, s37, 3264
v_mfma_f32_16x16x32_bf16 v[212:215], a[188:191], a[244:247], v[212:215]
ds_read_b64_tr_b16 a[196:197], v6 offset:1024
v_mfma_f32_16x16x32_bf16 v[216:219], a[40:43], a[248:251], v[216:219]
ds_read_b64_tr_b16 a[200:201], v6 offset:2048
buffer_load_dwordx4 v8, s[20:23], s42 offen offset:0 lds
v_mfma_f32_16x16x32_bf16 v[216:219], a[44:47], a[252:255], v[216:219]
ds_read_b64_tr_b16 a[198:199], v6 offset:1536
v_cvt_pk_bf16_f32 v147, v190, v191
v_mfma_f32_16x16x32_bf16 v[220:223], a[88:91], a[248:251], v[220:223]
ds_read_b64_tr_b16 a[202:203], v6 offset:2560
s_add_u32 s43, s37, 75968
v_mfma_f32_16x16x32_bf16 v[220:223], a[92:95], a[252:255], v[220:223]
buffer_load_dwordx4 v8, s[20:23], s43 offen offset:1024 lds
v_cvt_pk_bf16_f32 v148, v192, v193
v_mfma_f32_16x16x32_bf16 v[224:227], a[136:139], a[248:251], v[224:227]
ds_read_b64_tr_b16 a[208:209], v6 offset:3072
v_cvt_pk_bf16_f32 v149, v194, v195
v_mfma_f32_16x16x32_bf16 v[224:227], a[140:143], a[252:255], v[224:227]
v_cvt_pk_bf16_f32 v150, v196, v197
v_cvt_pk_bf16_f32 v151, v198, v199
v_mfma_f32_16x16x32_bf16 v[228:231], a[184:187], a[248:251], v[228:231]
ds_read_b64_tr_b16 a[210:211], v6 offset:3584
v_cvt_pk_bf16_f32 v152, v200, v201
v_mfma_f32_16x16x32_bf16 v[228:231], a[188:191], a[252:255], v[228:231]
v_cvt_pk_bf16_f32 v153, v202, v203
s_waitcnt lgkmcnt(3)
v_mfma_f32_16x16x32_bf16 v[156:159], a[192:195], a[0:3], 0
ds_read_b64_tr_b16 a[204:205], v6 offset:4096
s_add_u32 s42, s37, 148672
v_mfma_f32_16x16x32_bf16 v[156:159], a[196:199], a[4:7], v[156:159]
buffer_load_dwordx4 v8, s[20:23], s42 offen offset:2048 lds
v_cvt_pk_bf16_f32 v154, v204, v205
v_mfma_f32_16x16x32_bf16 v[160:163], a[192:195], a[48:51], 0
ds_read_b64_tr_b16 a[206:207], v6 offset:4608
v_cvt_pk_bf16_f32 v155, v206, v207
v_mfma_f32_16x16x32_bf16 v[160:163], a[196:199], a[52:55], v[160:163]
v_cvt_pk_bf16_f32 v40, v208, v209
v_cvt_pk_bf16_f32 v41, v210, v211
v_mfma_f32_16x16x32_bf16 v[164:167], a[192:195], a[96:99], 0
ds_read_b64_tr_b16 a[212:213], v6 offset:5120
v_cvt_pk_bf16_f32 v42, v212, v213
v_mfma_f32_16x16x32_bf16 v[164:167], a[196:199], a[100:103], v[164:167]
v_cvt_pk_bf16_f32 v43, v214, v215
v_cvt_pk_bf16_f32 v168, v216, v217
v_mfma_f32_16x16x32_bf16 v[172:175], a[192:195], a[144:147], 0
ds_read_b64_tr_b16 a[214:215], v6 offset:5632
s_add_u32 s43, s37, 221376
v_mfma_f32_16x16x32_bf16 v[172:175], a[196:199], a[148:151], v[172:175]
buffer_load_dwordx4 v8, s[20:23], s43 offen offset:3072 lds
s_waitcnt lgkmcnt(4)
v_mfma_f32_16x16x32_bf16 v[156:159], a[200:203], a[8:11], v[156:159]
ds_read_b64_tr_b16 a[216:217], v6 offset:55296
v_cvt_pk_bf16_f32 v169, v218, v219
v_mfma_f32_16x16x32_bf16 v[156:159], a[208:211], a[12:15], v[156:159]
v_cvt_pk_bf16_f32 v170, v220, v221
v_cvt_pk_bf16_f32 v171, v222, v223
v_mfma_f32_16x16x32_bf16 v[160:163], a[200:203], a[56:59], v[160:163]
ds_read_b64_tr_b16 a[218:219], v6 offset:55808
v_mfma_f32_16x16x32_bf16 v[160:163], a[208:211], a[60:63], v[160:163]
v_cvt_pk_bf16_f32 v44, v224, v225
v_mfma_f32_16x16x32_bf16 v[164:167], a[200:203], a[104:107], v[164:167]
ds_read_b64_tr_b16 a[220:221], v6 offset:56320
v_cvt_pk_bf16_f32 v45, v226, v227
v_mfma_f32_16x16x32_bf16 v[164:167], a[208:211], a[108:111], v[164:167]
v_cvt_pk_bf16_f32 v46, v228, v229
v_mfma_f32_16x16x32_bf16 v[172:175], a[200:203], a[152:155], v[172:175]
ds_read_b64_tr_b16 a[222:223], v6 offset:56832
v_mfma_f32_16x16x32_bf16 v[172:175], a[208:211], a[156:159], v[172:175]
s_waitcnt lgkmcnt(4)
v_mfma_f32_16x16x32_bf16 v[156:159], a[204:207], a[16:19], v[156:159]
ds_read_b64_tr_b16 a[224:225], v6 offset:57344
v_mfma_f32_16x16x32_bf16 v[156:159], a[212:215], a[20:23], v[156:159]
v_cvt_pk_bf16_f32 v47, v230, v231
v_mfma_f32_16x16x32_bf16 v[160:163], a[204:207], a[64:67], v[160:163]
ds_read_b64_tr_b16 a[226:227], v6 offset:57856
v_mfma_f32_16x16x32_bf16 v[160:163], a[212:215], a[68:71], v[160:163]
s_add_u32 m0, s39, 53248
v_mfma_f32_16x16x32_bf16 v[164:167], a[204:207], a[112:115], v[164:167]
ds_read_b64_tr_b16 a[228:229], v6 offset:58368
v_mfma_f32_16x16x32_bf16 v[164:167], a[212:215], a[116:119], v[164:167]
s_add_u32 s42, s37, 298176
v_mfma_f32_16x16x32_bf16 v[172:175], a[204:207], a[160:163], v[172:175]
ds_read_b64_tr_b16 a[230:231], v6 offset:58880
v_mfma_f32_16x16x32_bf16 v[172:175], a[212:215], a[164:167], v[172:175]
s_waitcnt lgkmcnt(4)
v_mfma_f32_16x16x32_bf16 v[156:159], a[216:219], a[24:27], v[156:159]
ds_read_b64_tr_b16 a[232:233], v6 offset:59392
v_mfma_f32_16x16x32_bf16 v[156:159], a[220:223], a[28:31], v[156:159]
buffer_load_dwordx4 v8, s[20:23], s42 offen offset:0 lds
v_mfma_f32_16x16x32_bf16 v[160:163], a[216:219], a[72:75], v[160:163]
ds_read_b64_tr_b16 a[234:235], v6 offset:59904
v_mfma_f32_16x16x32_bf16 v[160:163], a[220:223], a[76:79], v[160:163]
s_add_u32 s43, s37, 370880
v_mfma_f32_16x16x32_bf16 v[164:167], a[216:219], a[120:123], v[164:167]
ds_read_b64_tr_b16 a[236:237], v6 offset:60416
v_mfma_f32_16x16x32_bf16 v[164:167], a[220:223], a[124:127], v[164:167]
buffer_load_dwordx4 v8, s[20:23], s43 offen offset:1024 lds
v_mfma_f32_16x16x32_bf16 v[172:175], a[216:219], a[168:171], v[172:175]
ds_read_b64_tr_b16 a[238:239], v6 offset:60928
v_mfma_f32_16x16x32_bf16 v[172:175], a[220:223], a[172:175], v[172:175]
s_waitcnt lgkmcnt(4)
v_mfma_f32_16x16x32_bf16 v[156:159], a[224:227], a[32:35], v[156:159]
ds_read_b64_tr_b16 a[240:241], v7 offset:0
v_mfma_f32_16x16x32_bf16 v[156:159], a[228:231], a[36:39], v[156:159]
s_add_u32 m0, s39, 6144
v_mfma_f32_16x16x32_bf16 v[160:163], a[224:227], a[80:83], v[160:163]
ds_read_b64_tr_b16 a[242:243], v7 offset:512
v_mfma_f32_16x16x32_bf16 v[160:163], a[228:231], a[84:87], v[160:163]
s_add_u32 s42, s37, 445632
v_mfma_f32_16x16x32_bf16 v[164:167], a[224:227], a[128:131], v[164:167]
ds_read_b64_tr_b16 a[244:245], v7 offset:1024
v_mfma_f32_16x16x32_bf16 v[164:167], a[228:231], a[132:135], v[164:167]
buffer_load_dwordx4 v8, s[20:23], s42 offen offset:0 lds
v_mfma_f32_16x16x32_bf16 v[172:175], a[224:227], a[176:179], v[172:175]
ds_read_b64_tr_b16 a[246:247], v7 offset:1536
v_mfma_f32_16x16x32_bf16 v[172:175], a[228:231], a[180:183], v[172:175]
s_waitcnt lgkmcnt(4)
v_mfma_f32_16x16x32_bf16 v[156:159], a[232:235], a[40:43], v[156:159]
ds_read_b64_tr_b16 a[248:249], v7 offset:2048
v_mfma_f32_16x16x32_bf16 v[156:159], a[236:239], a[44:47], v[156:159]
s_add_u32 s43, s37, 518336
v_mfma_f32_16x16x32_bf16 v[160:163], a[232:235], a[88:91], v[160:163]
ds_read_b64_tr_b16 a[250:251], v7 offset:2560
v_mfma_f32_16x16x32_bf16 v[160:163], a[236:239], a[92:95], v[160:163]
buffer_load_dwordx4 v8, s[20:23], s43 offen offset:1024 lds
v_mfma_f32_16x16x32_bf16 v[164:167], a[232:235], a[136:139], v[164:167]
ds_read_b64_tr_b16 a[252:253], v7 offset:3072
v_mfma_f32_16x16x32_bf16 v[164:167], a[236:239], a[140:143], v[164:167]
s_add_u32 s42, s37, 591040
v_mfma_f32_16x16x32_bf16 v[172:175], a[232:235], a[184:187], v[172:175]
ds_read_b64_tr_b16 a[254:255], v7 offset:3584
v_mfma_f32_16x16x32_bf16 v[172:175], a[236:239], a[188:191], v[172:175]
s_waitcnt lgkmcnt(4)
v_mfma_f32_16x16x32_bf16 v[176:179], a[240:243], a[0:3], 0
ds_read_b64_tr_b16 a[192:193], v7 offset:4096
v_mfma_f32_16x16x32_bf16 v[176:179], a[244:247], a[4:7], v[176:179]
buffer_load_dwordx4 v8, s[20:23], s42 offen offset:2048 lds
v_mfma_f32_16x16x32_bf16 v[48:51], a[240:243], a[48:51], 0
ds_read_b64_tr_b16 a[194:195], v7 offset:4608
s_add_u32 s43, s37, 663744
v_mfma_f32_16x16x32_bf16 v[48:51], a[244:247], a[52:55], v[48:51]
buffer_load_dwordx4 v8, s[20:23], s43 offen offset:3072 lds
s_add_u32 m0, s39, 10240
v_mfma_f32_16x16x32_bf16 v[232:235], a[240:243], a[96:99], 0
ds_read_b64_tr_b16 a[196:197], v7 offset:5120
s_add_u32 s42, s37, 740544
v_mfma_f32_16x16x32_bf16 v[232:235], a[244:247], a[100:103], v[232:235]
buffer_load_dwordx4 v8, s[20:23], s42 offen offset:0 lds
v_cvt_pk_bf16_f32 v180, v156, v157
v_mfma_f32_16x16x32_bf16 v[236:239], a[240:243], a[144:147], 0
ds_read_b64_tr_b16 a[198:199], v7 offset:5632
s_add_u32 s43, s37, 813248
v_mfma_f32_16x16x32_bf16 v[236:239], a[244:247], a[148:151], v[236:239]
buffer_load_dwordx4 v8, s[20:23], s43 offen offset:1024 lds
s_waitcnt lgkmcnt(4)
v_mfma_f32_16x16x32_bf16 v[176:179], a[248:251], a[8:11], v[176:179]
ds_read_b64_tr_b16 a[200:201], v7 offset:55296
v_cvt_pk_bf16_f32 v181, v158, v159
v_mfma_f32_16x16x32_bf16 v[176:179], a[252:255], a[12:15], v[176:179]
v_cvt_pk_bf16_f32 v240, v160, v161
v_cvt_pk_bf16_f32 v241, v162, v163
v_mfma_f32_16x16x32_bf16 v[48:51], a[248:251], a[56:59], v[48:51]
ds_read_b64_tr_b16 a[202:203], v7 offset:55808
v_mfma_f32_16x16x32_bf16 v[48:51], a[252:255], a[60:63], v[48:51]
v_cvt_pk_bf16_f32 v244, v164, v165
v_mfma_f32_16x16x32_bf16 v[232:235], a[248:251], a[104:107], v[232:235]
ds_read_b64_tr_b16 a[208:209], v7 offset:56320
v_mfma_f32_16x16x32_bf16 v[232:235], a[252:255], a[108:111], v[232:235]
v_cvt_pk_bf16_f32 v245, v166, v167
v_mfma_f32_16x16x32_bf16 v[236:239], a[248:251], a[152:155], v[236:239]
ds_read_b64_tr_b16 a[210:211], v7 offset:56832
v_mfma_f32_16x16x32_bf16 v[236:239], a[252:255], a[156:159], v[236:239]
s_waitcnt lgkmcnt(4)
v_mfma_f32_16x16x32_bf16 v[176:179], a[192:195], a[16:19], v[176:179]
ds_read_b64_tr_b16 a[204:205], v7 offset:57344
v_mfma_f32_16x16x32_bf16 v[176:179], a[196:199], a[20:23], v[176:179]
v_cvt_pk_bf16_f32 v52, v172, v173
v_mfma_f32_16x16x32_bf16 v[48:51], a[192:195], a[64:67], v[48:51]
ds_read_b64_tr_b16 a[206:207], v7 offset:57856
v_mfma_f32_16x16x32_bf16 v[48:51], a[196:199], a[68:71], v[48:51]
v_cvt_pk_bf16_f32 v53, v174, v175
v_mfma_f32_16x16x32_bf16 v[232:235], a[192:195], a[112:115], v[232:235]
ds_read_b64_tr_b16 a[212:213], v7 offset:58368
v_mfma_f32_16x16x32_bf16 v[232:235], a[196:199], a[116:119], v[232:235]
v_mfma_f32_16x16x32_bf16 v[236:239], a[192:195], a[160:163], v[236:239]
ds_read_b64_tr_b16 a[214:215], v7 offset:58880
v_mfma_f32_16x16x32_bf16 v[236:239], a[196:199], a[164:167], v[236:239]
s_waitcnt lgkmcnt(4)
v_mfma_f32_16x16x32_bf16 v[176:179], a[200:203], a[24:27], v[176:179]
ds_read_b64_tr_b16 a[216:217], v7 offset:59392
v_mfma_f32_16x16x32_bf16 v[176:179], a[208:211], a[28:31], v[176:179]
v_mfma_f32_16x16x32_bf16 v[48:51], a[200:203], a[72:75], v[48:51]
ds_read_b64_tr_b16 a[218:219], v7 offset:59904
v_mfma_f32_16x16x32_bf16 v[48:51], a[208:211], a[76:79], v[48:51]
v_mfma_f32_16x16x32_bf16 v[232:235], a[200:203], a[120:123], v[232:235]
ds_read_b64_tr_b16 a[220:221], v7 offset:60416
v_mfma_f32_16x16x32_bf16 v[232:235], a[208:211], a[124:127], v[232:235]
v_mfma_f32_16x16x32_bf16 v[236:239], a[200:203], a[168:171], v[236:239]
ds_read_b64_tr_b16 a[222:223], v7 offset:60928
v_mfma_f32_16x16x32_bf16 v[236:239], a[208:211], a[172:175], v[236:239]
s_waitcnt lgkmcnt(4)
v_mfma_f32_16x16x32_bf16 v[176:179], a[204:207], a[32:35], v[176:179]
ds_read_b64_tr_b16 a[224:225], v17 offset:0
v_mfma_f32_16x16x32_bf16 v[176:179], a[212:215], a[36:39], v[176:179]
v_mfma_f32_16x16x32_bf16 v[48:51], a[204:207], a[80:83], v[48:51]
ds_read_b64_tr_b16 a[226:227], v17 offset:512
v_mfma_f32_16x16x32_bf16 v[48:51], a[212:215], a[84:87], v[48:51]
v_mfma_f32_16x16x32_bf16 v[232:235], a[204:207], a[128:131], v[232:235]
ds_read_b64_tr_b16 a[228:229], v17 offset:1024
v_mfma_f32_16x16x32_bf16 v[232:235], a[212:215], a[132:135], v[232:235]
v_mfma_f32_16x16x32_bf16 v[236:239], a[204:207], a[176:179], v[236:239]
ds_read_b64_tr_b16 a[230:231], v17 offset:1536
v_mfma_f32_16x16x32_bf16 v[236:239], a[212:215], a[180:183], v[236:239]
s_waitcnt lgkmcnt(4)
v_mfma_f32_16x16x32_bf16 v[176:179], a[216:219], a[40:43], v[176:179]
ds_read_b64_tr_b16 a[232:233], v17 offset:2048
v_mfma_f32_16x16x32_bf16 v[176:179], a[220:223], a[44:47], v[176:179]
v_mfma_f32_16x16x32_bf16 v[48:51], a[216:219], a[88:91], v[48:51]
ds_read_b64_tr_b16 a[234:235], v17 offset:2560
v_mfma_f32_16x16x32_bf16 v[48:51], a[220:223], a[92:95], v[48:51]
v_mfma_f32_16x16x32_bf16 v[232:235], a[216:219], a[136:139], v[232:235]
ds_read_b64_tr_b16 a[236:237], v17 offset:3072
v_mfma_f32_16x16x32_bf16 v[232:235], a[220:223], a[140:143], v[232:235]
v_mfma_f32_16x16x32_bf16 v[236:239], a[216:219], a[184:187], v[236:239]
ds_read_b64_tr_b16 a[238:239], v17 offset:3584
v_mfma_f32_16x16x32_bf16 v[236:239], a[220:223], a[188:191], v[236:239]
s_waitcnt lgkmcnt(4)
v_mfma_f32_16x16x32_bf16 v[80:83], a[224:227], a[0:3], 0
ds_read_b64_tr_b16 a[240:241], v17 offset:4096
v_mfma_f32_16x16x32_bf16 v[80:83], a[228:231], a[4:7], v[80:83]
v_cvt_pk_bf16_f32 v182, v176, v177
v_mfma_f32_16x16x32_bf16 v[88:91], a[224:227], a[48:51], 0
ds_read_b64_tr_b16 a[242:243], v17 offset:4608
v_mfma_f32_16x16x32_bf16 v[88:91], a[228:231], a[52:55], v[88:91]
v_cvt_pk_bf16_f32 v183, v178, v179
v_mfma_f32_16x16x32_bf16 v[96:99], a[224:227], a[96:99], 0
ds_read_b64_tr_b16 a[244:245], v17 offset:5120
v_mfma_f32_16x16x32_bf16 v[96:99], a[228:231], a[100:103], v[96:99]
v_cvt_pk_bf16_f32 v242, v48, v49
v_mfma_f32_16x16x32_bf16 v[248:251], a[224:227], a[144:147], 0
ds_read_b64_tr_b16 a[246:247], v17 offset:5632
v_cvt_pk_bf16_f32 v243, v50, v51
v_mfma_f32_16x16x32_bf16 v[248:251], a[228:231], a[148:151], v[248:251]
s_waitcnt lgkmcnt(4)
v_mfma_f32_16x16x32_bf16 v[80:83], a[232:235], a[8:11], v[80:83]
ds_read_b64_tr_b16 a[248:249], v17 offset:55296
v_mfma_f32_16x16x32_bf16 v[80:83], a[236:239], a[12:15], v[80:83]
v_cvt_pk_bf16_f32 v246, v232, v233
v_mfma_f32_16x16x32_bf16 v[88:91], a[232:235], a[56:59], v[88:91]
ds_read_b64_tr_b16 a[250:251], v17 offset:55808
v_mfma_f32_16x16x32_bf16 v[88:91], a[236:239], a[60:63], v[88:91]
v_cvt_pk_bf16_f32 v247, v234, v235
v_mfma_f32_16x16x32_bf16 v[96:99], a[232:235], a[104:107], v[96:99]
ds_read_b64_tr_b16 a[252:253], v17 offset:56320
v_mfma_f32_16x16x32_bf16 v[96:99], a[236:239], a[108:111], v[96:99]
v_cvt_pk_bf16_f32 v54, v236, v237
v_mfma_f32_16x16x32_bf16 v[248:251], a[232:235], a[152:155], v[248:251]
ds_read_b64_tr_b16 a[254:255], v17 offset:56832
v_mfma_f32_16x16x32_bf16 v[248:251], a[236:239], a[156:159], v[248:251]
s_waitcnt lgkmcnt(4)
v_mfma_f32_16x16x32_bf16 v[80:83], a[240:243], a[16:19], v[80:83]
ds_read_b64_tr_b16 a[192:193], v17 offset:57344
v_mfma_f32_16x16x32_bf16 v[80:83], a[244:247], a[20:23], v[80:83]
v_cvt_pk_bf16_f32 v55, v238, v239
v_mfma_f32_16x16x32_bf16 v[88:91], a[240:243], a[64:67], v[88:91]
ds_read_b64_tr_b16 a[194:195], v17 offset:57856
v_mfma_f32_16x16x32_bf16 v[88:91], a[244:247], a[68:71], v[88:91]
v_mfma_f32_16x16x32_bf16 v[96:99], a[240:243], a[112:115], v[96:99]
ds_read_b64_tr_b16 a[196:197], v17 offset:58368
v_mfma_f32_16x16x32_bf16 v[96:99], a[244:247], a[116:119], v[96:99]
v_mfma_f32_16x16x32_bf16 v[248:251], a[240:243], a[160:163], v[248:251]
ds_read_b64_tr_b16 a[198:199], v17 offset:58880
v_mfma_f32_16x16x32_bf16 v[248:251], a[244:247], a[164:167], v[248:251]
s_waitcnt lgkmcnt(4)
v_mfma_f32_16x16x32_bf16 v[80:83], a[248:251], a[24:27], v[80:83]
ds_read_b64_tr_b16 a[200:201], v17 offset:59392
v_mfma_f32_16x16x32_bf16 v[80:83], a[252:255], a[28:31], v[80:83]
v_mfma_f32_16x16x32_bf16 v[88:91], a[248:251], a[72:75], v[88:91]
ds_read_b64_tr_b16 a[202:203], v17 offset:59904
v_mfma_f32_16x16x32_bf16 v[88:91], a[252:255], a[76:79], v[88:91]
v_mfma_f32_16x16x32_bf16 v[96:99], a[248:251], a[120:123], v[96:99]
ds_read_b64_tr_b16 a[208:209], v17 offset:60416
v_mfma_f32_16x16x32_bf16 v[96:99], a[252:255], a[124:127], v[96:99]
v_mfma_f32_16x16x32_bf16 v[248:251], a[248:251], a[168:171], v[248:251]
ds_read_b64_tr_b16 a[210:211], v17 offset:60928
v_mfma_f32_16x16x32_bf16 v[248:251], a[252:255], a[172:175], v[248:251]
s_waitcnt lgkmcnt(4)
v_mfma_f32_16x16x32_bf16 v[80:83], a[192:195], a[32:35], v[80:83]
ds_read_b64_tr_b16 a[204:205], v18 offset:0
v_mfma_f32_16x16x32_bf16 v[80:83], a[196:199], a[36:39], v[80:83]
v_mfma_f32_16x16x32_bf16 v[88:91], a[192:195], a[80:83], v[88:91]
ds_read_b64_tr_b16 a[206:207], v18 offset:512
v_mfma_f32_16x16x32_bf16 v[88:91], a[196:199], a[84:87], v[88:91]
v_mfma_f32_16x16x32_bf16 v[96:99], a[192:195], a[128:131], v[96:99]
ds_read_b64_tr_b16 a[212:213], v18 offset:1024
v_mfma_f32_16x16x32_bf16 v[96:99], a[196:199], a[132:135], v[96:99]
v_mfma_f32_16x16x32_bf16 v[248:251], a[192:195], a[176:179], v[248:251]
ds_read_b64_tr_b16 a[214:215], v18 offset:1536
v_mfma_f32_16x16x32_bf16 v[248:251], a[196:199], a[180:183], v[248:251]
s_waitcnt lgkmcnt(4)
v_mfma_f32_16x16x32_bf16 v[80:83], a[200:203], a[40:43], v[80:83]
ds_read_b64_tr_b16 a[216:217], v18 offset:2048
v_mfma_f32_16x16x32_bf16 v[80:83], a[208:211], a[44:47], v[80:83]
v_mfma_f32_16x16x32_bf16 v[88:91], a[200:203], a[88:91], v[88:91]
ds_read_b64_tr_b16 a[218:219], v18 offset:2560
v_mfma_f32_16x16x32_bf16 v[88:91], a[208:211], a[92:95], v[88:91]
v_mfma_f32_16x16x32_bf16 v[96:99], a[200:203], a[136:139], v[96:99]
ds_read_b64_tr_b16 a[220:221], v18 offset:3072
v_mfma_f32_16x16x32_bf16 v[96:99], a[208:211], a[140:143], v[96:99]
v_mfma_f32_16x16x32_bf16 v[248:251], a[200:203], a[184:187], v[248:251]
ds_read_b64_tr_b16 a[222:223], v18 offset:3584
v_mfma_f32_16x16x32_bf16 v[248:251], a[208:211], a[188:191], v[248:251]
s_waitcnt lgkmcnt(4)
v_mfma_f32_16x16x32_bf16 v[252:255], a[204:207], a[0:3], 0
ds_read_b64_tr_b16 a[224:225], v18 offset:4096
v_mfma_f32_16x16x32_bf16 v[252:255], a[212:215], a[4:7], v[252:255]
v_cvt_pk_bf16_f32 v32, v80, v81
v_mfma_f32_16x16x32_bf16 v[36:39], a[204:207], a[48:51], 0
ds_read_b64_tr_b16 a[226:227], v18 offset:4608
v_mfma_f32_16x16x32_bf16 v[36:39], a[212:215], a[52:55], v[36:39]
v_cvt_pk_bf16_f32 v33, v82, v83
v_mfma_f32_16x16x32_bf16 v[104:107], a[204:207], a[96:99], 0
ds_read_b64_tr_b16 a[228:229], v18 offset:5120
v_mfma_f32_16x16x32_bf16 v[104:107], a[212:215], a[100:103], v[104:107]
v_cvt_pk_bf16_f32 v184, v88, v89
v_mfma_f32_16x16x32_bf16 v[188:191], a[204:207], a[144:147], 0
ds_read_b64_tr_b16 a[230:231], v18 offset:5632
v_cvt_pk_bf16_f32 v185, v90, v91
v_mfma_f32_16x16x32_bf16 v[188:191], a[212:215], a[148:151], v[188:191]
s_waitcnt lgkmcnt(4)
v_mfma_f32_16x16x32_bf16 v[252:255], a[216:219], a[8:11], v[252:255]
ds_read_b64_tr_b16 a[232:233], v18 offset:55296
v_mfma_f32_16x16x32_bf16 v[252:255], a[220:223], a[12:15], v[252:255]
v_cvt_pk_bf16_f32 v192, v96, v97
v_mfma_f32_16x16x32_bf16 v[36:39], a[216:219], a[56:59], v[36:39]
ds_read_b64_tr_b16 a[234:235], v18 offset:55808
v_mfma_f32_16x16x32_bf16 v[36:39], a[220:223], a[60:63], v[36:39]
v_cvt_pk_bf16_f32 v193, v98, v99
v_mfma_f32_16x16x32_bf16 v[104:107], a[216:219], a[104:107], v[104:107]
ds_read_b64_tr_b16 a[236:237], v18 offset:56320
v_mfma_f32_16x16x32_bf16 v[104:107], a[220:223], a[108:111], v[104:107]
v_cvt_pk_bf16_f32 v196, v248, v249
v_mfma_f32_16x16x32_bf16 v[188:191], a[216:219], a[152:155], v[188:191]
ds_read_b64_tr_b16 a[238:239], v18 offset:56832
v_mfma_f32_16x16x32_bf16 v[188:191], a[220:223], a[156:159], v[188:191]
s_waitcnt lgkmcnt(4)
v_mfma_f32_16x16x32_bf16 v[252:255], a[224:227], a[16:19], v[252:255]
ds_read_b64_tr_b16 a[240:241], v18 offset:57344
v_mfma_f32_16x16x32_bf16 v[252:255], a[228:231], a[20:23], v[252:255]
v_cvt_pk_bf16_f32 v197, v250, v251
v_mfma_f32_16x16x32_bf16 v[36:39], a[224:227], a[64:67], v[36:39]
ds_read_b64_tr_b16 a[242:243], v18 offset:57856
v_mfma_f32_16x16x32_bf16 v[36:39], a[228:231], a[68:71], v[36:39]
v_mfma_f32_16x16x32_bf16 v[104:107], a[224:227], a[112:115], v[104:107]
ds_read_b64_tr_b16 a[244:245], v18 offset:58368
v_mfma_f32_16x16x32_bf16 v[104:107], a[228:231], a[116:119], v[104:107]
v_mfma_f32_16x16x32_bf16 v[188:191], a[224:227], a[160:163], v[188:191]
ds_read_b64_tr_b16 a[246:247], v18 offset:58880
v_mfma_f32_16x16x32_bf16 v[188:191], a[228:231], a[164:167], v[188:191]
s_waitcnt lgkmcnt(4)
v_mfma_f32_16x16x32_bf16 v[252:255], a[232:235], a[24:27], v[252:255]
ds_read_b64_tr_b16 a[248:249], v18 offset:59392
v_mfma_f32_16x16x32_bf16 v[252:255], a[236:239], a[28:31], v[252:255]
v_mfma_f32_16x16x32_bf16 v[36:39], a[232:235], a[72:75], v[36:39]
ds_read_b64_tr_b16 a[250:251], v18 offset:59904
v_mfma_f32_16x16x32_bf16 v[36:39], a[236:239], a[76:79], v[36:39]
v_mfma_f32_16x16x32_bf16 v[104:107], a[232:235], a[120:123], v[104:107]
ds_read_b64_tr_b16 a[252:253], v18 offset:60416
v_mfma_f32_16x16x32_bf16 v[104:107], a[236:239], a[124:127], v[104:107]
v_mfma_f32_16x16x32_bf16 v[188:191], a[232:235], a[168:171], v[188:191]
ds_read_b64_tr_b16 a[254:255], v18 offset:60928
v_mfma_f32_16x16x32_bf16 v[188:191], a[236:239], a[172:175], v[188:191]
s_waitcnt lgkmcnt(4)
v_mfma_f32_16x16x32_bf16 v[252:255], a[240:243], a[32:35], v[252:255]
v_mfma_f32_16x16x32_bf16 v[252:255], a[244:247], a[36:39], v[252:255]
v_mfma_f32_16x16x32_bf16 v[36:39], a[240:243], a[80:83], v[36:39]
v_mfma_f32_16x16x32_bf16 v[36:39], a[244:247], a[84:87], v[36:39]
s_waitcnt vmcnt(0) lgkmcnt(0)
s_barrier
v_mfma_f32_16x16x32_bf16 v[104:107], a[240:243], a[128:131], v[104:107]
ds_read_b64_tr_b16 a[192:193], v17 offset:49152
v_mfma_f32_16x16x32_bf16 v[104:107], a[244:247], a[132:135], v[104:107]
ds_read_b64_tr_b16 a[194:195], v17 offset:49664
v_mfma_f32_16x16x32_bf16 v[188:191], a[240:243], a[176:179], v[188:191]
s_mov_b32 s44, -1408
v_mfma_f32_16x16x32_bf16 v[188:191], a[244:247], a[180:183], v[188:191]
ds_read_b64_tr_b16 a[196:197], v17 offset:50176
v_mfma_f32_16x16x32_bf16 v[252:255], a[248:251], a[40:43], v[252:255]
ds_read_b64_tr_b16 a[200:201], v17 offset:51200
v_mfma_f32_16x16x32_bf16 v[252:255], a[252:255], a[44:47], v[252:255]
ds_read_b64_tr_b16 a[198:199], v17 offset:50688
v_mfma_f32_16x16x32_bf16 v[36:39], a[248:251], a[88:91], v[36:39]
ds_read_b64_tr_b16 a[202:203], v17 offset:51712
v_mfma_f32_16x16x32_bf16 v[36:39], a[252:255], a[92:95], v[36:39]
v_mad_i32_i24 v8, v12, s44, v8
v_mfma_f32_16x16x32_bf16 v[104:107], a[248:251], a[136:139], v[104:107]
ds_read_b64_tr_b16 a[208:209], v17 offset:52224
v_mfma_f32_16x16x32_bf16 v[104:107], a[252:255], a[140:143], v[104:107]
s_add_u32 m0, s39, 0
v_mfma_f32_16x16x32_bf16 v[188:191], a[248:251], a[184:187], v[188:191]
ds_read_b64_tr_b16 a[210:211], v17 offset:52736
v_mfma_f32_16x16x32_bf16 v[188:191], a[252:255], a[188:191], v[188:191]
s_waitcnt lgkmcnt(3)
v_mfma_f32_16x16x32_bf16 v[200:203], a[0:3], a[192:195], 0
ds_read_b64_tr_b16 a[204:205], v17 offset:53248
v_mfma_f32_16x16x32_bf16 v[200:203], a[4:7], a[196:199], v[200:203]
s_add_u32 s42, s37, 3328
buffer_load_dwordx4 v8, s[20:23], s42 offen offset:0 lds
v_mfma_f32_16x16x32_bf16 v[204:207], a[48:51], a[192:195], 0
ds_read_b64_tr_b16 a[206:207], v17 offset:53760
s_add_u32 s43, s37, 76032
v_mfma_f32_16x16x32_bf16 v[204:207], a[52:55], a[196:199], v[204:207]
buffer_load_dwordx4 v8, s[20:23], s43 offen offset:1024 lds
s_add_u32 s42, s37, 148736
v_mfma_f32_16x16x32_bf16 v[208:211], a[96:99], a[192:195], 0
ds_read_b64_tr_b16 a[212:213], v17 offset:54272
buffer_load_dwordx4 v8, s[20:23], s42 offen offset:2048 lds
v_mfma_f32_16x16x32_bf16 v[208:211], a[100:103], a[196:199], v[208:211]
v_cvt_pk_bf16_f32 v34, v252, v253
v_cvt_pk_bf16_f32 v35, v254, v255
v_mfma_f32_16x16x32_bf16 v[212:215], a[144:147], a[192:195], 0
ds_read_b64_tr_b16 a[214:215], v17 offset:54784
s_add_u32 s43, s37, 221440
v_mfma_f32_16x16x32_bf16 v[212:215], a[148:151], a[196:199], v[212:215]
buffer_load_dwordx4 v8, s[20:23], s43 offen offset:3072 lds
s_waitcnt lgkmcnt(4)
v_mfma_f32_16x16x32_bf16 v[200:203], a[8:11], a[200:203], v[200:203]
ds_read_b64_tr_b16 a[216:217], v17 offset:6144
v_cvt_pk_bf16_f32 v186, v36, v37
v_mfma_f32_16x16x32_bf16 v[200:203], a[12:15], a[208:211], v[200:203]
v_cvt_pk_bf16_f32 v187, v38, v39
v_mfma_f32_16x16x32_bf16 v[204:207], a[56:59], a[200:203], v[204:207]
ds_read_b64_tr_b16 a[218:219], v17 offset:6656
v_mfma_f32_16x16x32_bf16 v[204:207], a[60:63], a[208:211], v[204:207]
v_cvt_pk_bf16_f32 v194, v104, v105
v_mfma_f32_16x16x32_bf16 v[208:211], a[104:107], a[200:203], v[208:211]
ds_read_b64_tr_b16 a[220:221], v17 offset:7168
v_cvt_pk_bf16_f32 v195, v106, v107
v_mfma_f32_16x16x32_bf16 v[208:211], a[108:111], a[208:211], v[208:211]
v_cvt_pk_bf16_f32 v198, v188, v189
v_mfma_f32_16x16x32_bf16 v[212:215], a[152:155], a[200:203], v[212:215]
ds_read_b64_tr_b16 a[222:223], v17 offset:7680
v_mfma_f32_16x16x32_bf16 v[212:215], a[156:159], a[208:211], v[212:215]
s_waitcnt lgkmcnt(4)
v_mfma_f32_16x16x32_bf16 v[200:203], a[16:19], a[204:207], v[200:203]
ds_read_b64_tr_b16 a[224:225], v17 offset:8192
v_mfma_f32_16x16x32_bf16 v[200:203], a[20:23], a[212:215], v[200:203]
v_cvt_pk_bf16_f32 v199, v190, v191
v_mfma_f32_16x16x32_bf16 v[204:207], a[64:67], a[204:207], v[204:207]
ds_read_b64_tr_b16 a[226:227], v17 offset:8704
v_mfma_f32_16x16x32_bf16 v[204:207], a[68:71], a[212:215], v[204:207]
s_add_u32 m0, s39, 4096
v_mfma_f32_16x16x32_bf16 v[208:211], a[112:115], a[204:207], v[208:211]
ds_read_b64_tr_b16 a[228:229], v17 offset:9216
v_mfma_f32_16x16x32_bf16 v[208:211], a[116:119], a[212:215], v[208:211]
s_add_u32 s42, s37, 298240
v_mfma_f32_16x16x32_bf16 v[212:215], a[160:163], a[204:207], v[212:215]
ds_read_b64_tr_b16 a[230:231], v17 offset:9728
v_mfma_f32_16x16x32_bf16 v[212:215], a[164:167], a[212:215], v[212:215]
buffer_load_dwordx4 v8, s[20:23], s42 offen offset:0 lds
v_mfma_f32_16x16x32_bf16 v[56:59], v[32:35], v[180:183], v[56:59]
s_add_u32 s43, s37, 370944
v_mfma_f32_16x16x32_bf16 v[60:63], v[32:35], v[240:243], v[60:63]
buffer_load_dwordx4 v8, s[20:23], s43 offen offset:1024 lds
v_mfma_f32_16x16x32_bf16 v[64:67], v[32:35], v[244:247], v[64:67]
s_add_u32 m0, s39, 55296
v_mfma_f32_16x16x32_bf16 v[68:71], v[32:35], v[52:55], v[68:71]
s_add_u32 s42, s37, 445696
v_mfma_f32_16x16x32_bf16 v[72:75], v[184:187], v[180:183], v[72:75]
buffer_load_dwordx4 v8, s[20:23], s42 offen offset:0 lds
v_mfma_f32_16x16x32_bf16 v[76:79], v[184:187], v[240:243], v[76:79]
v_mfma_f32_16x16x32_bf16 v[84:87], v[184:187], v[244:247], v[84:87]
s_add_u32 s43, s37, 518400
v_mfma_f32_16x16x32_bf16 v[92:95], v[184:187], v[52:55], v[92:95]
buffer_load_dwordx4 v8, s[20:23], s43 offen offset:1024 lds
v_mfma_f32_16x16x32_bf16 v[100:103], v[192:195], v[180:183], v[100:103]
v_mfma_f32_16x16x32_bf16 v[108:111], v[192:195], v[240:243], v[108:111]
v_mfma_f32_16x16x32_bf16 v[112:115], v[192:195], v[244:247], v[112:115]
v_mfma_f32_16x16x32_bf16 v[116:119], v[192:195], v[52:55], v[116:119]
v_mfma_f32_16x16x32_bf16 v[120:123], v[196:199], v[180:183], v[120:123]
s_add_u32 s42, s37, 591104
v_mfma_f32_16x16x32_bf16 v[128:131], v[196:199], v[240:243], v[128:131]
buffer_load_dwordx4 v8, s[20:23], s42 offen offset:2048 lds
v_mfma_f32_16x16x32_bf16 v[132:135], v[196:199], v[244:247], v[132:135]
v_mfma_f32_16x16x32_bf16 v[140:143], v[196:199], v[52:55], v[140:143]
s_waitcnt lgkmcnt(4)
v_mfma_f32_16x16x32_bf16 v[200:203], a[24:27], a[216:219], v[200:203]
ds_read_b64_tr_b16 a[232:233], v17 offset:10240
v_mfma_f32_16x16x32_bf16 v[200:203], a[28:31], a[220:223], v[200:203]
v_mfma_f32_16x16x32_bf16 v[204:207], a[72:75], a[216:219], v[204:207]
ds_read_b64_tr_b16 a[234:235], v17 offset:10752
v_mfma_f32_16x16x32_bf16 v[204:207], a[76:79], a[220:223], v[204:207]
s_add_u32 s43, s37, 663808
v_mfma_f32_16x16x32_bf16 v[208:211], a[120:123], a[216:219], v[208:211]
ds_read_b64_tr_b16 a[236:237], v17 offset:11264
v_mfma_f32_16x16x32_bf16 v[208:211], a[124:127], a[220:223], v[208:211]
buffer_load_dwordx4 v8, s[20:23], s43 offen offset:3072 lds
v_mfma_f32_16x16x32_bf16 v[212:215], a[168:171], a[216:219], v[212:215]
ds_read_b64_tr_b16 a[238:239], v17 offset:11776
v_mfma_f32_16x16x32_bf16 v[212:215], a[172:175], a[220:223], v[212:215]
s_waitcnt lgkmcnt(4)
v_mfma_f32_16x16x32_bf16 v[200:203], a[32:35], a[224:227], v[200:203]
ds_read_b64_tr_b16 a[240:241], v18 offset:49152
v_max3_f32 v31, v56, v57, v58
v_mfma_f32_16x16x32_bf16 v[200:203], a[36:39], a[228:231], v[200:203]
v_max3_f32 v31, v31, v59, v72
v_max3_f32 v31, v31, v73, v74
v_mfma_f32_16x16x32_bf16 v[204:207], a[80:83], a[224:227], v[204:207]
ds_read_b64_tr_b16 a[242:243], v18 offset:49664
s_add_u32 m0, s39, 59392
v_mfma_f32_16x16x32_bf16 v[204:207], a[84:87], a[228:231], v[204:207]
s_add_u32 s42, s37, 740608
v_mfma_f32_16x16x32_bf16 v[208:211], a[128:131], a[224:227], v[208:211]
ds_read_b64_tr_b16 a[244:245], v18 offset:50176
buffer_load_dwordx4 v8, s[20:23], s42 offen offset:0 lds
v_mfma_f32_16x16x32_bf16 v[208:211], a[132:135], a[228:231], v[208:211]
v_max_f32 v31, v31, v75
v_add_f32 v31, v31, v11
v_mfma_f32_16x16x32_bf16 v[212:215], a[176:179], a[224:227], v[212:215]
ds_read_b64_tr_b16 a[246:247], v18 offset:50688
v_max3_f32 v2, v100, v101, v102
v_mfma_f32_16x16x32_bf16 v[212:215], a[180:183], a[228:231], v[212:215]
v_max3_f32 v2, v2, v103, v120
s_waitcnt lgkmcnt(4)
v_mfma_f32_16x16x32_bf16 v[200:203], a[40:43], a[232:235], v[200:203]
ds_read_b64_tr_b16 a[248:249], v18 offset:51200
v_max3_f32 v2, v2, v121, v122
v_mfma_f32_16x16x32_bf16 v[200:203], a[44:47], a[236:239], v[200:203]
v_max_f32 v2, v2, v123
s_add_u32 s43, s37, 813312
v_mfma_f32_16x16x32_bf16 v[204:207], a[88:91], a[232:235], v[204:207]
ds_read_b64_tr_b16 a[250:251], v18 offset:51712
buffer_load_dwordx4 v8, s[20:23], s43 offen offset:1024 lds
v_mfma_f32_16x16x32_bf16 v[204:207], a[92:95], a[236:239], v[204:207]
v_add_f32 v2, v2, v23
v_max_f32 v31, v31, v2
v_mfma_f32_16x16x32_bf16 v[208:211], a[136:139], a[232:235], v[208:211]
ds_read_b64_tr_b16 a[252:253], v18 offset:52224
v_max3_f32 v16, v60, v61, v62
v_mfma_f32_16x16x32_bf16 v[208:211], a[140:143], a[236:239], v[208:211]
v_max3_f32 v16, v16, v63, v76
v_max3_f32 v16, v16, v77, v78
v_mfma_f32_16x16x32_bf16 v[212:215], a[184:187], a[232:235], v[212:215]
ds_read_b64_tr_b16 a[254:255], v18 offset:52736
v_max_f32 v16, v16, v79
v_mfma_f32_16x16x32_bf16 v[212:215], a[188:191], a[236:239], v[212:215]
v_add_f32 v16, v16, v11
s_waitcnt lgkmcnt(4)
v_mfma_f32_16x16x32_bf16 v[216:219], a[0:3], a[240:243], 0
ds_read_b64_tr_b16 a[192:193], v18 offset:53248
v_min_u32 v15, 53, v1
v_mfma_f32_16x16x32_bf16 v[216:219], a[4:7], a[244:247], v[216:219]
v_lshlrev_b32 v15, 7, v15
v_min_u32 v4, 17, v1
v_mfma_f32_16x16x32_bf16 v[220:223], a[48:51], a[240:243], 0
ds_read_b64_tr_b16 a[194:195], v18 offset:53760
v_lshlrev_b32 v4, 7, v4
v_mfma_f32_16x16x32_bf16 v[220:223], a[52:55], a[244:247], v[220:223]
s_mov_b32 m0, 163072
s_mul_i32 s42, s45, 6912
v_mfma_f32_16x16x32_bf16 v[224:227], a[96:99], a[240:243], 0
ds_read_b64_tr_b16 a[196:197], v18 offset:54272
s_add_u32 s42, s42, 3072
v_mfma_f32_16x16x32_bf16 v[224:227], a[100:103], a[244:247], v[224:227]
buffer_load_dword v15, s[20:23], s42 offen lds
s_mov_b32 m0, 163072
v_mfma_f32_16x16x32_bf16 v[228:231], a[144:147], a[240:243], 0
ds_read_b64_tr_b16 a[198:199], v18 offset:54784
s_mul_i32 s43, s45, 2304
v_mfma_f32_16x16x32_bf16 v[228:231], a[148:151], a[244:247], v[228:231]
s_add_u32 s43, s43, 3072
s_waitcnt lgkmcnt(4)
v_mfma_f32_16x16x32_bf16 v[216:219], a[8:11], a[248:251], v[216:219]
ds_read_b64_tr_b16 a[200:201], v18 offset:6144
buffer_load_dword v4, s[24:27], s43 offen lds
v_mfma_f32_16x16x32_bf16 v[216:219], a[12:15], a[252:255], v[216:219]
v_max3_f32 v5, v108, v109, v110
v_max3_f32 v5, v5, v111, v128
v_mfma_f32_16x16x32_bf16 v[220:223], a[56:59], a[248:251], v[220:223]
ds_read_b64_tr_b16 a[202:203], v18 offset:6656
v_max3_f32 v5, v5, v129, v130
v_mfma_f32_16x16x32_bf16 v[220:223], a[60:63], a[252:255], v[220:223]
v_max_f32 v5, v5, v131
v_add_f32 v5, v5, v23
v_mfma_f32_16x16x32_bf16 v[224:227], a[104:107], a[248:251], v[224:227]
ds_read_b64_tr_b16 a[208:209], v18 offset:7168
v_max_f32 v16, v16, v5
v_mfma_f32_16x16x32_bf16 v[224:227], a[108:111], a[252:255], v[224:227]
v_max3_f32 v27, v112, v113, v114
v_max3_f32 v27, v27, v115, v132
v_mfma_f32_16x16x32_bf16 v[228:231], a[152:155], a[248:251], v[228:231]
ds_read_b64_tr_b16 a[210:211], v18 offset:7680
v_max3_f32 v27, v27, v133, v134
v_mfma_f32_16x16x32_bf16 v[228:231], a[156:159], a[252:255], v[228:231]
v_max_f32 v27, v27, v135
s_waitcnt lgkmcnt(4)
v_mfma_f32_16x16x32_bf16 v[216:219], a[16:19], a[192:195], v[216:219]
ds_read_b64_tr_b16 a[204:205], v18 offset:8192
v_add_f32 v27, v27, v11
v_mfma_f32_16x16x32_bf16 v[216:219], a[20:23], a[196:199], v[216:219]
v_max3_f32 v28, v64, v65, v66
v_max3_f32 v28, v28, v67, v84
v_mfma_f32_16x16x32_bf16 v[220:223], a[64:67], a[192:195], v[220:223]
ds_read_b64_tr_b16 a[206:207], v18 offset:8704
v_max3_f32 v28, v28, v85, v86
v_mfma_f32_16x16x32_bf16 v[220:223], a[68:71], a[196:199], v[220:223]
v_max_f32 v28, v28, v87
v_cvt_pk_bf16_f32 v156, v200, v201
v_mfma_f32_16x16x32_bf16 v[224:227], a[112:115], a[192:195], v[224:227]
ds_read_b64_tr_b16 a[212:213], v18 offset:9216
v_cvt_pk_bf16_f32 v157, v202, v203
v_mfma_f32_16x16x32_bf16 v[224:227], a[116:119], a[196:199], v[224:227]
v_cvt_pk_bf16_f32 v158, v204, v205
v_cvt_pk_bf16_f32 v159, v206, v207
v_mfma_f32_16x16x32_bf16 v[228:231], a[160:163], a[192:195], v[228:231]
ds_read_b64_tr_b16 a[214:215], v18 offset:9728
v_cvt_pk_bf16_f32 v160, v208, v209
v_mfma_f32_16x16x32_bf16 v[228:231], a[164:167], a[196:199], v[228:231]
v_cvt_pk_bf16_f32 v161, v210, v211
s_waitcnt lgkmcnt(4)
v_mfma_f32_16x16x32_bf16 v[216:219], a[24:27], a[200:203], v[216:219]
ds_read_b64_tr_b16 a[216:217], v18 offset:10240
v_cvt_pk_bf16_f32 v162, v212, v213
v_mfma_f32_16x16x32_bf16 v[216:219], a[28:31], a[208:211], v[216:219]
v_cvt_pk_bf16_f32 v163, v214, v215
v_add_f32 v28, v28, v23
v_mfma_f32_16x16x32_bf16 v[220:223], a[72:75], a[200:203], v[220:223]
ds_read_b64_tr_b16 a[218:219], v18 offset:10752
v_max_f32 v27, v27, v28
v_mfma_f32_16x16x32_bf16 v[220:223], a[76:79], a[208:211], v[220:223]
v_max3_f32 v29, v116, v117, v118
v_mfma_f32_16x16x32_bf16 v[224:227], a[120:123], a[200:203], v[224:227]
ds_read_b64_tr_b16 a[220:221], v18 offset:11264
v_max3_f32 v29, v29, v119, v140
v_mfma_f32_16x16x32_bf16 v[224:227], a[124:127], a[208:211], v[224:227]
v_max3_f32 v29, v29, v141, v142
v_mfma_f32_16x16x32_bf16 v[228:231], a[168:171], a[200:203], v[228:231]
ds_read_b64_tr_b16 a[222:223], v18 offset:11776
v_max_f32 v29, v29, v143
v_mfma_f32_16x16x32_bf16 v[228:231], a[172:175], a[208:211], v[228:231]
v_add_f32 v29, v29, v11
s_waitcnt lgkmcnt(4)
v_mfma_f32_16x16x32_bf16 v[216:219], a[32:35], a[204:207], v[216:219]
ds_read_b64_tr_b16 a[224:225], v6 offset:49152
v_max3_f32 v3, v68, v69, v70
v_mfma_f32_16x16x32_bf16 v[216:219], a[36:39], a[212:215], v[216:219]
v_max3_f32 v3, v3, v71, v92
v_max3_f32 v3, v3, v93, v94
v_mfma_f32_16x16x32_bf16 v[220:223], a[80:83], a[204:207], v[220:223]
ds_read_b64_tr_b16 a[226:227], v6 offset:49664
v_max_f32 v3, v3, v95
v_mfma_f32_16x16x32_bf16 v[220:223], a[84:87], a[212:215], v[220:223]
v_add_f32 v3, v3, v23
v_max_f32 v29, v29, v3
v_mfma_f32_16x16x32_bf16 v[224:227], a[128:131], a[204:207], v[224:227]
ds_read_b64_tr_b16 a[228:229], v6 offset:50176
v_permlane32_swap_b32 v31, v16
v_mfma_f32_16x16x32_bf16 v[224:227], a[132:135], a[212:215], v[224:227]
v_max_f32 v30, v31, v16
v_permlane32_swap_b32 v27, v29
v_mfma_f32_16x16x32_bf16 v[228:231], a[176:179], a[204:207], v[228:231]
ds_read_b64_tr_b16 a[230:231], v6 offset:50688
v_max_f32 v24, v27, v29
v_mfma_f32_16x16x32_bf16 v[228:231], a[180:183], a[212:215], v[228:231]
s_waitcnt lgkmcnt(4)
v_mfma_f32_16x16x32_bf16 v[216:219], a[40:43], a[216:219], v[216:219]
ds_read_b64_tr_b16 a[232:233], v6 offset:51200
v_permlane16_swap_b32 v30, v24
v_mfma_f32_16x16x32_bf16 v[216:219], a[44:47], a[220:223], v[216:219]
v_max_f32 v25, v30, v24
v_mov_b32 v26, v25
v_mfma_f32_16x16x32_bf16 v[220:223], a[88:91], a[216:219], v[220:223]
ds_read_b64_tr_b16 a[234:235], v6 offset:51712
v_mfma_f32_16x16x32_bf16 v[220:223], a[92:95], a[220:223], v[220:223]
v_permlane16_swap_b32 v25, v26
v_mov_b32 v19, v25
v_mfma_f32_16x16x32_bf16 v[224:227], a[136:139], a[216:219], v[224:227]
ds_read_b64_tr_b16 a[236:237], v6 offset:52224
v_mov_b32 v20, v26
v_mfma_f32_16x16x32_bf16 v[224:227], a[140:143], a[220:223], v[224:227]
v_permlane32_swap_b32 v25, v19
v_mfma_f32_16x16x32_bf16 v[228:231], a[184:187], a[216:219], v[228:231]
ds_read_b64_tr_b16 a[238:239], v6 offset:52736
v_permlane32_swap_b32 v26, v20
v_mfma_f32_16x16x32_bf16 v[228:231], a[188:191], a[220:223], v[228:231]
v_fma_f32 v21, -v25, s40, v13
s_waitcnt lgkmcnt(4)
v_mfma_f32_16x16x32_bf16 v[164:167], a[224:227], a[0:3], 0
ds_read_b64_tr_b16 a[240:241], v6 offset:53248
v_fma_f32 v22, -v25, s40, v14
v_mfma_f32_16x16x32_bf16 v[164:167], a[228:231], a[4:7], v[164:167]
v_fma_f32 v2, -v19, s40, v13
v_fma_f32 v15, -v19, s40, v14
v_mfma_f32_16x16x32_bf16 v[172:175], a[224:227], a[48:51], 0
ds_read_b64_tr_b16 a[242:243], v6 offset:53760
v_fma_f32 v4, -v26, s40, v13
v_mfma_f32_16x16x32_bf16 v[172:175], a[228:231], a[52:55], v[172:175]
v_fma_f32 v5, -v26, s40, v14
v_fma_f32 v28, -v20, s40, v13
v_mfma_f32_16x16x32_bf16 v[176:179], a[224:227], a[96:99], 0
ds_read_b64_tr_b16 a[244:245], v6 offset:54272
v_fma_f32 v3, -v20, s40, v14
v_mfma_f32_16x16x32_bf16 v[176:179], a[228:231], a[100:103], v[176:179]
v_fma_f32 v56, v56, s40, v21
v_fma_f32 v57, v57, s40, v21
v_mfma_f32_16x16x32_bf16 v[48:51], a[224:227], a[144:147], 0
ds_read_b64_tr_b16 a[246:247], v6 offset:54784
v_fma_f32 v58, v58, s40, v21
v_mfma_f32_16x16x32_bf16 v[48:51], a[228:231], a[148:151], v[48:51]
v_fma_f32 v59, v59, s40, v21
s_waitcnt lgkmcnt(4)
v_mfma_f32_16x16x32_bf16 v[164:167], a[232:235], a[8:11], v[164:167]
ds_read_b64_tr_b16 a[248:249], v6 offset:6144
v_fma_f32 v72, v72, s40, v21
v_mfma_f32_16x16x32_bf16 v[164:167], a[236:239], a[12:15], v[164:167]
v_exp_f32 v56, v56
v_mfma_f32_16x16x32_bf16 v[172:175], a[232:235], a[56:59], v[172:175]
ds_read_b64_tr_b16 a[250:251], v6 offset:6656
v_fma_f32 v73, v73, s40, v21
v_mfma_f32_16x16x32_bf16 v[172:175], a[236:239], a[60:63], v[172:175]
v_exp_f32 v57, v57
v_mfma_f32_16x16x32_bf16 v[176:179], a[232:235], a[104:107], v[176:179]
ds_read_b64_tr_b16 a[252:253], v6 offset:7168
v_add_f32 v31, v56, v57
v_mfma_f32_16x16x32_bf16 v[176:179], a[236:239], a[108:111], v[176:179]
v_exp_f32 v58, v58
v_mfma_f32_16x16x32_bf16 v[48:51], a[232:235], a[152:155], v[48:51]
ds_read_b64_tr_b16 a[254:255], v6 offset:7680
v_fma_f32 v74, v74, s40, v21
v_mfma_f32_16x16x32_bf16 v[48:51], a[236:239], a[156:159], v[48:51]
v_fma_f32 v75, v75, s40, v21
s_waitcnt lgkmcnt(4)
v_mfma_f32_16x16x32_bf16 v[164:167], a[240:243], a[16:19], v[164:167]
ds_read_b64_tr_b16 a[192:193], v6 offset:8192
v_cvt_pk_bf16_f32 v232, v216, v217
v_mfma_f32_16x16x32_bf16 v[164:167], a[244:247], a[20:23], v[164:167]
v_exp_f32 v59, v59
v_mfma_f32_16x16x32_bf16 v[172:175], a[240:243], a[64:67], v[172:175]
ds_read_b64_tr_b16 a[194:195], v6 offset:8704
v_add_f32 v16, v58, v59
v_mfma_f32_16x16x32_bf16 v[172:175], a[244:247], a[68:71], v[172:175]
v_exp_f32 v72, v72
v_mfma_f32_16x16x32_bf16 v[176:179], a[240:243], a[112:115], v[176:179]
ds_read_b64_tr_b16 a[196:197], v6 offset:9216
v_cvt_pk_bf16_f32 v233, v218, v219
v_mfma_f32_16x16x32_bf16 v[176:179], a[244:247], a[116:119], v[176:179]
v_exp_f32 v73, v73
v_mfma_f32_16x16x32_bf16 v[48:51], a[240:243], a[160:163], v[48:51]
ds_read_b64_tr_b16 a[198:199], v6 offset:9728
v_cvt_pk_bf16_f32 v234, v220, v221
v_mfma_f32_16x16x32_bf16 v[48:51], a[244:247], a[164:167], v[48:51]
v_cvt_pk_bf16_f32 v235, v222, v223
s_waitcnt lgkmcnt(4)
v_mfma_f32_16x16x32_bf16 v[164:167], a[248:251], a[24:27], v[164:167]
ds_read_b64_tr_b16 a[200:201], v6 offset:10240
v_cvt_pk_bf16_f32 v236, v224, v225
v_mfma_f32_16x16x32_bf16 v[164:167], a[252:255], a[28:31], v[164:167]
v_exp_f32 v74, v74
v_mfma_f32_16x16x32_bf16 v[172:175], a[248:251], a[72:75], v[172:175]
ds_read_b64_tr_b16 a[202:203], v6 offset:10752
v_cvt_pk_bf16_f32 v237, v226, v227
v_mfma_f32_16x16x32_bf16 v[172:175], a[252:255], a[76:79], v[172:175]
v_cvt_pk_bf16_f32 v238, v228, v229
v_cvt_pk_bf16_f32 v239, v230, v231
v_mfma_f32_16x16x32_bf16 v[176:179], a[248:251], a[120:123], v[176:179]
ds_read_b64_tr_b16 a[208:209], v6 offset:11264
v_add_f32 v31, v31, v72
v_mfma_f32_16x16x32_bf16 v[176:179], a[252:255], a[124:127], v[176:179]
v_exp_f32 v75, v75
v_mfma_f32_16x16x32_bf16 v[48:51], a[248:251], a[168:171], v[48:51]
ds_read_b64_tr_b16 a[210:211], v6 offset:11776
v_add_f32 v31, v31, v73
v_mfma_f32_16x16x32_bf16 v[48:51], a[252:255], a[172:175], v[48:51]
v_add_f32 v16, v16, v74
s_waitcnt lgkmcnt(4)
v_mfma_f32_16x16x32_bf16 v[164:167], a[192:195], a[32:35], v[164:167]
ds_read_b64_tr_b16 a[204:205], v7 offset:49152
v_add_f32 v16, v16, v75
v_mfma_f32_16x16x32_bf16 v[164:167], a[196:199], a[36:39], v[164:167]
v_fma_f32 v100, v100, s40, v22
v_fma_f32 v101, v101, s40, v22
v_mfma_f32_16x16x32_bf16 v[172:175], a[192:195], a[80:83], v[172:175]
ds_read_b64_tr_b16 a[206:207], v7 offset:49664
v_fma_f32 v102, v102, s40, v22
v_mfma_f32_16x16x32_bf16 v[172:175], a[196:199], a[84:87], v[172:175]
v_exp_f32 v100, v100
v_mfma_f32_16x16x32_bf16 v[176:179], a[192:195], a[128:131], v[176:179]
ds_read_b64_tr_b16 a[212:213], v7 offset:50176
v_fma_f32 v103, v103, s40, v22
v_mfma_f32_16x16x32_bf16 v[176:179], a[196:199], a[132:135], v[176:179]
v_exp_f32 v101, v101
v_mfma_f32_16x16x32_bf16 v[48:51], a[192:195], a[176:179], v[48:51]
ds_read_b64_tr_b16 a[214:215], v7 offset:50688
v_add_f32 v31, v31, v100
v_mfma_f32_16x16x32_bf16 v[48:51], a[196:199], a[180:183], v[48:51]
v_add_f32 v31, v31, v101
s_waitcnt lgkmcnt(4)
v_mfma_f32_16x16x32_bf16 v[164:167], a[200:203], a[40:43], v[164:167]
ds_read_b64_tr_b16 a[216:217], v7 offset:51200
v_fma_f32 v120, v120, s40, v22
v_mfma_f32_16x16x32_bf16 v[164:167], a[208:211], a[44:47], v[164:167]
v_exp_f32 v102, v102
v_mfma_f32_16x16x32_bf16 v[172:175], a[200:203], a[88:91], v[172:175]
ds_read_b64_tr_b16 a[218:219], v7 offset:51712
v_add_f32 v16, v16, v102
v_mfma_f32_16x16x32_bf16 v[172:175], a[208:211], a[92:95], v[172:175]
v_exp_f32 v103, v103
v_mfma_f32_16x16x32_bf16 v[176:179], a[200:203], a[136:139], v[176:179]
ds_read_b64_tr_b16 a[220:221], v7 offset:52224
v_add_f32 v16, v16, v103
v_mfma_f32_16x16x32_bf16 v[176:179], a[208:211], a[140:143], v[176:179]
v_exp_f32 v120, v120
v_mfma_f32_16x16x32_bf16 v[48:51], a[200:203], a[184:187], v[48:51]
ds_read_b64_tr_b16 a[222:223], v7 offset:52736
v_fma_f32 v121, v121, s40, v22
v_mfma_f32_16x16x32_bf16 v[48:51], a[208:211], a[188:191], v[48:51]
v_fma_f32 v122, v122, s40, v22
s_waitcnt lgkmcnt(4)
v_mfma_f32_16x16x32_bf16 v[80:83], a[204:207], a[0:3], 0
ds_read_b64_tr_b16 a[224:225], v7 offset:53248
v_fma_f32 v123, v123, s40, v22
v_mfma_f32_16x16x32_bf16 v[80:83], a[212:215], a[4:7], v[80:83]
v_exp_f32 v121, v121
v_mfma_f32_16x16x32_bf16 v[88:91], a[204:207], a[48:51], 0
ds_read_b64_tr_b16 a[226:227], v7 offset:53760
v_add_f32 v31, v31, v120
v_mfma_f32_16x16x32_bf16 v[88:91], a[212:215], a[52:55], v[88:91]
v_exp_f32 v122, v122
v_mfma_f32_16x16x32_bf16 v[96:99], a[204:207], a[96:99], 0
ds_read_b64_tr_b16 a[228:229], v7 offset:54272
v_add_f32 v31, v31, v121
v_mfma_f32_16x16x32_bf16 v[96:99], a[212:215], a[100:103], v[96:99]
v_exp_f32 v123, v123
v_mfma_f32_16x16x32_bf16 v[248:251], a[204:207], a[144:147], 0
ds_read_b64_tr_b16 a[230:231], v7 offset:54784
v_add_f32 v16, v16, v122
v_mfma_f32_16x16x32_bf16 v[248:251], a[212:215], a[148:151], v[248:251]
v_add_f32 v16, v16, v123
s_waitcnt lgkmcnt(4)
v_mfma_f32_16x16x32_bf16 v[80:83], a[216:219], a[8:11], v[80:83]
ds_read_b64_tr_b16 a[232:233], v7 offset:6144
v_add_f32 v31, v31, v16
v_mfma_f32_16x16x32_bf16 v[80:83], a[220:223], a[12:15], v[80:83]
v_fma_f32 v60, v60, s40, v2
v_fma_f32 v61, v61, s40, v2
v_mfma_f32_16x16x32_bf16 v[88:91], a[216:219], a[56:59], v[88:91]
ds_read_b64_tr_b16 a[234:235], v7 offset:6656
v_fma_f32 v62, v62, s40, v2
v_mfma_f32_16x16x32_bf16 v[88:91], a[220:223], a[60:63], v[88:91]
v_exp_f32 v60, v60
v_mfma_f32_16x16x32_bf16 v[96:99], a[216:219], a[104:107], v[96:99]
ds_read_b64_tr_b16 a[236:237], v7 offset:7168
v_fma_f32 v63, v63, s40, v2
v_mfma_f32_16x16x32_bf16 v[96:99], a[220:223], a[108:111], v[96:99]
v_exp_f32 v61, v61
v_mfma_f32_16x16x32_bf16 v[248:251], a[216:219], a[152:155], v[248:251]
ds_read_b64_tr_b16 a[238:239], v7 offset:7680
v_add_f32 v27, v60, v61
v_mfma_f32_16x16x32_bf16 v[248:251], a[220:223], a[156:159], v[248:251]
v_fma_f32 v76, v76, s40, v2
s_waitcnt lgkmcnt(4)
v_mfma_f32_16x16x32_bf16 v[80:83], a[224:227], a[16:19], v[80:83]
ds_read_b64_tr_b16 a[240:241], v7 offset:8192
v_fma_f32 v77, v77, s40, v2
v_mfma_f32_16x16x32_bf16 v[80:83], a[228:231], a[20:23], v[80:83]
v_exp_f32 v62, v62
v_mfma_f32_16x16x32_bf16 v[88:91], a[224:227], a[64:67], v[88:91]
ds_read_b64_tr_b16 a[242:243], v7 offset:8704
v_fma_f32 v78, v78, s40, v2
v_mfma_f32_16x16x32_bf16 v[88:91], a[228:231], a[68:71], v[88:91]
v_exp_f32 v63, v63
v_mfma_f32_16x16x32_bf16 v[96:99], a[224:227], a[112:115], v[96:99]
ds_read_b64_tr_b16 a[244:245], v7 offset:9216
v_add_f32 v29, v62, v63
v_mfma_f32_16x16x32_bf16 v[96:99], a[228:231], a[116:119], v[96:99]
v_exp_f32 v76, v76
v_mfma_f32_16x16x32_bf16 v[248:251], a[224:227], a[160:163], v[248:251]
ds_read_b64_tr_b16 a[246:247], v7 offset:9728
v_fma_f32 v79, v79, s40, v2
v_mfma_f32_16x16x32_bf16 v[248:251], a[228:231], a[164:167], v[248:251]
v_add_f32 v27, v27, v76
s_waitcnt lgkmcnt(4)
v_mfma_f32_16x16x32_bf16 v[80:83], a[232:235], a[24:27], v[80:83]
ds_read_b64_tr_b16 a[248:249], v7 offset:10240
v_cvt_pk_bf16_f32 v252, v164, v165
v_mfma_f32_16x16x32_bf16 v[80:83], a[236:239], a[28:31], v[80:83]
v_exp_f32 v77, v77
v_mfma_f32_16x16x32_bf16 v[88:91], a[232:235], a[72:75], v[88:91]
ds_read_b64_tr_b16 a[250:251], v7 offset:10752
v_cvt_pk_bf16_f32 v253, v166, v167
v_mfma_f32_16x16x32_bf16 v[88:91], a[236:239], a[76:79], v[88:91]
v_exp_f32 v78, v78
v_mfma_f32_16x16x32_bf16 v[96:99], a[232:235], a[120:123], v[96:99]
ds_read_b64_tr_b16 a[252:253], v7 offset:11264
v_cvt_pk_bf16_f32 v36, v172, v173
v_mfma_f32_16x16x32_bf16 v[96:99], a[236:239], a[124:127], v[96:99]
v_exp_f32 v79, v79
v_mfma_f32_16x16x32_bf16 v[248:251], a[232:235], a[168:171], v[248:251]
ds_read_b64_tr_b16 a[254:255], v7 offset:11776
v_cvt_pk_bf16_f32 v37, v174, v175
v_mfma_f32_16x16x32_bf16 v[248:251], a[236:239], a[172:175], v[248:251]
v_cvt_pk_bf16_f32 v104, v176, v177
s_waitcnt lgkmcnt(4)
v_mfma_f32_16x16x32_bf16 v[80:83], a[240:243], a[32:35], v[80:83]
v_cvt_pk_bf16_f32 v105, v178, v179
v_cvt_pk_bf16_f32 v188, v48, v49
v_mfma_f32_16x16x32_bf16 v[80:83], a[244:247], a[36:39], v[80:83]
v_cvt_pk_bf16_f32 v189, v50, v51
v_add_f32 v27, v27, v77
v_mfma_f32_16x16x32_bf16 v[88:91], a[240:243], a[80:83], v[88:91]
v_add_f32 v29, v29, v78
v_add_f32 v29, v29, v79
v_mfma_f32_16x16x32_bf16 v[88:91], a[244:247], a[84:87], v[88:91]
s_waitcnt vmcnt(2) lgkmcnt(0)
s_barrier
v_mfma_f32_16x16x32_bf16 v[96:99], a[240:243], a[128:131], v[96:99]
ds_read_b64_tr_b16 a[192:193], v6 offset:0
v_fma_f32 v108, v108, s40, v15
v_mfma_f32_16x16x32_bf16 v[96:99], a[244:247], a[132:135], v[96:99]
ds_read_b64_tr_b16 a[194:195], v6 offset:512
v_fma_f32 v109, v109, s40, v15
v_mfma_f32_16x16x32_bf16 v[248:251], a[240:243], a[176:179], v[248:251]
v_exp_f32 v108, v108
v_mfma_f32_16x16x32_bf16 v[248:251], a[244:247], a[180:183], v[248:251]
ds_read_b64_tr_b16 a[196:197], v6 offset:1024
v_mfma_f32_16x16x32_bf16 v[80:83], a[248:251], a[40:43], v[80:83]
ds_read_b64_tr_b16 a[200:201], v6 offset:2048
v_fma_f32 v110, v110, s40, v15
v_mfma_f32_16x16x32_bf16 v[80:83], a[252:255], a[44:47], v[80:83]
ds_read_b64_tr_b16 a[198:199], v6 offset:1536
v_fma_f32 v111, v111, s40, v15
v_mfma_f32_16x16x32_bf16 v[88:91], a[248:251], a[88:91], v[88:91]
ds_read_b64_tr_b16 a[202:203], v6 offset:2560
v_add_f32 v27, v27, v108
v_mfma_f32_16x16x32_bf16 v[88:91], a[252:255], a[92:95], v[88:91]
v_exp_f32 v109, v109
v_mfma_f32_16x16x32_bf16 v[96:99], a[248:251], a[136:139], v[96:99]
ds_read_b64_tr_b16 a[208:209], v6 offset:3072
v_add_f32 v27, v27, v109
v_mfma_f32_16x16x32_bf16 v[96:99], a[252:255], a[140:143], v[96:99]
v_exp_f32 v110, v110
v_mfma_f32_16x16x32_bf16 v[248:251], a[248:251], a[184:187], v[248:251]
ds_read_b64_tr_b16 a[210:211], v6 offset:3584
v_add_f32 v29, v29, v110
v_mfma_f32_16x16x32_bf16 v[248:251], a[252:255], a[188:191], v[248:251]
v_fma_f32 v128, v128, s40, v15
s_waitcnt lgkmcnt(3)
v_mfma_f32_16x16x32_bf16 v[32:35], a[192:195], a[0:3], 0
ds_read_b64_tr_b16 a[204:205], v6 offset:4096
v_fma_f32 v129, v129, s40, v15
v_mfma_f32_16x16x32_bf16 v[32:35], a[196:199], a[4:7], v[32:35]
v_exp_f32 v111, v111
v_mfma_f32_16x16x32_bf16 v[184:187], a[192:195], a[48:51], 0
ds_read_b64_tr_b16 a[206:207], v6 offset:4608
v_add_f32 v29, v29, v111
v_mfma_f32_16x16x32_bf16 v[184:187], a[196:199], a[52:55], v[184:187]
v_exp_f32 v128, v128
v_mfma_f32_16x16x32_bf16 v[192:195], a[192:195], a[96:99], 0
ds_read_b64_tr_b16 a[212:213], v6 offset:5120
v_fma_f32 v130, v130, s40, v15
v_mfma_f32_16x16x32_bf16 v[192:195], a[196:199], a[100:103], v[192:195]
v_exp_f32 v129, v129
v_mfma_f32_16x16x32_bf16 v[180:183], a[192:195], a[144:147], 0
ds_read_b64_tr_b16 a[214:215], v6 offset:5632
v_fma_f32 v131, v131, s40, v15
v_mfma_f32_16x16x32_bf16 v[180:183], a[196:199], a[148:151], v[180:183]
v_add_f32 v27, v27, v128
s_waitcnt lgkmcnt(4)
v_mfma_f32_16x16x32_bf16 v[32:35], a[200:203], a[8:11], v[32:35]
ds_read_b64_tr_b16 a[216:217], v6 offset:55296
v_add_f32 v27, v27, v129
v_mfma_f32_16x16x32_bf16 v[32:35], a[208:211], a[12:15], v[32:35]
v_exp_f32 v130, v130
v_mfma_f32_16x16x32_bf16 v[184:187], a[200:203], a[56:59], v[184:187]
ds_read_b64_tr_b16 a[218:219], v6 offset:55808
s_add_u32 m0, s39, 49152
v_mfma_f32_16x16x32_bf16 v[184:187], a[208:211], a[60:63], v[184:187]
v_exp_f32 v131, v131
v_mfma_f32_16x16x32_bf16 v[192:195], a[200:203], a[104:107], v[192:195]
ds_read_b64_tr_b16 a[220:221], v6 offset:56320
s_add_u32 s42, s37, 4096
v_mfma_f32_16x16x32_bf16 v[192:195], a[208:211], a[108:111], v[192:195]
buffer_load_dwordx4 v8, s[20:23], s42 offen offset:0 lds
v_add_f32 v29, v29, v130
v_mfma_f32_16x16x32_bf16 v[180:183], a[200:203], a[152:155], v[180:183]
ds_read_b64_tr_b16 a[222:223], v6 offset:56832
v_add_f32 v29, v29, v131
v_mfma_f32_16x16x32_bf16 v[180:183], a[208:211], a[156:159], v[180:183]
v_add_f32 v27, v27, v29
s_waitcnt lgkmcnt(4)
v_mfma_f32_16x16x32_bf16 v[32:35], a[204:207], a[16:19], v[32:35]
ds_read_b64_tr_b16 a[224:225], v6 offset:57344
v_fma_f32 v64, v64, s40, v5
v_mfma_f32_16x16x32_bf16 v[32:35], a[212:215], a[20:23], v[32:35]
v_exp_f32 v64, v64
v_mfma_f32_16x16x32_bf16 v[184:187], a[204:207], a[64:67], v[184:187]
ds_read_b64_tr_b16 a[226:227], v6 offset:57856
v_fma_f32 v65, v65, s40, v5
v_mfma_f32_16x16x32_bf16 v[184:187], a[212:215], a[68:71], v[184:187]
v_exp_f32 v65, v65
v_mfma_f32_16x16x32_bf16 v[192:195], a[204:207], a[112:115], v[192:195]
ds_read_b64_tr_b16 a[228:229], v6 offset:58368
s_add_u32 s43, s37, 76800
v_mfma_f32_16x16x32_bf16 v[192:195], a[212:215], a[116:119], v[192:195]
buffer_load_dwordx4 v8, s[20:23], s43 offen offset:1024 lds
v_fma_f32 v66, v66, s40, v5
v_mfma_f32_16x16x32_bf16 v[180:183], a[204:207], a[160:163], v[180:183]
ds_read_b64_tr_b16 a[230:231], v6 offset:58880
v_fma_f32 v67, v67, s40, v5
v_mfma_f32_16x16x32_bf16 v[180:183], a[212:215], a[164:167], v[180:183]
v_add_f32 v30, v64, v65
s_waitcnt lgkmcnt(4)
v_mfma_f32_16x16x32_bf16 v[32:35], a[216:219], a[24:27], v[32:35]
ds_read_b64_tr_b16 a[232:233], v6 offset:59392
s_add_u32 s42, s37, 149504
v_mfma_f32_16x16x32_bf16 v[32:35], a[220:223], a[28:31], v[32:35]
v_exp_f32 v66, v66
v_mfma_f32_16x16x32_bf16 v[184:187], a[216:219], a[72:75], v[184:187]
ds_read_b64_tr_b16 a[234:235], v6 offset:59904
buffer_load_dwordx4 v8, s[20:23], s42 offen offset:2048 lds
v_mfma_f32_16x16x32_bf16 v[184:187], a[220:223], a[76:79], v[184:187]
v_exp_f32 v67, v67
v_mfma_f32_16x16x32_bf16 v[192:195], a[216:219], a[120:123], v[192:195]
ds_read_b64_tr_b16 a[236:237], v6 offset:60416
v_add_f32 v24, v66, v67
v_mfma_f32_16x16x32_bf16 v[192:195], a[220:223], a[124:127], v[192:195]
v_fma_f32 v84, v84, s40, v5
v_fma_f32 v85, v85, s40, v5
v_mfma_f32_16x16x32_bf16 v[180:183], a[216:219], a[168:171], v[180:183]
ds_read_b64_tr_b16 a[238:239], v6 offset:60928
v_fma_f32 v86, v86, s40, v5
v_mfma_f32_16x16x32_bf16 v[180:183], a[220:223], a[172:175], v[180:183]
s_add_u32 s43, s37, 222208
s_waitcnt lgkmcnt(4)
v_mfma_f32_16x16x32_bf16 v[32:35], a[224:227], a[32:35], v[32:35]
ds_read_b64_tr_b16 a[240:241], v7 offset:0
buffer_load_dwordx4 v8, s[20:23], s43 offen offset:3072 lds
v_mfma_f32_16x16x32_bf16 v[32:35], a[228:231], a[36:39], v[32:35]
v_exp_f32 v84, v84
v_mfma_f32_16x16x32_bf16 v[184:187], a[224:227], a[80:83], v[184:187]
ds_read_b64_tr_b16 a[242:243], v7 offset:512
v_fma_f32 v87, v87, s40, v5
v_mfma_f32_16x16x32_bf16 v[184:187], a[228:231], a[84:87], v[184:187]
v_exp_f32 v85, v85
v_mfma_f32_16x16x32_bf16 v[192:195], a[224:227], a[128:131], v[192:195]
ds_read_b64_tr_b16 a[244:245], v7 offset:1024
v_add_f32 v30, v30, v84
v_mfma_f32_16x16x32_bf16 v[192:195], a[228:231], a[132:135], v[192:195]
v_exp_f32 v86, v86
v_mfma_f32_16x16x32_bf16 v[180:183], a[224:227], a[176:179], v[180:183]
ds_read_b64_tr_b16 a[246:247], v7 offset:1536
v_add_f32 v30, v30, v85
v_mfma_f32_16x16x32_bf16 v[180:183], a[228:231], a[180:183], v[180:183]
v_add_f32 v24, v24, v86
s_waitcnt lgkmcnt(4)
v_mfma_f32_16x16x32_bf16 v[32:35], a[232:235], a[40:43], v[32:35]
ds_read_b64_tr_b16 a[248:249], v7 offset:2048
v_cvt_pk_bf16_f32 v254, v80, v81
v_mfma_f32_16x16x32_bf16 v[32:35], a[236:239], a[44:47], v[32:35]
v_exp_f32 v87, v87
v_mfma_f32_16x16x32_bf16 v[184:187], a[232:235], a[88:91], v[184:187]
ds_read_b64_tr_b16 a[250:251], v7 offset:2560
v_cvt_pk_bf16_f32 v255, v82, v83
v_mfma_f32_16x16x32_bf16 v[184:187], a[236:239], a[92:95], v[184:187]
v_cvt_pk_bf16_f32 v38, v88, v89
v_cvt_pk_bf16_f32 v39, v90, v91
v_mfma_f32_16x16x32_bf16 v[192:195], a[232:235], a[136:139], v[192:195]
ds_read_b64_tr_b16 a[252:253], v7 offset:3072
v_cvt_pk_bf16_f32 v106, v96, v97
v_mfma_f32_16x16x32_bf16 v[192:195], a[236:239], a[140:143], v[192:195]
v_cvt_pk_bf16_f32 v107, v98, v99
v_cvt_pk_bf16_f32 v190, v248, v249
v_mfma_f32_16x16x32_bf16 v[180:183], a[232:235], a[184:187], v[180:183]
ds_read_b64_tr_b16 a[254:255], v7 offset:3584
v_cvt_pk_bf16_f32 v191, v250, v251
v_mfma_f32_16x16x32_bf16 v[180:183], a[236:239], a[188:191], v[180:183]
v_add_f32 v24, v24, v87
s_waitcnt lgkmcnt(4)
v_mfma_f32_16x16x32_bf16 v[240:243], a[240:243], a[0:3], 0
ds_read_b64_tr_b16 a[192:193], v7 offset:4096
s_add_u32 m0, s39, 53248
v_mfma_f32_16x16x32_bf16 v[240:243], a[244:247], a[4:7], v[240:243]
s_add_u32 s42, s37, 299008
buffer_load_dwordx4 v8, s[20:23], s42 offen offset:0 lds
v_mfma_f32_16x16x32_bf16 v[244:247], a[240:243], a[48:51], 0
ds_read_b64_tr_b16 a[194:195], v7 offset:4608
v_fma_f32 v112, v112, s40, v4
v_mfma_f32_16x16x32_bf16 v[244:247], a[244:247], a[52:55], v[244:247]
v_exp_f32 v112, v112
v_mfma_f32_16x16x32_bf16 v[52:55], a[240:243], a[96:99], 0
ds_read_b64_tr_b16 a[196:197], v7 offset:5120
v_fma_f32 v113, v113, s40, v4
v_mfma_f32_16x16x32_bf16 v[52:55], a[244:247], a[100:103], v[52:55]
v_exp_f32 v113, v113
v_mfma_f32_16x16x32_bf16 v[196:199], a[240:243], a[144:147], 0
ds_read_b64_tr_b16 a[198:199], v7 offset:5632
v_fma_f32 v114, v114, s40, v4
v_mfma_f32_16x16x32_bf16 v[196:199], a[244:247], a[148:151], v[196:199]
s_add_u32 s43, s37, 371712
s_waitcnt lgkmcnt(4)
v_mfma_f32_16x16x32_bf16 v[240:243], a[248:251], a[8:11], v[240:243]
ds_read_b64_tr_b16 a[200:201], v7 offset:55296
buffer_load_dwordx4 v8, s[20:23], s43 offen offset:1024 lds
v_mfma_f32_16x16x32_bf16 v[240:243], a[252:255], a[12:15], v[240:243]
v_exp_f32 v114, v114
v_mfma_f32_16x16x32_bf16 v[244:247], a[248:251], a[56:59], v[244:247]
ds_read_b64_tr_b16 a[202:203], v7 offset:55808
v_fma_f32 v115, v115, s40, v4
v_mfma_f32_16x16x32_bf16 v[244:247], a[252:255], a[60:63], v[244:247]
v_exp_f32 v115, v115
v_mfma_f32_16x16x32_bf16 v[52:55], a[248:251], a[104:107], v[52:55]
ds_read_b64_tr_b16 a[208:209], v7 offset:56320
v_add_f32 v30, v30, v112
v_mfma_f32_16x16x32_bf16 v[52:55], a[252:255], a[108:111], v[52:55]
v_add_f32 v30, v30, v113
v_add_f32 v24, v24, v114
v_mfma_f32_16x16x32_bf16 v[196:199], a[248:251], a[152:155], v[196:199]
ds_read_b64_tr_b16 a[210:211], v7 offset:56832
v_add_f32 v24, v24, v115
v_mfma_f32_16x16x32_bf16 v[196:199], a[252:255], a[156:159], v[196:199]
s_add_u32 m0, s39, 6144
s_waitcnt lgkmcnt(4)
v_mfma_f32_16x16x32_bf16 v[240:243], a[192:195], a[16:19], v[240:243]
ds_read_b64_tr_b16 a[204:205], v7 offset:57344
s_add_u32 s42, s37, 446464
v_mfma_f32_16x16x32_bf16 v[240:243], a[196:199], a[20:23], v[240:243]
buffer_load_dwordx4 v8, s[20:23], s42 offen offset:0 lds
v_fma_f32 v132, v132, s40, v4
v_mfma_f32_16x16x32_bf16 v[244:247], a[192:195], a[64:67], v[244:247]
ds_read_b64_tr_b16 a[206:207], v7 offset:57856
v_fma_f32 v133, v133, s40, v4
v_mfma_f32_16x16x32_bf16 v[244:247], a[196:199], a[68:71], v[244:247]
v_exp_f32 v132, v132
v_mfma_f32_16x16x32_bf16 v[52:55], a[192:195], a[112:115], v[52:55]
ds_read_b64_tr_b16 a[212:213], v7 offset:58368
v_fma_f32 v134, v134, s40, v4
v_mfma_f32_16x16x32_bf16 v[52:55], a[196:199], a[116:119], v[52:55]
v_exp_f32 v133, v133
v_mfma_f32_16x16x32_bf16 v[196:199], a[192:195], a[160:163], v[196:199]
ds_read_b64_tr_b16 a[214:215], v7 offset:58880
s_add_u32 s43, s37, 519168
v_mfma_f32_16x16x32_bf16 v[196:199], a[196:199], a[164:167], v[196:199]
buffer_load_dwordx4 v8, s[20:23], s43 offen offset:1024 lds
s_waitcnt lgkmcnt(4)
v_mfma_f32_16x16x32_bf16 v[240:243], a[200:203], a[24:27], v[240:243]
ds_read_b64_tr_b16 a[216:217], v7 offset:59392
v_fma_f32 v135, v135, s40, v4
v_mfma_f32_16x16x32_bf16 v[240:243], a[208:211], a[28:31], v[240:243]
v_exp_f32 v134, v134
v_mfma_f32_16x16x32_bf16 v[244:247], a[200:203], a[72:75], v[244:247]
ds_read_b64_tr_b16 a[218:219], v7 offset:59904
v_add_f32 v30, v30, v132
v_mfma_f32_16x16x32_bf16 v[244:247], a[208:211], a[76:79], v[244:247]
v_exp_f32 v135, v135
v_mfma_f32_16x16x32_bf16 v[52:55], a[200:203], a[120:123], v[52:55]
ds_read_b64_tr_b16 a[220:221], v7 offset:60416
v_add_f32 v30, v30, v133
v_mfma_f32_16x16x32_bf16 v[52:55], a[208:211], a[124:127], v[52:55]
v_add_f32 v24, v24, v134
v_add_f32 v24, v24, v135
v_mfma_f32_16x16x32_bf16 v[196:199], a[200:203], a[168:171], v[196:199]
ds_read_b64_tr_b16 a[222:223], v7 offset:60928
v_add_f32 v30, v30, v24
v_mfma_f32_16x16x32_bf16 v[196:199], a[208:211], a[172:175], v[196:199]
s_add_u32 s42, s37, 591872
s_waitcnt lgkmcnt(4)
v_mfma_f32_16x16x32_bf16 v[240:243], a[204:207], a[32:35], v[240:243]
ds_read_b64_tr_b16 a[224:225], v17 offset:0
buffer_load_dwordx4 v8, s[20:23], s42 offen offset:2048 lds
v_mfma_f32_16x16x32_bf16 v[240:243], a[212:215], a[36:39], v[240:243]
v_fma_f32 v68, v68, s40, v3
v_fma_f32 v69, v69, s40, v3
v_mfma_f32_16x16x32_bf16 v[244:247], a[204:207], a[80:83], v[244:247]
ds_read_b64_tr_b16 a[226:227], v17 offset:512
v_fma_f32 v70, v70, s40, v3
v_mfma_f32_16x16x32_bf16 v[244:247], a[212:215], a[84:87], v[244:247]
v_exp_f32 v68, v68
v_mfma_f32_16x16x32_bf16 v[52:55], a[204:207], a[128:131], v[52:55]
ds_read_b64_tr_b16 a[228:229], v17 offset:1024
s_add_u32 s43, s37, 664576
v_mfma_f32_16x16x32_bf16 v[52:55], a[212:215], a[132:135], v[52:55]
v_exp_f32 v69, v69
v_mfma_f32_16x16x32_bf16 v[196:199], a[204:207], a[176:179], v[196:199]
ds_read_b64_tr_b16 a[230:231], v17 offset:1536
buffer_load_dwordx4 v8, s[20:23], s43 offen offset:3072 lds
v_mfma_f32_16x16x32_bf16 v[196:199], a[212:215], a[180:183], v[196:199]
v_fma_f32 v71, v71, s40, v3
s_waitcnt lgkmcnt(4)
v_mfma_f32_16x16x32_bf16 v[240:243], a[216:219], a[40:43], v[240:243]
ds_read_b64_tr_b16 a[232:233], v17 offset:2048
v_add_f32 v25, v68, v69
v_mfma_f32_16x16x32_bf16 v[240:243], a[220:223], a[44:47], v[240:243]
v_exp_f32 v70, v70
v_mfma_f32_16x16x32_bf16 v[244:247], a[216:219], a[88:91], v[244:247]
ds_read_b64_tr_b16 a[234:235], v17 offset:2560
v_fma_f32 v92, v92, s40, v3
v_mfma_f32_16x16x32_bf16 v[244:247], a[220:223], a[92:95], v[244:247]
v_exp_f32 v71, v71
v_mfma_f32_16x16x32_bf16 v[52:55], a[216:219], a[136:139], v[52:55]
ds_read_b64_tr_b16 a[236:237], v17 offset:3072
v_add_f32 v19, v70, v71
v_mfma_f32_16x16x32_bf16 v[52:55], a[220:223], a[140:143], v[52:55]
v_exp_f32 v92, v92
v_mfma_f32_16x16x32_bf16 v[196:199], a[216:219], a[184:187], v[196:199]
ds_read_b64_tr_b16 a[238:239], v17 offset:3584
s_add_u32 m0, s39, 10240
v_mfma_f32_16x16x32_bf16 v[196:199], a[220:223], a[188:191], v[196:199]
s_add_u32 s42, s37, 741376
s_waitcnt lgkmcnt(4)
v_mfma_f32_16x16x32_bf16 v[200:203], a[224:227], a[0:3], 0
ds_read_b64_tr_b16 a[240:241], v17 offset:4096
buffer_load_dwordx4 v8, s[20:23], s42 offen offset:0 lds
v_mfma_f32_16x16x32_bf16 v[200:203], a[228:231], a[4:7], v[200:203]
v_fma_f32 v93, v93, s40, v3
v_fma_f32 v94, v94, s40, v3
v_mfma_f32_16x16x32_bf16 v[204:207], a[224:227], a[48:51], 0
ds_read_b64_tr_b16 a[242:243], v17 offset:4608
v_fma_f32 v95, v95, s40, v3
v_mfma_f32_16x16x32_bf16 v[204:207], a[228:231], a[52:55], v[204:207]
v_exp_f32 v93, v93
v_mfma_f32_16x16x32_bf16 v[208:211], a[224:227], a[96:99], 0
ds_read_b64_tr_b16 a[244:245], v17 offset:5120
s_add_u32 s43, s37, 814080
v_mfma_f32_16x16x32_bf16 v[208:211], a[228:231], a[100:103], v[208:211]
v_exp_f32 v94, v94
v_mfma_f32_16x16x32_bf16 v[212:215], a[224:227], a[144:147], 0
ds_read_b64_tr_b16 a[246:247], v17 offset:5632
buffer_load_dwordx4 v8, s[20:23], s43 offen offset:1024 lds
v_mfma_f32_16x16x32_bf16 v[212:215], a[228:231], a[148:151], v[212:215]
v_add_f32 v25, v25, v92
s_waitcnt lgkmcnt(4)
v_mfma_f32_16x16x32_bf16 v[200:203], a[232:235], a[8:11], v[200:203]
ds_read_b64_tr_b16 a[248:249], v17 offset:55296
v_add_f32 v25, v25, v93
v_mfma_f32_16x16x32_bf16 v[200:203], a[236:239], a[12:15], v[200:203]
v_exp_f32 v95, v95
v_mfma_f32_16x16x32_bf16 v[204:207], a[232:235], a[56:59], v[204:207]
ds_read_b64_tr_b16 a[250:251], v17 offset:55808
v_add_f32 v19, v19, v94
v_mfma_f32_16x16x32_bf16 v[204:207], a[236:239], a[60:63], v[204:207]
v_add_f32 v19, v19, v95
v_fma_f32 v116, v116, s40, v28
v_mfma_f32_16x16x32_bf16 v[208:211], a[232:235], a[104:107], v[208:211]
ds_read_b64_tr_b16 a[252:253], v17 offset:56320
v_cvt_pk_bf16_f32 v216, v32, v33
v_mfma_f32_16x16x32_bf16 v[208:211], a[236:239], a[108:111], v[208:211]
v_cvt_pk_bf16_f32 v217, v34, v35
v_cvt_pk_bf16_f32 v220, v184, v185
v_mfma_f32_16x16x32_bf16 v[212:215], a[232:235], a[152:155], v[212:215]
ds_read_b64_tr_b16 a[254:255], v17 offset:56832
v_cvt_pk_bf16_f32 v221, v186, v187
v_mfma_f32_16x16x32_bf16 v[212:215], a[236:239], a[156:159], v[212:215]
v_cvt_pk_bf16_f32 v224, v192, v193
s_waitcnt lgkmcnt(4)
v_mfma_f32_16x16x32_bf16 v[200:203], a[240:243], a[16:19], v[200:203]
ds_read_b64_tr_b16 a[192:193], v17 offset:57344
v_cvt_pk_bf16_f32 v225, v194, v195
v_mfma_f32_16x16x32_bf16 v[200:203], a[244:247], a[20:23], v[200:203]
v_cvt_pk_bf16_f32 v228, v180, v181
v_cvt_pk_bf16_f32 v229, v182, v183
v_mfma_f32_16x16x32_bf16 v[204:207], a[240:243], a[64:67], v[204:207]
ds_read_b64_tr_b16 a[194:195], v17 offset:57856
v_fma_f32 v117, v117, s40, v28
v_mfma_f32_16x16x32_bf16 v[204:207], a[244:247], a[68:71], v[204:207]
v_exp_f32 v116, v116
v_mfma_f32_16x16x32_bf16 v[208:211], a[240:243], a[112:115], v[208:211]
ds_read_b64_tr_b16 a[196:197], v17 offset:58368
v_fma_f32 v118, v118, s40, v28
v_mfma_f32_16x16x32_bf16 v[208:211], a[244:247], a[116:119], v[208:211]
v_exp_f32 v117, v117
v_mfma_f32_16x16x32_bf16 v[212:215], a[240:243], a[160:163], v[212:215]
ds_read_b64_tr_b16 a[198:199], v17 offset:58880
v_fma_f32 v119, v119, s40, v28
v_mfma_f32_16x16x32_bf16 v[212:215], a[244:247], a[164:167], v[212:215]
v_add_f32 v25, v25, v116
s_waitcnt lgkmcnt(4)
v_mfma_f32_16x16x32_bf16 v[200:203], a[248:251], a[24:27], v[200:203]
ds_read_b64_tr_b16 a[200:201], v17 offset:59392
v_add_f32 v25, v25, v117
v_mfma_f32_16x16x32_bf16 v[200:203], a[252:255], a[28:31], v[200:203]
v_exp_f32 v118, v118
v_mfma_f32_16x16x32_bf16 v[204:207], a[248:251], a[72:75], v[204:207]
ds_read_b64_tr_b16 a[202:203], v17 offset:59904
v_add_f32 v19, v19, v118
v_mfma_f32_16x16x32_bf16 v[204:207], a[252:255], a[76:79], v[204:207]
v_exp_f32 v119, v119
v_mfma_f32_16x16x32_bf16 v[208:211], a[248:251], a[120:123], v[208:211]
ds_read_b64_tr_b16 a[208:209], v17 offset:60416
v_add_f32 v19, v19, v119
v_mfma_f32_16x16x32_bf16 v[208:211], a[252:255], a[124:127], v[208:211]
v_fma_f32 v140, v140, s40, v28
v_fma_f32 v141, v141, s40, v28
v_mfma_f32_16x16x32_bf16 v[212:215], a[248:251], a[168:171], v[212:215]
ds_read_b64_tr_b16 a[210:211], v17 offset:60928
v_fma_f32 v142, v142, s40, v28
v_mfma_f32_16x16x32_bf16 v[212:215], a[252:255], a[172:175], v[212:215]
v_fma_f32 v143, v143, s40, v28
s_waitcnt lgkmcnt(4)
v_mfma_f32_16x16x32_bf16 v[200:203], a[192:195], a[32:35], v[200:203]
ds_read_b64_tr_b16 a[204:205], v18 offset:0
v_permlane32_swap_b32 v31, v27
v_mfma_f32_16x16x32_bf16 v[200:203], a[196:199], a[36:39], v[200:203]
v_exp_f32 v140, v140
v_mfma_f32_16x16x32_bf16 v[204:207], a[192:195], a[80:83], v[204:207]
ds_read_b64_tr_b16 a[206:207], v18 offset:512
v_add_f32 v25, v25, v140
v_mfma_f32_16x16x32_bf16 v[204:207], a[196:199], a[84:87], v[204:207]
v_exp_f32 v141, v141
v_mfma_f32_16x16x32_bf16 v[208:211], a[192:195], a[128:131], v[208:211]
ds_read_b64_tr_b16 a[212:213], v18 offset:1024
v_add_f32 v25, v25, v141
v_mfma_f32_16x16x32_bf16 v[208:211], a[196:199], a[132:135], v[208:211]
v_exp_f32 v142, v142
v_mfma_f32_16x16x32_bf16 v[212:215], a[192:195], a[176:179], v[212:215]
ds_read_b64_tr_b16 a[214:215], v18 offset:1536
v_add_f32 v19, v19, v142
v_mfma_f32_16x16x32_bf16 v[212:215], a[196:199], a[180:183], v[212:215]
v_add_f32 v26, v31, v27
s_waitcnt lgkmcnt(4)
v_mfma_f32_16x16x32_bf16 v[200:203], a[200:203], a[40:43], v[200:203]
ds_read_b64_tr_b16 a[216:217], v18 offset:2048
v_cvt_pk_bf16_f32 v218, v240, v241
v_mfma_f32_16x16x32_bf16 v[200:203], a[208:211], a[44:47], v[200:203]
v_exp_f32 v143, v143
v_mfma_f32_16x16x32_bf16 v[204:207], a[200:203], a[88:91], v[204:207]
ds_read_b64_tr_b16 a[218:219], v18 offset:2560
v_add_f32 v19, v19, v143
v_mfma_f32_16x16x32_bf16 v[204:207], a[208:211], a[92:95], v[204:207]
v_add_f32 v25, v25, v19
v_cvt_pk_bf16_f32 v219, v242, v243
v_mfma_f32_16x16x32_bf16 v[208:211], a[200:203], a[136:139], v[208:211]
ds_read_b64_tr_b16 a[220:221], v18 offset:3072
v_cvt_pk_bf16_f32 v222, v244, v245
v_mfma_f32_16x16x32_bf16 v[208:211], a[208:211], a[140:143], v[208:211]
v_permlane32_swap_b32 v30, v25
v_add_f32 v20, v30, v25
v_mfma_f32_16x16x32_bf16 v[212:215], a[200:203], a[184:187], v[212:215]
ds_read_b64_tr_b16 a[222:223], v18 offset:3584
v_cvt_pk_bf16_f32 v223, v246, v247
v_mfma_f32_16x16x32_bf16 v[212:215], a[208:211], a[188:191], v[212:215]
v_permlane16_swap_b32 v26, v20
s_waitcnt lgkmcnt(4)
v_mfma_f32_16x16x32_bf16 v[164:167], a[204:207], a[0:3], 0
ds_read_b64_tr_b16 a[224:225], v18 offset:4096
v_add_f32 v21, v26, v20
v_mfma_f32_16x16x32_bf16 v[164:167], a[212:215], a[4:7], v[164:167]
v_rcp_f32 v21, v21
v_mfma_f32_16x16x32_bf16 v[172:175], a[204:207], a[48:51], 0
ds_read_b64_tr_b16 a[226:227], v18 offset:4608
v_mov_b32 v22, v21
v_mfma_f32_16x16x32_bf16 v[172:175], a[212:215], a[52:55], v[172:175]
v_cvt_pk_bf16_f32 v226, v52, v53
v_cvt_pk_bf16_f32 v227, v54, v55
v_mfma_f32_16x16x32_bf16 v[176:179], a[204:207], a[96:99], 0
ds_read_b64_tr_b16 a[228:229], v18 offset:5120
v_permlane16_swap_b32 v21, v22
v_mfma_f32_16x16x32_bf16 v[176:179], a[212:215], a[100:103], v[176:179]
v_mov_b32 v16, v21
v_mov_b32 v2, v22
v_mfma_f32_16x16x32_bf16 v[48:51], a[204:207], a[144:147], 0
ds_read_b64_tr_b16 a[230:231], v18 offset:5632
v_cvt_pk_bf16_f32 v230, v196, v197
v_mfma_f32_16x16x32_bf16 v[48:51], a[212:215], a[148:151], v[48:51]
v_permlane32_swap_b32 v21, v16
s_waitcnt lgkmcnt(4)
v_mfma_f32_16x16x32_bf16 v[164:167], a[216:219], a[8:11], v[164:167]
ds_read_b64_tr_b16 a[232:233], v18 offset:55296
v_permlane32_swap_b32 v22, v2
v_mfma_f32_16x16x32_bf16 v[164:167], a[220:223], a[12:15], v[164:167]
v_mul_f32 v56, v56, v21
v_mul_f32 v57, v57, v21
v_mfma_f32_16x16x32_bf16 v[172:175], a[216:219], a[56:59], v[172:175]
ds_read_b64_tr_b16 a[234:235], v18 offset:55808
v_mul_f32 v58, v58, v21
v_mfma_f32_16x16x32_bf16 v[172:175], a[220:223], a[60:63], v[172:175]
v_mul_f32 v59, v59, v21
v_cvt_pk_bf16_f32 v80, v56, v57
v_mfma_f32_16x16x32_bf16 v[176:179], a[216:219], a[104:107], v[176:179]
ds_read_b64_tr_b16 a[236:237], v18 offset:56320
v_cvt_pk_bf16_f32 v81, v58, v59
v_mfma_f32_16x16x32_bf16 v[176:179], a[220:223], a[108:111], v[176:179]
v_mul_f32 v72, v72, v21
v_mul_f32 v73, v73, v21
v_mfma_f32_16x16x32_bf16 v[48:51], a[216:219], a[152:155], v[48:51]
ds_read_b64_tr_b16 a[238:239], v18 offset:56832
v_mul_f32 v74, v74, v21
v_mfma_f32_16x16x32_bf16 v[48:51], a[220:223], a[156:159], v[48:51]
v_mul_f32 v75, v75, v21
s_waitcnt lgkmcnt(4)
v_mfma_f32_16x16x32_bf16 v[164:167], a[224:227], a[16:19], v[164:167]
ds_read_b64_tr_b16 a[240:241], v18 offset:57344
v_cvt_pk_bf16_f32 v82, v72, v73
v_mfma_f32_16x16x32_bf16 v[164:167], a[228:231], a[20:23], v[164:167]
v_cvt_pk_bf16_f32 v83, v74, v75
v_cvt_pk_bf16_f32 v231, v198, v199
v_mfma_f32_16x16x32_bf16 v[172:175], a[224:227], a[64:67], v[172:175]
ds_read_b64_tr_b16 a[242:243], v18 offset:57856
v_mul_f32 v100, v100, v21
v_mfma_f32_16x16x32_bf16 v[172:175], a[228:231], a[68:71], v[172:175]
v_mul_f32 v101, v101, v21
v_mul_f32 v102, v102, v21
v_mfma_f32_16x16x32_bf16 v[176:179], a[224:227], a[112:115], v[176:179]
ds_read_b64_tr_b16 a[244:245], v18 offset:58368
v_mul_f32 v103, v103, v21
v_mfma_f32_16x16x32_bf16 v[176:179], a[228:231], a[116:119], v[176:179]
v_cvt_pk_bf16_f32 v88, v100, v101
v_cvt_pk_bf16_f32 v89, v102, v103
v_mfma_f32_16x16x32_bf16 v[48:51], a[224:227], a[160:163], v[48:51]
ds_read_b64_tr_b16 a[246:247], v18 offset:58880
v_mul_f32 v120, v120, v21
v_mfma_f32_16x16x32_bf16 v[48:51], a[228:231], a[164:167], v[48:51]
v_mul_f32 v121, v121, v21
s_waitcnt lgkmcnt(4)
v_mfma_f32_16x16x32_bf16 v[164:167], a[232:235], a[24:27], v[164:167]
ds_read_b64_tr_b16 a[248:249], v18 offset:59392
v_mul_f32 v122, v122, v21
v_mfma_f32_16x16x32_bf16 v[164:167], a[236:239], a[28:31], v[164:167]
v_mul_f32 v123, v123, v21
v_cvt_pk_bf16_f32 v90, v120, v121
v_mfma_f32_16x16x32_bf16 v[172:175], a[232:235], a[72:75], v[172:175]
ds_read_b64_tr_b16 a[250:251], v18 offset:59904
v_cvt_pk_bf16_f32 v91, v122, v123
v_mfma_f32_16x16x32_bf16 v[172:175], a[236:239], a[76:79], v[172:175]
v_mul_f32 v60, v60, v16
v_mul_f32 v61, v61, v16
v_mfma_f32_16x16x32_bf16 v[176:179], a[232:235], a[120:123], v[176:179]
ds_read_b64_tr_b16 a[252:253], v18 offset:60416
v_mul_f32 v62, v62, v16
v_mfma_f32_16x16x32_bf16 v[176:179], a[236:239], a[124:127], v[176:179]
v_mul_f32 v63, v63, v16
v_cvt_pk_bf16_f32 v96, v60, v61
v_mfma_f32_16x16x32_bf16 v[48:51], a[232:235], a[168:171], v[48:51]
ds_read_b64_tr_b16 a[254:255], v18 offset:60928
v_cvt_pk_bf16_f32 v97, v62, v63
v_mfma_f32_16x16x32_bf16 v[48:51], a[236:239], a[172:175], v[48:51]
v_mul_f32 v76, v76, v16
s_waitcnt lgkmcnt(4)
v_mfma_f32_16x16x32_bf16 v[164:167], a[240:243], a[32:35], v[164:167]
v_mul_f32 v77, v77, v16
v_mul_f32 v78, v78, v16
v_mfma_f32_16x16x32_bf16 v[164:167], a[244:247], a[36:39], v[164:167]
v_mul_f32 v79, v79, v16
v_cvt_pk_bf16_f32 v98, v76, v77
v_mfma_f32_16x16x32_bf16 v[172:175], a[240:243], a[80:83], v[172:175]
v_cvt_pk_bf16_f32 v99, v78, v79
v_mul_f32 v108, v108, v16
v_mfma_f32_16x16x32_bf16 v[172:175], a[244:247], a[84:87], v[172:175]
s_waitcnt vmcnt(0) lgkmcnt(0)
s_barrier
v_mfma_f32_16x16x32_bf16 v[176:179], a[240:243], a[128:131], v[176:179]
ds_read_b64_tr_b16 a[192:193], v6 offset:49152
v_mul_f32 v109, v109, v16
v_mfma_f32_16x16x32_bf16 v[176:179], a[244:247], a[132:135], v[176:179]
ds_read_b64_tr_b16 a[194:195], v6 offset:49664
v_mul_f32 v110, v110, v16
v_mfma_f32_16x16x32_bf16 v[48:51], a[240:243], a[176:179], v[48:51]
v_mul_f32 v111, v111, v16
v_cvt_pk_bf16_f32 v248, v108, v109
v_mfma_f32_16x16x32_bf16 v[48:51], a[244:247], a[180:183], v[48:51]
ds_read_b64_tr_b16 a[196:197], v6 offset:50176
v_mfma_f32_16x16x32_bf16 v[164:167], a[248:251], a[40:43], v[164:167]
ds_read_b64_tr_b16 a[200:201], v6 offset:51200
v_cvt_pk_bf16_f32 v249, v110, v111
v_mfma_f32_16x16x32_bf16 v[164:167], a[252:255], a[44:47], v[164:167]
ds_read_b64_tr_b16 a[198:199], v6 offset:50688
v_mul_f32 v128, v128, v16
v_mfma_f32_16x16x32_bf16 v[172:175], a[248:251], a[88:91], v[172:175]
ds_read_b64_tr_b16 a[202:203], v6 offset:51712
v_mul_f32 v129, v129, v16
v_mfma_f32_16x16x32_bf16 v[172:175], a[252:255], a[92:95], v[172:175]
v_mul_f32 v130, v130, v16
v_mul_f32 v131, v131, v16
v_mfma_f32_16x16x32_bf16 v[176:179], a[248:251], a[136:139], v[176:179]
ds_read_b64_tr_b16 a[208:209], v6 offset:52224
v_cvt_pk_bf16_f32 v250, v128, v129
v_mfma_f32_16x16x32_bf16 v[176:179], a[252:255], a[140:143], v[176:179]
v_cvt_pk_bf16_f32 v251, v130, v131
v_mul_f32 v64, v64, v22
v_mfma_f32_16x16x32_bf16 v[48:51], a[248:251], a[184:187], v[48:51]
ds_read_b64_tr_b16 a[210:211], v6 offset:52736
v_mul_f32 v65, v65, v22
v_mfma_f32_16x16x32_bf16 v[48:51], a[252:255], a[188:191], v[48:51]
v_mul_f32 v66, v66, v22
s_waitcnt lgkmcnt(3)
v_mfma_f32_16x16x32_bf16 v[32:35], a[192:195], a[0:3], 0
ds_read_b64_tr_b16 a[204:205], v6 offset:53248
v_mul_f32 v67, v67, v22
v_mfma_f32_16x16x32_bf16 v[32:35], a[196:199], a[4:7], v[32:35]
v_cvt_pk_bf16_f32 v184, v64, v65
v_cvt_pk_bf16_f32 v185, v66, v67
v_mfma_f32_16x16x32_bf16 v[192:195], a[192:195], a[48:51], 0
ds_read_b64_tr_b16 a[206:207], v6 offset:53760
v_mul_f32 v84, v84, v22
v_mfma_f32_16x16x32_bf16 v[192:195], a[196:199], a[52:55], v[192:195]
v_mul_f32 v85, v85, v22
v_mul_f32 v86, v86, v22
v_mfma_f32_16x16x32_bf16 v[180:183], a[192:195], a[96:99], 0
ds_read_b64_tr_b16 a[212:213], v6 offset:54272
v_mul_f32 v87, v87, v22
v_mfma_f32_16x16x32_bf16 v[180:183], a[196:199], a[100:103], v[180:183]
v_cvt_pk_bf16_f32 v186, v84, v85
v_cvt_pk_bf16_f32 v187, v86, v87
v_mfma_f32_16x16x32_bf16 v[240:243], a[192:195], a[144:147], 0
ds_read_b64_tr_b16 a[214:215], v6 offset:54784
v_mul_f32 v112, v112, v22
v_mfma_f32_16x16x32_bf16 v[240:243], a[196:199], a[148:151], v[240:243]
v_mul_f32 v113, v113, v22
s_waitcnt lgkmcnt(4)
v_mfma_f32_16x16x32_bf16 v[32:35], a[200:203], a[8:11], v[32:35]
ds_read_b64_tr_b16 a[216:217], v6 offset:6144
v_cvt_pk_bf16_f32 v244, v200, v201
v_mfma_f32_16x16x32_bf16 v[32:35], a[208:211], a[12:15], v[32:35]
v_cvt_pk_bf16_f32 v245, v202, v203
v_cvt_pk_bf16_f32 v52, v204, v205
v_mfma_f32_16x16x32_bf16 v[192:195], a[200:203], a[56:59], v[192:195]
ds_read_b64_tr_b16 a[218:219], v6 offset:6656
v_cvt_pk_bf16_f32 v53, v206, v207
v_mfma_f32_16x16x32_bf16 v[192:195], a[208:211], a[60:63], v[192:195]
v_cvt_pk_bf16_f32 v56, v208, v209
v_cvt_pk_bf16_f32 v57, v210, v211
v_mfma_f32_16x16x32_bf16 v[180:183], a[200:203], a[104:107], v[180:183]
ds_read_b64_tr_b16 a[220:221], v6 offset:7168
v_cvt_pk_bf16_f32 v72, v212, v213
v_mfma_f32_16x16x32_bf16 v[180:183], a[208:211], a[108:111], v[180:183]
v_cvt_pk_bf16_f32 v73, v214, v215
v_mul_f32 v114, v114, v22
v_mfma_f32_16x16x32_bf16 v[240:243], a[200:203], a[152:155], v[240:243]
ds_read_b64_tr_b16 a[222:223], v6 offset:7680
v_mul_f32 v115, v115, v22
v_mfma_f32_16x16x32_bf16 v[240:243], a[208:211], a[156:159], v[240:243]
v_cvt_pk_bf16_f32 v196, v112, v113
s_waitcnt lgkmcnt(4)
v_mfma_f32_16x16x32_bf16 v[32:35], a[204:207], a[16:19], v[32:35]
ds_read_b64_tr_b16 a[224:225], v6 offset:8192
v_cvt_pk_bf16_f32 v197, v114, v115
v_mfma_f32_16x16x32_bf16 v[32:35], a[212:215], a[20:23], v[32:35]
v_mul_f32 v132, v132, v22
v_mul_f32 v133, v133, v22
v_mfma_f32_16x16x32_bf16 v[192:195], a[204:207], a[64:67], v[192:195]
ds_read_b64_tr_b16 a[226:227], v6 offset:8704
v_mul_f32 v134, v134, v22
v_mfma_f32_16x16x32_bf16 v[192:195], a[212:215], a[68:71], v[192:195]
v_mul_f32 v135, v135, v22
v_cvt_pk_bf16_f32 v198, v132, v133
v_mfma_f32_16x16x32_bf16 v[180:183], a[204:207], a[112:115], v[180:183]
ds_read_b64_tr_b16 a[228:229], v6 offset:9216
v_cvt_pk_bf16_f32 v199, v134, v135
v_mfma_f32_16x16x32_bf16 v[180:183], a[212:215], a[116:119], v[180:183]
v_mul_f32 v68, v68, v2
v_mul_f32 v69, v69, v2
v_mfma_f32_16x16x32_bf16 v[240:243], a[204:207], a[160:163], v[240:243]
ds_read_b64_tr_b16 a[230:231], v6 offset:9728
v_mul_f32 v70, v70, v2
v_mfma_f32_16x16x32_bf16 v[240:243], a[212:215], a[164:167], v[240:243]
v_mul_f32 v71, v71, v2
s_waitcnt lgkmcnt(4)
v_mfma_f32_16x16x32_bf16 v[32:35], a[216:219], a[24:27], v[32:35]
ds_read_b64_tr_b16 a[232:233], v6 offset:10240
v_cvt_pk_bf16_f32 v100, v68, v69
v_mfma_f32_16x16x32_bf16 v[32:35], a[220:223], a[28:31], v[32:35]
v_cvt_pk_bf16_f32 v101, v70, v71
v_mul_f32 v92, v92, v2
v_mfma_f32_16x16x32_bf16 v[192:195], a[216:219], a[72:75], v[192:195]
ds_read_b64_tr_b16 a[234:235], v6 offset:10752
v_mul_f32 v93, v93, v2
v_mfma_f32_16x16x32_bf16 v[192:195], a[220:223], a[76:79], v[192:195]
v_mul_f32 v94, v94, v2
v_mul_f32 v95, v95, v2
v_mfma_f32_16x16x32_bf16 v[180:183], a[216:219], a[120:123], v[180:183]
ds_read_b64_tr_b16 a[236:237], v6 offset:11264
v_cvt_pk_bf16_f32 v102, v92, v93
v_mfma_f32_16x16x32_bf16 v[180:183], a[220:223], a[124:127], v[180:183]
v_cvt_pk_bf16_f32 v103, v94, v95
v_mul_f32 v116, v116, v2
v_mfma_f32_16x16x32_bf16 v[240:243], a[216:219], a[168:171], v[240:243]
ds_read_b64_tr_b16 a[238:239], v6 offset:11776
v_mul_f32 v117, v117, v2
v_mfma_f32_16x16x32_bf16 v[240:243], a[220:223], a[172:175], v[240:243]
v_mul_f32 v118, v118, v2
s_waitcnt lgkmcnt(4)
v_mfma_f32_16x16x32_bf16 v[32:35], a[224:227], a[32:35], v[32:35]
ds_read_b64_tr_b16 a[240:241], v7 offset:49152
s_mov_b32 s44, 704
v_mfma_f32_16x16x32_bf16 v[32:35], a[228:231], a[36:39], v[32:35]
v_mad_i32_i24 v8, v12, s44, v8
s_add_u32 m0, s39, 0
v_mfma_f32_16x16x32_bf16 v[192:195], a[224:227], a[80:83], v[192:195]
ds_read_b64_tr_b16 a[242:243], v7 offset:49664
s_add_u32 s42, s37, 4032
v_mfma_f32_16x16x32_bf16 v[192:195], a[228:231], a[84:87], v[192:195]
buffer_load_dwordx4 v8, s[20:23], s42 offen offset:0 lds
v_mul_f32 v119, v119, v2
v_mfma_f32_16x16x32_bf16 v[180:183], a[224:227], a[128:131], v[180:183]
ds_read_b64_tr_b16 a[244:245], v7 offset:50176
v_cvt_pk_bf16_f32 v120, v116, v117
v_mfma_f32_16x16x32_bf16 v[180:183], a[228:231], a[132:135], v[180:183]
v_cvt_pk_bf16_f32 v121, v118, v119
v_mul_f32 v140, v140, v2
v_mfma_f32_16x16x32_bf16 v[240:243], a[224:227], a[176:179], v[240:243]
ds_read_b64_tr_b16 a[246:247], v7 offset:50688
v_mul_f32 v141, v141, v2
v_mfma_f32_16x16x32_bf16 v[240:243], a[228:231], a[180:183], v[240:243]
v_mul_f32 v142, v142, v2
s_waitcnt lgkmcnt(4)
v_mfma_f32_16x16x32_bf16 v[32:35], a[232:235], a[40:43], v[32:35]
ds_read_b64_tr_b16 a[248:249], v7 offset:51200
s_add_u32 s43, s37, 76736
v_mfma_f32_16x16x32_bf16 v[32:35], a[236:239], a[44:47], v[32:35]
buffer_load_dwordx4 v8, s[20:23], s43 offen offset:1024 lds
v_mul_f32 v143, v143, v2
v_mfma_f32_16x16x32_bf16 v[192:195], a[232:235], a[88:91], v[192:195]
ds_read_b64_tr_b16 a[250:251], v7 offset:51712
v_cvt_pk_bf16_f32 v122, v140, v141
v_mfma_f32_16x16x32_bf16 v[192:195], a[236:239], a[92:95], v[192:195]
v_cvt_pk_bf16_f32 v123, v142, v143
s_add_u32 s42, s37, 149440
v_mfma_f32_16x16x32_bf16 v[180:183], a[232:235], a[136:139], v[180:183]
ds_read_b64_tr_b16 a[252:253], v7 offset:52224
buffer_load_dwordx4 v8, s[20:23], s42 offen offset:2048 lds
v_mfma_f32_16x16x32_bf16 v[180:183], a[236:239], a[140:143], v[180:183]
s_add_u32 s43, s37, 222144
buffer_load_dwordx4 v8, s[20:23], s43 offen offset:3072 lds
v_mfma_f32_16x16x32_bf16 v[240:243], a[232:235], a[184:187], v[240:243]
ds_read_b64_tr_b16 a[254:255], v7 offset:52736
v_cvt_pk_bf16_f32 v246, v164, v165
v_mfma_f32_16x16x32_bf16 v[240:243], a[236:239], a[188:191], v[240:243]
v_cvt_pk_bf16_f32 v247, v166, v167
v_cvt_pk_bf16_f32 v54, v172, v173
v_mfma_f32_16x16x32_bf16 v[60:63], v[124:127], v[80:83], 0
v_cvt_pk_bf16_f32 v55, v174, v175
v_cvt_pk_bf16_f32 v58, v176, v177
v_mfma_f32_16x16x32_bf16 v[60:63], v[136:139], v[88:91], v[60:63]
v_cvt_pk_bf16_f32 v59, v178, v179
v_cvt_pk_bf16_f32 v74, v48, v49
v_mfma_f32_16x16x32_bf16 v[76:79], v[124:127], v[96:99], 0
v_cvt_pk_bf16_f32 v75, v50, v51
s_add_u32 m0, s39, 4096
v_mfma_f32_16x16x32_bf16 v[76:79], v[136:139], v[248:251], v[76:79]
s_add_u32 s42, s37, 298944
buffer_load_dwordx4 v8, s[20:23], s42 offen offset:0 lds
v_mfma_f32_16x16x32_bf16 v[108:111], v[124:127], v[184:187], 0
s_add_u32 s43, s37, 371648
buffer_load_dwordx4 v8, s[20:23], s43 offen offset:1024 lds
v_mfma_f32_16x16x32_bf16 v[108:111], v[136:139], v[196:199], v[108:111]
s_add_u32 m0, s39, 55296
s_add_u32 s42, s37, 446400
v_mfma_f32_16x16x32_bf16 v[128:131], v[124:127], v[100:103], 0
buffer_load_dwordx4 v8, s[20:23], s42 offen offset:0 lds
s_add_u32 s43, s37, 519104
v_mfma_f32_16x16x32_bf16 v[128:131], v[136:139], v[120:123], v[128:131]
buffer_load_dwordx4 v8, s[20:23], s43 offen offset:1024 lds
s_add_u32 s42, s37, 591808
v_mfma_f32_16x16x32_bf16 v[64:67], v[144:147], v[80:83], 0
buffer_load_dwordx4 v8, s[20:23], s42 offen offset:2048 lds
s_add_u32 s43, s37, 664512
v_mfma_f32_16x16x32_bf16 v[64:67], v[148:151], v[88:91], v[64:67]
buffer_load_dwordx4 v8, s[20:23], s43 offen offset:3072 lds
s_add_u32 m0, s39, 59392
v_mfma_f32_16x16x32_bf16 v[84:87], v[144:147], v[96:99], 0
s_add_u32 s42, s37, 741312
buffer_load_dwordx4 v8, s[20:23], s42 offen offset:0 lds
v_mfma_f32_16x16x32_bf16 v[84:87], v[148:151], v[248:251], v[84:87]
s_add_u32 s43, s37, 814016
buffer_load_dwordx4 v8, s[20:23], s43 offen offset:1024 lds
v_mfma_f32_16x16x32_bf16 v[200:203], v[144:147], v[184:187], 0
v_cvt_pk_bf16_f32 v204, v32, v33
v_cvt_pk_bf16_f32 v205, v34, v35
v_mfma_f32_16x16x32_bf16 v[200:203], v[148:151], v[196:199], v[200:203]
v_cvt_pk_bf16_f32 v208, v192, v193
v_cvt_pk_bf16_f32 v209, v194, v195
v_mfma_f32_16x16x32_bf16 v[212:215], v[144:147], v[100:103], 0
v_cvt_pk_bf16_f32 v112, v180, v181
v_cvt_pk_bf16_f32 v113, v182, v183
v_mfma_f32_16x16x32_bf16 v[212:215], v[148:151], v[120:123], v[212:215]
v_cvt_pk_bf16_f32 v132, v240, v241
v_cvt_pk_bf16_f32 v133, v242, v243
v_mfma_f32_16x16x32_bf16 v[68:71], v[152:155], v[80:83], 0
v_cvt_pk_bf16_f32 v92, v60, v61
v_cvt_pk_bf16_f32 v93, v62, v63
v_mfma_f32_16x16x32_bf16 v[68:71], v[40:43], v[88:91], v[68:71]
v_cvt_pk_bf16_f32 v94, v64, v65
v_cvt_pk_bf16_f32 v95, v66, v67
v_mfma_f32_16x16x32_bf16 v[116:119], v[152:155], v[96:99], 0
v_cvt_pk_bf16_f32 v140, v76, v77
v_cvt_pk_bf16_f32 v141, v78, v79
v_mfma_f32_16x16x32_bf16 v[116:119], v[40:43], v[248:251], v[116:119]
v_cvt_pk_bf16_f32 v164, v108, v109
v_cvt_pk_bf16_f32 v165, v110, v111
v_mfma_f32_16x16x32_bf16 v[172:175], v[152:155], v[184:187], 0
v_cvt_pk_bf16_f32 v176, v128, v129
v_cvt_pk_bf16_f32 v177, v130, v131
v_mfma_f32_16x16x32_bf16 v[172:175], v[40:43], v[196:199], v[172:175]
v_cvt_pk_bf16_f32 v142, v84, v85
v_mfma_f32_16x16x32_bf16 v[48:51], v[152:155], v[100:103], 0
v_cvt_pk_bf16_f32 v143, v86, v87
v_mfma_f32_16x16x32_bf16 v[48:51], v[40:43], v[120:123], v[48:51]
ds_write_b128 v10, v[92:95] offset:0
v_mfma_f32_16x16x32_bf16 v[124:127], v[168:171], v[80:83], 0
v_cvt_pk_bf16_f32 v166, v200, v201
v_cvt_pk_bf16_f32 v167, v202, v203
v_mfma_f32_16x16x32_bf16 v[124:127], v[44:47], v[88:91], v[124:127]
v_cvt_pk_bf16_f32 v178, v212, v213
v_mfma_f32_16x16x32_bf16 v[136:139], v[168:171], v[96:99], 0
v_cvt_pk_bf16_f32 v179, v214, v215
v_mfma_f32_16x16x32_bf16 v[136:139], v[44:47], v[248:251], v[136:139]
v_cvt_pk_bf16_f32 v32, v68, v69
v_mfma_f32_16x16x32_bf16 v[192:195], v[168:171], v[184:187], 0
v_cvt_pk_bf16_f32 v33, v70, v71
v_mfma_f32_16x16x32_bf16 v[192:195], v[44:47], v[196:199], v[192:195]
ds_read_b128 v[144:147], v9 offset:3168
v_mfma_f32_16x16x32_bf16 v[180:183], v[168:171], v[100:103], 0
v_cvt_pk_bf16_f32 v148, v116, v117
v_cvt_pk_bf16_f32 v149, v118, v119
v_mfma_f32_16x16x32_bf16 v[180:183], v[44:47], v[120:123], v[180:183]
ds_read_b128 v[240:243], v9 offset:3264
v_mfma_f32_16x16x32_bf16 v[60:63], v[156:159], v[80:83], 0
v_cvt_pk_bf16_f32 v64, v172, v173
v_cvt_pk_bf16_f32 v65, v174, v175
v_mfma_f32_16x16x32_bf16 v[60:63], v[160:163], v[88:91], v[60:63]
ds_read_b128 v[76:79], v9 offset:3360
v_mfma_f32_16x16x32_bf16 v[108:111], v[156:159], v[96:99], 0
v_cvt_pk_bf16_f32 v128, v48, v49
v_cvt_pk_bf16_f32 v129, v50, v51
v_mfma_f32_16x16x32_bf16 v[108:111], v[160:163], v[248:251], v[108:111]
ds_read_b128 v[152:155], v9 offset:3456
v_mfma_f32_16x16x32_bf16 v[84:87], v[156:159], v[184:187], 0
v_cvt_pk_bf16_f32 v34, v124, v125
v_cvt_pk_bf16_f32 v35, v126, v127
v_mfma_f32_16x16x32_bf16 v[84:87], v[160:163], v[196:199], v[84:87]
ds_read_b128 v[40:43], v9 offset:3072
ds_write_b128 v10, v[140:143] offset:1024
v_mfma_f32_16x16x32_bf16 v[92:95], v[156:159], v[100:103], 0
v_cvt_pk_bf16_f32 v150, v136, v137
v_cvt_pk_bf16_f32 v151, v138, v139
v_mfma_f32_16x16x32_bf16 v[92:95], v[160:163], v[120:123], v[92:95]
ds_read_b128 v[200:203], v9 offset:3168
v_mfma_f32_16x16x32_bf16 v[212:215], v[232:235], v[80:83], 0
v_cvt_pk_bf16_f32 v66, v192, v193
v_cvt_pk_bf16_f32 v67, v194, v195
v_mfma_f32_16x16x32_bf16 v[212:215], v[236:239], v[88:91], v[212:215]
ds_read_b128 v[68:71], v9 offset:3264
v_mfma_f32_16x16x32_bf16 v[168:171], v[232:235], v[96:99], 0
v_cvt_pk_bf16_f32 v130, v180, v181
v_cvt_pk_bf16_f32 v131, v182, v183
v_mfma_f32_16x16x32_bf16 v[168:171], v[236:239], v[248:251], v[168:171]
ds_read_b128 v[116:119], v9 offset:3360
v_mfma_f32_16x16x32_bf16 v[44:47], v[232:235], v[184:187], 0
v_cvt_pk_bf16_f32 v172, v60, v61
v_cvt_pk_bf16_f32 v173, v62, v63
v_mfma_f32_16x16x32_bf16 v[44:47], v[236:239], v[196:199], v[44:47]
ds_read_b128 v[48:51], v9 offset:2976
v_mfma_f32_16x16x32_bf16 v[124:127], v[232:235], v[100:103], 0
v_cvt_pk_bf16_f32 v140, v108, v109
v_cvt_pk_bf16_f32 v141, v110, v111
v_mfma_f32_16x16x32_bf16 v[124:127], v[236:239], v[120:123], v[124:127]
ds_read_b128 v[156:159], v9 offset:3072
s_waitcnt lgkmcnt(15)
v_mfma_f32_16x16x32_bf16 v[136:139], a[240:243], a[0:3], 0
ds_read_b64_tr_b16 a[192:193], v7 offset:53248
v_cvt_pk_bf16_f32 v160, v84, v85
v_mfma_f32_16x16x32_bf16 v[136:139], a[244:247], a[4:7], v[136:139]
ds_read_b128 v[80:83], v9 offset:3168
v_cvt_pk_bf16_f32 v161, v86, v87
v_mfma_f32_16x16x32_bf16 v[192:195], a[240:243], a[48:51], 0
ds_read_b64_tr_b16 a[194:195], v7 offset:53760
v_cvt_pk_bf16_f32 v88, v92, v93
v_mfma_f32_16x16x32_bf16 v[192:195], a[244:247], a[52:55], v[192:195]
ds_read_b128 v[96:99], v9 offset:3264
ds_write_b128 v10, v[164:167] offset:2048
v_mfma_f32_16x16x32_bf16 v[180:183], a[240:243], a[96:99], 0
ds_read_b64_tr_b16 a[196:197], v7 offset:54272
v_cvt_pk_bf16_f32 v89, v94, v95
v_mfma_f32_16x16x32_bf16 v[180:183], a[244:247], a[100:103], v[180:183]
ds_read_b128 v[248:251], v9 offset:2880
v_cvt_pk_bf16_f32 v174, v212, v213
v_mfma_f32_16x16x32_bf16 v[184:187], a[240:243], a[144:147], 0
ds_read_b64_tr_b16 a[198:199], v7 offset:54784
v_cvt_pk_bf16_f32 v175, v214, v215
v_mfma_f32_16x16x32_bf16 v[184:187], a[244:247], a[148:151], v[184:187]
ds_read_b128 v[60:63], v9 offset:2976
s_waitcnt lgkmcnt(15)
v_mfma_f32_16x16x32_bf16 v[136:139], a[248:251], a[8:11], v[136:139]
ds_read_b64_tr_b16 a[200:201], v7 offset:6144
v_cvt_pk_bf16_f32 v142, v168, v169
v_mfma_f32_16x16x32_bf16 v[136:139], a[252:255], a[12:15], v[136:139]
ds_read_b128 v[196:199], v9 offset:3072
v_cvt_pk_bf16_f32 v143, v170, v171
v_mfma_f32_16x16x32_bf16 v[192:195], a[248:251], a[56:59], v[192:195]
ds_read_b64_tr_b16 a[202:203], v7 offset:6656
v_mfma_f32_16x16x32_bf16 v[192:195], a[252:255], a[60:63], v[192:195]
ds_read_b128 v[232:235], v9 offset:3168
v_mfma_f32_16x16x32_bf16 v[180:183], a[248:251], a[104:107], v[180:183]
ds_read_b64_tr_b16 a[208:209], v7 offset:7168
v_mfma_f32_16x16x32_bf16 v[180:183], a[252:255], a[108:111], v[180:183]
v_cvt_pk_bf16_f32 v162, v44, v45
v_mfma_f32_16x16x32_bf16 v[184:187], a[248:251], a[152:155], v[184:187]
ds_read_b64_tr_b16 a[210:211], v7 offset:7680
v_mfma_f32_16x16x32_bf16 v[184:187], a[252:255], a[156:159], v[184:187]
s_waitcnt lgkmcnt(7)
v_mfma_f32_16x16x32_bf16 v[136:139], a[192:195], a[16:19], v[136:139]
ds_read_b64_tr_b16 a[204:205], v7 offset:8192
v_mfma_f32_16x16x32_bf16 v[136:139], a[196:199], a[20:23], v[136:139]
ds_write_b128 v10, v[176:179] offset:3072
v_mfma_f32_16x16x32_bf16 v[192:195], a[192:195], a[64:67], v[192:195]
ds_read_b64_tr_b16 a[206:207], v7 offset:8704
v_mfma_f32_16x16x32_bf16 v[192:195], a[196:199], a[68:71], v[192:195]
v_cvt_pk_bf16_f32 v163, v46, v47
v_mfma_f32_16x16x32_bf16 v[180:183], a[192:195], a[112:115], v[180:183]
ds_read_b64_tr_b16 a[212:213], v7 offset:9216
v_mfma_f32_16x16x32_bf16 v[180:183], a[196:199], a[116:119], v[180:183]
v_cvt_pk_bf16_f32 v90, v124, v125
v_mfma_f32_16x16x32_bf16 v[184:187], a[192:195], a[160:163], v[184:187]
ds_read_b64_tr_b16 a[214:215], v7 offset:9728
v_mfma_f32_16x16x32_bf16 v[184:187], a[196:199], a[164:167], v[184:187]
s_waitcnt lgkmcnt(5)
v_mfma_f32_16x16x32_bf16 v[136:139], a[200:203], a[24:27], v[136:139]
ds_read_b64_tr_b16 a[216:217], v7 offset:10240
v_cvt_pk_bf16_f32 v91, v126, v127
v_mfma_f32_16x16x32_bf16 v[136:139], a[208:211], a[28:31], v[136:139]
v_mfma_f32_16x16x32_bf16 v[192:195], a[200:203], a[72:75], v[192:195]
ds_read_b64_tr_b16 a[218:219], v7 offset:10752
v_mfma_f32_16x16x32_bf16 v[192:195], a[208:211], a[76:79], v[192:195]
v_mfma_f32_16x16x32_bf16 v[180:183], a[200:203], a[120:123], v[180:183]
ds_read_b64_tr_b16 a[220:221], v7 offset:11264
v_mfma_f32_16x16x32_bf16 v[180:183], a[208:211], a[124:127], v[180:183]
v_mfma_f32_16x16x32_bf16 v[184:187], a[200:203], a[168:171], v[184:187]
ds_read_b64_tr_b16 a[222:223], v7 offset:11776
v_mfma_f32_16x16x32_bf16 v[184:187], a[208:211], a[172:175], v[184:187]
s_waitcnt lgkmcnt(4)
v_mfma_f32_16x16x32_bf16 v[136:139], a[204:207], a[32:35], v[136:139]
ds_read_b64_tr_b16 a[224:225], v17 offset:49152
v_mfma_f32_16x16x32_bf16 v[136:139], a[212:215], a[36:39], v[136:139]
ds_write_b128 v10, v[32:35] offset:4096
v_mfma_f32_16x16x32_bf16 v[192:195], a[204:207], a[80:83], v[192:195]
ds_read_b64_tr_b16 a[226:227], v17 offset:49664
v_mfma_f32_16x16x32_bf16 v[192:195], a[212:215], a[84:87], v[192:195]
v_mfma_f32_16x16x32_bf16 v[180:183], a[204:207], a[128:131], v[180:183]
ds_read_b64_tr_b16 a[228:229], v17 offset:50176
v_mfma_f32_16x16x32_bf16 v[180:183], a[212:215], a[132:135], v[180:183]
v_mfma_f32_16x16x32_bf16 v[184:187], a[204:207], a[176:179], v[184:187]
ds_read_b64_tr_b16 a[230:231], v17 offset:50688
v_mfma_f32_16x16x32_bf16 v[184:187], a[212:215], a[180:183], v[184:187]
s_waitcnt lgkmcnt(5)
v_mfma_f32_16x16x32_bf16 v[136:139], a[216:219], a[40:43], v[136:139]
ds_read_b64_tr_b16 a[232:233], v17 offset:51200
v_mfma_f32_16x16x32_bf16 v[136:139], a[220:223], a[44:47], v[136:139]
v_mfma_f32_16x16x32_bf16 v[192:195], a[216:219], a[88:91], v[192:195]
ds_read_b64_tr_b16 a[234:235], v17 offset:51712
v_mfma_f32_16x16x32_bf16 v[192:195], a[220:223], a[92:95], v[192:195]
v_mfma_f32_16x16x32_bf16 v[180:183], a[216:219], a[136:139], v[180:183]
ds_read_b64_tr_b16 a[236:237], v17 offset:52224
v_mfma_f32_16x16x32_bf16 v[180:183], a[220:223], a[140:143], v[180:183]
ds_write_b128 v10, v[148:151] offset:5120
v_mfma_f32_16x16x32_bf16 v[184:187], a[216:219], a[184:187], v[184:187]
ds_read_b64_tr_b16 a[238:239], v17 offset:52736
v_mfma_f32_16x16x32_bf16 v[184:187], a[220:223], a[188:191], v[184:187]
s_waitcnt lgkmcnt(5)
v_mfma_f32_16x16x32_bf16 v[100:103], a[224:227], a[0:3], 0
ds_read_b64_tr_b16 a[240:241], v17 offset:53248
v_mfma_f32_16x16x32_bf16 v[100:103], a[228:231], a[4:7], v[100:103]
v_cvt_pk_bf16_f32 v206, v136, v137
v_mfma_f32_16x16x32_bf16 v[108:111], a[224:227], a[48:51], 0
ds_read_b64_tr_b16 a[242:243], v17 offset:53760
v_mfma_f32_16x16x32_bf16 v[108:111], a[228:231], a[52:55], v[108:111]
v_cvt_pk_bf16_f32 v207, v138, v139
v_mfma_f32_16x16x32_bf16 v[236:239], a[224:227], a[96:99], 0
ds_read_b64_tr_b16 a[244:245], v17 offset:54272
v_mfma_f32_16x16x32_bf16 v[236:239], a[228:231], a[100:103], v[236:239]
v_cvt_pk_bf16_f32 v210, v192, v193
v_mfma_f32_16x16x32_bf16 v[120:123], a[224:227], a[144:147], 0
ds_read_b64_tr_b16 a[246:247], v17 offset:54784
v_cvt_pk_bf16_f32 v211, v194, v195
v_mfma_f32_16x16x32_bf16 v[120:123], a[228:231], a[148:151], v[120:123]
s_waitcnt lgkmcnt(4)
v_mfma_f32_16x16x32_bf16 v[100:103], a[232:235], a[8:11], v[100:103]
ds_read_b64_tr_b16 a[248:249], v17 offset:6144
v_mfma_f32_16x16x32_bf16 v[100:103], a[236:239], a[12:15], v[100:103]
v_cvt_pk_bf16_f32 v114, v180, v181
v_mfma_f32_16x16x32_bf16 v[108:111], a[232:235], a[56:59], v[108:111]
ds_read_b64_tr_b16 a[250:251], v17 offset:6656
v_mfma_f32_16x16x32_bf16 v[108:111], a[236:239], a[60:63], v[108:111]
ds_write_b128 v10, v[64:67] offset:6144
v_mfma_f32_16x16x32_bf16 v[236:239], a[232:235], a[104:107], v[236:239]
ds_read_b64_tr_b16 a[252:253], v17 offset:7168
v_mfma_f32_16x16x32_bf16 v[236:239], a[236:239], a[108:111], v[236:239]
v_cvt_pk_bf16_f32 v115, v182, v183
v_mfma_f32_16x16x32_bf16 v[120:123], a[232:235], a[152:155], v[120:123]
ds_read_b64_tr_b16 a[254:255], v17 offset:7680
v_mfma_f32_16x16x32_bf16 v[120:123], a[236:239], a[156:159], v[120:123]
s_waitcnt lgkmcnt(5)
v_mfma_f32_16x16x32_bf16 v[100:103], a[240:243], a[16:19], v[100:103]
ds_read_b64_tr_b16 a[192:193], v17 offset:8192
v_mfma_f32_16x16x32_bf16 v[100:103], a[244:247], a[20:23], v[100:103]
v_cvt_pk_bf16_f32 v134, v184, v185
v_mfma_f32_16x16x32_bf16 v[108:111], a[240:243], a[64:67], v[108:111]
ds_read_b64_tr_b16 a[194:195], v17 offset:8704
v_mfma_f32_16x16x32_bf16 v[108:111], a[244:247], a[68:71], v[108:111]
v_cvt_pk_bf16_f32 v135, v186, v187
v_mfma_f32_16x16x32_bf16 v[236:239], a[240:243], a[112:115], v[236:239]
ds_read_b64_tr_b16 a[196:197], v17 offset:9216
v_mfma_f32_16x16x32_bf16 v[236:239], a[244:247], a[116:119], v[236:239]
v_mfma_f32_16x16x32_bf16 v[120:123], a[240:243], a[160:163], v[120:123]
ds_read_b64_tr_b16 a[198:199], v17 offset:9728
v_mfma_f32_16x16x32_bf16 v[120:123], a[244:247], a[164:167], v[120:123]
v_mfma_f32_16x16x32_bf16 v[144:147], v[204:207], v[216:219], v[144:147]
v_mfma_f32_16x16x32_bf16 v[240:243], v[204:207], v[220:223], v[240:243]
ds_write_b128 v10, v[128:131] offset:7168
v_mfma_f32_16x16x32_bf16 v[76:79], v[204:207], v[224:227], v[76:79]
v_mfma_f32_16x16x32_bf16 v[152:155], v[204:207], v[228:231], v[152:155]
v_mfma_f32_16x16x32_bf16 v[40:43], v[208:211], v[216:219], v[40:43]
v_mfma_f32_16x16x32_bf16 v[200:203], v[208:211], v[220:223], v[200:203]
v_mfma_f32_16x16x32_bf16 v[68:71], v[208:211], v[224:227], v[68:71]
v_mfma_f32_16x16x32_bf16 v[116:119], v[208:211], v[228:231], v[116:119]
v_mfma_f32_16x16x32_bf16 v[48:51], v[112:115], v[216:219], v[48:51]
v_mfma_f32_16x16x32_bf16 v[156:159], v[112:115], v[220:223], v[156:159]
v_mfma_f32_16x16x32_bf16 v[80:83], v[112:115], v[224:227], v[80:83]
v_mfma_f32_16x16x32_bf16 v[96:99], v[112:115], v[228:231], v[96:99]
v_mfma_f32_16x16x32_bf16 v[248:251], v[132:135], v[216:219], v[248:251]
v_mfma_f32_16x16x32_bf16 v[60:63], v[132:135], v[220:223], v[60:63]
v_mfma_f32_16x16x32_bf16 v[196:199], v[132:135], v[224:227], v[196:199]
v_mfma_f32_16x16x32_bf16 v[232:235], v[132:135], v[228:231], v[232:235]
s_waitcnt lgkmcnt(5)
v_mfma_f32_16x16x32_bf16 v[100:103], a[248:251], a[24:27], v[100:103]
ds_read_b64_tr_b16 a[200:201], v17 offset:10240
v_mfma_f32_16x16x32_bf16 v[100:103], a[252:255], a[28:31], v[100:103]
ds_write_b128 v10, v[172:175] offset:8192
v_mfma_f32_16x16x32_bf16 v[108:111], a[248:251], a[72:75], v[108:111]
ds_read_b64_tr_b16 a[202:203], v17 offset:10752
v_mfma_f32_16x16x32_bf16 v[108:111], a[252:255], a[76:79], v[108:111]
v_mfma_f32_16x16x32_bf16 v[236:239], a[248:251], a[120:123], v[236:239]
ds_read_b64_tr_b16 a[208:209], v17 offset:11264
v_mfma_f32_16x16x32_bf16 v[236:239], a[252:255], a[124:127], v[236:239]
v_mfma_f32_16x16x32_bf16 v[120:123], a[248:251], a[168:171], v[120:123]
ds_read_b64_tr_b16 a[210:211], v17 offset:11776
v_mfma_f32_16x16x32_bf16 v[120:123], a[252:255], a[172:175], v[120:123]
s_waitcnt lgkmcnt(6)
v_mfma_f32_16x16x32_bf16 v[100:103], a[192:195], a[32:35], v[100:103]
ds_read_b64_tr_b16 a[204:205], v18 offset:49152
v_mfma_f32_16x16x32_bf16 v[100:103], a[196:199], a[36:39], v[100:103]
v_mfma_f32_16x16x32_bf16 v[108:111], a[192:195], a[80:83], v[108:111]
ds_read_b64_tr_b16 a[206:207], v18 offset:49664
v_mfma_f32_16x16x32_bf16 v[108:111], a[196:199], a[84:87], v[108:111]
v_mfma_f32_16x16x32_bf16 v[236:239], a[192:195], a[128:131], v[236:239]
ds_read_b64_tr_b16 a[212:213], v18 offset:50176
v_mfma_f32_16x16x32_bf16 v[236:239], a[196:199], a[132:135], v[236:239]
ds_write_b128 v10, v[140:143] offset:9216
v_mfma_f32_16x16x32_bf16 v[120:123], a[192:195], a[176:179], v[120:123]
ds_read_b64_tr_b16 a[214:215], v18 offset:50688
v_mfma_f32_16x16x32_bf16 v[120:123], a[196:199], a[180:183], v[120:123]
s_waitcnt lgkmcnt(5)
v_mfma_f32_16x16x32_bf16 v[100:103], a[200:203], a[40:43], v[100:103]
ds_read_b64_tr_b16 a[216:217], v18 offset:51200
v_mfma_f32_16x16x32_bf16 v[100:103], a[208:211], a[44:47], v[100:103]
v_mfma_f32_16x16x32_bf16 v[108:111], a[200:203], a[88:91], v[108:111]
ds_read_b64_tr_b16 a[218:219], v18 offset:51712
v_mfma_f32_16x16x32_bf16 v[108:111], a[208:211], a[92:95], v[108:111]
v_mfma_f32_16x16x32_bf16 v[236:239], a[200:203], a[136:139], v[236:239]
ds_read_b64_tr_b16 a[220:221], v18 offset:52224
v_mfma_f32_16x16x32_bf16 v[236:239], a[208:211], a[140:143], v[236:239]
v_mfma_f32_16x16x32_bf16 v[120:123], a[200:203], a[184:187], v[120:123]
ds_read_b64_tr_b16 a[222:223], v18 offset:52736
v_mfma_f32_16x16x32_bf16 v[120:123], a[208:211], a[188:191], v[120:123]
s_waitcnt lgkmcnt(4)
v_mfma_f32_16x16x32_bf16 v[84:87], a[204:207], a[0:3], 0
ds_read_b64_tr_b16 a[224:225], v18 offset:53248
v_mfma_f32_16x16x32_bf16 v[84:87], a[212:215], a[4:7], v[84:87]
v_cvt_pk_bf16_f32 v164, v100, v101
v_mfma_f32_16x16x32_bf16 v[92:95], a[204:207], a[48:51], 0
ds_read_b64_tr_b16 a[226:227], v18 offset:53760
v_mfma_f32_16x16x32_bf16 v[92:95], a[212:215], a[52:55], v[92:95]
ds_write_b128 v10, v[160:163] offset:10240
v_mfma_f32_16x16x32_bf16 v[212:215], a[204:207], a[96:99], 0
ds_read_b64_tr_b16 a[228:229], v18 offset:54272
v_cvt_pk_bf16_f32 v165, v102, v103
v_mfma_f32_16x16x32_bf16 v[212:215], a[212:215], a[100:103], v[212:215]
v_cvt_pk_bf16_f32 v168, v108, v109
v_mfma_f32_16x16x32_bf16 v[176:179], a[204:207], a[144:147], 0
ds_read_b64_tr_b16 a[230:231], v18 offset:54784
v_cvt_pk_bf16_f32 v169, v110, v111
v_mfma_f32_16x16x32_bf16 v[176:179], a[212:215], a[148:151], v[176:179]
s_waitcnt lgkmcnt(5)
v_mfma_f32_16x16x32_bf16 v[84:87], a[216:219], a[8:11], v[84:87]
ds_read_b64_tr_b16 a[232:233], v18 offset:6144
v_mfma_f32_16x16x32_bf16 v[84:87], a[220:223], a[12:15], v[84:87]
v_cvt_pk_bf16_f32 v44, v236, v237
v_mfma_f32_16x16x32_bf16 v[92:95], a[216:219], a[56:59], v[92:95]
ds_read_b64_tr_b16 a[234:235], v18 offset:6656
v_mfma_f32_16x16x32_bf16 v[92:95], a[220:223], a[60:63], v[92:95]
v_cvt_pk_bf16_f32 v45, v238, v239
v_mfma_f32_16x16x32_bf16 v[212:215], a[216:219], a[104:107], v[212:215]
ds_read_b64_tr_b16 a[236:237], v18 offset:7168
v_mfma_f32_16x16x32_bf16 v[212:215], a[220:223], a[108:111], v[212:215]
v_cvt_pk_bf16_f32 v124, v120, v121
v_mfma_f32_16x16x32_bf16 v[176:179], a[216:219], a[152:155], v[176:179]
ds_read_b64_tr_b16 a[238:239], v18 offset:7680
v_mfma_f32_16x16x32_bf16 v[176:179], a[220:223], a[156:159], v[176:179]
s_waitcnt lgkmcnt(4)
v_mfma_f32_16x16x32_bf16 v[84:87], a[224:227], a[16:19], v[84:87]
ds_read_b64_tr_b16 a[240:241], v18 offset:8192
v_mfma_f32_16x16x32_bf16 v[84:87], a[228:231], a[20:23], v[84:87]
ds_write_b128 v10, v[88:91] offset:11264
v_mfma_f32_16x16x32_bf16 v[92:95], a[224:227], a[64:67], v[92:95]
ds_read_b64_tr_b16 a[242:243], v18 offset:8704
v_mfma_f32_16x16x32_bf16 v[92:95], a[228:231], a[68:71], v[92:95]
v_cvt_pk_bf16_f32 v125, v122, v123
v_mfma_f32_16x16x32_bf16 v[212:215], a[224:227], a[112:115], v[212:215]
ds_read_b64_tr_b16 a[244:245], v18 offset:9216
v_mfma_f32_16x16x32_bf16 v[212:215], a[228:231], a[116:119], v[212:215]
v_mfma_f32_16x16x32_bf16 v[176:179], a[224:227], a[160:163], v[176:179]
ds_read_b64_tr_b16 a[246:247], v18 offset:9728
v_mfma_f32_16x16x32_bf16 v[176:179], a[228:231], a[164:167], v[176:179]
s_waitcnt lgkmcnt(5)
v_mfma_f32_16x16x32_bf16 v[84:87], a[232:235], a[24:27], v[84:87]
ds_read_b64_tr_b16 a[248:249], v18 offset:10240
v_mfma_f32_16x16x32_bf16 v[84:87], a[236:239], a[28:31], v[84:87]
v_mfma_f32_16x16x32_bf16 v[92:95], a[232:235], a[72:75], v[92:95]
ds_read_b64_tr_b16 a[250:251], v18 offset:10752
v_mfma_f32_16x16x32_bf16 v[92:95], a[236:239], a[76:79], v[92:95]
v_mfma_f32_16x16x32_bf16 v[212:215], a[232:235], a[120:123], v[212:215]
ds_read_b64_tr_b16 a[252:253], v18 offset:11264
v_mfma_f32_16x16x32_bf16 v[212:215], a[236:239], a[124:127], v[212:215]
v_mfma_f32_16x16x32_bf16 v[176:179], a[232:235], a[168:171], v[176:179]
ds_read_b64_tr_b16 a[254:255], v18 offset:11776
v_mfma_f32_16x16x32_bf16 v[176:179], a[236:239], a[172:175], v[176:179]
s_waitcnt lgkmcnt(4)
v_mfma_f32_16x16x32_bf16 v[84:87], a[240:243], a[32:35], v[84:87]
v_mfma_f32_16x16x32_bf16 v[84:87], a[244:247], a[36:39], v[84:87]
v_mfma_f32_16x16x32_bf16 v[92:95], a[240:243], a[80:83], v[92:95]
v_mfma_f32_16x16x32_bf16 v[92:95], a[244:247], a[84:87], v[92:95]
s_waitcnt vmcnt(0) lgkmcnt(0)
s_barrier
v_mfma_f32_16x16x32_bf16 v[212:215], a[240:243], a[128:131], v[212:215]
ds_read_b64_tr_b16 a[192:193], v6 offset:0
v_mfma_f32_16x16x32_bf16 v[212:215], a[244:247], a[132:135], v[212:215]
ds_read_b64_tr_b16 a[194:195], v6 offset:512
v_mfma_f32_16x16x32_bf16 v[176:179], a[240:243], a[176:179], v[176:179]
s_mov_b32 s44, -704
v_mfma_f32_16x16x32_bf16 v[176:179], a[244:247], a[180:183], v[176:179]
ds_read_b64_tr_b16 a[196:197], v6 offset:1024
v_mfma_f32_16x16x32_bf16 v[84:87], a[248:251], a[40:43], v[84:87]
ds_read_b64_tr_b16 a[200:201], v6 offset:2048
v_mfma_f32_16x16x32_bf16 v[84:87], a[252:255], a[44:47], v[84:87]
ds_read_b64_tr_b16 a[198:199], v6 offset:1536
v_mfma_f32_16x16x32_bf16 v[92:95], a[248:251], a[88:91], v[92:95]
ds_read_b64_tr_b16 a[202:203], v6 offset:2560
v_mfma_f32_16x16x32_bf16 v[92:95], a[252:255], a[92:95], v[92:95]
v_mad_i32_i24 v8, v12, s44, v8
v_mfma_f32_16x16x32_bf16 v[212:215], a[248:251], a[136:139], v[212:215]
ds_read_b64_tr_b16 a[208:209], v6 offset:3072
v_mfma_f32_16x16x32_bf16 v[212:215], a[252:255], a[140:143], v[212:215]
s_add_u32 m0, s39, 49152
v_mfma_f32_16x16x32_bf16 v[176:179], a[248:251], a[184:187], v[176:179]
ds_read_b64_tr_b16 a[210:211], v6 offset:3584
v_mfma_f32_16x16x32_bf16 v[176:179], a[252:255], a[188:191], v[176:179]
s_waitcnt lgkmcnt(3)
v_mfma_f32_16x16x32_bf16 v[32:35], a[192:195], a[0:3], 0
ds_read_b64_tr_b16 a[204:205], v6 offset:4096
v_mfma_f32_16x16x32_bf16 v[32:35], a[196:199], a[4:7], v[32:35]
s_add_u32 s42, s37, 4864
buffer_load_dwordx4 v8, s[20:23], s42 offen offset:0 lds
v_mfma_f32_16x16x32_bf16 v[148:151], a[192:195], a[48:51], 0
ds_read_b64_tr_b16 a[206:207], v6 offset:4608
s_add_u32 s43, s37, 77568
v_mfma_f32_16x16x32_bf16 v[148:151], a[196:199], a[52:55], v[148:151]
buffer_load_dwordx4 v8, s[20:23], s43 offen offset:1024 lds
s_add_u32 s42, s37, 150272
v_mfma_f32_16x16x32_bf16 v[136:139], a[192:195], a[96:99], 0
ds_read_b64_tr_b16 a[212:213], v6 offset:5120
buffer_load_dwordx4 v8, s[20:23], s42 offen offset:2048 lds
v_mfma_f32_16x16x32_bf16 v[136:139], a[196:199], a[100:103], v[136:139]
v_cvt_pk_bf16_f32 v166, v84, v85
v_cvt_pk_bf16_f32 v167, v86, v87
v_mfma_f32_16x16x32_bf16 v[192:195], a[192:195], a[144:147], 0
ds_read_b64_tr_b16 a[214:215], v6 offset:5632
s_add_u32 s43, s37, 222976
v_mfma_f32_16x16x32_bf16 v[192:195], a[196:199], a[148:151], v[192:195]
buffer_load_dwordx4 v8, s[20:23], s43 offen offset:3072 lds
s_waitcnt lgkmcnt(4)
v_mfma_f32_16x16x32_bf16 v[32:35], a[200:203], a[8:11], v[32:35]
ds_read_b64_tr_b16 a[216:217], v6 offset:55296
v_cvt_pk_bf16_f32 v170, v92, v93
v_mfma_f32_16x16x32_bf16 v[32:35], a[208:211], a[12:15], v[32:35]
v_cvt_pk_bf16_f32 v171, v94, v95
v_mfma_f32_16x16x32_bf16 v[148:151], a[200:203], a[56:59], v[148:151]
ds_read_b64_tr_b16 a[218:219], v6 offset:55808
v_mfma_f32_16x16x32_bf16 v[148:151], a[208:211], a[60:63], v[148:151]
v_cvt_pk_bf16_f32 v46, v212, v213
v_mfma_f32_16x16x32_bf16 v[136:139], a[200:203], a[104:107], v[136:139]
ds_read_b64_tr_b16 a[220:221], v6 offset:56320
v_cvt_pk_bf16_f32 v47, v214, v215
v_mfma_f32_16x16x32_bf16 v[136:139], a[208:211], a[108:111], v[136:139]
v_cvt_pk_bf16_f32 v126, v176, v177
v_mfma_f32_16x16x32_bf16 v[192:195], a[200:203], a[152:155], v[192:195]
ds_read_b64_tr_b16 a[222:223], v6 offset:56832
v_mfma_f32_16x16x32_bf16 v[192:195], a[208:211], a[156:159], v[192:195]
s_waitcnt lgkmcnt(4)
v_mfma_f32_16x16x32_bf16 v[32:35], a[204:207], a[16:19], v[32:35]
ds_read_b64_tr_b16 a[224:225], v6 offset:57344
v_mfma_f32_16x16x32_bf16 v[32:35], a[212:215], a[20:23], v[32:35]
v_cvt_pk_bf16_f32 v127, v178, v179
v_mfma_f32_16x16x32_bf16 v[148:151], a[204:207], a[64:67], v[148:151]
ds_read_b64_tr_b16 a[226:227], v6 offset:57856
v_mfma_f32_16x16x32_bf16 v[148:151], a[212:215], a[68:71], v[148:151]
s_add_u32 m0, s39, 53248
v_mfma_f32_16x16x32_bf16 v[136:139], a[204:207], a[112:115], v[136:139]
ds_read_b64_tr_b16 a[228:229], v6 offset:58368
v_mfma_f32_16x16x32_bf16 v[136:139], a[212:215], a[116:119], v[136:139]
s_add_u32 s42, s37, 299776
v_mfma_f32_16x16x32_bf16 v[192:195], a[204:207], a[160:163], v[192:195]
ds_read_b64_tr_b16 a[230:231], v6 offset:58880
v_mfma_f32_16x16x32_bf16 v[192:195], a[212:215], a[164:167], v[192:195]
buffer_load_dwordx4 v8, s[20:23], s42 offen offset:0 lds
v_mfma_f32_16x16x32_bf16 v[144:147], v[164:167], v[244:247], v[144:147]
s_add_u32 s43, s37, 372480
v_mfma_f32_16x16x32_bf16 v[240:243], v[164:167], v[52:55], v[240:243]
buffer_load_dwordx4 v8, s[20:23], s43 offen offset:1024 lds
v_mfma_f32_16x16x32_bf16 v[76:79], v[164:167], v[56:59], v[76:79]
s_add_u32 m0, s39, 6144
v_mfma_f32_16x16x32_bf16 v[152:155], v[164:167], v[72:75], v[152:155]
s_add_u32 s42, s37, 447232
v_mfma_f32_16x16x32_bf16 v[40:43], v[168:171], v[244:247], v[40:43]
buffer_load_dwordx4 v8, s[20:23], s42 offen offset:0 lds
v_mfma_f32_16x16x32_bf16 v[200:203], v[168:171], v[52:55], v[200:203]
v_mfma_f32_16x16x32_bf16 v[68:71], v[168:171], v[56:59], v[68:71]
s_add_u32 s43, s37, 519936
v_mfma_f32_16x16x32_bf16 v[116:119], v[168:171], v[72:75], v[116:119]
buffer_load_dwordx4 v8, s[20:23], s43 offen offset:1024 lds
v_mfma_f32_16x16x32_bf16 v[48:51], v[44:47], v[244:247], v[48:51]
v_mfma_f32_16x16x32_bf16 v[156:159], v[44:47], v[52:55], v[156:159]
v_mfma_f32_16x16x32_bf16 v[80:83], v[44:47], v[56:59], v[80:83]
v_mfma_f32_16x16x32_bf16 v[96:99], v[44:47], v[72:75], v[96:99]
v_mfma_f32_16x16x32_bf16 v[248:251], v[124:127], v[244:247], v[248:251]
s_add_u32 s42, s37, 592640
v_mfma_f32_16x16x32_bf16 v[60:63], v[124:127], v[52:55], v[60:63]
buffer_load_dwordx4 v8, s[20:23], s42 offen offset:2048 lds
v_mfma_f32_16x16x32_bf16 v[196:199], v[124:127], v[56:59], v[196:199]
v_mfma_f32_16x16x32_bf16 v[232:235], v[124:127], v[72:75], v[232:235]
s_waitcnt lgkmcnt(4)
v_mfma_f32_16x16x32_bf16 v[32:35], a[216:219], a[24:27], v[32:35]
ds_read_b64_tr_b16 a[232:233], v6 offset:59392
v_mfma_f32_16x16x32_bf16 v[32:35], a[220:223], a[28:31], v[32:35]
v_mfma_f32_16x16x32_bf16 v[148:151], a[216:219], a[72:75], v[148:151]
ds_read_b64_tr_b16 a[234:235], v6 offset:59904
v_mfma_f32_16x16x32_bf16 v[148:151], a[220:223], a[76:79], v[148:151]
s_add_u32 s43, s37, 665344
v_mfma_f32_16x16x32_bf16 v[136:139], a[216:219], a[120:123], v[136:139]
ds_read_b64_tr_b16 a[236:237], v6 offset:60416
v_mfma_f32_16x16x32_bf16 v[136:139], a[220:223], a[124:127], v[136:139]
buffer_load_dwordx4 v8, s[20:23], s43 offen offset:3072 lds
v_mfma_f32_16x16x32_bf16 v[192:195], a[216:219], a[168:171], v[192:195]
ds_read_b64_tr_b16 a[238:239], v6 offset:60928
v_mfma_f32_16x16x32_bf16 v[192:195], a[220:223], a[172:175], v[192:195]
s_waitcnt lgkmcnt(4)
v_mfma_f32_16x16x32_bf16 v[32:35], a[224:227], a[32:35], v[32:35]
ds_read_b64_tr_b16 a[240:241], v7 offset:0
v_mfma_f32_16x16x32_bf16 v[32:35], a[228:231], a[36:39], v[32:35]
s_add_u32 m0, s39, 10240
v_mfma_f32_16x16x32_bf16 v[148:151], a[224:227], a[80:83], v[148:151]
ds_read_b64_tr_b16 a[242:243], v7 offset:512
v_mfma_f32_16x16x32_bf16 v[148:151], a[228:231], a[84:87], v[148:151]
s_add_u32 s42, s37, 742144
v_mfma_f32_16x16x32_bf16 v[136:139], a[224:227], a[128:131], v[136:139]
ds_read_b64_tr_b16 a[244:245], v7 offset:1024
v_mfma_f32_16x16x32_bf16 v[136:139], a[228:231], a[132:135], v[136:139]
buffer_load_dwordx4 v8, s[20:23], s42 offen offset:0 lds
v_mfma_f32_16x16x32_bf16 v[192:195], a[224:227], a[176:179], v[192:195]
ds_read_b64_tr_b16 a[246:247], v7 offset:1536
v_mfma_f32_16x16x32_bf16 v[192:195], a[228:231], a[180:183], v[192:195]
s_waitcnt lgkmcnt(4)
v_mfma_f32_16x16x32_bf16 v[32:35], a[232:235], a[40:43], v[32:35]
ds_read_b64_tr_b16 a[248:249], v7 offset:2048
v_mfma_f32_16x16x32_bf16 v[32:35], a[236:239], a[44:47], v[32:35]
s_add_u32 s43, s37, 814848
v_mfma_f32_16x16x32_bf16 v[148:151], a[232:235], a[88:91], v[148:151]
ds_read_b64_tr_b16 a[250:251], v7 offset:2560
v_mfma_f32_16x16x32_bf16 v[148:151], a[236:239], a[92:95], v[148:151]
buffer_load_dwordx4 v8, s[20:23], s43 offen offset:1024 lds
v_mfma_f32_16x16x32_bf16 v[136:139], a[232:235], a[136:139], v[136:139]
ds_read_b64_tr_b16 a[252:253], v7 offset:3072
v_mfma_f32_16x16x32_bf16 v[136:139], a[236:239], a[140:143], v[136:139]
v_mfma_f32_16x16x32_bf16 v[192:195], a[232:235], a[184:187], v[192:195]
ds_read_b64_tr_b16 a[254:255], v7 offset:3584
v_mfma_f32_16x16x32_bf16 v[192:195], a[236:239], a[188:191], v[192:195]
s_waitcnt lgkmcnt(4)
v_mfma_f32_16x16x32_bf16 v[64:67], a[240:243], a[0:3], 0
ds_read_b64_tr_b16 a[192:193], v7 offset:4096
v_mfma_f32_16x16x32_bf16 v[64:67], a[244:247], a[4:7], v[64:67]
v_cvt_pk_bf16_f32 v180, v32, v33
v_mfma_f32_16x16x32_bf16 v[184:187], a[240:243], a[48:51], 0
ds_read_b64_tr_b16 a[194:195], v7 offset:4608
v_mfma_f32_16x16x32_bf16 v[184:187], a[244:247], a[52:55], v[184:187]
v_cvt_pk_bf16_f32 v181, v34, v35
v_mfma_f32_16x16x32_bf16 v[128:131], a[240:243], a[96:99], 0
ds_read_b64_tr_b16 a[196:197], v7 offset:5120
v_mfma_f32_16x16x32_bf16 v[128:131], a[244:247], a[100:103], v[128:131]
v_cvt_pk_bf16_f32 v204, v148, v149
v_mfma_f32_16x16x32_bf16 v[208:211], a[240:243], a[144:147], 0
ds_read_b64_tr_b16 a[198:199], v7 offset:5632
v_cvt_pk_bf16_f32 v205, v150, v151
v_mfma_f32_16x16x32_bf16 v[208:211], a[244:247], a[148:151], v[208:211]
s_waitcnt lgkmcnt(4)
v_mfma_f32_16x16x32_bf16 v[64:67], a[248:251], a[8:11], v[64:67]
ds_read_b64_tr_b16 a[200:201], v7 offset:55296
v_mfma_f32_16x16x32_bf16 v[64:67], a[252:255], a[12:15], v[64:67]
v_cvt_pk_bf16_f32 v112, v136, v137
v_mfma_f32_16x16x32_bf16 v[184:187], a[248:251], a[56:59], v[184:187]
ds_read_b64_tr_b16 a[202:203], v7 offset:55808
v_mfma_f32_16x16x32_bf16 v[184:187], a[252:255], a[60:63], v[184:187]
v_cvt_pk_bf16_f32 v113, v138, v139
v_mfma_f32_16x16x32_bf16 v[128:131], a[248:251], a[104:107], v[128:131]
ds_read_b64_tr_b16 a[208:209], v7 offset:56320
v_mfma_f32_16x16x32_bf16 v[128:131], a[252:255], a[108:111], v[128:131]
v_cvt_pk_bf16_f32 v216, v192, v193
v_mfma_f32_16x16x32_bf16 v[208:211], a[248:251], a[152:155], v[208:211]
ds_read_b64_tr_b16 a[210:211], v7 offset:56832
v_mfma_f32_16x16x32_bf16 v[208:211], a[252:255], a[156:159], v[208:211]
s_waitcnt lgkmcnt(4)
v_mfma_f32_16x16x32_bf16 v[64:67], a[192:195], a[16:19], v[64:67]
ds_read_b64_tr_b16 a[204:205], v7 offset:57344
v_mfma_f32_16x16x32_bf16 v[64:67], a[196:199], a[20:23], v[64:67]
v_cvt_pk_bf16_f32 v217, v194, v195
v_mfma_f32_16x16x32_bf16 v[184:187], a[192:195], a[64:67], v[184:187]
ds_read_b64_tr_b16 a[206:207], v7 offset:57856
v_mfma_f32_16x16x32_bf16 v[184:187], a[196:199], a[68:71], v[184:187]
v_mfma_f32_16x16x32_bf16 v[128:131], a[192:195], a[112:115], v[128:131]
ds_read_b64_tr_b16 a[212:213], v7 offset:58368
v_mfma_f32_16x16x32_bf16 v[128:131], a[196:199], a[116:119], v[128:131]
v_mfma_f32_16x16x32_bf16 v[208:211], a[192:195], a[160:163], v[208:211]
ds_read_b64_tr_b16 a[214:215], v7 offset:58880
v_mfma_f32_16x16x32_bf16 v[208:211], a[196:199], a[164:167], v[208:211]
s_waitcnt lgkmcnt(4)
v_mfma_f32_16x16x32_bf16 v[64:67], a[200:203], a[24:27], v[64:67]
ds_read_b64_tr_b16 a[216:217], v7 offset:59392
v_mfma_f32_16x16x32_bf16 v[64:67], a[208:211], a[28:31], v[64:67]
v_mfma_f32_16x16x32_bf16 v[184:187], a[200:203], a[72:75], v[184:187]
ds_read_b64_tr_b16 a[218:219], v7 offset:59904
v_mfma_f32_16x16x32_bf16 v[184:187], a[208:211], a[76:79], v[184:187]
v_mfma_f32_16x16x32_bf16 v[128:131], a[200:203], a[120:123], v[128:131]
ds_read_b64_tr_b16 a[220:221], v7 offset:60416
v_mfma_f32_16x16x32_bf16 v[128:131], a[208:211], a[124:127], v[128:131]
v_mfma_f32_16x16x32_bf16 v[208:211], a[200:203], a[168:171], v[208:211]
ds_read_b64_tr_b16 a[222:223], v7 offset:60928
v_mfma_f32_16x16x32_bf16 v[208:211], a[208:211], a[172:175], v[208:211]
s_waitcnt lgkmcnt(4)
v_mfma_f32_16x16x32_bf16 v[64:67], a[204:207], a[32:35], v[64:67]
ds_read_b64_tr_b16 a[224:225], v17 offset:0
v_mfma_f32_16x16x32_bf16 v[64:67], a[212:215], a[36:39], v[64:67]
v_mfma_f32_16x16x32_bf16 v[184:187], a[204:207], a[80:83], v[184:187]
ds_read_b64_tr_b16 a[226:227], v17 offset:512
v_mfma_f32_16x16x32_bf16 v[184:187], a[212:215], a[84:87], v[184:187]
v_mfma_f32_16x16x32_bf16 v[128:131], a[204:207], a[128:131], v[128:131]
ds_read_b64_tr_b16 a[228:229], v17 offset:1024
v_mfma_f32_16x16x32_bf16 v[128:131], a[212:215], a[132:135], v[128:131]
v_mfma_f32_16x16x32_bf16 v[208:211], a[204:207], a[176:179], v[208:211]
ds_read_b64_tr_b16 a[230:231], v17 offset:1536
v_mfma_f32_16x16x32_bf16 v[208:211], a[212:215], a[180:183], v[208:211]
s_waitcnt lgkmcnt(4)
v_mfma_f32_16x16x32_bf16 v[64:67], a[216:219], a[40:43], v[64:67]
ds_read_b64_tr_b16 a[232:233], v17 offset:2048
v_mfma_f32_16x16x32_bf16 v[64:67], a[220:223], a[44:47], v[64:67]
v_mfma_f32_16x16x32_bf16 v[184:187], a[216:219], a[88:91], v[184:187]
ds_read_b64_tr_b16 a[234:235], v17 offset:2560
v_mfma_f32_16x16x32_bf16 v[184:187], a[220:223], a[92:95], v[184:187]
v_mfma_f32_16x16x32_bf16 v[128:131], a[216:219], a[136:139], v[128:131]
ds_read_b64_tr_b16 a[236:237], v17 offset:3072
v_mfma_f32_16x16x32_bf16 v[128:131], a[220:223], a[140:143], v[128:131]
v_mfma_f32_16x16x32_bf16 v[208:211], a[216:219], a[184:187], v[208:211]
ds_read_b64_tr_b16 a[238:239], v17 offset:3584
v_mfma_f32_16x16x32_bf16 v[208:211], a[220:223], a[188:191], v[208:211]
s_waitcnt lgkmcnt(4)
v_mfma_f32_16x16x32_bf16 v[220:223], a[0:3], a[224:227], 0
ds_read_b64_tr_b16 a[240:241], v17 offset:4096
v_mfma_f32_16x16x32_bf16 v[220:223], a[4:7], a[228:231], v[220:223]
v_cvt_pk_bf16_f32 v182, v64, v65
v_mfma_f32_16x16x32_bf16 v[224:227], a[48:51], a[224:227], 0
ds_read_b64_tr_b16 a[242:243], v17 offset:4608
v_mfma_f32_16x16x32_bf16 v[224:227], a[52:55], a[228:231], v[224:227]
v_cvt_pk_bf16_f32 v183, v66, v67
v_mfma_f32_16x16x32_bf16 v[228:231], a[96:99], a[224:227], 0
ds_read_b64_tr_b16 a[244:245], v17 offset:5120
v_mfma_f32_16x16x32_bf16 v[228:231], a[100:103], a[228:231], v[228:231]
v_cvt_pk_bf16_f32 v206, v184, v185
v_mfma_f32_16x16x32_bf16 v[132:135], a[144:147], a[224:227], 0
ds_read_b64_tr_b16 a[246:247], v17 offset:5632
v_cvt_pk_bf16_f32 v207, v186, v187
v_mfma_f32_16x16x32_bf16 v[132:135], a[148:151], a[228:231], v[132:135]
s_waitcnt lgkmcnt(4)
v_mfma_f32_16x16x32_bf16 v[220:223], a[8:11], a[232:235], v[220:223]
ds_read_b64_tr_b16 a[248:249], v17 offset:55296
v_mfma_f32_16x16x32_bf16 v[220:223], a[12:15], a[236:239], v[220:223]
v_cvt_pk_bf16_f32 v114, v128, v129
v_mfma_f32_16x16x32_bf16 v[224:227], a[56:59], a[232:235], v[224:227]
ds_read_b64_tr_b16 a[250:251], v17 offset:55808
v_mfma_f32_16x16x32_bf16 v[224:227], a[60:63], a[236:239], v[224:227]
v_cvt_pk_bf16_f32 v115, v130, v131
v_mfma_f32_16x16x32_bf16 v[228:231], a[104:107], a[232:235], v[228:231]
ds_read_b64_tr_b16 a[252:253], v17 offset:56320
v_mfma_f32_16x16x32_bf16 v[228:231], a[108:111], a[236:239], v[228:231]
v_cvt_pk_bf16_f32 v218, v208, v209
v_mfma_f32_16x16x32_bf16 v[132:135], a[152:155], a[232:235], v[132:135]
ds_read_b64_tr_b16 a[254:255], v17 offset:56832
v_mfma_f32_16x16x32_bf16 v[132:135], a[156:159], a[236:239], v[132:135]
s_waitcnt lgkmcnt(4)
v_mfma_f32_16x16x32_bf16 v[220:223], a[16:19], a[240:243], v[220:223]
ds_read_b64_tr_b16 a[192:193], v17 offset:57344
v_mfma_f32_16x16x32_bf16 v[220:223], a[20:23], a[244:247], v[220:223]
v_cvt_pk_bf16_f32 v219, v210, v211
v_mfma_f32_16x16x32_bf16 v[224:227], a[64:67], a[240:243], v[224:227]
ds_read_b64_tr_b16 a[194:195], v17 offset:57856
v_mfma_f32_16x16x32_bf16 v[224:227], a[68:71], a[244:247], v[224:227]
v_mfma_f32_16x16x32_bf16 v[228:231], a[112:115], a[240:243], v[228:231]
ds_read_b64_tr_b16 a[196:197], v17 offset:58368
v_mfma_f32_16x16x32_bf16 v[228:231], a[116:119], a[244:247], v[228:231]
v_mfma_f32_16x16x32_bf16 v[132:135], a[160:163], a[240:243], v[132:135]
ds_read_b64_tr_b16 a[198:199], v17 offset:58880
v_mfma_f32_16x16x32_bf16 v[132:135], a[164:167], a[244:247], v[132:135]
v_mfma_f32_16x16x32_bf16 v[144:147], v[180:183], v[252:255], v[144:147]
v_mfma_f32_16x16x32_bf16 v[240:243], v[180:183], v[36:39], v[240:243]
v_mfma_f32_16x16x32_bf16 v[76:79], v[180:183], v[104:107], v[76:79]
v_mfma_f32_16x16x32_bf16 v[152:155], v[180:183], v[188:191], v[152:155]
v_mfma_f32_16x16x32_bf16 v[40:43], v[204:207], v[252:255], v[40:43]
v_mfma_f32_16x16x32_bf16 v[200:203], v[204:207], v[36:39], v[200:203]
v_mfma_f32_16x16x32_bf16 v[68:71], v[204:207], v[104:107], v[68:71]
v_mfma_f32_16x16x32_bf16 v[116:119], v[204:207], v[188:191], v[116:119]
v_mfma_f32_16x16x32_bf16 v[48:51], v[112:115], v[252:255], v[48:51]
v_mfma_f32_16x16x32_bf16 v[156:159], v[112:115], v[36:39], v[156:159]
v_mfma_f32_16x16x32_bf16 v[80:83], v[112:115], v[104:107], v[80:83]
v_mfma_f32_16x16x32_bf16 v[96:99], v[112:115], v[188:191], v[96:99]
v_mfma_f32_16x16x32_bf16 v[248:251], v[216:219], v[252:255], v[248:251]
v_mfma_f32_16x16x32_bf16 v[60:63], v[216:219], v[36:39], v[60:63]
v_mfma_f32_16x16x32_bf16 v[196:199], v[216:219], v[104:107], v[196:199]
v_mfma_f32_16x16x32_bf16 v[232:235], v[216:219], v[188:191], v[232:235]
s_waitcnt lgkmcnt(4)
v_mfma_f32_16x16x32_bf16 v[220:223], a[24:27], a[248:251], v[220:223]
ds_read_b64_tr_b16 a[200:201], v17 offset:59392
v_mfma_f32_16x16x32_bf16 v[220:223], a[28:31], a[252:255], v[220:223]
v_mfma_f32_16x16x32_bf16 v[224:227], a[72:75], a[248:251], v[224:227]
ds_read_b64_tr_b16 a[202:203], v17 offset:59904
v_mfma_f32_16x16x32_bf16 v[224:227], a[76:79], a[252:255], v[224:227]
v_mfma_f32_16x16x32_bf16 v[228:231], a[120:123], a[248:251], v[228:231]
ds_read_b64_tr_b16 a[208:209], v17 offset:60416
v_mfma_f32_16x16x32_bf16 v[228:231], a[124:127], a[252:255], v[228:231]
v_mfma_f32_16x16x32_bf16 v[132:135], a[168:171], a[248:251], v[132:135]
ds_read_b64_tr_b16 a[210:211], v17 offset:60928
v_mfma_f32_16x16x32_bf16 v[132:135], a[172:175], a[252:255], v[132:135]
s_waitcnt lgkmcnt(4)
v_mfma_f32_16x16x32_bf16 v[220:223], a[32:35], a[192:195], v[220:223]
ds_read_b64_tr_b16 a[204:205], v18 offset:0
v_mfma_f32_16x16x32_bf16 v[220:223], a[36:39], a[196:199], v[220:223]
v_max3_f32 v15, v144, v145, v146
v_mfma_f32_16x16x32_bf16 v[224:227], a[80:83], a[192:195], v[224:227]
ds_read_b64_tr_b16 a[206:207], v18 offset:512
v_mfma_f32_16x16x32_bf16 v[224:227], a[84:87], a[196:199], v[224:227]
v_max3_f32 v15, v15, v147, v40
v_mfma_f32_16x16x32_bf16 v[228:231], a[128:131], a[192:195], v[228:231]
ds_read_b64_tr_b16 a[212:213], v18 offset:1024
v_mfma_f32_16x16x32_bf16 v[228:231], a[132:135], a[196:199], v[228:231]
v_max3_f32 v15, v15, v41, v42
v_mfma_f32_16x16x32_bf16 v[132:135], a[176:179], a[192:195], v[132:135]
ds_read_b64_tr_b16 a[214:215], v18 offset:1536
v_mfma_f32_16x16x32_bf16 v[132:135], a[180:183], a[196:199], v[132:135]
s_waitcnt lgkmcnt(4)
v_mfma_f32_16x16x32_bf16 v[220:223], a[40:43], a[200:203], v[220:223]
ds_read_b64_tr_b16 a[216:217], v18 offset:2048
v_mfma_f32_16x16x32_bf16 v[220:223], a[44:47], a[208:211], v[220:223]
v_max_f32 v15, v15, v43
v_mfma_f32_16x16x32_bf16 v[224:227], a[88:91], a[200:203], v[224:227]
ds_read_b64_tr_b16 a[218:219], v18 offset:2560
v_mfma_f32_16x16x32_bf16 v[224:227], a[92:95], a[208:211], v[224:227]
v_add_f32 v15, v15, v11
v_mfma_f32_16x16x32_bf16 v[228:231], a[136:139], a[200:203], v[228:231]
ds_read_b64_tr_b16 a[220:221], v18 offset:3072
v_mfma_f32_16x16x32_bf16 v[228:231], a[140:143], a[208:211], v[228:231]
v_max3_f32 v29, v48, v49, v50
v_mfma_f32_16x16x32_bf16 v[132:135], a[184:187], a[200:203], v[132:135]
ds_read_b64_tr_b16 a[222:223], v18 offset:3584
v_mfma_f32_16x16x32_bf16 v[132:135], a[188:191], a[208:211], v[132:135]
s_waitcnt lgkmcnt(4)
v_mfma_f32_16x16x32_bf16 v[172:175], a[0:3], a[204:207], 0
ds_read_b64_tr_b16 a[224:225], v18 offset:4096
v_mfma_f32_16x16x32_bf16 v[172:175], a[4:7], a[212:215], v[172:175]
v_max3_f32 v29, v29, v51, v248
v_mfma_f32_16x16x32_bf16 v[140:143], a[48:51], a[204:207], 0
ds_read_b64_tr_b16 a[226:227], v18 offset:4608
v_max3_f32 v29, v29, v249, v250
v_mfma_f32_16x16x32_bf16 v[140:143], a[52:55], a[212:215], v[140:143]
v_max_f32 v29, v29, v251
v_add_f32 v29, v29, v23
v_mfma_f32_16x16x32_bf16 v[160:163], a[96:99], a[204:207], 0
ds_read_b64_tr_b16 a[228:229], v18 offset:5120
v_max_f32 v15, v15, v29
v_mfma_f32_16x16x32_bf16 v[160:163], a[100:103], a[212:215], v[160:163]
v_max3_f32 v5, v240, v241, v242
v_max3_f32 v5, v5, v243, v200
v_mfma_f32_16x16x32_bf16 v[100:103], a[144:147], a[204:207], 0
ds_read_b64_tr_b16 a[230:231], v18 offset:5632
v_max3_f32 v5, v5, v201, v202
v_mfma_f32_16x16x32_bf16 v[100:103], a[148:151], a[212:215], v[100:103]
v_max_f32 v5, v5, v203
s_waitcnt lgkmcnt(4)
v_mfma_f32_16x16x32_bf16 v[172:175], a[8:11], a[216:219], v[172:175]
ds_read_b64_tr_b16 a[232:233], v18 offset:55296
v_add_f32 v5, v5, v11
v_mfma_f32_16x16x32_bf16 v[172:175], a[12:15], a[220:223], v[172:175]
v_max3_f32 v4, v156, v157, v158
v_max3_f32 v4, v4, v159, v60
v_mfma_f32_16x16x32_bf16 v[140:143], a[56:59], a[216:219], v[140:143]
ds_read_b64_tr_b16 a[234:235], v18 offset:55808
v_max3_f32 v4, v4, v61, v62
v_mfma_f32_16x16x32_bf16 v[140:143], a[60:63], a[220:223], v[140:143]
v_max_f32 v4, v4, v63
v_add_f32 v4, v4, v23
v_mfma_f32_16x16x32_bf16 v[160:163], a[104:107], a[216:219], v[160:163]
ds_read_b64_tr_b16 a[236:237], v18 offset:56320
v_max_f32 v5, v5, v4
v_mfma_f32_16x16x32_bf16 v[160:163], a[108:111], a[220:223], v[160:163]
v_max3_f32 v24, v80, v81, v82
v_cvt_pk_bf16_f32 v108, v220, v221
v_mfma_f32_16x16x32_bf16 v[100:103], a[152:155], a[216:219], v[100:103]
ds_read_b64_tr_b16 a[238:239], v18 offset:56832
v_cvt_pk_bf16_f32 v109, v222, v223
v_mfma_f32_16x16x32_bf16 v[100:103], a[156:159], a[220:223], v[100:103]
v_cvt_pk_bf16_f32 v110, v224, v225
s_waitcnt lgkmcnt(4)
v_mfma_f32_16x16x32_bf16 v[172:175], a[16:19], a[224:227], v[172:175]
ds_read_b64_tr_b16 a[240:241], v18 offset:57344
v_cvt_pk_bf16_f32 v111, v226, v227
v_mfma_f32_16x16x32_bf16 v[172:175], a[20:23], a[228:231], v[172:175]
v_cvt_pk_bf16_f32 v236, v228, v229
v_mfma_f32_16x16x32_bf16 v[140:143], a[64:67], a[224:227], v[140:143]
ds_read_b64_tr_b16 a[242:243], v18 offset:57856
v_mfma_f32_16x16x32_bf16 v[140:143], a[68:71], a[228:231], v[140:143]
v_cvt_pk_bf16_f32 v237, v230, v231
v_mfma_f32_16x16x32_bf16 v[160:163], a[112:115], a[224:227], v[160:163]
ds_read_b64_tr_b16 a[244:245], v18 offset:58368
v_mfma_f32_16x16x32_bf16 v[160:163], a[116:119], a[228:231], v[160:163]
v_cvt_pk_bf16_f32 v238, v132, v133
v_mfma_f32_16x16x32_bf16 v[100:103], a[160:163], a[224:227], v[100:103]
ds_read_b64_tr_b16 a[246:247], v18 offset:58880
v_mfma_f32_16x16x32_bf16 v[100:103], a[164:167], a[228:231], v[100:103]
s_waitcnt lgkmcnt(4)
v_mfma_f32_16x16x32_bf16 v[172:175], a[24:27], a[232:235], v[172:175]
ds_read_b64_tr_b16 a[248:249], v18 offset:59392
v_cvt_pk_bf16_f32 v239, v134, v135
v_mfma_f32_16x16x32_bf16 v[172:175], a[28:31], a[236:239], v[172:175]
v_max3_f32 v24, v24, v83, v196
v_mfma_f32_16x16x32_bf16 v[140:143], a[72:75], a[232:235], v[140:143]
ds_read_b64_tr_b16 a[250:251], v18 offset:59904
v_max3_f32 v24, v24, v197, v198
v_mfma_f32_16x16x32_bf16 v[140:143], a[76:79], a[236:239], v[140:143]
v_max_f32 v24, v24, v199
v_mfma_f32_16x16x32_bf16 v[160:163], a[120:123], a[232:235], v[160:163]
ds_read_b64_tr_b16 a[252:253], v18 offset:60416
v_mfma_f32_16x16x32_bf16 v[160:163], a[124:127], a[236:239], v[160:163]
v_add_f32 v24, v24, v11
v_mfma_f32_16x16x32_bf16 v[100:103], a[168:171], a[232:235], v[100:103]
ds_read_b64_tr_b16 a[254:255], v18 offset:60928
v_max3_f32 v3, v76, v77, v78
v_mfma_f32_16x16x32_bf16 v[100:103], a[172:175], a[236:239], v[100:103]
v_max3_f32 v3, v3, v79, v68
s_waitcnt lgkmcnt(4)
v_mfma_f32_16x16x32_bf16 v[172:175], a[32:35], a[240:243], v[172:175]
v_max3_f32 v3, v3, v69, v70
v_mfma_f32_16x16x32_bf16 v[172:175], a[36:39], a[244:247], v[172:175]
v_max_f32 v3, v3, v71
v_mfma_f32_16x16x32_bf16 v[140:143], a[80:83], a[240:243], v[140:143]
v_add_f32 v3, v3, v23
v_mfma_f32_16x16x32_bf16 v[140:143], a[84:87], a[244:247], v[140:143]
s_waitcnt vmcnt(0) lgkmcnt(0)
s_barrier
v_mfma_f32_16x16x32_bf16 v[160:163], a[128:131], a[240:243], v[160:163]
ds_read_b64_tr_b16 a[192:193], v6 offset:49152
v_max_f32 v24, v24, v3
v_mfma_f32_16x16x32_bf16 v[160:163], a[132:135], a[244:247], v[160:163]
ds_read_b64_tr_b16 a[194:195], v6 offset:49664
v_mfma_f32_16x16x32_bf16 v[100:103], a[176:179], a[240:243], v[100:103]
v_max3_f32 v28, v96, v97, v98
v_mfma_f32_16x16x32_bf16 v[100:103], a[180:183], a[244:247], v[100:103]
ds_read_b64_tr_b16 a[196:197], v6 offset:50176
v_mfma_f32_16x16x32_bf16 v[172:175], a[40:43], a[248:251], v[172:175]
ds_read_b64_tr_b16 a[200:201], v6 offset:51200
v_max3_f32 v28, v28, v99, v232
v_mfma_f32_16x16x32_bf16 v[172:175], a[44:47], a[252:255], v[172:175]
ds_read_b64_tr_b16 a[198:199], v6 offset:50688
v_max3_f32 v28, v28, v233, v234
v_mfma_f32_16x16x32_bf16 v[140:143], a[88:91], a[248:251], v[140:143]
ds_read_b64_tr_b16 a[202:203], v6 offset:51712
v_max_f32 v28, v28, v235
v_mfma_f32_16x16x32_bf16 v[140:143], a[92:95], a[252:255], v[140:143]
v_add_f32 v28, v28, v11
v_max3_f32 v31, v152, v153, v154
v_mfma_f32_16x16x32_bf16 v[160:163], a[136:139], a[248:251], v[160:163]
ds_read_b64_tr_b16 a[208:209], v6 offset:52224
v_max3_f32 v31, v31, v155, v116
v_mfma_f32_16x16x32_bf16 v[160:163], a[140:143], a[252:255], v[160:163]
v_max3_f32 v31, v31, v117, v118
v_max_f32 v31, v31, v119
v_mfma_f32_16x16x32_bf16 v[100:103], a[184:187], a[248:251], v[100:103]
ds_read_b64_tr_b16 a[210:211], v6 offset:52736
v_add_f32 v31, v31, v23
v_mfma_f32_16x16x32_bf16 v[100:103], a[188:191], a[252:255], v[100:103]
v_max_f32 v28, v28, v31
s_waitcnt lgkmcnt(3)
v_mfma_f32_16x16x32_bf16 v[88:91], a[0:3], a[192:195], 0
ds_read_b64_tr_b16 a[204:205], v6 offset:53248
s_add_u32 m0, s39, 0
v_mfma_f32_16x16x32_bf16 v[88:91], a[4:7], a[196:199], v[88:91]
s_add_u32 s42, s37, 3456
buffer_load_dwordx4 v8, s[20:23], s42 offen offset:0 lds
v_mfma_f32_16x16x32_bf16 v[120:123], a[48:51], a[192:195], 0
ds_read_b64_tr_b16 a[206:207], v6 offset:53760
v_permlane32_swap_b32 v15, v5
v_mfma_f32_16x16x32_bf16 v[120:123], a[52:55], a[196:199], v[120:123]
v_max_f32 v27, v15, v5
v_permlane32_swap_b32 v24, v28
v_mfma_f32_16x16x32_bf16 v[84:87], a[96:99], a[192:195], 0
ds_read_b64_tr_b16 a[212:213], v6 offset:54272
v_max_f32 v19, v24, v28
v_mfma_f32_16x16x32_bf16 v[84:87], a[100:103], a[196:199], v[84:87]
s_add_u32 s43, s37, 76160
buffer_load_dwordx4 v8, s[20:23], s43 offen offset:1024 lds
v_mfma_f32_16x16x32_bf16 v[92:95], a[144:147], a[192:195], 0
ds_read_b64_tr_b16 a[214:215], v6 offset:54784
v_permlane16_swap_b32 v27, v19
v_mfma_f32_16x16x32_bf16 v[92:95], a[148:151], a[196:199], v[92:95]
v_max_f32 v30, v27, v19
s_waitcnt lgkmcnt(4)
v_mfma_f32_16x16x32_bf16 v[88:91], a[8:11], a[200:203], v[88:91]
ds_read_b64_tr_b16 a[216:217], v6 offset:6144
v_mov_b32 v25, v30
v_mfma_f32_16x16x32_bf16 v[88:91], a[12:15], a[208:211], v[88:91]
s_add_u32 s42, s37, 148864
buffer_load_dwordx4 v8, s[20:23], s42 offen offset:2048 lds
v_mfma_f32_16x16x32_bf16 v[120:123], a[56:59], a[200:203], v[120:123]
ds_read_b64_tr_b16 a[218:219], v6 offset:6656
v_permlane16_swap_b32 v30, v25
v_mfma_f32_16x16x32_bf16 v[120:123], a[60:63], a[208:211], v[120:123]
v_mov_b32 v26, v30
v_mov_b32 v20, v25
v_mfma_f32_16x16x32_bf16 v[84:87], a[104:107], a[200:203], v[84:87]
ds_read_b64_tr_b16 a[220:221], v6 offset:7168
s_add_u32 s43, s37, 221568
v_mfma_f32_16x16x32_bf16 v[84:87], a[108:111], a[208:211], v[84:87]
v_permlane32_swap_b32 v30, v26
v_permlane32_swap_b32 v25, v20
v_mfma_f32_16x16x32_bf16 v[92:95], a[152:155], a[200:203], v[92:95]
ds_read_b64_tr_b16 a[222:223], v6 offset:7680
buffer_load_dwordx4 v8, s[20:23], s43 offen offset:3072 lds
v_mfma_f32_16x16x32_bf16 v[92:95], a[156:159], a[208:211], v[92:95]
v_fma_f32 v21, -v30, s40, v13
s_waitcnt lgkmcnt(4)
v_mfma_f32_16x16x32_bf16 v[88:91], a[16:19], a[204:207], v[88:91]
ds_read_b64_tr_b16 a[224:225], v6 offset:8192
v_fma_f32 v16, -v30, s40, v14
v_mfma_f32_16x16x32_bf16 v[88:91], a[20:23], a[212:215], v[88:91]
v_fma_f32 v22, -v26, s40, v13
v_fma_f32 v2, -v26, s40, v14
v_mfma_f32_16x16x32_bf16 v[120:123], a[64:67], a[204:207], v[120:123]
ds_read_b64_tr_b16 a[226:227], v6 offset:8704
v_cvt_pk_bf16_f32 v212, v172, v173
v_mfma_f32_16x16x32_bf16 v[120:123], a[68:71], a[212:215], v[120:123]
v_cvt_pk_bf16_f32 v213, v174, v175
v_cvt_pk_bf16_f32 v214, v140, v141
v_mfma_f32_16x16x32_bf16 v[84:87], a[112:115], a[204:207], v[84:87]
ds_read_b64_tr_b16 a[228:229], v6 offset:9216
v_cvt_pk_bf16_f32 v215, v142, v143
v_mfma_f32_16x16x32_bf16 v[84:87], a[116:119], a[212:215], v[84:87]
v_cvt_pk_bf16_f32 v176, v160, v161
v_cvt_pk_bf16_f32 v177, v162, v163
v_mfma_f32_16x16x32_bf16 v[92:95], a[160:163], a[204:207], v[92:95]
ds_read_b64_tr_b16 a[230:231], v6 offset:9728
v_cvt_pk_bf16_f32 v178, v100, v101
v_mfma_f32_16x16x32_bf16 v[92:95], a[164:167], a[212:215], v[92:95]
v_cvt_pk_bf16_f32 v179, v102, v103
s_waitcnt lgkmcnt(4)
v_mfma_f32_16x16x32_bf16 v[88:91], a[24:27], a[216:219], v[88:91]
ds_read_b64_tr_b16 a[232:233], v6 offset:10240
v_fma_f32 v29, -v25, s40, v13
v_mfma_f32_16x16x32_bf16 v[88:91], a[28:31], a[220:223], v[88:91]
s_add_u32 m0, s39, 4096
s_add_u32 s42, s37, 298368
v_mfma_f32_16x16x32_bf16 v[120:123], a[72:75], a[216:219], v[120:123]
ds_read_b64_tr_b16 a[234:235], v6 offset:10752
buffer_load_dwordx4 v8, s[20:23], s42 offen offset:0 lds
v_mfma_f32_16x16x32_bf16 v[120:123], a[76:79], a[220:223], v[120:123]
v_fma_f32 v4, -v25, s40, v14
v_fma_f32 v3, -v20, s40, v13
v_mfma_f32_16x16x32_bf16 v[84:87], a[120:123], a[216:219], v[84:87]
ds_read_b64_tr_b16 a[236:237], v6 offset:11264
v_fma_f32 v31, -v20, s40, v14
v_mfma_f32_16x16x32_bf16 v[84:87], a[124:127], a[220:223], v[84:87]
v_fma_f32 v144, v144, s40, v21
s_add_u32 s43, s37, 371072
v_mfma_f32_16x16x32_bf16 v[92:95], a[168:171], a[216:219], v[92:95]
ds_read_b64_tr_b16 a[238:239], v6 offset:11776
buffer_load_dwordx4 v8, s[20:23], s43 offen offset:1024 lds
v_mfma_f32_16x16x32_bf16 v[92:95], a[172:175], a[220:223], v[92:95]
v_fma_f32 v145, v145, s40, v21
s_waitcnt lgkmcnt(4)
v_mfma_f32_16x16x32_bf16 v[88:91], a[32:35], a[224:227], v[88:91]
ds_read_b64_tr_b16 a[240:241], v7 offset:49152
v_fma_f32 v146, v146, s40, v21
v_mfma_f32_16x16x32_bf16 v[88:91], a[36:39], a[228:231], v[88:91]
v_exp_f32 v144, v144
v_mfma_f32_16x16x32_bf16 v[120:123], a[80:83], a[224:227], v[120:123]
ds_read_b64_tr_b16 a[242:243], v7 offset:49664
s_add_u32 m0, s39, 55296
v_mfma_f32_16x16x32_bf16 v[120:123], a[84:87], a[228:231], v[120:123]
v_exp_f32 v145, v145
v_mfma_f32_16x16x32_bf16 v[84:87], a[128:131], a[224:227], v[84:87]
ds_read_b64_tr_b16 a[244:245], v7 offset:50176
s_add_u32 s42, s37, 445824
v_mfma_f32_16x16x32_bf16 v[84:87], a[132:135], a[228:231], v[84:87]
v_exp_f32 v146, v146
v_mfma_f32_16x16x32_bf16 v[92:95], a[176:179], a[224:227], v[92:95]
ds_read_b64_tr_b16 a[246:247], v7 offset:50688
buffer_load_dwordx4 v8, s[20:23], s42 offen offset:0 lds
v_mfma_f32_16x16x32_bf16 v[92:95], a[180:183], a[228:231], v[92:95]
v_fma_f32 v147, v147, s40, v21
s_waitcnt lgkmcnt(4)
v_mfma_f32_16x16x32_bf16 v[88:91], a[40:43], a[232:235], v[88:91]
ds_read_b64_tr_b16 a[248:249], v7 offset:51200
v_add_f32 v15, v144, v145
v_mfma_f32_16x16x32_bf16 v[88:91], a[44:47], a[236:239], v[88:91]
v_exp_f32 v147, v147
v_mfma_f32_16x16x32_bf16 v[120:123], a[88:91], a[232:235], v[120:123]
ds_read_b64_tr_b16 a[250:251], v7 offset:51712
v_add_f32 v5, v146, v147
v_mfma_f32_16x16x32_bf16 v[120:123], a[92:95], a[236:239], v[120:123]
s_add_u32 s43, s37, 518528
buffer_load_dwordx4 v8, s[20:23], s43 offen offset:1024 lds
v_mfma_f32_16x16x32_bf16 v[84:87], a[136:139], a[232:235], v[84:87]
ds_read_b64_tr_b16 a[252:253], v7 offset:52224
v_fma_f32 v40, v40, s40, v21
v_mfma_f32_16x16x32_bf16 v[84:87], a[140:143], a[236:239], v[84:87]
v_exp_f32 v40, v40
v_mfma_f32_16x16x32_bf16 v[92:95], a[184:187], a[232:235], v[92:95]
ds_read_b64_tr_b16 a[254:255], v7 offset:52736
v_fma_f32 v41, v41, s40, v21
v_mfma_f32_16x16x32_bf16 v[92:95], a[188:191], a[236:239], v[92:95]
v_fma_f32 v42, v42, s40, v21
s_waitcnt lgkmcnt(4)
v_mfma_f32_16x16x32_bf16 v[164:167], a[0:3], a[240:243], 0
ds_read_b64_tr_b16 a[192:193], v7 offset:53248
s_add_u32 s42, s37, 591232
v_mfma_f32_16x16x32_bf16 v[164:167], a[4:7], a[244:247], v[164:167]
v_exp_f32 v41, v41
v_mfma_f32_16x16x32_bf16 v[168:171], a[48:51], a[240:243], 0
ds_read_b64_tr_b16 a[194:195], v7 offset:53760
buffer_load_dwordx4 v8, s[20:23], s42 offen offset:2048 lds
v_mfma_f32_16x16x32_bf16 v[168:171], a[52:55], a[244:247], v[168:171]
v_exp_f32 v42, v42
v_mfma_f32_16x16x32_bf16 v[44:47], a[96:99], a[240:243], 0
ds_read_b64_tr_b16 a[196:197], v7 offset:54272
v_fma_f32 v43, v43, s40, v21
v_mfma_f32_16x16x32_bf16 v[44:47], a[100:103], a[244:247], v[44:47]
v_exp_f32 v43, v43
v_mfma_f32_16x16x32_bf16 v[244:247], a[144:147], a[240:243], 0
ds_read_b64_tr_b16 a[198:199], v7 offset:54784
v_add_f32 v15, v15, v40
v_mfma_f32_16x16x32_bf16 v[244:247], a[148:151], a[244:247], v[244:247]
v_add_f32 v15, v15, v41
s_waitcnt lgkmcnt(4)
v_mfma_f32_16x16x32_bf16 v[164:167], a[8:11], a[248:251], v[164:167]
ds_read_b64_tr_b16 a[200:201], v7 offset:6144
s_add_u32 s43, s37, 663936
v_mfma_f32_16x16x32_bf16 v[164:167], a[12:15], a[252:255], v[164:167]
buffer_load_dwordx4 v8, s[20:23], s43 offen offset:3072 lds
v_add_f32 v5, v5, v42
v_mfma_f32_16x16x32_bf16 v[168:171], a[56:59], a[248:251], v[168:171]
ds_read_b64_tr_b16 a[202:203], v7 offset:6656
v_add_f32 v5, v5, v43
v_mfma_f32_16x16x32_bf16 v[168:171], a[60:63], a[252:255], v[168:171]
v_fma_f32 v48, v48, s40, v16
s_add_u32 m0, s39, 59392
v_mfma_f32_16x16x32_bf16 v[44:47], a[104:107], a[248:251], v[44:47]
ds_read_b64_tr_b16 a[208:209], v7 offset:7168
s_add_u32 s42, s37, 740736
v_mfma_f32_16x16x32_bf16 v[44:47], a[108:111], a[252:255], v[44:47]
v_exp_f32 v48, v48
v_mfma_f32_16x16x32_bf16 v[244:247], a[152:155], a[248:251], v[244:247]
ds_read_b64_tr_b16 a[210:211], v7 offset:7680
buffer_load_dwordx4 v8, s[20:23], s42 offen offset:0 lds
v_mfma_f32_16x16x32_bf16 v[244:247], a[156:159], a[252:255], v[244:247]
v_fma_f32 v49, v49, s40, v16
s_waitcnt lgkmcnt(4)
v_mfma_f32_16x16x32_bf16 v[164:167], a[16:19], a[192:195], v[164:167]
ds_read_b64_tr_b16 a[204:205], v7 offset:8192
v_fma_f32 v50, v50, s40, v16
v_mfma_f32_16x16x32_bf16 v[164:167], a[20:23], a[196:199], v[164:167]
v_exp_f32 v49, v49
v_mfma_f32_16x16x32_bf16 v[168:171], a[64:67], a[192:195], v[168:171]
ds_read_b64_tr_b16 a[206:207], v7 offset:8704
v_fma_f32 v51, v51, s40, v16
v_mfma_f32_16x16x32_bf16 v[168:171], a[68:71], a[196:199], v[168:171]
v_exp_f32 v50, v50
v_mfma_f32_16x16x32_bf16 v[44:47], a[112:115], a[192:195], v[44:47]
ds_read_b64_tr_b16 a[212:213], v7 offset:9216
s_add_u32 s43, s37, 813440
v_mfma_f32_16x16x32_bf16 v[44:47], a[116:119], a[196:199], v[44:47]
buffer_load_dwordx4 v8, s[20:23], s43 offen offset:1024 lds
v_add_f32 v15, v15, v48
v_mfma_f32_16x16x32_bf16 v[244:247], a[160:163], a[192:195], v[244:247]
ds_read_b64_tr_b16 a[214:215], v7 offset:9728
v_add_f32 v15, v15, v49
v_mfma_f32_16x16x32_bf16 v[244:247], a[164:167], a[196:199], v[244:247]
v_add_f32 v5, v5, v50
s_waitcnt lgkmcnt(4)
v_mfma_f32_16x16x32_bf16 v[164:167], a[24:27], a[200:203], v[164:167]
ds_read_b64_tr_b16 a[216:217], v7 offset:10240
v_cvt_pk_bf16_f32 v52, v88, v89
v_mfma_f32_16x16x32_bf16 v[164:167], a[28:31], a[208:211], v[164:167]
v_exp_f32 v51, v51
v_mfma_f32_16x16x32_bf16 v[168:171], a[72:75], a[200:203], v[168:171]
ds_read_b64_tr_b16 a[218:219], v7 offset:10752
v_cvt_pk_bf16_f32 v53, v90, v91
v_mfma_f32_16x16x32_bf16 v[168:171], a[76:79], a[208:211], v[168:171]
v_cvt_pk_bf16_f32 v54, v120, v121
v_cvt_pk_bf16_f32 v55, v122, v123
v_mfma_f32_16x16x32_bf16 v[44:47], a[120:123], a[200:203], v[44:47]
ds_read_b64_tr_b16 a[220:221], v7 offset:11264
v_cvt_pk_bf16_f32 v56, v84, v85
v_mfma_f32_16x16x32_bf16 v[44:47], a[124:127], a[208:211], v[44:47]
v_cvt_pk_bf16_f32 v57, v86, v87
v_cvt_pk_bf16_f32 v58, v92, v93
v_mfma_f32_16x16x32_bf16 v[244:247], a[168:171], a[200:203], v[244:247]
ds_read_b64_tr_b16 a[222:223], v7 offset:11776
v_cvt_pk_bf16_f32 v59, v94, v95
v_mfma_f32_16x16x32_bf16 v[244:247], a[172:175], a[208:211], v[244:247]
v_add_f32 v5, v5, v51
s_waitcnt lgkmcnt(4)
v_mfma_f32_16x16x32_bf16 v[164:167], a[32:35], a[204:207], v[164:167]
ds_read_b64_tr_b16 a[224:225], v17 offset:49152
v_fma_f32 v248, v248, s40, v16
v_mfma_f32_16x16x32_bf16 v[164:167], a[36:39], a[212:215], v[164:167]
v_exp_f32 v248, v248
v_mfma_f32_16x16x32_bf16 v[168:171], a[80:83], a[204:207], v[168:171]
ds_read_b64_tr_b16 a[226:227], v17 offset:49664
v_fma_f32 v249, v249, s40, v16
v_mfma_f32_16x16x32_bf16 v[168:171], a[84:87], a[212:215], v[168:171]
v_exp_f32 v249, v249
v_mfma_f32_16x16x32_bf16 v[44:47], a[128:131], a[204:207], v[44:47]
ds_read_b64_tr_b16 a[228:229], v17 offset:50176
v_fma_f32 v250, v250, s40, v16
v_mfma_f32_16x16x32_bf16 v[44:47], a[132:135], a[212:215], v[44:47]
v_exp_f32 v250, v250
v_mfma_f32_16x16x32_bf16 v[244:247], a[176:179], a[204:207], v[244:247]
ds_read_b64_tr_b16 a[230:231], v17 offset:50688
v_fma_f32 v251, v251, s40, v16
v_mfma_f32_16x16x32_bf16 v[244:247], a[180:183], a[212:215], v[244:247]
v_add_f32 v15, v15, v248
s_waitcnt lgkmcnt(4)
v_mfma_f32_16x16x32_bf16 v[164:167], a[40:43], a[216:219], v[164:167]
ds_read_b64_tr_b16 a[232:233], v17 offset:51200
v_add_f32 v15, v15, v249
v_mfma_f32_16x16x32_bf16 v[164:167], a[44:47], a[220:223], v[164:167]
v_exp_f32 v251, v251
v_mfma_f32_16x16x32_bf16 v[168:171], a[88:91], a[216:219], v[168:171]
ds_read_b64_tr_b16 a[234:235], v17 offset:51712
v_add_f32 v5, v5, v250
v_mfma_f32_16x16x32_bf16 v[168:171], a[92:95], a[220:223], v[168:171]
v_add_f32 v5, v5, v251
v_add_f32 v15, v15, v5
v_mfma_f32_16x16x32_bf16 v[44:47], a[136:139], a[216:219], v[44:47]
ds_read_b64_tr_b16 a[236:237], v17 offset:52224
v_fma_f32 v240, v240, s40, v22
v_mfma_f32_16x16x32_bf16 v[44:47], a[140:143], a[220:223], v[44:47]
v_exp_f32 v240, v240
v_mfma_f32_16x16x32_bf16 v[244:247], a[184:187], a[216:219], v[244:247]
ds_read_b64_tr_b16 a[238:239], v17 offset:52736
v_mfma_f32_16x16x32_bf16 v[244:247], a[188:191], a[220:223], v[244:247]
v_fma_f32 v241, v241, s40, v22
s_waitcnt lgkmcnt(4)
v_mfma_f32_16x16x32_bf16 v[72:75], a[0:3], a[224:227], 0
ds_read_b64_tr_b16 a[240:241], v17 offset:53248
v_fma_f32 v242, v242, s40, v22
v_mfma_f32_16x16x32_bf16 v[72:75], a[4:7], a[228:231], v[72:75]
v_exp_f32 v241, v241
v_mfma_f32_16x16x32_bf16 v[124:127], a[48:51], a[224:227], 0
ds_read_b64_tr_b16 a[242:243], v17 offset:53760
v_fma_f32 v243, v243, s40, v22
v_mfma_f32_16x16x32_bf16 v[124:127], a[52:55], a[228:231], v[124:127]
v_exp_f32 v242, v242
v_mfma_f32_16x16x32_bf16 v[32:35], a[96:99], a[224:227], 0
ds_read_b64_tr_b16 a[244:245], v17 offset:54272
v_add_f32 v24, v240, v241
v_mfma_f32_16x16x32_bf16 v[32:35], a[100:103], a[228:231], v[32:35]
v_exp_f32 v243, v243
v_mfma_f32_16x16x32_bf16 v[148:151], a[144:147], a[224:227], 0
ds_read_b64_tr_b16 a[246:247], v17 offset:54784
v_add_f32 v28, v242, v243
v_mfma_f32_16x16x32_bf16 v[148:151], a[148:151], a[228:231], v[148:151]
v_fma_f32 v200, v200, s40, v22
s_waitcnt lgkmcnt(4)
v_mfma_f32_16x16x32_bf16 v[72:75], a[8:11], a[232:235], v[72:75]
ds_read_b64_tr_b16 a[248:249], v17 offset:6144
v_fma_f32 v201, v201, s40, v22
v_mfma_f32_16x16x32_bf16 v[72:75], a[12:15], a[236:239], v[72:75]
v_exp_f32 v200, v200
v_mfma_f32_16x16x32_bf16 v[124:127], a[56:59], a[232:235], v[124:127]
ds_read_b64_tr_b16 a[250:251], v17 offset:6656
v_fma_f32 v202, v202, s40, v22
v_mfma_f32_16x16x32_bf16 v[124:127], a[60:63], a[236:239], v[124:127]
v_exp_f32 v201, v201
v_mfma_f32_16x16x32_bf16 v[32:35], a[104:107], a[232:235], v[32:35]
ds_read_b64_tr_b16 a[252:253], v17 offset:7168
v_fma_f32 v203, v203, s40, v22
v_mfma_f32_16x16x32_bf16 v[32:35], a[108:111], a[236:239], v[32:35]
v_exp_f32 v202, v202
v_mfma_f32_16x16x32_bf16 v[148:151], a[152:155], a[232:235], v[148:151]
ds_read_b64_tr_b16 a[254:255], v17 offset:7680
v_add_f32 v24, v24, v200
v_mfma_f32_16x16x32_bf16 v[148:151], a[156:159], a[236:239], v[148:151]
v_add_f32 v24, v24, v201
s_waitcnt lgkmcnt(4)
v_mfma_f32_16x16x32_bf16 v[72:75], a[16:19], a[240:243], v[72:75]
ds_read_b64_tr_b16 a[192:193], v17 offset:8192
v_add_f32 v28, v28, v202
v_mfma_f32_16x16x32_bf16 v[72:75], a[20:23], a[244:247], v[72:75]
v_exp_f32 v203, v203
v_mfma_f32_16x16x32_bf16 v[124:127], a[64:67], a[240:243], v[124:127]
ds_read_b64_tr_b16 a[194:195], v17 offset:8704
v_add_f32 v28, v28, v203
v_mfma_f32_16x16x32_bf16 v[124:127], a[68:71], a[244:247], v[124:127]
v_cvt_pk_bf16_f32 v136, v164, v165
v_cvt_pk_bf16_f32 v137, v166, v167
v_mfma_f32_16x16x32_bf16 v[32:35], a[112:115], a[240:243], v[32:35]
ds_read_b64_tr_b16 a[196:197], v17 offset:9216
v_cvt_pk_bf16_f32 v138, v168, v169
v_mfma_f32_16x16x32_bf16 v[32:35], a[116:119], a[244:247], v[32:35]
v_cvt_pk_bf16_f32 v139, v170, v171
v_cvt_pk_bf16_f32 v192, v44, v45
v_mfma_f32_16x16x32_bf16 v[148:151], a[160:163], a[240:243], v[148:151]
ds_read_b64_tr_b16 a[198:199], v17 offset:9728
v_cvt_pk_bf16_f32 v193, v46, v47
v_mfma_f32_16x16x32_bf16 v[148:151], a[164:167], a[244:247], v[148:151]
v_cvt_pk_bf16_f32 v194, v244, v245
s_waitcnt lgkmcnt(4)
v_mfma_f32_16x16x32_bf16 v[72:75], a[24:27], a[248:251], v[72:75]
ds_read_b64_tr_b16 a[200:201], v17 offset:10240
v_cvt_pk_bf16_f32 v195, v246, v247
v_mfma_f32_16x16x32_bf16 v[72:75], a[28:31], a[252:255], v[72:75]
v_fma_f32 v156, v156, s40, v2
v_mfma_f32_16x16x32_bf16 v[124:127], a[72:75], a[248:251], v[124:127]
ds_read_b64_tr_b16 a[202:203], v17 offset:10752
v_fma_f32 v157, v157, s40, v2
v_mfma_f32_16x16x32_bf16 v[124:127], a[76:79], a[252:255], v[124:127]
v_exp_f32 v156, v156
v_mfma_f32_16x16x32_bf16 v[32:35], a[120:123], a[248:251], v[32:35]
ds_read_b64_tr_b16 a[208:209], v17 offset:11264
v_mfma_f32_16x16x32_bf16 v[32:35], a[124:127], a[252:255], v[32:35]
v_exp_f32 v157, v157
v_mfma_f32_16x16x32_bf16 v[148:151], a[168:171], a[248:251], v[148:151]
ds_read_b64_tr_b16 a[210:211], v17 offset:11776
v_fma_f32 v158, v158, s40, v2
v_mfma_f32_16x16x32_bf16 v[148:151], a[172:175], a[252:255], v[148:151]
v_fma_f32 v159, v159, s40, v2
s_waitcnt lgkmcnt(4)
v_mfma_f32_16x16x32_bf16 v[72:75], a[32:35], a[192:195], v[72:75]
ds_read_b64_tr_b16 a[204:205], v18 offset:49152
v_add_f32 v24, v24, v156
v_mfma_f32_16x16x32_bf16 v[72:75], a[36:39], a[196:199], v[72:75]
v_exp_f32 v158, v158
v_mfma_f32_16x16x32_bf16 v[124:127], a[80:83], a[192:195], v[124:127]
ds_read_b64_tr_b16 a[206:207], v18 offset:49664
v_add_f32 v24, v24, v157
v_mfma_f32_16x16x32_bf16 v[124:127], a[84:87], a[196:199], v[124:127]
v_exp_f32 v159, v159
v_mfma_f32_16x16x32_bf16 v[32:35], a[128:131], a[192:195], v[32:35]
ds_read_b64_tr_b16 a[212:213], v18 offset:50176
v_mfma_f32_16x16x32_bf16 v[32:35], a[132:135], a[196:199], v[32:35]
v_add_f32 v28, v28, v158
v_add_f32 v28, v28, v159
v_mfma_f32_16x16x32_bf16 v[148:151], a[176:179], a[192:195], v[148:151]
ds_read_b64_tr_b16 a[214:215], v18 offset:50688
v_mfma_f32_16x16x32_bf16 v[148:151], a[180:183], a[196:199], v[148:151]
s_waitcnt lgkmcnt(4)
v_mfma_f32_16x16x32_bf16 v[72:75], a[40:43], a[200:203], v[72:75]
ds_read_b64_tr_b16 a[216:217], v18 offset:51200
v_fma_f32 v60, v60, s40, v2
v_mfma_f32_16x16x32_bf16 v[72:75], a[44:47], a[208:211], v[72:75]
v_exp_f32 v60, v60
v_mfma_f32_16x16x32_bf16 v[124:127], a[88:91], a[200:203], v[124:127]
ds_read_b64_tr_b16 a[218:219], v18 offset:51712
v_mfma_f32_16x16x32_bf16 v[124:127], a[92:95], a[208:211], v[124:127]
v_fma_f32 v61, v61, s40, v2
v_mfma_f32_16x16x32_bf16 v[32:35], a[136:139], a[200:203], v[32:35]
ds_read_b64_tr_b16 a[220:221], v18 offset:52224
v_fma_f32 v62, v62, s40, v2
v_mfma_f32_16x16x32_bf16 v[32:35], a[140:143], a[208:211], v[32:35]
v_exp_f32 v61, v61
v_mfma_f32_16x16x32_bf16 v[148:151], a[184:187], a[200:203], v[148:151]
ds_read_b64_tr_b16 a[222:223], v18 offset:52736
v_mfma_f32_16x16x32_bf16 v[148:151], a[188:191], a[208:211], v[148:151]
v_fma_f32 v63, v63, s40, v2
s_waitcnt lgkmcnt(4)
v_mfma_f32_16x16x32_bf16 v[64:67], a[0:3], a[204:207], 0
ds_read_b64_tr_b16 a[224:225], v18 offset:53248
v_add_f32 v24, v24, v60
v_mfma_f32_16x16x32_bf16 v[64:67], a[4:7], a[212:215], v[64:67]
v_exp_f32 v62, v62
v_mfma_f32_16x16x32_bf16 v[184:187], a[48:51], a[204:207], 0
ds_read_b64_tr_b16 a[226:227], v18 offset:53760
v_add_f32 v24, v24, v61
v_mfma_f32_16x16x32_bf16 v[184:187], a[52:55], a[212:215], v[184:187]
v_exp_f32 v63, v63
v_mfma_f32_16x16x32_bf16 v[128:131], a[96:99], a[204:207], 0
ds_read_b64_tr_b16 a[228:229], v18 offset:54272
v_add_f32 v28, v28, v62
v_mfma_f32_16x16x32_bf16 v[128:131], a[100:103], a[212:215], v[128:131]
v_add_f32 v28, v28, v63
v_add_f32 v24, v24, v28
v_mfma_f32_16x16x32_bf16 v[208:211], a[144:147], a[204:207], 0
ds_read_b64_tr_b16 a[230:231], v18 offset:54784
v_fma_f32 v76, v76, s40, v4
v_mfma_f32_16x16x32_bf16 v[208:211], a[148:151], a[212:215], v[208:211]
v_fma_f32 v77, v77, s40, v4
s_waitcnt lgkmcnt(4)
v_mfma_f32_16x16x32_bf16 v[64:67], a[8:11], a[216:219], v[64:67]
ds_read_b64_tr_b16 a[232:233], v18 offset:6144
v_fma_f32 v78, v78, s40, v4
v_mfma_f32_16x16x32_bf16 v[64:67], a[12:15], a[220:223], v[64:67]
v_exp_f32 v76, v76
v_mfma_f32_16x16x32_bf16 v[184:187], a[56:59], a[216:219], v[184:187]
ds_read_b64_tr_b16 a[234:235], v18 offset:6656
v_fma_f32 v79, v79, s40, v4
v_mfma_f32_16x16x32_bf16 v[184:187], a[60:63], a[220:223], v[184:187]
v_exp_f32 v77, v77
v_mfma_f32_16x16x32_bf16 v[128:131], a[104:107], a[216:219], v[128:131]
ds_read_b64_tr_b16 a[236:237], v18 offset:7168
v_add_f32 v27, v76, v77
v_mfma_f32_16x16x32_bf16 v[128:131], a[108:111], a[220:223], v[128:131]
v_exp_f32 v78, v78
v_mfma_f32_16x16x32_bf16 v[208:211], a[152:155], a[216:219], v[208:211]
ds_read_b64_tr_b16 a[238:239], v18 offset:7680
v_fma_f32 v68, v68, s40, v4
v_mfma_f32_16x16x32_bf16 v[208:211], a[156:159], a[220:223], v[208:211]
v_cvt_pk_bf16_f32 v180, v72, v73
s_waitcnt lgkmcnt(4)
v_mfma_f32_16x16x32_bf16 v[64:67], a[16:19], a[224:227], v[64:67]
ds_read_b64_tr_b16 a[240:241], v18 offset:8192
v_cvt_pk_bf16_f32 v181, v74, v75
v_mfma_f32_16x16x32_bf16 v[64:67], a[20:23], a[228:231], v[64:67]
v_exp_f32 v79, v79
v_mfma_f32_16x16x32_bf16 v[184:187], a[64:67], a[224:227], v[184:187]
ds_read_b64_tr_b16 a[242:243], v18 offset:8704
v_add_f32 v19, v78, v79
v_mfma_f32_16x16x32_bf16 v[184:187], a[68:71], a[228:231], v[184:187]
v_exp_f32 v68, v68
v_mfma_f32_16x16x32_bf16 v[128:131], a[112:115], a[224:227], v[128:131]
ds_read_b64_tr_b16 a[244:245], v18 offset:9216
v_cvt_pk_bf16_f32 v182, v124, v125
v_mfma_f32_16x16x32_bf16 v[128:131], a[116:119], a[228:231], v[128:131]
v_cvt_pk_bf16_f32 v183, v126, v127
v_cvt_pk_bf16_f32 v204, v32, v33
v_mfma_f32_16x16x32_bf16 v[208:211], a[160:163], a[224:227], v[208:211]
ds_read_b64_tr_b16 a[246:247], v18 offset:9728
v_cvt_pk_bf16_f32 v205, v34, v35
v_mfma_f32_16x16x32_bf16 v[208:211], a[164:167], a[228:231], v[208:211]
v_cvt_pk_bf16_f32 v206, v148, v149
s_waitcnt lgkmcnt(4)
v_mfma_f32_16x16x32_bf16 v[64:67], a[24:27], a[232:235], v[64:67]
ds_read_b64_tr_b16 a[248:249], v18 offset:10240
v_cvt_pk_bf16_f32 v207, v150, v151
v_mfma_f32_16x16x32_bf16 v[64:67], a[28:31], a[236:239], v[64:67]
v_fma_f32 v69, v69, s40, v4
v_mfma_f32_16x16x32_bf16 v[184:187], a[72:75], a[232:235], v[184:187]
ds_read_b64_tr_b16 a[250:251], v18 offset:10752
v_fma_f32 v70, v70, s40, v4
v_mfma_f32_16x16x32_bf16 v[184:187], a[76:79], a[236:239], v[184:187]
v_exp_f32 v69, v69
v_mfma_f32_16x16x32_bf16 v[128:131], a[120:123], a[232:235], v[128:131]
ds_read_b64_tr_b16 a[252:253], v18 offset:11264
v_mfma_f32_16x16x32_bf16 v[128:131], a[124:127], a[236:239], v[128:131]
v_exp_f32 v70, v70
v_mfma_f32_16x16x32_bf16 v[208:211], a[168:171], a[232:235], v[208:211]
ds_read_b64_tr_b16 a[254:255], v18 offset:11776
v_fma_f32 v71, v71, s40, v4
v_mfma_f32_16x16x32_bf16 v[208:211], a[172:175], a[236:239], v[208:211]
v_add_f32 v27, v27, v68
s_waitcnt lgkmcnt(4)
v_mfma_f32_16x16x32_bf16 v[64:67], a[32:35], a[240:243], v[64:67]
v_exp_f32 v71, v71
v_mfma_f32_16x16x32_bf16 v[64:67], a[36:39], a[244:247], v[64:67]
v_add_f32 v27, v27, v69
v_mfma_f32_16x16x32_bf16 v[184:187], a[80:83], a[240:243], v[184:187]
v_add_f32 v19, v19, v70
v_mfma_f32_16x16x32_bf16 v[184:187], a[84:87], a[244:247], v[184:187]
s_waitcnt vmcnt(0) lgkmcnt(0)
s_barrier
v_mfma_f32_16x16x32_bf16 v[128:131], a[128:131], a[240:243], v[128:131]
ds_read_b64_tr_b16 a[192:193], v6 offset:0
v_add_f32 v19, v19, v71
v_mfma_f32_16x16x32_bf16 v[128:131], a[132:135], a[244:247], v[128:131]
ds_read_b64_tr_b16 a[194:195], v6 offset:512
v_fma_f32 v80, v80, s40, v29
v_mfma_f32_16x16x32_bf16 v[208:211], a[176:179], a[240:243], v[208:211]
v_exp_f32 v80, v80
v_mfma_f32_16x16x32_bf16 v[208:211], a[180:183], a[244:247], v[208:211]
ds_read_b64_tr_b16 a[196:197], v6 offset:1024
v_mfma_f32_16x16x32_bf16 v[64:67], a[40:43], a[248:251], v[64:67]
ds_read_b64_tr_b16 a[200:201], v6 offset:2048
v_fma_f32 v81, v81, s40, v29
v_mfma_f32_16x16x32_bf16 v[64:67], a[44:47], a[252:255], v[64:67]
ds_read_b64_tr_b16 a[198:199], v6 offset:1536
v_fma_f32 v82, v82, s40, v29
v_mfma_f32_16x16x32_bf16 v[184:187], a[88:91], a[248:251], v[184:187]
ds_read_b64_tr_b16 a[202:203], v6 offset:2560
v_fma_f32 v83, v83, s40, v29
v_mfma_f32_16x16x32_bf16 v[184:187], a[92:95], a[252:255], v[184:187]
v_exp_f32 v81, v81
v_mfma_f32_16x16x32_bf16 v[128:131], a[136:139], a[248:251], v[128:131]
ds_read_b64_tr_b16 a[208:209], v6 offset:3072
v_add_f32 v27, v27, v80
v_mfma_f32_16x16x32_bf16 v[128:131], a[140:143], a[252:255], v[128:131]
v_exp_f32 v82, v82
v_mfma_f32_16x16x32_bf16 v[208:211], a[184:187], a[248:251], v[208:211]
ds_read_b64_tr_b16 a[210:211], v6 offset:3584
s_mov_b32 s44, 704
v_mfma_f32_16x16x32_bf16 v[208:211], a[188:191], a[252:255], v[208:211]
v_mad_i32_i24 v8, v12, s44, v8
s_waitcnt lgkmcnt(3)
v_mfma_f32_16x16x32_bf16 v[112:115], a[192:195], a[0:3], 0
ds_read_b64_tr_b16 a[204:205], v6 offset:4096
s_add_u32 m0, s39, 49152
v_mfma_f32_16x16x32_bf16 v[112:115], a[196:199], a[4:7], v[112:115]
v_exp_f32 v83, v83
v_mfma_f32_16x16x32_bf16 v[252:255], a[192:195], a[48:51], 0
ds_read_b64_tr_b16 a[206:207], v6 offset:4608
s_add_u32 s42, s37, 3584
v_mfma_f32_16x16x32_bf16 v[252:255], a[196:199], a[52:55], v[252:255]
buffer_load_dwordx4 v8, s[20:23], s42 offen offset:0 lds
v_add_f32 v27, v27, v81
v_mfma_f32_16x16x32_bf16 v[36:39], a[192:195], a[96:99], 0
ds_read_b64_tr_b16 a[212:213], v6 offset:5120
v_add_f32 v19, v19, v82
v_mfma_f32_16x16x32_bf16 v[36:39], a[196:199], a[100:103], v[36:39]
v_add_f32 v19, v19, v83
v_fma_f32 v196, v196, s40, v29
v_mfma_f32_16x16x32_bf16 v[104:107], a[192:195], a[144:147], 0
ds_read_b64_tr_b16 a[214:215], v6 offset:5632
s_add_u32 s43, s37, 76288
v_mfma_f32_16x16x32_bf16 v[104:107], a[196:199], a[148:151], v[104:107]
buffer_load_dwordx4 v8, s[20:23], s43 offen offset:1024 lds
s_waitcnt lgkmcnt(4)
v_mfma_f32_16x16x32_bf16 v[112:115], a[200:203], a[8:11], v[112:115]
ds_read_b64_tr_b16 a[216:217], v6 offset:55296
v_fma_f32 v197, v197, s40, v29
v_mfma_f32_16x16x32_bf16 v[112:115], a[208:211], a[12:15], v[112:115]
v_exp_f32 v196, v196
v_mfma_f32_16x16x32_bf16 v[252:255], a[200:203], a[56:59], v[252:255]
ds_read_b64_tr_b16 a[218:219], v6 offset:55808
v_fma_f32 v198, v198, s40, v29
v_mfma_f32_16x16x32_bf16 v[252:255], a[208:211], a[60:63], v[252:255]
v_exp_f32 v197, v197
v_mfma_f32_16x16x32_bf16 v[36:39], a[200:203], a[104:107], v[36:39]
ds_read_b64_tr_b16 a[220:221], v6 offset:56320
s_add_u32 s42, s37, 148992
v_mfma_f32_16x16x32_bf16 v[36:39], a[208:211], a[108:111], v[36:39]
v_exp_f32 v198, v198
v_mfma_f32_16x16x32_bf16 v[104:107], a[200:203], a[152:155], v[104:107]
ds_read_b64_tr_b16 a[222:223], v6 offset:56832
buffer_load_dwordx4 v8, s[20:23], s42 offen offset:2048 lds
v_mfma_f32_16x16x32_bf16 v[104:107], a[208:211], a[156:159], v[104:107]
v_fma_f32 v199, v199, s40, v29
s_waitcnt lgkmcnt(4)
v_mfma_f32_16x16x32_bf16 v[112:115], a[204:207], a[16:19], v[112:115]
ds_read_b64_tr_b16 a[224:225], v6 offset:57344
v_add_f32 v27, v27, v196
v_mfma_f32_16x16x32_bf16 v[112:115], a[212:215], a[20:23], v[112:115]
v_exp_f32 v199, v199
v_mfma_f32_16x16x32_bf16 v[252:255], a[204:207], a[64:67], v[252:255]
ds_read_b64_tr_b16 a[226:227], v6 offset:57856
v_add_f32 v27, v27, v197
v_mfma_f32_16x16x32_bf16 v[252:255], a[212:215], a[68:71], v[252:255]
v_add_f32 v19, v19, v198
s_add_u32 s43, s37, 221696
v_mfma_f32_16x16x32_bf16 v[36:39], a[204:207], a[112:115], v[36:39]
ds_read_b64_tr_b16 a[228:229], v6 offset:58368
buffer_load_dwordx4 v8, s[20:23], s43 offen offset:3072 lds
v_mfma_f32_16x16x32_bf16 v[36:39], a[212:215], a[116:119], v[36:39]
v_add_f32 v19, v19, v199
v_add_f32 v27, v27, v19
v_mfma_f32_16x16x32_bf16 v[104:107], a[204:207], a[160:163], v[104:107]
ds_read_b64_tr_b16 a[230:231], v6 offset:58880
v_fma_f32 v152, v152, s40, v31
v_mfma_f32_16x16x32_bf16 v[104:107], a[212:215], a[164:167], v[104:107]
v_cvt_pk_bf16_f32 v188, v64, v65
s_waitcnt lgkmcnt(4)
v_mfma_f32_16x16x32_bf16 v[112:115], a[216:219], a[24:27], v[112:115]
ds_read_b64_tr_b16 a[232:233], v6 offset:59392
v_cvt_pk_bf16_f32 v189, v66, v67
v_mfma_f32_16x16x32_bf16 v[112:115], a[220:223], a[28:31], v[112:115]
v_exp_f32 v152, v152
v_mfma_f32_16x16x32_bf16 v[252:255], a[216:219], a[72:75], v[252:255]
ds_read_b64_tr_b16 a[234:235], v6 offset:59904
v_cvt_pk_bf16_f32 v190, v184, v185
v_mfma_f32_16x16x32_bf16 v[252:255], a[220:223], a[76:79], v[252:255]
v_cvt_pk_bf16_f32 v191, v186, v187
v_cvt_pk_bf16_f32 v216, v128, v129
v_mfma_f32_16x16x32_bf16 v[36:39], a[216:219], a[120:123], v[36:39]
ds_read_b64_tr_b16 a[236:237], v6 offset:60416
v_cvt_pk_bf16_f32 v217, v130, v131
v_mfma_f32_16x16x32_bf16 v[36:39], a[220:223], a[124:127], v[36:39]
v_cvt_pk_bf16_f32 v218, v208, v209
v_cvt_pk_bf16_f32 v219, v210, v211
v_mfma_f32_16x16x32_bf16 v[104:107], a[216:219], a[168:171], v[104:107]
ds_read_b64_tr_b16 a[238:239], v6 offset:60928
v_fma_f32 v153, v153, s40, v31
v_mfma_f32_16x16x32_bf16 v[104:107], a[220:223], a[172:175], v[104:107]
s_add_u32 m0, s39, 53248
s_waitcnt lgkmcnt(4)
v_mfma_f32_16x16x32_bf16 v[112:115], a[224:227], a[32:35], v[112:115]
ds_read_b64_tr_b16 a[240:241], v7 offset:0
s_add_u32 s42, s37, 298496
v_mfma_f32_16x16x32_bf16 v[112:115], a[228:231], a[36:39], v[112:115]
buffer_load_dwordx4 v8, s[20:23], s42 offen offset:0 lds
v_fma_f32 v154, v154, s40, v31
v_mfma_f32_16x16x32_bf16 v[252:255], a[224:227], a[80:83], v[252:255]
ds_read_b64_tr_b16 a[242:243], v7 offset:512
v_fma_f32 v155, v155, s40, v31
v_mfma_f32_16x16x32_bf16 v[252:255], a[228:231], a[84:87], v[252:255]
v_exp_f32 v153, v153
v_mfma_f32_16x16x32_bf16 v[36:39], a[224:227], a[128:131], v[36:39]
ds_read_b64_tr_b16 a[244:245], v7 offset:1024
s_add_u32 s43, s37, 371200
v_mfma_f32_16x16x32_bf16 v[36:39], a[228:231], a[132:135], v[36:39]
v_exp_f32 v154, v154
v_mfma_f32_16x16x32_bf16 v[104:107], a[224:227], a[176:179], v[104:107]
ds_read_b64_tr_b16 a[246:247], v7 offset:1536
buffer_load_dwordx4 v8, s[20:23], s43 offen offset:1024 lds
v_mfma_f32_16x16x32_bf16 v[104:107], a[228:231], a[180:183], v[104:107]
v_add_f32 v30, v152, v153
s_waitcnt lgkmcnt(4)
v_mfma_f32_16x16x32_bf16 v[112:115], a[232:235], a[40:43], v[112:115]
ds_read_b64_tr_b16 a[248:249], v7 offset:2048
v_fma_f32 v116, v116, s40, v31
v_mfma_f32_16x16x32_bf16 v[112:115], a[236:239], a[44:47], v[112:115]
v_exp_f32 v155, v155
v_mfma_f32_16x16x32_bf16 v[252:255], a[232:235], a[88:91], v[252:255]
ds_read_b64_tr_b16 a[250:251], v7 offset:2560
v_add_f32 v26, v154, v155
v_mfma_f32_16x16x32_bf16 v[252:255], a[236:239], a[92:95], v[252:255]
v_exp_f32 v116, v116
v_mfma_f32_16x16x32_bf16 v[36:39], a[232:235], a[136:139], v[36:39]
ds_read_b64_tr_b16 a[252:253], v7 offset:3072
s_add_u32 m0, s39, 6144
v_mfma_f32_16x16x32_bf16 v[36:39], a[236:239], a[140:143], v[36:39]
s_add_u32 s42, s37, 445952
buffer_load_dwordx4 v8, s[20:23], s42 offen offset:0 lds
v_mfma_f32_16x16x32_bf16 v[104:107], a[232:235], a[184:187], v[104:107]
ds_read_b64_tr_b16 a[254:255], v7 offset:3584
v_fma_f32 v117, v117, s40, v31
v_mfma_f32_16x16x32_bf16 v[104:107], a[236:239], a[188:191], v[104:107]
v_fma_f32 v118, v118, s40, v31
s_waitcnt lgkmcnt(4)
v_mfma_f32_16x16x32_bf16 v[220:223], a[240:243], a[0:3], 0
ds_read_b64_tr_b16 a[192:193], v7 offset:4096
s_add_u32 s43, s37, 518656
v_mfma_f32_16x16x32_bf16 v[220:223], a[244:247], a[4:7], v[220:223]
v_exp_f32 v117, v117
v_mfma_f32_16x16x32_bf16 v[224:227], a[240:243], a[48:51], 0
ds_read_b64_tr_b16 a[194:195], v7 offset:4608
buffer_load_dwordx4 v8, s[20:23], s43 offen offset:1024 lds
v_mfma_f32_16x16x32_bf16 v[224:227], a[244:247], a[52:55], v[224:227]
v_exp_f32 v118, v118
v_mfma_f32_16x16x32_bf16 v[228:231], a[240:243], a[96:99], 0
ds_read_b64_tr_b16 a[196:197], v7 offset:5120
v_fma_f32 v119, v119, s40, v31
v_mfma_f32_16x16x32_bf16 v[228:231], a[244:247], a[100:103], v[228:231]
v_exp_f32 v119, v119
v_mfma_f32_16x16x32_bf16 v[132:135], a[240:243], a[144:147], 0
ds_read_b64_tr_b16 a[198:199], v7 offset:5632
v_add_f32 v30, v30, v116
v_mfma_f32_16x16x32_bf16 v[132:135], a[244:247], a[148:151], v[132:135]
v_add_f32 v30, v30, v117
s_waitcnt lgkmcnt(4)
v_mfma_f32_16x16x32_bf16 v[220:223], a[248:251], a[8:11], v[220:223]
ds_read_b64_tr_b16 a[200:201], v7 offset:55296
v_add_f32 v26, v26, v118
v_mfma_f32_16x16x32_bf16 v[220:223], a[252:255], a[12:15], v[220:223]
s_add_u32 s42, s37, 591360
buffer_load_dwordx4 v8, s[20:23], s42 offen offset:2048 lds
v_mfma_f32_16x16x32_bf16 v[224:227], a[248:251], a[56:59], v[224:227]
ds_read_b64_tr_b16 a[202:203], v7 offset:55808
v_add_f32 v26, v26, v119
v_mfma_f32_16x16x32_bf16 v[224:227], a[252:255], a[60:63], v[224:227]
v_fma_f32 v96, v96, s40, v3
v_fma_f32 v97, v97, s40, v3
v_mfma_f32_16x16x32_bf16 v[228:231], a[248:251], a[104:107], v[228:231]
ds_read_b64_tr_b16 a[208:209], v7 offset:56320
s_add_u32 s43, s37, 664064
v_mfma_f32_16x16x32_bf16 v[228:231], a[252:255], a[108:111], v[228:231]
v_exp_f32 v96, v96
v_mfma_f32_16x16x32_bf16 v[132:135], a[248:251], a[152:155], v[132:135]
ds_read_b64_tr_b16 a[210:211], v7 offset:56832
buffer_load_dwordx4 v8, s[20:23], s43 offen offset:3072 lds
v_mfma_f32_16x16x32_bf16 v[132:135], a[252:255], a[156:159], v[132:135]
v_fma_f32 v98, v98, s40, v3
s_waitcnt lgkmcnt(4)
v_mfma_f32_16x16x32_bf16 v[220:223], a[192:195], a[16:19], v[220:223]
ds_read_b64_tr_b16 a[204:205], v7 offset:57344
v_fma_f32 v99, v99, s40, v3
v_mfma_f32_16x16x32_bf16 v[220:223], a[196:199], a[20:23], v[220:223]
v_exp_f32 v97, v97
v_mfma_f32_16x16x32_bf16 v[224:227], a[192:195], a[64:67], v[224:227]
ds_read_b64_tr_b16 a[206:207], v7 offset:57856
s_add_u32 m0, s39, 10240
v_mfma_f32_16x16x32_bf16 v[224:227], a[196:199], a[68:71], v[224:227]
v_exp_f32 v98, v98
v_mfma_f32_16x16x32_bf16 v[228:231], a[192:195], a[112:115], v[228:231]
ds_read_b64_tr_b16 a[212:213], v7 offset:58368
s_add_u32 s42, s37, 740864
v_mfma_f32_16x16x32_bf16 v[228:231], a[196:199], a[116:119], v[228:231]
v_exp_f32 v99, v99
v_mfma_f32_16x16x32_bf16 v[132:135], a[192:195], a[160:163], v[132:135]
ds_read_b64_tr_b16 a[214:215], v7 offset:58880
buffer_load_dwordx4 v8, s[20:23], s42 offen offset:0 lds
v_mfma_f32_16x16x32_bf16 v[132:135], a[196:199], a[164:167], v[132:135]
v_add_f32 v30, v30, v96
s_waitcnt lgkmcnt(4)
v_mfma_f32_16x16x32_bf16 v[220:223], a[200:203], a[24:27], v[220:223]
ds_read_b64_tr_b16 a[216:217], v7 offset:59392
v_add_f32 v30, v30, v97
v_mfma_f32_16x16x32_bf16 v[220:223], a[208:211], a[28:31], v[220:223]
v_add_f32 v26, v26, v98
v_add_f32 v26, v26, v99
v_mfma_f32_16x16x32_bf16 v[224:227], a[200:203], a[72:75], v[224:227]
ds_read_b64_tr_b16 a[218:219], v7 offset:59904
v_fma_f32 v232, v232, s40, v3
v_mfma_f32_16x16x32_bf16 v[224:227], a[208:211], a[76:79], v[224:227]
s_add_u32 s43, s37, 813568
buffer_load_dwordx4 v8, s[20:23], s43 offen offset:1024 lds
v_mfma_f32_16x16x32_bf16 v[228:231], a[200:203], a[120:123], v[228:231]
ds_read_b64_tr_b16 a[220:221], v7 offset:60416
v_fma_f32 v233, v233, s40, v3
v_mfma_f32_16x16x32_bf16 v[228:231], a[208:211], a[124:127], v[228:231]
v_exp_f32 v232, v232
v_mfma_f32_16x16x32_bf16 v[132:135], a[200:203], a[168:171], v[132:135]
ds_read_b64_tr_b16 a[222:223], v7 offset:60928
v_cvt_pk_bf16_f32 v172, v112, v113
v_mfma_f32_16x16x32_bf16 v[132:135], a[208:211], a[172:175], v[132:135]
v_cvt_pk_bf16_f32 v173, v114, v115
s_waitcnt lgkmcnt(4)
v_mfma_f32_16x16x32_bf16 v[220:223], a[204:207], a[32:35], v[220:223]
ds_read_b64_tr_b16 a[224:225], v17 offset:0
v_cvt_pk_bf16_f32 v140, v252, v253
v_mfma_f32_16x16x32_bf16 v[220:223], a[212:215], a[36:39], v[220:223]
v_exp_f32 v233, v233
v_mfma_f32_16x16x32_bf16 v[224:227], a[204:207], a[80:83], v[224:227]
ds_read_b64_tr_b16 a[226:227], v17 offset:512
v_cvt_pk_bf16_f32 v141, v254, v255
v_mfma_f32_16x16x32_bf16 v[224:227], a[212:215], a[84:87], v[224:227]
v_cvt_pk_bf16_f32 v160, v36, v37
v_cvt_pk_bf16_f32 v161, v38, v39
v_mfma_f32_16x16x32_bf16 v[228:231], a[204:207], a[128:131], v[228:231]
ds_read_b64_tr_b16 a[228:229], v17 offset:1024
v_cvt_pk_bf16_f32 v100, v104, v105
v_mfma_f32_16x16x32_bf16 v[228:231], a[212:215], a[132:135], v[228:231]
v_cvt_pk_bf16_f32 v101, v106, v107
v_fma_f32 v234, v234, s40, v3
v_mfma_f32_16x16x32_bf16 v[132:135], a[204:207], a[176:179], v[132:135]
ds_read_b64_tr_b16 a[230:231], v17 offset:1536
v_fma_f32 v235, v235, s40, v3
v_mfma_f32_16x16x32_bf16 v[132:135], a[212:215], a[180:183], v[132:135]
v_add_f32 v30, v30, v232
s_waitcnt lgkmcnt(4)
v_mfma_f32_16x16x32_bf16 v[220:223], a[216:219], a[40:43], v[220:223]
ds_read_b64_tr_b16 a[232:233], v17 offset:2048
v_add_f32 v30, v30, v233
v_mfma_f32_16x16x32_bf16 v[220:223], a[220:223], a[44:47], v[220:223]
v_exp_f32 v234, v234
v_mfma_f32_16x16x32_bf16 v[224:227], a[216:219], a[88:91], v[224:227]
ds_read_b64_tr_b16 a[234:235], v17 offset:2560
v_add_f32 v26, v26, v234
v_mfma_f32_16x16x32_bf16 v[224:227], a[220:223], a[92:95], v[224:227]
v_exp_f32 v235, v235
v_mfma_f32_16x16x32_bf16 v[228:231], a[216:219], a[136:139], v[228:231]
ds_read_b64_tr_b16 a[236:237], v17 offset:3072
v_add_f32 v26, v26, v235
v_mfma_f32_16x16x32_bf16 v[228:231], a[220:223], a[140:143], v[228:231]
v_add_f32 v30, v30, v26
v_permlane32_swap_b32 v15, v24
v_mfma_f32_16x16x32_bf16 v[132:135], a[216:219], a[184:187], v[132:135]
ds_read_b64_tr_b16 a[238:239], v17 offset:3584
v_add_f32 v25, v15, v24
v_mfma_f32_16x16x32_bf16 v[132:135], a[220:223], a[188:191], v[132:135]
v_permlane32_swap_b32 v27, v30
s_waitcnt lgkmcnt(4)
v_mfma_f32_16x16x32_bf16 v[88:91], a[224:227], a[0:3], 0
ds_read_b64_tr_b16 a[240:241], v17 offset:4096
v_add_f32 v20, v27, v30
v_mfma_f32_16x16x32_bf16 v[88:91], a[228:231], a[4:7], v[88:91]
v_cvt_pk_bf16_f32 v174, v220, v221
v_mfma_f32_16x16x32_bf16 v[120:123], a[224:227], a[48:51], 0
ds_read_b64_tr_b16 a[242:243], v17 offset:4608
v_permlane16_swap_b32 v25, v20
v_mfma_f32_16x16x32_bf16 v[120:123], a[228:231], a[52:55], v[120:123]
v_add_f32 v21, v25, v20
v_cvt_pk_bf16_f32 v175, v222, v223
v_mfma_f32_16x16x32_bf16 v[84:87], a[224:227], a[96:99], 0
ds_read_b64_tr_b16 a[244:245], v17 offset:5120
v_cvt_pk_bf16_f32 v142, v224, v225
v_mfma_f32_16x16x32_bf16 v[84:87], a[228:231], a[100:103], v[84:87]
v_rcp_f32 v21, v21
v_mfma_f32_16x16x32_bf16 v[92:95], a[224:227], a[144:147], 0
ds_read_b64_tr_b16 a[246:247], v17 offset:5632
v_mov_b32 v16, v21
v_mfma_f32_16x16x32_bf16 v[92:95], a[228:231], a[148:151], v[92:95]
v_cvt_pk_bf16_f32 v143, v226, v227
s_waitcnt lgkmcnt(4)
v_mfma_f32_16x16x32_bf16 v[88:91], a[232:235], a[8:11], v[88:91]
ds_read_b64_tr_b16 a[248:249], v17 offset:55296
v_permlane16_swap_b32 v21, v16
v_mfma_f32_16x16x32_bf16 v[88:91], a[236:239], a[12:15], v[88:91]
v_mov_b32 v5, v21
v_mov_b32 v22, v16
v_mfma_f32_16x16x32_bf16 v[120:123], a[232:235], a[56:59], v[120:123]
ds_read_b64_tr_b16 a[250:251], v17 offset:55808
v_mfma_f32_16x16x32_bf16 v[120:123], a[236:239], a[60:63], v[120:123]
v_permlane32_swap_b32 v21, v5
v_permlane32_swap_b32 v16, v22
v_mfma_f32_16x16x32_bf16 v[84:87], a[232:235], a[104:107], v[84:87]
ds_read_b64_tr_b16 a[252:253], v17 offset:56320
v_mul_f32 v144, v144, v21
v_mfma_f32_16x16x32_bf16 v[84:87], a[236:239], a[108:111], v[84:87]
v_mul_f32 v145, v145, v21
v_mul_f32 v146, v146, v21
v_mfma_f32_16x16x32_bf16 v[92:95], a[232:235], a[152:155], v[92:95]
ds_read_b64_tr_b16 a[254:255], v17 offset:56832
v_mul_f32 v147, v147, v21
v_mfma_f32_16x16x32_bf16 v[92:95], a[236:239], a[156:159], v[92:95]
v_cvt_pk_bf16_f32 v164, v144, v145
s_waitcnt lgkmcnt(4)
v_mfma_f32_16x16x32_bf16 v[88:91], a[240:243], a[16:19], v[88:91]
ds_read_b64_tr_b16 a[192:193], v17 offset:57344
v_cvt_pk_bf16_f32 v165, v146, v147
v_mfma_f32_16x16x32_bf16 v[88:91], a[244:247], a[20:23], v[88:91]
v_mul_f32 v40, v40, v21
v_mul_f32 v41, v41, v21
v_mfma_f32_16x16x32_bf16 v[120:123], a[240:243], a[64:67], v[120:123]
ds_read_b64_tr_b16 a[194:195], v17 offset:57856
v_mul_f32 v42, v42, v21
v_mfma_f32_16x16x32_bf16 v[120:123], a[244:247], a[68:71], v[120:123]
v_mul_f32 v43, v43, v21
v_cvt_pk_bf16_f32 v166, v40, v41
v_mfma_f32_16x16x32_bf16 v[84:87], a[240:243], a[112:115], v[84:87]
ds_read_b64_tr_b16 a[196:197], v17 offset:58368
v_cvt_pk_bf16_f32 v167, v42, v43
v_mfma_f32_16x16x32_bf16 v[84:87], a[244:247], a[116:119], v[84:87]
v_mul_f32 v48, v48, v21
v_mul_f32 v49, v49, v21
v_mfma_f32_16x16x32_bf16 v[92:95], a[240:243], a[160:163], v[92:95]
ds_read_b64_tr_b16 a[198:199], v17 offset:58880
v_mul_f32 v50, v50, v21
v_mfma_f32_16x16x32_bf16 v[92:95], a[244:247], a[164:167], v[92:95]
v_cvt_pk_bf16_f32 v162, v228, v229
s_waitcnt lgkmcnt(4)
v_mfma_f32_16x16x32_bf16 v[88:91], a[248:251], a[24:27], v[88:91]
ds_read_b64_tr_b16 a[200:201], v17 offset:59392
v_cvt_pk_bf16_f32 v163, v230, v231
v_mfma_f32_16x16x32_bf16 v[88:91], a[252:255], a[28:31], v[88:91]
v_cvt_pk_bf16_f32 v102, v132, v133
v_cvt_pk_bf16_f32 v103, v134, v135
v_mfma_f32_16x16x32_bf16 v[120:123], a[248:251], a[72:75], v[120:123]
ds_read_b64_tr_b16 a[202:203], v17 offset:59904
v_mul_f32 v51, v51, v21
v_mfma_f32_16x16x32_bf16 v[120:123], a[252:255], a[76:79], v[120:123]
v_cvt_pk_bf16_f32 v168, v48, v49
v_cvt_pk_bf16_f32 v169, v50, v51
v_mfma_f32_16x16x32_bf16 v[84:87], a[248:251], a[120:123], v[84:87]
ds_read_b64_tr_b16 a[208:209], v17 offset:60416
v_mul_f32 v248, v248, v21
v_mfma_f32_16x16x32_bf16 v[84:87], a[252:255], a[124:127], v[84:87]
v_mul_f32 v249, v249, v21
v_mul_f32 v250, v250, v21
v_mfma_f32_16x16x32_bf16 v[92:95], a[248:251], a[168:171], v[92:95]
ds_read_b64_tr_b16 a[210:211], v17 offset:60928
v_mul_f32 v251, v251, v21
v_mfma_f32_16x16x32_bf16 v[92:95], a[252:255], a[172:175], v[92:95]
v_cvt_pk_bf16_f32 v170, v248, v249
s_waitcnt lgkmcnt(4)
v_mfma_f32_16x16x32_bf16 v[88:91], a[192:195], a[32:35], v[88:91]
ds_read_b64_tr_b16 a[204:205], v18 offset:0
v_cvt_pk_bf16_f32 v171, v250, v251
v_mfma_f32_16x16x32_bf16 v[88:91], a[196:199], a[36:39], v[88:91]
v_mul_f32 v240, v240, v5
v_mfma_f32_16x16x32_bf16 v[120:123], a[192:195], a[80:83], v[120:123]
ds_read_b64_tr_b16 a[206:207], v18 offset:512
v_mfma_f32_16x16x32_bf16 v[120:123], a[196:199], a[84:87], v[120:123]
v_mul_f32 v241, v241, v5
v_mul_f32 v242, v242, v5
v_mfma_f32_16x16x32_bf16 v[84:87], a[192:195], a[128:131], v[84:87]
ds_read_b64_tr_b16 a[212:213], v18 offset:1024
v_mul_f32 v243, v243, v5
v_mfma_f32_16x16x32_bf16 v[84:87], a[196:199], a[132:135], v[84:87]
v_cvt_pk_bf16_f32 v44, v240, v241
v_cvt_pk_bf16_f32 v45, v242, v243
v_mfma_f32_16x16x32_bf16 v[92:95], a[192:195], a[176:179], v[92:95]
ds_read_b64_tr_b16 a[214:215], v18 offset:1536
v_mfma_f32_16x16x32_bf16 v[92:95], a[196:199], a[180:183], v[92:95]
s_waitcnt lgkmcnt(4)
v_mfma_f32_16x16x32_bf16 v[88:91], a[200:203], a[40:43], v[88:91]
ds_read_b64_tr_b16 a[216:217], v18 offset:2048
v_mfma_f32_16x16x32_bf16 v[88:91], a[208:211], a[44:47], v[88:91]
v_mul_f32 v200, v200, v5
v_mfma_f32_16x16x32_bf16 v[120:123], a[200:203], a[88:91], v[120:123]
ds_read_b64_tr_b16 a[218:219], v18 offset:2560
v_mfma_f32_16x16x32_bf16 v[120:123], a[208:211], a[92:95], v[120:123]
v_mul_f32 v201, v201, v5
v_mul_f32 v202, v202, v5
v_mfma_f32_16x16x32_bf16 v[84:87], a[200:203], a[136:139], v[84:87]
ds_read_b64_tr_b16 a[220:221], v18 offset:3072
v_mul_f32 v203, v203, v5
v_mfma_f32_16x16x32_bf16 v[84:87], a[208:211], a[140:143], v[84:87]
v_cvt_pk_bf16_f32 v46, v200, v201
v_cvt_pk_bf16_f32 v47, v202, v203
v_mfma_f32_16x16x32_bf16 v[92:95], a[200:203], a[184:187], v[92:95]
ds_read_b64_tr_b16 a[222:223], v18 offset:3584
v_mfma_f32_16x16x32_bf16 v[92:95], a[208:211], a[188:191], v[92:95]
s_waitcnt lgkmcnt(4)
v_mfma_f32_16x16x32_bf16 v[244:247], a[204:207], a[0:3], 0
ds_read_b64_tr_b16 a[224:225], v18 offset:4096
v_mul_f32 v156, v156, v5
v_mfma_f32_16x16x32_bf16 v[244:247], a[212:215], a[4:7], v[244:247]
v_mul_f32 v157, v157, v5
v_mul_f32 v158, v158, v5
v_mfma_f32_16x16x32_bf16 v[72:75], a[204:207], a[48:51], 0
ds_read_b64_tr_b16 a[226:227], v18 offset:4608
v_mul_f32 v159, v159, v5
v_mfma_f32_16x16x32_bf16 v[72:75], a[212:215], a[52:55], v[72:75]
v_cvt_pk_bf16_f32 v124, v156, v157
v_cvt_pk_bf16_f32 v125, v158, v159
v_mfma_f32_16x16x32_bf16 v[32:35], a[204:207], a[96:99], 0
ds_read_b64_tr_b16 a[228:229], v18 offset:5120
v_mul_f32 v60, v60, v5
v_mfma_f32_16x16x32_bf16 v[32:35], a[212:215], a[100:103], v[32:35]
v_mul_f32 v61, v61, v5
v_mul_f32 v62, v62, v5
v_mfma_f32_16x16x32_bf16 v[148:151], a[204:207], a[144:147], 0
ds_read_b64_tr_b16 a[230:231], v18 offset:5632
v_mul_f32 v63, v63, v5
v_mfma_f32_16x16x32_bf16 v[148:151], a[212:215], a[148:151], v[148:151]
v_cvt_pk_bf16_f32 v126, v60, v61
s_waitcnt lgkmcnt(4)
v_mfma_f32_16x16x32_bf16 v[244:247], a[216:219], a[8:11], v[244:247]
ds_read_b64_tr_b16 a[232:233], v18 offset:55296
v_cvt_pk_bf16_f32 v127, v62, v63
v_mfma_f32_16x16x32_bf16 v[244:247], a[220:223], a[12:15], v[244:247]
v_mul_f32 v76, v76, v16
v_cvt_pk_bf16_f32 v64, v88, v89
v_mfma_f32_16x16x32_bf16 v[72:75], a[216:219], a[56:59], v[72:75]
ds_read_b64_tr_b16 a[234:235], v18 offset:55808
v_mul_f32 v77, v77, v16
v_mfma_f32_16x16x32_bf16 v[72:75], a[220:223], a[60:63], v[72:75]
v_cvt_pk_bf16_f32 v65, v90, v91
v_cvt_pk_bf16_f32 v184, v120, v121
v_mfma_f32_16x16x32_bf16 v[32:35], a[216:219], a[104:107], v[32:35]
ds_read_b64_tr_b16 a[236:237], v18 offset:56320
v_mul_f32 v78, v78, v16
v_mfma_f32_16x16x32_bf16 v[32:35], a[220:223], a[108:111], v[32:35]
v_mul_f32 v79, v79, v16
v_cvt_pk_bf16_f32 v185, v122, v123
v_mfma_f32_16x16x32_bf16 v[148:151], a[216:219], a[152:155], v[148:151]
ds_read_b64_tr_b16 a[238:239], v18 offset:56832
v_cvt_pk_bf16_f32 v128, v84, v85
v_mfma_f32_16x16x32_bf16 v[148:151], a[220:223], a[156:159], v[148:151]
s_waitcnt lgkmcnt(4)
v_mfma_f32_16x16x32_bf16 v[244:247], a[224:227], a[16:19], v[244:247]
ds_read_b64_tr_b16 a[240:241], v18 offset:57344
v_cvt_pk_bf16_f32 v129, v86, v87
v_mfma_f32_16x16x32_bf16 v[244:247], a[228:231], a[20:23], v[244:247]
v_cvt_pk_bf16_f32 v208, v92, v93
v_mfma_f32_16x16x32_bf16 v[72:75], a[224:227], a[64:67], v[72:75]
ds_read_b64_tr_b16 a[242:243], v18 offset:57856
v_cvt_pk_bf16_f32 v209, v94, v95
v_mfma_f32_16x16x32_bf16 v[72:75], a[228:231], a[68:71], v[72:75]
v_cvt_pk_bf16_f32 v112, v76, v77
v_mfma_f32_16x16x32_bf16 v[32:35], a[224:227], a[112:115], v[32:35]
ds_read_b64_tr_b16 a[244:245], v18 offset:58368
v_mfma_f32_16x16x32_bf16 v[32:35], a[228:231], a[116:119], v[32:35]
v_cvt_pk_bf16_f32 v113, v78, v79
v_mfma_f32_16x16x32_bf16 v[148:151], a[224:227], a[160:163], v[148:151]
ds_read_b64_tr_b16 a[246:247], v18 offset:58880
v_mfma_f32_16x16x32_bf16 v[148:151], a[228:231], a[164:167], v[148:151]
s_waitcnt lgkmcnt(4)
v_mfma_f32_16x16x32_bf16 v[244:247], a[232:235], a[24:27], v[244:247]
ds_read_b64_tr_b16 a[248:249], v18 offset:59392
v_mfma_f32_16x16x32_bf16 v[244:247], a[236:239], a[28:31], v[244:247]
v_mul_f32 v68, v68, v16
v_mfma_f32_16x16x32_bf16 v[72:75], a[232:235], a[72:75], v[72:75]
ds_read_b64_tr_b16 a[250:251], v18 offset:59904
v_mul_f32 v69, v69, v16
v_mfma_f32_16x16x32_bf16 v[72:75], a[236:239], a[76:79], v[72:75]
v_mul_f32 v70, v70, v16
v_mul_f32 v71, v71, v16
v_mfma_f32_16x16x32_bf16 v[32:35], a[232:235], a[120:123], v[32:35]
ds_read_b64_tr_b16 a[252:253], v18 offset:60416
v_cvt_pk_bf16_f32 v114, v68, v69
v_mfma_f32_16x16x32_bf16 v[32:35], a[236:239], a[124:127], v[32:35]
v_cvt_pk_bf16_f32 v115, v70, v71
v_mfma_f32_16x16x32_bf16 v[148:151], a[232:235], a[168:171], v[148:151]
ds_read_b64_tr_b16 a[254:255], v18 offset:60928
v_mfma_f32_16x16x32_bf16 v[148:151], a[236:239], a[172:175], v[148:151]
s_waitcnt lgkmcnt(4)
v_mfma_f32_16x16x32_bf16 v[244:247], a[240:243], a[32:35], v[244:247]
v_mul_f32 v80, v80, v16
v_mfma_f32_16x16x32_bf16 v[244:247], a[244:247], a[36:39], v[244:247]
v_mul_f32 v81, v81, v16
v_mfma_f32_16x16x32_bf16 v[72:75], a[240:243], a[80:83], v[72:75]
v_mul_f32 v82, v82, v16
v_mfma_f32_16x16x32_bf16 v[72:75], a[244:247], a[84:87], v[72:75]
s_waitcnt vmcnt(0) lgkmcnt(0)
s_barrier
v_mfma_f32_16x16x32_bf16 v[32:35], a[240:243], a[128:131], v[32:35]
ds_read_b64_tr_b16 a[192:193], v6 offset:49152
v_mul_f32 v83, v83, v16
v_mfma_f32_16x16x32_bf16 v[32:35], a[244:247], a[132:135], v[32:35]
ds_read_b64_tr_b16 a[194:195], v6 offset:49664
v_cvt_pk_bf16_f32 v252, v80, v81
v_mfma_f32_16x16x32_bf16 v[148:151], a[240:243], a[176:179], v[148:151]
v_cvt_pk_bf16_f32 v253, v82, v83
v_mul_f32 v196, v196, v16
v_mfma_f32_16x16x32_bf16 v[148:151], a[244:247], a[180:183], v[148:151]
ds_read_b64_tr_b16 a[196:197], v6 offset:50176
v_mfma_f32_16x16x32_bf16 v[244:247], a[248:251], a[40:43], v[244:247]
ds_read_b64_tr_b16 a[200:201], v6 offset:51200
v_mul_f32 v197, v197, v16
v_mfma_f32_16x16x32_bf16 v[244:247], a[252:255], a[44:47], v[244:247]
ds_read_b64_tr_b16 a[198:199], v6 offset:50688
v_mul_f32 v198, v198, v16
v_mfma_f32_16x16x32_bf16 v[72:75], a[248:251], a[88:91], v[72:75]
ds_read_b64_tr_b16 a[202:203], v6 offset:51712
v_mul_f32 v199, v199, v16
v_mfma_f32_16x16x32_bf16 v[72:75], a[252:255], a[92:95], v[72:75]
v_cvt_pk_bf16_f32 v254, v196, v197
s_mov_b32 s44, -704
v_mfma_f32_16x16x32_bf16 v[32:35], a[248:251], a[136:139], v[32:35]
ds_read_b64_tr_b16 a[208:209], v6 offset:52224
v_mad_i32_i24 v8, v12, s44, v8
v_mfma_f32_16x16x32_bf16 v[32:35], a[252:255], a[140:143], v[32:35]
s_add_u32 m0, s39, 0
s_add_u32 s42, s37, 4224
v_mfma_f32_16x16x32_bf16 v[148:151], a[248:251], a[184:187], v[148:151]
ds_read_b64_tr_b16 a[210:211], v6 offset:52736
buffer_load_dwordx4 v8, s[20:23], s42 offen offset:0 lds
v_mfma_f32_16x16x32_bf16 v[148:151], a[252:255], a[188:191], v[148:151]
v_cvt_pk_bf16_f32 v255, v198, v199
s_waitcnt lgkmcnt(3)
v_mfma_f32_16x16x32_bf16 v[36:39], a[192:195], a[0:3], 0
ds_read_b64_tr_b16 a[204:205], v6 offset:53248
v_mul_f32 v152, v152, v22
v_mfma_f32_16x16x32_bf16 v[36:39], a[196:199], a[4:7], v[36:39]
v_mul_f32 v153, v153, v22
v_mul_f32 v154, v154, v22
v_mfma_f32_16x16x32_bf16 v[104:107], a[192:195], a[48:51], 0
ds_read_b64_tr_b16 a[206:207], v6 offset:53760
v_mul_f32 v155, v155, v22
v_mfma_f32_16x16x32_bf16 v[104:107], a[196:199], a[52:55], v[104:107]
s_add_u32 s43, s37, 76928
buffer_load_dwordx4 v8, s[20:23], s43 offen offset:1024 lds
v_mfma_f32_16x16x32_bf16 v[220:223], a[192:195], a[96:99], 0
ds_read_b64_tr_b16 a[212:213], v6 offset:54272
v_cvt_pk_bf16_f32 v224, v152, v153
v_mfma_f32_16x16x32_bf16 v[220:223], a[196:199], a[100:103], v[220:223]
v_cvt_pk_bf16_f32 v225, v154, v155
v_mul_f32 v116, v116, v22
v_mfma_f32_16x16x32_bf16 v[144:147], a[192:195], a[144:147], 0
ds_read_b64_tr_b16 a[214:215], v6 offset:54784
v_mul_f32 v117, v117, v22
v_mfma_f32_16x16x32_bf16 v[144:147], a[196:199], a[148:151], v[144:147]
s_add_u32 s42, s37, 149632
s_waitcnt lgkmcnt(4)
v_mfma_f32_16x16x32_bf16 v[36:39], a[200:203], a[8:11], v[36:39]
ds_read_b64_tr_b16 a[216:217], v6 offset:6144
buffer_load_dwordx4 v8, s[20:23], s42 offen offset:2048 lds
v_mfma_f32_16x16x32_bf16 v[36:39], a[208:211], a[12:15], v[36:39]
v_mul_f32 v118, v118, v22
v_mul_f32 v119, v119, v22
v_mfma_f32_16x16x32_bf16 v[104:107], a[200:203], a[56:59], v[104:107]
ds_read_b64_tr_b16 a[218:219], v6 offset:6656
v_cvt_pk_bf16_f32 v226, v116, v117
v_mfma_f32_16x16x32_bf16 v[104:107], a[208:211], a[60:63], v[104:107]
v_cvt_pk_bf16_f32 v227, v118, v119
v_mul_f32 v96, v96, v22
v_mfma_f32_16x16x32_bf16 v[220:223], a[200:203], a[104:107], v[220:223]
ds_read_b64_tr_b16 a[220:221], v6 offset:7168
s_add_u32 s43, s37, 222336
v_mfma_f32_16x16x32_bf16 v[220:223], a[208:211], a[108:111], v[220:223]
buffer_load_dwordx4 v8, s[20:23], s43 offen offset:3072 lds
v_mul_f32 v97, v97, v22
v_mfma_f32_16x16x32_bf16 v[144:147], a[200:203], a[152:155], v[144:147]
ds_read_b64_tr_b16 a[222:223], v6 offset:7680
v_mul_f32 v98, v98, v22
v_mfma_f32_16x16x32_bf16 v[144:147], a[208:211], a[156:159], v[144:147]
v_mul_f32 v99, v99, v22
s_waitcnt lgkmcnt(4)
v_mfma_f32_16x16x32_bf16 v[36:39], a[204:207], a[16:19], v[36:39]
ds_read_b64_tr_b16 a[224:225], v6 offset:8192
v_cvt_pk_bf16_f32 v40, v96, v97
v_mfma_f32_16x16x32_bf16 v[36:39], a[212:215], a[20:23], v[36:39]
v_cvt_pk_bf16_f32 v66, v244, v245
v_cvt_pk_bf16_f32 v67, v246, v247
v_mfma_f32_16x16x32_bf16 v[104:107], a[204:207], a[64:67], v[104:107]
ds_read_b64_tr_b16 a[226:227], v6 offset:8704
v_cvt_pk_bf16_f32 v186, v72, v73
v_mfma_f32_16x16x32_bf16 v[104:107], a[212:215], a[68:71], v[104:107]
v_cvt_pk_bf16_f32 v187, v74, v75
v_cvt_pk_bf16_f32 v130, v32, v33
v_mfma_f32_16x16x32_bf16 v[220:223], a[204:207], a[112:115], v[220:223]
ds_read_b64_tr_b16 a[228:229], v6 offset:9216
v_cvt_pk_bf16_f32 v131, v34, v35
v_mfma_f32_16x16x32_bf16 v[220:223], a[212:215], a[116:119], v[220:223]
v_cvt_pk_bf16_f32 v210, v148, v149
v_cvt_pk_bf16_f32 v211, v150, v151
v_mfma_f32_16x16x32_bf16 v[144:147], a[204:207], a[160:163], v[144:147]
ds_read_b64_tr_b16 a[230:231], v6 offset:9728
s_add_u32 m0, s39, 4096
v_mfma_f32_16x16x32_bf16 v[144:147], a[212:215], a[164:167], v[144:147]
s_add_u32 s42, s37, 299136
s_waitcnt lgkmcnt(4)
v_mfma_f32_16x16x32_bf16 v[36:39], a[216:219], a[24:27], v[36:39]
ds_read_b64_tr_b16 a[232:233], v6 offset:10240
buffer_load_dwordx4 v8, s[20:23], s42 offen offset:0 lds
v_mfma_f32_16x16x32_bf16 v[36:39], a[220:223], a[28:31], v[36:39]
v_cvt_pk_bf16_f32 v41, v98, v99
v_mul_f32 v232, v232, v22
v_mfma_f32_16x16x32_bf16 v[104:107], a[216:219], a[72:75], v[104:107]
ds_read_b64_tr_b16 a[234:235], v6 offset:10752
v_mul_f32 v233, v233, v22
v_mfma_f32_16x16x32_bf16 v[104:107], a[220:223], a[76:79], v[104:107]
v_mul_f32 v234, v234, v22
v_mfma_f32_16x16x32_bf16 v[220:223], a[216:219], a[120:123], v[220:223]
ds_read_b64_tr_b16 a[236:237], v6 offset:11264
v_mfma_f32_16x16x32_bf16 v[220:223], a[220:223], a[124:127], v[220:223]
v_mul_f32 v235, v235, v22
v_mfma_f32_16x16x32_bf16 v[144:147], a[216:219], a[168:171], v[144:147]
ds_read_b64_tr_b16 a[238:239], v6 offset:11776
v_mfma_f32_16x16x32_bf16 v[144:147], a[220:223], a[172:175], v[144:147]
s_add_u32 s43, s37, 371840
s_waitcnt lgkmcnt(4)
v_mfma_f32_16x16x32_bf16 v[36:39], a[224:227], a[32:35], v[36:39]
ds_read_b64_tr_b16 a[240:241], v7 offset:49152
buffer_load_dwordx4 v8, s[20:23], s43 offen offset:1024 lds
v_mfma_f32_16x16x32_bf16 v[36:39], a[228:231], a[36:39], v[36:39]
v_cvt_pk_bf16_f32 v42, v232, v233
v_mfma_f32_16x16x32_bf16 v[104:107], a[224:227], a[80:83], v[104:107]
ds_read_b64_tr_b16 a[242:243], v7 offset:49664
v_cvt_pk_bf16_f32 v43, v234, v235
v_mfma_f32_16x16x32_bf16 v[104:107], a[228:231], a[84:87], v[104:107]
s_add_u32 m0, s39, 55296
v_mfma_f32_16x16x32_bf16 v[220:223], a[224:227], a[128:131], v[220:223]
ds_read_b64_tr_b16 a[244:245], v7 offset:50176
v_mfma_f32_16x16x32_bf16 v[220:223], a[228:231], a[132:135], v[220:223]
s_add_u32 s42, s37, 446592
buffer_load_dwordx4 v8, s[20:23], s42 offen offset:0 lds
v_mfma_f32_16x16x32_bf16 v[144:147], a[224:227], a[176:179], v[144:147]
ds_read_b64_tr_b16 a[246:247], v7 offset:50688
v_mfma_f32_16x16x32_bf16 v[144:147], a[228:231], a[180:183], v[144:147]
s_waitcnt lgkmcnt(4)
v_mfma_f32_16x16x32_bf16 v[36:39], a[232:235], a[40:43], v[36:39]
ds_read_b64_tr_b16 a[248:249], v7 offset:51200
v_mfma_f32_16x16x32_bf16 v[36:39], a[236:239], a[44:47], v[36:39]
s_add_u32 s43, s37, 519296
v_mfma_f32_16x16x32_bf16 v[104:107], a[232:235], a[88:91], v[104:107]
ds_read_b64_tr_b16 a[250:251], v7 offset:51712
v_mfma_f32_16x16x32_bf16 v[104:107], a[236:239], a[92:95], v[104:107]
buffer_load_dwordx4 v8, s[20:23], s43 offen offset:1024 lds
v_mfma_f32_16x16x32_bf16 v[220:223], a[232:235], a[136:139], v[220:223]
ds_read_b64_tr_b16 a[252:253], v7 offset:52224
v_mfma_f32_16x16x32_bf16 v[220:223], a[236:239], a[140:143], v[220:223]
s_add_u32 s42, s37, 592000
v_mfma_f32_16x16x32_bf16 v[144:147], a[232:235], a[184:187], v[144:147]
ds_read_b64_tr_b16 a[254:255], v7 offset:52736
v_mfma_f32_16x16x32_bf16 v[144:147], a[236:239], a[188:191], v[144:147]
buffer_load_dwordx4 v8, s[20:23], s42 offen offset:2048 lds
v_mfma_f32_16x16x32_bf16 v[228:231], v[108:111], v[164:167], 0
s_add_u32 s43, s37, 664704
v_mfma_f32_16x16x32_bf16 v[228:231], v[236:239], v[168:171], v[228:231]
buffer_load_dwordx4 v8, s[20:23], s43 offen offset:3072 lds
v_mfma_f32_16x16x32_bf16 v[132:135], v[108:111], v[44:47], 0
s_add_u32 m0, s39, 59392
s_add_u32 s42, s37, 741504
v_mfma_f32_16x16x32_bf16 v[132:135], v[236:239], v[124:127], v[132:135]
buffer_load_dwordx4 v8, s[20:23], s42 offen offset:0 lds
v_mfma_f32_16x16x32_bf16 v[48:51], v[108:111], v[112:115], 0
v_cvt_pk_bf16_f32 v248, v36, v37
v_cvt_pk_bf16_f32 v249, v38, v39
v_mfma_f32_16x16x32_bf16 v[48:51], v[236:239], v[252:255], v[48:51]
v_cvt_pk_bf16_f32 v240, v104, v105
v_mfma_f32_16x16x32_bf16 v[200:203], v[108:111], v[224:227], 0
s_add_u32 s43, s37, 814208
buffer_load_dwordx4 v8, s[20:23], s43 offen offset:1024 lds
v_mfma_f32_16x16x32_bf16 v[200:203], v[236:239], v[40:43], v[200:203]
v_cvt_pk_bf16_f32 v241, v106, v107
v_mfma_f32_16x16x32_bf16 v[156:159], v[212:215], v[164:167], 0
v_cvt_pk_bf16_f32 v60, v220, v221
v_cvt_pk_bf16_f32 v61, v222, v223
v_mfma_f32_16x16x32_bf16 v[156:159], v[176:179], v[168:171], v[156:159]
v_cvt_pk_bf16_f32 v88, v144, v145
v_mfma_f32_16x16x32_bf16 v[120:123], v[212:215], v[44:47], 0
v_cvt_pk_bf16_f32 v89, v146, v147
v_mfma_f32_16x16x32_bf16 v[120:123], v[176:179], v[124:127], v[120:123]
v_cvt_pk_bf16_f32 v84, v228, v229
v_mfma_f32_16x16x32_bf16 v[92:95], v[212:215], v[112:115], 0
v_cvt_pk_bf16_f32 v85, v230, v231
v_cvt_pk_bf16_f32 v76, v132, v133
v_mfma_f32_16x16x32_bf16 v[92:95], v[176:179], v[252:255], v[92:95]
v_cvt_pk_bf16_f32 v77, v134, v135
v_cvt_pk_bf16_f32 v68, v48, v49
v_mfma_f32_16x16x32_bf16 v[80:83], v[212:215], v[224:227], 0
v_cvt_pk_bf16_f32 v69, v50, v51
v_cvt_pk_bf16_f32 v196, v200, v201
v_mfma_f32_16x16x32_bf16 v[80:83], v[176:179], v[40:43], v[80:83]
v_cvt_pk_bf16_f32 v197, v202, v203
v_accvgpr_write_b32 a192, v84
v_mfma_f32_16x16x32_bf16 v[152:155], v[52:55], v[164:167], 0
v_cvt_pk_bf16_f32 v86, v156, v157
v_cvt_pk_bf16_f32 v87, v158, v159
v_mfma_f32_16x16x32_bf16 v[152:155], v[56:59], v[168:171], v[152:155]
v_accvgpr_write_b32 a193, v85
v_accvgpr_write_b32 a194, v86
v_mfma_f32_16x16x32_bf16 v[116:119], v[52:55], v[44:47], 0
v_cvt_pk_bf16_f32 v78, v120, v121
v_cvt_pk_bf16_f32 v79, v122, v123
v_mfma_f32_16x16x32_bf16 v[116:119], v[56:59], v[124:127], v[116:119]
v_accvgpr_write_b32 a195, v87
v_accvgpr_write_b32 a196, v76
v_mfma_f32_16x16x32_bf16 v[244:247], v[52:55], v[112:115], 0
v_cvt_pk_bf16_f32 v70, v92, v93
v_cvt_pk_bf16_f32 v71, v94, v95
v_mfma_f32_16x16x32_bf16 v[244:247], v[56:59], v[252:255], v[244:247]
v_accvgpr_write_b32 a197, v77
v_accvgpr_write_b32 a198, v78
v_mfma_f32_16x16x32_bf16 v[72:75], v[52:55], v[224:227], 0
v_cvt_pk_bf16_f32 v198, v80, v81
v_cvt_pk_bf16_f32 v199, v82, v83
v_mfma_f32_16x16x32_bf16 v[72:75], v[56:59], v[40:43], v[72:75]
v_accvgpr_write_b32 a199, v79
v_accvgpr_write_b32 a200, v68
v_mfma_f32_16x16x32_bf16 v[32:35], v[136:139], v[164:167], 0
v_cvt_pk_bf16_f32 v148, v152, v153
v_cvt_pk_bf16_f32 v149, v154, v155
v_mfma_f32_16x16x32_bf16 v[32:35], v[192:195], v[168:171], v[32:35]
v_accvgpr_write_b32 a201, v69
v_accvgpr_write_b32 a202, v70
v_mfma_f32_16x16x32_bf16 v[96:99], v[136:139], v[44:47], 0
v_cvt_pk_bf16_f32 v232, v116, v117
v_cvt_pk_bf16_f32 v233, v118, v119
v_mfma_f32_16x16x32_bf16 v[96:99], v[192:195], v[124:127], v[96:99]
v_accvgpr_write_b32 a203, v71
v_accvgpr_write_b32 a208, v196
v_mfma_f32_16x16x32_bf16 v[36:39], v[136:139], v[112:115], 0
v_cvt_pk_bf16_f32 v108, v244, v245
v_cvt_pk_bf16_f32 v109, v246, v247
v_mfma_f32_16x16x32_bf16 v[36:39], v[192:195], v[252:255], v[36:39]
v_accvgpr_write_b32 a209, v197
v_accvgpr_write_b32 a210, v198
v_mfma_f32_16x16x32_bf16 v[236:239], v[136:139], v[224:227], 0
v_cvt_pk_bf16_f32 v104, v72, v73
v_cvt_pk_bf16_f32 v105, v74, v75
v_mfma_f32_16x16x32_bf16 v[236:239], v[192:195], v[40:43], v[236:239]
v_accvgpr_write_b32 a211, v199
v_accvgpr_write_b32 a204, v148
v_mfma_f32_16x16x32_bf16 v[220:223], v[180:183], v[164:167], 0
v_cvt_pk_bf16_f32 v150, v32, v33
v_cvt_pk_bf16_f32 v151, v34, v35
v_mfma_f32_16x16x32_bf16 v[220:223], v[204:207], v[168:171], v[220:223]
v_accvgpr_write_b32 a205, v149
v_accvgpr_write_b32 a206, v150
v_mfma_f32_16x16x32_bf16 v[144:147], v[180:183], v[44:47], 0
v_cvt_pk_bf16_f32 v234, v96, v97
v_cvt_pk_bf16_f32 v235, v98, v99
v_mfma_f32_16x16x32_bf16 v[144:147], v[204:207], v[124:127], v[144:147]
v_accvgpr_write_b32 a207, v151
v_accvgpr_write_b32 a212, v232
v_mfma_f32_16x16x32_bf16 v[228:231], v[180:183], v[112:115], 0
v_cvt_pk_bf16_f32 v110, v36, v37
v_cvt_pk_bf16_f32 v111, v38, v39
v_mfma_f32_16x16x32_bf16 v[228:231], v[204:207], v[252:255], v[228:231]
v_accvgpr_write_b32 a213, v233
v_accvgpr_write_b32 a214, v234
v_mfma_f32_16x16x32_bf16 v[132:135], v[180:183], v[224:227], 0
v_cvt_pk_bf16_f32 v106, v236, v237
v_cvt_pk_bf16_f32 v107, v238, v239
v_mfma_f32_16x16x32_bf16 v[132:135], v[204:207], v[40:43], v[132:135]
v_accvgpr_write_b32 a215, v235
v_accvgpr_write_b32 a216, v108
v_mfma_f32_16x16x32_bf16 v[212:215], v[188:191], v[164:167], 0
v_cvt_pk_bf16_f32 v48, v220, v221
v_cvt_pk_bf16_f32 v49, v222, v223
v_mfma_f32_16x16x32_bf16 v[212:215], v[216:219], v[168:171], v[212:215]
v_accvgpr_write_b32 a217, v109
v_accvgpr_write_b32 a218, v110
v_mfma_f32_16x16x32_bf16 v[176:179], v[188:191], v[44:47], 0
v_cvt_pk_bf16_f32 v200, v144, v145
v_cvt_pk_bf16_f32 v201, v146, v147
v_mfma_f32_16x16x32_bf16 v[176:179], v[216:219], v[124:127], v[176:179]
v_accvgpr_write_b32 a219, v111
v_accvgpr_write_b32 a220, v104
v_mfma_f32_16x16x32_bf16 v[156:159], v[188:191], v[112:115], 0
v_cvt_pk_bf16_f32 v120, v228, v229
v_cvt_pk_bf16_f32 v121, v230, v231
v_mfma_f32_16x16x32_bf16 v[156:159], v[216:219], v[252:255], v[156:159]
v_accvgpr_write_b32 a221, v105
v_accvgpr_write_b32 a222, v106
v_mfma_f32_16x16x32_bf16 v[84:87], v[188:191], v[224:227], 0
v_cvt_pk_bf16_f32 v92, v132, v133
v_cvt_pk_bf16_f32 v93, v134, v135
v_mfma_f32_16x16x32_bf16 v[84:87], v[216:219], v[40:43], v[84:87]
v_accvgpr_write_b32 a223, v107
s_waitcnt lgkmcnt(4)
v_mfma_f32_16x16x32_bf16 v[52:55], a[240:243], a[0:3], 0
ds_read_b64_tr_b16 a[224:225], v7 offset:53248
v_cvt_pk_bf16_f32 v50, v212, v213
v_mfma_f32_16x16x32_bf16 v[52:55], a[244:247], a[4:7], v[52:55]
v_cvt_pk_bf16_f32 v51, v214, v215
v_accvgpr_write_b32 a228, v48
v_mfma_f32_16x16x32_bf16 v[80:83], a[240:243], a[48:51], 0
ds_read_b64_tr_b16 a[226:227], v7 offset:53760
v_cvt_pk_bf16_f32 v202, v176, v177
v_mfma_f32_16x16x32_bf16 v[80:83], a[244:247], a[52:55], v[80:83]
v_cvt_pk_bf16_f32 v203, v178, v179
v_accvgpr_write_b32 a229, v49
v_mfma_f32_16x16x32_bf16 v[56:59], a[240:243], a[96:99], 0
ds_read_b64_tr_b16 a[232:233], v7 offset:54272
v_cvt_pk_bf16_f32 v122, v156, v157
v_mfma_f32_16x16x32_bf16 v[56:59], a[244:247], a[100:103], v[56:59]
v_cvt_pk_bf16_f32 v123, v158, v159
v_accvgpr_write_b32 a230, v50
v_mfma_f32_16x16x32_bf16 v[76:79], a[240:243], a[144:147], 0
ds_read_b64_tr_b16 a[234:235], v7 offset:54784
v_cvt_pk_bf16_f32 v94, v84, v85
v_mfma_f32_16x16x32_bf16 v[76:79], a[244:247], a[148:151], v[76:79]
v_cvt_pk_bf16_f32 v95, v86, v87
s_waitcnt lgkmcnt(4)
v_mfma_f32_16x16x32_bf16 v[52:55], a[248:251], a[8:11], v[52:55]
ds_read_b64_tr_b16 a[236:237], v7 offset:6144
v_accvgpr_write_b32 a231, v51
v_mfma_f32_16x16x32_bf16 v[52:55], a[252:255], a[12:15], v[52:55]
v_accvgpr_write_b32 a240, v200
v_mfma_f32_16x16x32_bf16 v[80:83], a[248:251], a[56:59], v[80:83]
ds_read_b64_tr_b16 a[238:239], v7 offset:6656
v_mfma_f32_16x16x32_bf16 v[80:83], a[252:255], a[60:63], v[80:83]
v_accvgpr_write_b32 a241, v201
v_mfma_f32_16x16x32_bf16 v[56:59], a[248:251], a[104:107], v[56:59]
ds_read_b64_tr_b16 a[244:245], v7 offset:7168
v_mfma_f32_16x16x32_bf16 v[56:59], a[252:255], a[108:111], v[56:59]
v_accvgpr_write_b32 a242, v202
v_mfma_f32_16x16x32_bf16 v[76:79], a[248:251], a[152:155], v[76:79]
ds_read_b64_tr_b16 a[246:247], v7 offset:7680
v_mfma_f32_16x16x32_bf16 v[76:79], a[252:255], a[156:159], v[76:79]
s_waitcnt lgkmcnt(4)
v_mfma_f32_16x16x32_bf16 v[52:55], a[224:227], a[16:19], v[52:55]
ds_read_b64_tr_b16 a[248:249], v7 offset:8192
v_mfma_f32_16x16x32_bf16 v[52:55], a[232:235], a[20:23], v[52:55]
v_accvgpr_write_b32 a243, v203
v_mfma_f32_16x16x32_bf16 v[80:83], a[224:227], a[64:67], v[80:83]
ds_read_b64_tr_b16 a[250:251], v7 offset:8704
v_mfma_f32_16x16x32_bf16 v[80:83], a[232:235], a[68:71], v[80:83]
v_mfma_f32_16x16x32_bf16 v[56:59], a[224:227], a[112:115], v[56:59]
ds_read_b64_tr_b16 a[252:253], v7 offset:9216
v_mfma_f32_16x16x32_bf16 v[56:59], a[232:235], a[116:119], v[56:59]
v_mfma_f32_16x16x32_bf16 v[76:79], a[224:227], a[160:163], v[76:79]
ds_read_b64_tr_b16 a[254:255], v7 offset:9728
v_mfma_f32_16x16x32_bf16 v[76:79], a[232:235], a[164:167], v[76:79]
s_waitcnt lgkmcnt(4)
v_mfma_f32_16x16x32_bf16 v[52:55], a[236:239], a[24:27], v[52:55]
ds_read_b64_tr_b16 a[224:225], v7 offset:10240
v_mfma_f32_16x16x32_bf16 v[52:55], a[244:247], a[28:31], v[52:55]
v_mfma_f32_16x16x32_bf16 v[80:83], a[236:239], a[72:75], v[80:83]
ds_read_b64_tr_b16 a[226:227], v7 offset:10752
v_mfma_f32_16x16x32_bf16 v[80:83], a[244:247], a[76:79], v[80:83]
v_mfma_f32_16x16x32_bf16 v[56:59], a[236:239], a[120:123], v[56:59]
ds_read_b64_tr_b16 a[232:233], v7 offset:11264
v_mfma_f32_16x16x32_bf16 v[56:59], a[244:247], a[124:127], v[56:59]
v_mfma_f32_16x16x32_bf16 v[76:79], a[236:239], a[168:171], v[76:79]
ds_read_b64_tr_b16 a[234:235], v7 offset:11776
v_mfma_f32_16x16x32_bf16 v[76:79], a[244:247], a[172:175], v[76:79]
s_waitcnt lgkmcnt(4)
v_mfma_f32_16x16x32_bf16 v[52:55], a[248:251], a[32:35], v[52:55]
ds_read_b64_tr_b16 a[236:237], v17 offset:49152
v_mfma_f32_16x16x32_bf16 v[52:55], a[252:255], a[36:39], v[52:55]
v_mfma_f32_16x16x32_bf16 v[80:83], a[248:251], a[80:83], v[80:83]
ds_read_b64_tr_b16 a[238:239], v17 offset:49664
v_mfma_f32_16x16x32_bf16 v[80:83], a[252:255], a[84:87], v[80:83]
v_mfma_f32_16x16x32_bf16 v[56:59], a[248:251], a[128:131], v[56:59]
ds_read_b64_tr_b16 a[244:245], v17 offset:50176
v_mfma_f32_16x16x32_bf16 v[56:59], a[252:255], a[132:135], v[56:59]
v_mfma_f32_16x16x32_bf16 v[76:79], a[248:251], a[176:179], v[76:79]
ds_read_b64_tr_b16 a[246:247], v17 offset:50688
v_mfma_f32_16x16x32_bf16 v[76:79], a[252:255], a[180:183], v[76:79]
s_waitcnt lgkmcnt(4)
v_mfma_f32_16x16x32_bf16 v[52:55], a[224:227], a[40:43], v[52:55]
ds_read_b64_tr_b16 a[248:249], v17 offset:51200
v_mfma_f32_16x16x32_bf16 v[52:55], a[232:235], a[44:47], v[52:55]
v_mfma_f32_16x16x32_bf16 v[80:83], a[224:227], a[88:91], v[80:83]
ds_read_b64_tr_b16 a[250:251], v17 offset:51712
v_mfma_f32_16x16x32_bf16 v[80:83], a[232:235], a[92:95], v[80:83]
v_mfma_f32_16x16x32_bf16 v[56:59], a[224:227], a[136:139], v[56:59]
ds_read_b64_tr_b16 a[252:253], v17 offset:52224
v_mfma_f32_16x16x32_bf16 v[56:59], a[232:235], a[140:143], v[56:59]
v_mfma_f32_16x16x32_bf16 v[76:79], a[224:227], a[184:187], v[76:79]
ds_read_b64_tr_b16 a[254:255], v17 offset:52736
v_mfma_f32_16x16x32_bf16 v[76:79], a[232:235], a[188:191], v[76:79]
s_waitcnt lgkmcnt(4)
v_mfma_f32_16x16x32_bf16 v[152:155], a[236:239], a[0:3], 0
ds_read_b64_tr_b16 a[224:225], v17 offset:53248
v_mfma_f32_16x16x32_bf16 v[152:155], a[244:247], a[4:7], v[152:155]
v_cvt_pk_bf16_f32 v250, v52, v53
v_mfma_f32_16x16x32_bf16 v[116:119], a[236:239], a[48:51], 0
ds_read_b64_tr_b16 a[226:227], v17 offset:53760
v_mfma_f32_16x16x32_bf16 v[116:119], a[244:247], a[52:55], v[116:119]
v_cvt_pk_bf16_f32 v251, v54, v55
v_mfma_f32_16x16x32_bf16 v[68:71], a[236:239], a[96:99], 0
ds_read_b64_tr_b16 a[232:233], v17 offset:54272
v_mfma_f32_16x16x32_bf16 v[68:71], a[244:247], a[100:103], v[68:71]
v_cvt_pk_bf16_f32 v242, v80, v81
v_mfma_f32_16x16x32_bf16 v[244:247], a[236:239], a[144:147], 0
ds_read_b64_tr_b16 a[234:235], v17 offset:54784
v_cvt_pk_bf16_f32 v243, v82, v83
v_mfma_f32_16x16x32_bf16 v[244:247], a[244:247], a[148:151], v[244:247]
s_waitcnt lgkmcnt(4)
v_mfma_f32_16x16x32_bf16 v[152:155], a[248:251], a[8:11], v[152:155]
ds_read_b64_tr_b16 a[236:237], v17 offset:6144
v_mfma_f32_16x16x32_bf16 v[152:155], a[252:255], a[12:15], v[152:155]
v_cvt_pk_bf16_f32 v62, v56, v57
v_mfma_f32_16x16x32_bf16 v[116:119], a[248:251], a[56:59], v[116:119]
ds_read_b64_tr_b16 a[238:239], v17 offset:6656
v_mfma_f32_16x16x32_bf16 v[116:119], a[252:255], a[60:63], v[116:119]
v_cvt_pk_bf16_f32 v63, v58, v59
v_mfma_f32_16x16x32_bf16 v[68:71], a[248:251], a[104:107], v[68:71]
ds_read_b64_tr_b16 a[244:245], v17 offset:7168
v_mfma_f32_16x16x32_bf16 v[68:71], a[252:255], a[108:111], v[68:71]
v_cvt_pk_bf16_f32 v90, v76, v77
v_mfma_f32_16x16x32_bf16 v[244:247], a[248:251], a[152:155], v[244:247]
ds_read_b64_tr_b16 a[246:247], v17 offset:7680
v_mfma_f32_16x16x32_bf16 v[244:247], a[252:255], a[156:159], v[244:247]
s_waitcnt lgkmcnt(4)
v_mfma_f32_16x16x32_bf16 v[152:155], a[224:227], a[16:19], v[152:155]
ds_read_b64_tr_b16 a[248:249], v17 offset:8192
v_mfma_f32_16x16x32_bf16 v[152:155], a[232:235], a[20:23], v[152:155]
v_cvt_pk_bf16_f32 v91, v78, v79
v_mfma_f32_16x16x32_bf16 v[116:119], a[224:227], a[64:67], v[116:119]
ds_read_b64_tr_b16 a[250:251], v17 offset:8704
v_mfma_f32_16x16x32_bf16 v[116:119], a[232:235], a[68:71], v[116:119]
v_mfma_f32_16x16x32_bf16 v[68:71], a[224:227], a[112:115], v[68:71]
ds_read_b64_tr_b16 a[252:253], v17 offset:9216
v_mfma_f32_16x16x32_bf16 v[68:71], a[232:235], a[116:119], v[68:71]
v_mfma_f32_16x16x32_bf16 v[244:247], a[224:227], a[160:163], v[244:247]
ds_read_b64_tr_b16 a[254:255], v17 offset:9728
v_mfma_f32_16x16x32_bf16 v[244:247], a[232:235], a[164:167], v[244:247]
s_waitcnt lgkmcnt(4)
v_mfma_f32_16x16x32_bf16 v[152:155], a[236:239], a[24:27], v[152:155]
ds_read_b64_tr_b16 a[224:225], v17 offset:10240
v_mfma_f32_16x16x32_bf16 v[152:155], a[244:247], a[28:31], v[152:155]
v_mfma_f32_16x16x32_bf16 v[116:119], a[236:239], a[72:75], v[116:119]
ds_read_b64_tr_b16 a[226:227], v17 offset:10752
v_mfma_f32_16x16x32_bf16 v[116:119], a[244:247], a[76:79], v[116:119]
v_mfma_f32_16x16x32_bf16 v[68:71], a[236:239], a[120:123], v[68:71]
ds_read_b64_tr_b16 a[232:233], v17 offset:11264
v_mfma_f32_16x16x32_bf16 v[68:71], a[244:247], a[124:127], v[68:71]
v_mfma_f32_16x16x32_bf16 v[244:247], a[236:239], a[168:171], v[244:247]
ds_read_b64_tr_b16 a[234:235], v17 offset:11776
v_mfma_f32_16x16x32_bf16 v[244:247], a[244:247], a[172:175], v[244:247]
s_waitcnt lgkmcnt(4)
v_mfma_f32_16x16x32_bf16 v[152:155], a[248:251], a[32:35], v[152:155]
ds_read_b64_tr_b16 a[236:237], v18 offset:49152
v_mfma_f32_16x16x32_bf16 v[152:155], a[252:255], a[36:39], v[152:155]
v_mfma_f32_16x16x32_bf16 v[116:119], a[248:251], a[80:83], v[116:119]
ds_read_b64_tr_b16 a[238:239], v18 offset:49664
v_mfma_f32_16x16x32_bf16 v[116:119], a[252:255], a[84:87], v[116:119]
v_mfma_f32_16x16x32_bf16 v[68:71], a[248:251], a[128:131], v[68:71]
ds_read_b64_tr_b16 a[244:245], v18 offset:50176
v_mfma_f32_16x16x32_bf16 v[68:71], a[252:255], a[132:135], v[68:71]
v_mfma_f32_16x16x32_bf16 v[244:247], a[248:251], a[176:179], v[244:247]
ds_read_b64_tr_b16 a[246:247], v18 offset:50688
v_mfma_f32_16x16x32_bf16 v[244:247], a[252:255], a[180:183], v[244:247]
s_waitcnt lgkmcnt(4)
v_mfma_f32_16x16x32_bf16 v[152:155], a[224:227], a[40:43], v[152:155]
ds_read_b64_tr_b16 a[248:249], v18 offset:51200
v_mfma_f32_16x16x32_bf16 v[152:155], a[232:235], a[44:47], v[152:155]
v_mfma_f32_16x16x32_bf16 v[116:119], a[224:227], a[88:91], v[116:119]
ds_read_b64_tr_b16 a[250:251], v18 offset:51712
v_mfma_f32_16x16x32_bf16 v[116:119], a[232:235], a[92:95], v[116:119]
v_mfma_f32_16x16x32_bf16 v[68:71], a[224:227], a[136:139], v[68:71]
ds_read_b64_tr_b16 a[252:253], v18 offset:52224
v_mfma_f32_16x16x32_bf16 v[68:71], a[232:235], a[140:143], v[68:71]
v_mfma_f32_16x16x32_bf16 v[244:247], a[224:227], a[184:187], v[244:247]
ds_read_b64_tr_b16 a[254:255], v18 offset:52736
v_mfma_f32_16x16x32_bf16 v[244:247], a[232:235], a[188:191], v[244:247]
s_waitcnt lgkmcnt(4)
v_mfma_f32_16x16x32_bf16 v[136:139], a[236:239], a[0:3], 0
ds_read_b64_tr_b16 a[224:225], v18 offset:53248
v_mfma_f32_16x16x32_bf16 v[136:139], a[244:247], a[4:7], v[136:139]
v_cvt_pk_bf16_f32 v72, v152, v153
v_mfma_f32_16x16x32_bf16 v[192:195], a[236:239], a[48:51], 0
ds_read_b64_tr_b16 a[226:227], v18 offset:53760
v_mfma_f32_16x16x32_bf16 v[192:195], a[244:247], a[52:55], v[192:195]
v_cvt_pk_bf16_f32 v73, v154, v155
v_mfma_f32_16x16x32_bf16 v[196:199], a[236:239], a[96:99], 0
ds_read_b64_tr_b16 a[232:233], v18 offset:54272
v_mfma_f32_16x16x32_bf16 v[196:199], a[244:247], a[100:103], v[196:199]
v_cvt_pk_bf16_f32 v32, v116, v117
v_mfma_f32_16x16x32_bf16 v[96:99], a[236:239], a[144:147], 0
ds_read_b64_tr_b16 a[234:235], v18 offset:54784
v_cvt_pk_bf16_f32 v33, v118, v119
v_mfma_f32_16x16x32_bf16 v[96:99], a[244:247], a[148:151], v[96:99]
s_waitcnt lgkmcnt(4)
v_mfma_f32_16x16x32_bf16 v[136:139], a[248:251], a[8:11], v[136:139]
ds_read_b64_tr_b16 a[236:237], v18 offset:6144
v_mfma_f32_16x16x32_bf16 v[136:139], a[252:255], a[12:15], v[136:139]
v_cvt_pk_bf16_f32 v148, v68, v69
v_mfma_f32_16x16x32_bf16 v[192:195], a[248:251], a[56:59], v[192:195]
ds_read_b64_tr_b16 a[238:239], v18 offset:6656
v_mfma_f32_16x16x32_bf16 v[192:195], a[252:255], a[60:63], v[192:195]
v_cvt_pk_bf16_f32 v149, v70, v71
v_mfma_f32_16x16x32_bf16 v[196:199], a[248:251], a[104:107], v[196:199]
ds_read_b64_tr_b16 a[244:245], v18 offset:7168
v_mfma_f32_16x16x32_bf16 v[196:199], a[252:255], a[108:111], v[196:199]
v_cvt_pk_bf16_f32 v36, v244, v245
v_mfma_f32_16x16x32_bf16 v[96:99], a[248:251], a[152:155], v[96:99]
ds_read_b64_tr_b16 a[246:247], v18 offset:7680
v_mfma_f32_16x16x32_bf16 v[96:99], a[252:255], a[156:159], v[96:99]
s_waitcnt lgkmcnt(4)
v_mfma_f32_16x16x32_bf16 v[136:139], a[224:227], a[16:19], v[136:139]
ds_read_b64_tr_b16 a[248:249], v18 offset:8192
v_mfma_f32_16x16x32_bf16 v[136:139], a[232:235], a[20:23], v[136:139]
v_cvt_pk_bf16_f32 v37, v246, v247
v_mfma_f32_16x16x32_bf16 v[192:195], a[224:227], a[64:67], v[192:195]
ds_read_b64_tr_b16 a[250:251], v18 offset:8704
v_mfma_f32_16x16x32_bf16 v[192:195], a[232:235], a[68:71], v[192:195]
v_mfma_f32_16x16x32_bf16 v[196:199], a[224:227], a[112:115], v[196:199]
ds_read_b64_tr_b16 a[252:253], v18 offset:9216
v_mfma_f32_16x16x32_bf16 v[196:199], a[232:235], a[116:119], v[196:199]
v_mfma_f32_16x16x32_bf16 v[96:99], a[224:227], a[160:163], v[96:99]
ds_read_b64_tr_b16 a[254:255], v18 offset:9728
v_mfma_f32_16x16x32_bf16 v[96:99], a[232:235], a[164:167], v[96:99]
s_waitcnt lgkmcnt(4)
v_mfma_f32_16x16x32_bf16 v[136:139], a[236:239], a[24:27], v[136:139]
ds_read_b64_tr_b16 a[224:225], v18 offset:10240
v_mfma_f32_16x16x32_bf16 v[136:139], a[244:247], a[28:31], v[136:139]
v_mfma_f32_16x16x32_bf16 v[192:195], a[236:239], a[72:75], v[192:195]
ds_read_b64_tr_b16 a[226:227], v18 offset:10752
v_mfma_f32_16x16x32_bf16 v[192:195], a[244:247], a[76:79], v[192:195]
v_mfma_f32_16x16x32_bf16 v[196:199], a[236:239], a[120:123], v[196:199]
ds_read_b64_tr_b16 a[232:233], v18 offset:11264
v_mfma_f32_16x16x32_bf16 v[196:199], a[244:247], a[124:127], v[196:199]
ds_read_b128 v[180:183], v9 offset:6048
v_mfma_f32_16x16x32_bf16 v[96:99], a[236:239], a[168:171], v[96:99]
ds_read_b64_tr_b16 a[234:235], v18 offset:11776
v_mfma_f32_16x16x32_bf16 v[96:99], a[244:247], a[172:175], v[96:99]
s_waitcnt lgkmcnt(5)
v_mfma_f32_16x16x32_bf16 v[136:139], a[248:251], a[32:35], v[136:139]
ds_read_b128 v[236:239], v9 offset:6144
v_mfma_f32_16x16x32_bf16 v[136:139], a[252:255], a[36:39], v[136:139]
ds_read_b128 v[204:207], v9 offset:6240
v_mfma_f32_16x16x32_bf16 v[192:195], a[248:251], a[80:83], v[192:195]
v_mfma_f32_16x16x32_bf16 v[192:195], a[252:255], a[84:87], v[192:195]
s_waitcnt vmcnt(0) lgkmcnt(2)
s_barrier
v_mfma_f32_16x16x32_bf16 v[196:199], a[248:251], a[128:131], v[196:199]
ds_read_b64_tr_b16 a[236:237], v6 offset:0
v_mfma_f32_16x16x32_bf16 v[196:199], a[252:255], a[132:135], v[196:199]
ds_read_b64_tr_b16 a[238:239], v6 offset:512
v_mfma_f32_16x16x32_bf16 v[96:99], a[248:251], a[176:179], v[96:99]
ds_read_b128 v[232:235], v9 offset:6336
v_mfma_f32_16x16x32_bf16 v[96:99], a[252:255], a[180:183], v[96:99]
ds_read_b64_tr_b16 a[244:245], v6 offset:1024
v_mfma_f32_16x16x32_bf16 v[136:139], a[224:227], a[40:43], v[136:139]
ds_read_b64_tr_b16 a[248:249], v6 offset:2048
v_mfma_f32_16x16x32_bf16 v[136:139], a[232:235], a[44:47], v[136:139]
ds_read_b64_tr_b16 a[246:247], v6 offset:1536
ds_read_b128 v[164:167], v9 offset:5952
v_mfma_f32_16x16x32_bf16 v[192:195], a[224:227], a[88:91], v[192:195]
ds_read_b64_tr_b16 a[250:251], v6 offset:2560
ds_read_b128 v[220:223], v9 offset:6048
v_mfma_f32_16x16x32_bf16 v[192:195], a[232:235], a[92:95], v[192:195]
ds_read_b128 v[168:171], v9 offset:6144
v_mfma_f32_16x16x32_bf16 v[196:199], a[224:227], a[136:139], v[196:199]
ds_read_b64_tr_b16 a[252:253], v6 offset:3072
v_mfma_f32_16x16x32_bf16 v[196:199], a[232:235], a[140:143], v[196:199]
ds_read_b128 v[44:47], v9 offset:6240
v_mfma_f32_16x16x32_bf16 v[96:99], a[224:227], a[184:187], v[96:99]
ds_read_b64_tr_b16 a[254:255], v6 offset:3584
v_mfma_f32_16x16x32_bf16 v[96:99], a[232:235], a[188:191], v[96:99]
ds_read_b128 v[144:147], v9 offset:5856
s_waitcnt lgkmcnt(8)
v_mfma_f32_16x16x32_bf16 v[124:127], a[236:239], a[0:3], 0
ds_read_b64_tr_b16 a[224:225], v6 offset:4096
ds_read_b128 v[108:111], v9 offset:5952
v_mfma_f32_16x16x32_bf16 v[124:127], a[244:247], a[4:7], v[124:127]
ds_read_b128 v[112:115], v9 offset:6048
s_add_u32 m0, s39, 49152
v_mfma_f32_16x16x32_bf16 v[228:231], a[236:239], a[48:51], 0
ds_read_b64_tr_b16 a[226:227], v6 offset:4608
s_add_u32 s42, s37, 4992
v_mfma_f32_16x16x32_bf16 v[228:231], a[244:247], a[52:55], v[228:231]
ds_read_b128 v[252:255], v9 offset:6144
buffer_load_dwordx4 v8, s[20:23], s42 offen offset:0 lds
v_mfma_f32_16x16x32_bf16 v[188:191], a[236:239], a[96:99], 0
ds_read_b64_tr_b16 a[232:233], v6 offset:5120
s_add_u32 s43, s37, 77696
v_mfma_f32_16x16x32_bf16 v[188:191], a[244:247], a[100:103], v[188:191]
ds_read_b128 v[224:227], v9 offset:5760
buffer_load_dwordx4 v8, s[20:23], s43 offen offset:1024 lds
v_mfma_f32_16x16x32_bf16 v[132:135], a[236:239], a[144:147], 0
ds_read_b64_tr_b16 a[234:235], v6 offset:5632
s_add_u32 s42, s37, 150400
v_mfma_f32_16x16x32_bf16 v[132:135], a[244:247], a[148:151], v[132:135]
ds_read_b128 v[216:219], v9 offset:5856
s_waitcnt lgkmcnt(10)
v_mfma_f32_16x16x32_bf16 v[124:127], a[248:251], a[8:11], v[124:127]
ds_read_b64_tr_b16 a[236:237], v6 offset:55296
buffer_load_dwordx4 v8, s[20:23], s42 offen offset:2048 lds
v_mfma_f32_16x16x32_bf16 v[124:127], a[252:255], a[12:15], v[124:127]
ds_read_b128 v[40:43], v9 offset:5952
v_cvt_pk_bf16_f32 v74, v136, v137
v_mfma_f32_16x16x32_bf16 v[228:231], a[248:251], a[56:59], v[228:231]
ds_read_b64_tr_b16 a[238:239], v6 offset:55808
v_cvt_pk_bf16_f32 v75, v138, v139
v_mfma_f32_16x16x32_bf16 v[228:231], a[252:255], a[60:63], v[228:231]
ds_read_b128 v[104:107], v9 offset:6048
s_add_u32 s43, s37, 223104
v_mfma_f32_16x16x32_bf16 v[188:191], a[248:251], a[104:107], v[188:191]
ds_read_b64_tr_b16 a[244:245], v6 offset:56320
buffer_load_dwordx4 v8, s[20:23], s43 offen offset:3072 lds
v_mfma_f32_16x16x32_bf16 v[188:191], a[252:255], a[108:111], v[188:191]
v_cvt_pk_bf16_f32 v34, v192, v193
v_cvt_pk_bf16_f32 v35, v194, v195
v_mfma_f32_16x16x32_bf16 v[132:135], a[248:251], a[152:155], v[132:135]
ds_read_b64_tr_b16 a[246:247], v6 offset:56832
v_cvt_pk_bf16_f32 v150, v196, v197
v_mfma_f32_16x16x32_bf16 v[132:135], a[252:255], a[156:159], v[132:135]
v_cvt_pk_bf16_f32 v151, v198, v199
s_waitcnt lgkmcnt(7)
v_mfma_f32_16x16x32_bf16 v[124:127], a[224:227], a[16:19], v[124:127]
ds_read_b64_tr_b16 a[248:249], v6 offset:57344
v_mfma_f32_16x16x32_bf16 v[124:127], a[232:235], a[20:23], v[124:127]
v_cvt_pk_bf16_f32 v38, v96, v97
v_mfma_f32_16x16x32_bf16 v[228:231], a[224:227], a[64:67], v[228:231]
ds_read_b64_tr_b16 a[250:251], v6 offset:57856
v_mfma_f32_16x16x32_bf16 v[228:231], a[232:235], a[68:71], v[228:231]
v_cvt_pk_bf16_f32 v39, v98, v99
v_mfma_f32_16x16x32_bf16 v[188:191], a[224:227], a[112:115], v[188:191]
ds_read_b64_tr_b16 a[252:253], v6 offset:58368
v_mfma_f32_16x16x32_bf16 v[188:191], a[232:235], a[116:119], v[188:191]
s_add_u32 m0, s39, 53248
v_mfma_f32_16x16x32_bf16 v[132:135], a[224:227], a[160:163], v[132:135]
ds_read_b64_tr_b16 a[254:255], v6 offset:58880
v_mfma_f32_16x16x32_bf16 v[132:135], a[232:235], a[164:167], v[132:135]
s_add_u32 s42, s37, 299904
v_mfma_f32_16x16x32_bf16 v[180:183], v[72:75], v[248:251], v[180:183]
buffer_load_dwordx4 v8, s[20:23], s42 offen offset:0 lds
v_mfma_f32_16x16x32_bf16 v[236:239], v[72:75], v[240:243], v[236:239]
s_add_u32 s43, s37, 372608
v_mfma_f32_16x16x32_bf16 v[204:207], v[72:75], v[60:63], v[204:207]
buffer_load_dwordx4 v8, s[20:23], s43 offen offset:1024 lds
v_mfma_f32_16x16x32_bf16 v[232:235], v[72:75], v[88:91], v[232:235]
s_add_u32 m0, s39, 6144
v_mfma_f32_16x16x32_bf16 v[164:167], v[32:35], v[248:251], v[164:167]
s_add_u32 s42, s37, 447360
v_mfma_f32_16x16x32_bf16 v[220:223], v[32:35], v[240:243], v[220:223]
buffer_load_dwordx4 v8, s[20:23], s42 offen offset:0 lds
v_mfma_f32_16x16x32_bf16 v[168:171], v[32:35], v[60:63], v[168:171]
s_add_u32 s43, s37, 520064
v_mfma_f32_16x16x32_bf16 v[44:47], v[32:35], v[88:91], v[44:47]
buffer_load_dwordx4 v8, s[20:23], s43 offen offset:1024 lds
v_mfma_f32_16x16x32_bf16 v[144:147], v[148:151], v[248:251], v[144:147]
v_mfma_f32_16x16x32_bf16 v[108:111], v[148:151], v[240:243], v[108:111]
v_mfma_f32_16x16x32_bf16 v[112:115], v[148:151], v[60:63], v[112:115]
v_mfma_f32_16x16x32_bf16 v[252:255], v[148:151], v[88:91], v[252:255]
v_mfma_f32_16x16x32_bf16 v[224:227], v[36:39], v[248:251], v[224:227]
s_add_u32 s42, s37, 592768
s_waitcnt lgkmcnt(10)
v_mfma_f32_16x16x32_bf16 v[216:219], v[36:39], v[240:243], v[216:219]
buffer_load_dwordx4 v8, s[20:23], s42 offen offset:2048 lds
s_waitcnt lgkmcnt(8)
v_mfma_f32_16x16x32_bf16 v[40:43], v[36:39], v[60:63], v[40:43]
s_waitcnt lgkmcnt(6)
v_mfma_f32_16x16x32_bf16 v[104:107], v[36:39], v[88:91], v[104:107]
s_waitcnt lgkmcnt(4)
v_mfma_f32_16x16x32_bf16 v[124:127], a[236:239], a[24:27], v[124:127]
ds_read_b64_tr_b16 a[224:225], v6 offset:59392
v_mfma_f32_16x16x32_bf16 v[124:127], a[244:247], a[28:31], v[124:127]
v_mfma_f32_16x16x32_bf16 v[228:231], a[236:239], a[72:75], v[228:231]
ds_read_b64_tr_b16 a[226:227], v6 offset:59904
v_mfma_f32_16x16x32_bf16 v[228:231], a[244:247], a[76:79], v[228:231]
s_add_u32 s43, s37, 665472
v_mfma_f32_16x16x32_bf16 v[188:191], a[236:239], a[120:123], v[188:191]
ds_read_b64_tr_b16 a[232:233], v6 offset:60416
v_mfma_f32_16x16x32_bf16 v[188:191], a[244:247], a[124:127], v[188:191]
buffer_load_dwordx4 v8, s[20:23], s43 offen offset:3072 lds
v_mfma_f32_16x16x32_bf16 v[132:135], a[236:239], a[168:171], v[132:135]
ds_read_b64_tr_b16 a[234:235], v6 offset:60928
v_mfma_f32_16x16x32_bf16 v[132:135], a[244:247], a[172:175], v[132:135]
s_waitcnt lgkmcnt(4)
v_mfma_f32_16x16x32_bf16 v[124:127], a[248:251], a[32:35], v[124:127]
ds_read_b64_tr_b16 a[236:237], v7 offset:0
v_mfma_f32_16x16x32_bf16 v[124:127], a[252:255], a[36:39], v[124:127]
s_add_u32 m0, s39, 10240
v_mfma_f32_16x16x32_bf16 v[228:231], a[248:251], a[80:83], v[228:231]
ds_read_b64_tr_b16 a[238:239], v7 offset:512
v_mfma_f32_16x16x32_bf16 v[228:231], a[252:255], a[84:87], v[228:231]
s_add_u32 s42, s37, 742272
v_mfma_f32_16x16x32_bf16 v[188:191], a[248:251], a[128:131], v[188:191]
ds_read_b64_tr_b16 a[244:245], v7 offset:1024
v_mfma_f32_16x16x32_bf16 v[188:191], a[252:255], a[132:135], v[188:191]
buffer_load_dwordx4 v8, s[20:23], s42 offen offset:0 lds
v_mfma_f32_16x16x32_bf16 v[132:135], a[248:251], a[176:179], v[132:135]
ds_read_b64_tr_b16 a[246:247], v7 offset:1536
v_mfma_f32_16x16x32_bf16 v[132:135], a[252:255], a[180:183], v[132:135]
s_waitcnt lgkmcnt(4)
v_mfma_f32_16x16x32_bf16 v[124:127], a[224:227], a[40:43], v[124:127]
ds_read_b64_tr_b16 a[248:249], v7 offset:2048
v_mfma_f32_16x16x32_bf16 v[124:127], a[232:235], a[44:47], v[124:127]
s_add_u32 s43, s37, 814976
v_mfma_f32_16x16x32_bf16 v[228:231], a[224:227], a[88:91], v[228:231]
ds_read_b64_tr_b16 a[250:251], v7 offset:2560
v_mfma_f32_16x16x32_bf16 v[228:231], a[232:235], a[92:95], v[228:231]
buffer_load_dwordx4 v8, s[20:23], s43 offen offset:1024 lds
v_mfma_f32_16x16x32_bf16 v[188:191], a[224:227], a[136:139], v[188:191]
ds_read_b64_tr_b16 a[252:253], v7 offset:3072
v_mfma_f32_16x16x32_bf16 v[188:191], a[232:235], a[140:143], v[188:191]
v_mfma_f32_16x16x32_bf16 v[132:135], a[224:227], a[184:187], v[132:135]
ds_read_b64_tr_b16 a[254:255], v7 offset:3584
v_mfma_f32_16x16x32_bf16 v[132:135], a[232:235], a[188:191], v[132:135]
s_waitcnt lgkmcnt(4)
v_mfma_f32_16x16x32_bf16 v[212:215], a[236:239], a[0:3], 0
ds_read_b64_tr_b16 a[224:225], v7 offset:4096
v_mfma_f32_16x16x32_bf16 v[212:215], a[244:247], a[4:7], v[212:215]
v_cvt_pk_bf16_f32 v176, v124, v125
v_mfma_f32_16x16x32_bf16 v[156:159], a[236:239], a[48:51], 0
ds_read_b64_tr_b16 a[226:227], v7 offset:4608
v_mfma_f32_16x16x32_bf16 v[156:159], a[244:247], a[52:55], v[156:159]
v_cvt_pk_bf16_f32 v177, v126, v127
v_mfma_f32_16x16x32_bf16 v[84:87], a[236:239], a[96:99], 0
ds_read_b64_tr_b16 a[232:233], v7 offset:5120
v_mfma_f32_16x16x32_bf16 v[84:87], a[244:247], a[100:103], v[84:87]
v_cvt_pk_bf16_f32 v48, v228, v229
v_mfma_f32_16x16x32_bf16 v[200:203], a[236:239], a[144:147], 0
ds_read_b64_tr_b16 a[234:235], v7 offset:5632
v_cvt_pk_bf16_f32 v49, v230, v231
v_mfma_f32_16x16x32_bf16 v[200:203], a[244:247], a[148:151], v[200:203]
s_waitcnt lgkmcnt(4)
v_mfma_f32_16x16x32_bf16 v[212:215], a[248:251], a[8:11], v[212:215]
ds_read_b64_tr_b16 a[236:237], v7 offset:55296
v_mfma_f32_16x16x32_bf16 v[212:215], a[252:255], a[12:15], v[212:215]
v_cvt_pk_bf16_f32 v52, v188, v189
v_mfma_f32_16x16x32_bf16 v[156:159], a[248:251], a[56:59], v[156:159]
ds_read_b64_tr_b16 a[238:239], v7 offset:55808
v_mfma_f32_16x16x32_bf16 v[156:159], a[252:255], a[60:63], v[156:159]
v_cvt_pk_bf16_f32 v53, v190, v191
v_mfma_f32_16x16x32_bf16 v[84:87], a[248:251], a[104:107], v[84:87]
ds_read_b64_tr_b16 a[244:245], v7 offset:56320
v_mfma_f32_16x16x32_bf16 v[84:87], a[252:255], a[108:111], v[84:87]
v_cvt_pk_bf16_f32 v80, v132, v133
v_mfma_f32_16x16x32_bf16 v[200:203], a[248:251], a[152:155], v[200:203]
ds_read_b64_tr_b16 a[246:247], v7 offset:56832
v_mfma_f32_16x16x32_bf16 v[200:203], a[252:255], a[156:159], v[200:203]
s_waitcnt lgkmcnt(4)
v_mfma_f32_16x16x32_bf16 v[212:215], a[224:227], a[16:19], v[212:215]
ds_read_b64_tr_b16 a[248:249], v7 offset:57344
v_mfma_f32_16x16x32_bf16 v[212:215], a[232:235], a[20:23], v[212:215]
v_cvt_pk_bf16_f32 v81, v134, v135
v_mfma_f32_16x16x32_bf16 v[156:159], a[224:227], a[64:67], v[156:159]
ds_read_b64_tr_b16 a[250:251], v7 offset:57856
v_mfma_f32_16x16x32_bf16 v[156:159], a[232:235], a[68:71], v[156:159]
v_mfma_f32_16x16x32_bf16 v[84:87], a[224:227], a[112:115], v[84:87]
ds_read_b64_tr_b16 a[252:253], v7 offset:58368
v_mfma_f32_16x16x32_bf16 v[84:87], a[232:235], a[116:119], v[84:87]
v_mfma_f32_16x16x32_bf16 v[200:203], a[224:227], a[160:163], v[200:203]
ds_read_b64_tr_b16 a[254:255], v7 offset:58880
v_mfma_f32_16x16x32_bf16 v[200:203], a[232:235], a[164:167], v[200:203]
s_waitcnt lgkmcnt(4)
v_mfma_f32_16x16x32_bf16 v[212:215], a[236:239], a[24:27], v[212:215]
ds_read_b64_tr_b16 a[224:225], v7 offset:59392
v_mfma_f32_16x16x32_bf16 v[212:215], a[244:247], a[28:31], v[212:215]
v_mfma_f32_16x16x32_bf16 v[156:159], a[236:239], a[72:75], v[156:159]
ds_read_b64_tr_b16 a[226:227], v7 offset:59904
v_mfma_f32_16x16x32_bf16 v[156:159], a[244:247], a[76:79], v[156:159]
v_mfma_f32_16x16x32_bf16 v[84:87], a[236:239], a[120:123], v[84:87]
ds_read_b64_tr_b16 a[232:233], v7 offset:60416
v_mfma_f32_16x16x32_bf16 v[84:87], a[244:247], a[124:127], v[84:87]
v_mfma_f32_16x16x32_bf16 v[200:203], a[236:239], a[168:171], v[200:203]
ds_read_b64_tr_b16 a[234:235], v7 offset:60928
v_mfma_f32_16x16x32_bf16 v[200:203], a[244:247], a[172:175], v[200:203]
s_waitcnt lgkmcnt(4)
v_mfma_f32_16x16x32_bf16 v[212:215], a[248:251], a[32:35], v[212:215]
ds_read_b64_tr_b16 a[236:237], v17 offset:0
v_mfma_f32_16x16x32_bf16 v[212:215], a[252:255], a[36:39], v[212:215]
v_mfma_f32_16x16x32_bf16 v[156:159], a[248:251], a[80:83], v[156:159]
ds_read_b64_tr_b16 a[238:239], v17 offset:512
v_mfma_f32_16x16x32_bf16 v[156:159], a[252:255], a[84:87], v[156:159]
v_mfma_f32_16x16x32_bf16 v[84:87], a[248:251], a[128:131], v[84:87]
ds_read_b64_tr_b16 a[244:245], v17 offset:1024
v_mfma_f32_16x16x32_bf16 v[84:87], a[252:255], a[132:135], v[84:87]
v_mfma_f32_16x16x32_bf16 v[200:203], a[248:251], a[176:179], v[200:203]
ds_read_b64_tr_b16 a[246:247], v17 offset:1536
v_mfma_f32_16x16x32_bf16 v[200:203], a[252:255], a[180:183], v[200:203]
s_waitcnt lgkmcnt(4)
v_mfma_f32_16x16x32_bf16 v[212:215], a[224:227], a[40:43], v[212:215]
ds_read_b64_tr_b16 a[248:249], v17 offset:2048
v_mfma_f32_16x16x32_bf16 v[212:215], a[232:235], a[44:47], v[212:215]
v_mfma_f32_16x16x32_bf16 v[156:159], a[224:227], a[88:91], v[156:159]
ds_read_b64_tr_b16 a[250:251], v17 offset:2560
v_mfma_f32_16x16x32_bf16 v[156:159], a[232:235], a[92:95], v[156:159]
v_mfma_f32_16x16x32_bf16 v[84:87], a[224:227], a[136:139], v[84:87]
ds_read_b64_tr_b16 a[252:253], v17 offset:3072
v_mfma_f32_16x16x32_bf16 v[84:87], a[232:235], a[140:143], v[84:87]
v_mfma_f32_16x16x32_bf16 v[200:203], a[224:227], a[184:187], v[200:203]
ds_read_b64_tr_b16 a[254:255], v17 offset:3584
v_mfma_f32_16x16x32_bf16 v[200:203], a[232:235], a[188:191], v[200:203]
s_waitcnt lgkmcnt(4)
v_mfma_f32_16x16x32_bf16 v[56:59], a[236:239], a[0:3], 0
ds_read_b64_tr_b16 a[224:225], v17 offset:4096
v_mfma_f32_16x16x32_bf16 v[56:59], a[244:247], a[4:7], v[56:59]
v_cvt_pk_bf16_f32 v178, v212, v213
v_mfma_f32_16x16x32_bf16 v[76:79], a[236:239], a[48:51], 0
ds_read_b64_tr_b16 a[226:227], v17 offset:4608
v_mfma_f32_16x16x32_bf16 v[76:79], a[244:247], a[52:55], v[76:79]
v_cvt_pk_bf16_f32 v179, v214, v215
v_mfma_f32_16x16x32_bf16 v[152:155], a[236:239], a[96:99], 0
ds_read_b64_tr_b16 a[232:233], v17 offset:5120
v_mfma_f32_16x16x32_bf16 v[152:155], a[244:247], a[100:103], v[152:155]
v_cvt_pk_bf16_f32 v50, v156, v157
v_mfma_f32_16x16x32_bf16 v[116:119], a[236:239], a[144:147], 0
ds_read_b64_tr_b16 a[234:235], v17 offset:5632
v_cvt_pk_bf16_f32 v51, v158, v159
v_mfma_f32_16x16x32_bf16 v[116:119], a[244:247], a[148:151], v[116:119]
s_waitcnt lgkmcnt(4)
v_mfma_f32_16x16x32_bf16 v[56:59], a[248:251], a[8:11], v[56:59]
ds_read_b64_tr_b16 a[236:237], v17 offset:55296
v_mfma_f32_16x16x32_bf16 v[56:59], a[252:255], a[12:15], v[56:59]
v_cvt_pk_bf16_f32 v54, v84, v85
v_mfma_f32_16x16x32_bf16 v[76:79], a[248:251], a[56:59], v[76:79]
ds_read_b64_tr_b16 a[238:239], v17 offset:55808
v_mfma_f32_16x16x32_bf16 v[76:79], a[252:255], a[60:63], v[76:79]
v_cvt_pk_bf16_f32 v55, v86, v87
v_mfma_f32_16x16x32_bf16 v[152:155], a[248:251], a[104:107], v[152:155]
ds_read_b64_tr_b16 a[244:245], v17 offset:56320
v_mfma_f32_16x16x32_bf16 v[152:155], a[252:255], a[108:111], v[152:155]
v_cvt_pk_bf16_f32 v82, v200, v201
v_mfma_f32_16x16x32_bf16 v[116:119], a[248:251], a[152:155], v[116:119]
ds_read_b64_tr_b16 a[246:247], v17 offset:56832
v_mfma_f32_16x16x32_bf16 v[116:119], a[252:255], a[156:159], v[116:119]
s_waitcnt lgkmcnt(4)
v_mfma_f32_16x16x32_bf16 v[56:59], a[224:227], a[16:19], v[56:59]
ds_read_b64_tr_b16 a[248:249], v17 offset:57344
v_mfma_f32_16x16x32_bf16 v[56:59], a[232:235], a[20:23], v[56:59]
v_cvt_pk_bf16_f32 v83, v202, v203
v_mfma_f32_16x16x32_bf16 v[76:79], a[224:227], a[64:67], v[76:79]
ds_read_b64_tr_b16 a[250:251], v17 offset:57856
v_mfma_f32_16x16x32_bf16 v[76:79], a[232:235], a[68:71], v[76:79]
v_mfma_f32_16x16x32_bf16 v[152:155], a[224:227], a[112:115], v[152:155]
ds_read_b64_tr_b16 a[252:253], v17 offset:58368
v_mfma_f32_16x16x32_bf16 v[152:155], a[232:235], a[116:119], v[152:155]
v_mfma_f32_16x16x32_bf16 v[116:119], a[224:227], a[160:163], v[116:119]
ds_read_b64_tr_b16 a[254:255], v17 offset:58880
v_mfma_f32_16x16x32_bf16 v[116:119], a[232:235], a[164:167], v[116:119]
v_mfma_f32_16x16x32_bf16 v[180:183], v[176:179], v[172:175], v[180:183]
v_mfma_f32_16x16x32_bf16 v[236:239], v[176:179], v[140:143], v[236:239]
v_mfma_f32_16x16x32_bf16 v[204:207], v[176:179], v[160:163], v[204:207]
v_mfma_f32_16x16x32_bf16 v[232:235], v[176:179], v[100:103], v[232:235]
v_mfma_f32_16x16x32_bf16 v[164:167], v[48:51], v[172:175], v[164:167]
v_mfma_f32_16x16x32_bf16 v[220:223], v[48:51], v[140:143], v[220:223]
v_mfma_f32_16x16x32_bf16 v[168:171], v[48:51], v[160:163], v[168:171]
v_mfma_f32_16x16x32_bf16 v[44:47], v[48:51], v[100:103], v[44:47]
v_mfma_f32_16x16x32_bf16 v[144:147], v[52:55], v[172:175], v[144:147]
v_mfma_f32_16x16x32_bf16 v[108:111], v[52:55], v[140:143], v[108:111]
v_mfma_f32_16x16x32_bf16 v[112:115], v[52:55], v[160:163], v[112:115]
v_mfma_f32_16x16x32_bf16 v[252:255], v[52:55], v[100:103], v[252:255]
v_mfma_f32_16x16x32_bf16 v[224:227], v[80:83], v[172:175], v[224:227]
v_mfma_f32_16x16x32_bf16 v[216:219], v[80:83], v[140:143], v[216:219]
v_mfma_f32_16x16x32_bf16 v[40:43], v[80:83], v[160:163], v[40:43]
v_mfma_f32_16x16x32_bf16 v[104:107], v[80:83], v[100:103], v[104:107]
s_waitcnt lgkmcnt(4)
v_mfma_f32_16x16x32_bf16 v[56:59], a[236:239], a[24:27], v[56:59]
ds_read_b64_tr_b16 a[224:225], v17 offset:59392
v_mfma_f32_16x16x32_bf16 v[56:59], a[244:247], a[28:31], v[56:59]
v_mfma_f32_16x16x32_bf16 v[76:79], a[236:239], a[72:75], v[76:79]
ds_read_b64_tr_b16 a[226:227], v17 offset:59904
v_mfma_f32_16x16x32_bf16 v[76:79], a[244:247], a[76:79], v[76:79]
v_mfma_f32_16x16x32_bf16 v[152:155], a[236:239], a[120:123], v[152:155]
ds_read_b64_tr_b16 a[232:233], v17 offset:60416
v_mfma_f32_16x16x32_bf16 v[152:155], a[244:247], a[124:127], v[152:155]
v_mfma_f32_16x16x32_bf16 v[116:119], a[236:239], a[168:171], v[116:119]
ds_read_b64_tr_b16 a[234:235], v17 offset:60928
v_mfma_f32_16x16x32_bf16 v[116:119], a[244:247], a[172:175], v[116:119]
s_waitcnt lgkmcnt(4)
v_mfma_f32_16x16x32_bf16 v[56:59], a[248:251], a[32:35], v[56:59]
ds_read_b64_tr_b16 a[236:237], v18 offset:0
v_mfma_f32_16x16x32_bf16 v[56:59], a[252:255], a[36:39], v[56:59]
v_mfma_f32_16x16x32_bf16 v[76:79], a[248:251], a[80:83], v[76:79]
ds_read_b64_tr_b16 a[238:239], v18 offset:512
v_mfma_f32_16x16x32_bf16 v[76:79], a[252:255], a[84:87], v[76:79]
v_mfma_f32_16x16x32_bf16 v[152:155], a[248:251], a[128:131], v[152:155]
ds_read_b64_tr_b16 a[244:245], v18 offset:1024
v_mfma_f32_16x16x32_bf16 v[152:155], a[252:255], a[132:135], v[152:155]
v_mfma_f32_16x16x32_bf16 v[116:119], a[248:251], a[176:179], v[116:119]
ds_read_b64_tr_b16 a[246:247], v18 offset:1536
v_mfma_f32_16x16x32_bf16 v[116:119], a[252:255], a[180:183], v[116:119]
s_waitcnt lgkmcnt(4)
v_mfma_f32_16x16x32_bf16 v[56:59], a[224:227], a[40:43], v[56:59]
ds_read_b64_tr_b16 a[248:249], v18 offset:2048
v_mfma_f32_16x16x32_bf16 v[56:59], a[232:235], a[44:47], v[56:59]
v_mfma_f32_16x16x32_bf16 v[76:79], a[224:227], a[88:91], v[76:79]
ds_read_b64_tr_b16 a[250:251], v18 offset:2560
v_mfma_f32_16x16x32_bf16 v[76:79], a[232:235], a[92:95], v[76:79]
v_mfma_f32_16x16x32_bf16 v[152:155], a[224:227], a[136:139], v[152:155]
ds_read_b64_tr_b16 a[252:253], v18 offset:3072
v_mfma_f32_16x16x32_bf16 v[152:155], a[232:235], a[140:143], v[152:155]
v_mfma_f32_16x16x32_bf16 v[116:119], a[224:227], a[184:187], v[116:119]
ds_read_b64_tr_b16 a[254:255], v18 offset:3584
v_mfma_f32_16x16x32_bf16 v[116:119], a[232:235], a[188:191], v[116:119]
s_waitcnt lgkmcnt(4)
v_mfma_f32_16x16x32_bf16 v[68:71], a[236:239], a[0:3], 0
ds_read_b64_tr_b16 a[224:225], v18 offset:4096
v_mfma_f32_16x16x32_bf16 v[68:71], a[244:247], a[4:7], v[68:71]
v_cvt_pk_bf16_f32 v244, v56, v57
v_mfma_f32_16x16x32_bf16 v[136:139], a[236:239], a[48:51], 0
ds_read_b64_tr_b16 a[226:227], v18 offset:4608
v_mfma_f32_16x16x32_bf16 v[136:139], a[244:247], a[52:55], v[136:139]
v_cvt_pk_bf16_f32 v245, v58, v59
v_mfma_f32_16x16x32_bf16 v[192:195], a[236:239], a[96:99], 0
ds_read_b64_tr_b16 a[232:233], v18 offset:5120
v_mfma_f32_16x16x32_bf16 v[192:195], a[244:247], a[100:103], v[192:195]
v_cvt_pk_bf16_f32 v196, v76, v77
v_mfma_f32_16x16x32_bf16 v[96:99], a[236:239], a[144:147], 0
ds_read_b64_tr_b16 a[234:235], v18 offset:5632
v_cvt_pk_bf16_f32 v197, v78, v79
v_mfma_f32_16x16x32_bf16 v[96:99], a[244:247], a[148:151], v[96:99]
s_waitcnt lgkmcnt(4)
v_mfma_f32_16x16x32_bf16 v[68:71], a[248:251], a[8:11], v[68:71]
ds_read_b64_tr_b16 a[236:237], v18 offset:55296
v_mfma_f32_16x16x32_bf16 v[68:71], a[252:255], a[12:15], v[68:71]
v_cvt_pk_bf16_f32 v72, v152, v153
v_mfma_f32_16x16x32_bf16 v[136:139], a[248:251], a[56:59], v[136:139]
ds_read_b64_tr_b16 a[238:239], v18 offset:55808
v_mfma_f32_16x16x32_bf16 v[136:139], a[252:255], a[60:63], v[136:139]
v_cvt_pk_bf16_f32 v73, v154, v155
v_mfma_f32_16x16x32_bf16 v[192:195], a[248:251], a[104:107], v[192:195]
ds_read_b64_tr_b16 a[244:245], v18 offset:56320
v_mfma_f32_16x16x32_bf16 v[192:195], a[252:255], a[108:111], v[192:195]
v_cvt_pk_bf16_f32 v32, v116, v117
v_mfma_f32_16x16x32_bf16 v[96:99], a[248:251], a[152:155], v[96:99]
ds_read_b64_tr_b16 a[246:247], v18 offset:56832
v_mfma_f32_16x16x32_bf16 v[96:99], a[252:255], a[156:159], v[96:99]
s_waitcnt lgkmcnt(4)
v_mfma_f32_16x16x32_bf16 v[68:71], a[224:227], a[16:19], v[68:71]
ds_read_b64_tr_b16 a[248:249], v18 offset:57344
v_mfma_f32_16x16x32_bf16 v[68:71], a[232:235], a[20:23], v[68:71]
v_cvt_pk_bf16_f32 v33, v118, v119
v_mfma_f32_16x16x32_bf16 v[136:139], a[224:227], a[64:67], v[136:139]
ds_read_b64_tr_b16 a[250:251], v18 offset:57856
v_mfma_f32_16x16x32_bf16 v[136:139], a[232:235], a[68:71], v[136:139]
v_mfma_f32_16x16x32_bf16 v[192:195], a[224:227], a[112:115], v[192:195]
ds_read_b64_tr_b16 a[252:253], v18 offset:58368
v_mfma_f32_16x16x32_bf16 v[192:195], a[232:235], a[116:119], v[192:195]
v_mfma_f32_16x16x32_bf16 v[96:99], a[224:227], a[160:163], v[96:99]
ds_read_b64_tr_b16 a[254:255], v18 offset:58880
v_mfma_f32_16x16x32_bf16 v[96:99], a[232:235], a[164:167], v[96:99]
s_waitcnt lgkmcnt(4)
v_mfma_f32_16x16x32_bf16 v[68:71], a[236:239], a[24:27], v[68:71]
ds_read_b64_tr_b16 a[224:225], v18 offset:59392
v_mfma_f32_16x16x32_bf16 v[68:71], a[244:247], a[28:31], v[68:71]
v_mfma_f32_16x16x32_bf16 v[136:139], a[236:239], a[72:75], v[136:139]
ds_read_b64_tr_b16 a[226:227], v18 offset:59904
v_mfma_f32_16x16x32_bf16 v[136:139], a[244:247], a[76:79], v[136:139]
v_mfma_f32_16x16x32_bf16 v[192:195], a[236:239], a[120:123], v[192:195]
ds_read_b64_tr_b16 a[232:233], v18 offset:60416
v_mfma_f32_16x16x32_bf16 v[192:195], a[244:247], a[124:127], v[192:195]
v_mfma_f32_16x16x32_bf16 v[96:99], a[236:239], a[168:171], v[96:99]
ds_read_b64_tr_b16 a[234:235], v18 offset:60928
v_mfma_f32_16x16x32_bf16 v[96:99], a[244:247], a[172:175], v[96:99]
s_waitcnt lgkmcnt(4)
v_mfma_f32_16x16x32_bf16 v[68:71], a[248:251], a[32:35], v[68:71]
v_mfma_f32_16x16x32_bf16 v[68:71], a[252:255], a[36:39], v[68:71]
v_mfma_f32_16x16x32_bf16 v[136:139], a[248:251], a[80:83], v[136:139]
v_mfma_f32_16x16x32_bf16 v[136:139], a[252:255], a[84:87], v[136:139]
s_waitcnt vmcnt(0) lgkmcnt(0)
s_barrier
v_mfma_f32_16x16x32_bf16 v[192:195], a[248:251], a[128:131], v[192:195]
ds_read_b64_tr_b16 a[236:237], v6 offset:49152
v_mfma_f32_16x16x32_bf16 v[192:195], a[252:255], a[132:135], v[192:195]
ds_read_b64_tr_b16 a[238:239], v6 offset:49664
v_mfma_f32_16x16x32_bf16 v[96:99], a[248:251], a[176:179], v[96:99]
s_mov_b32 s44, 1408
v_mfma_f32_16x16x32_bf16 v[96:99], a[252:255], a[180:183], v[96:99]
ds_read_b64_tr_b16 a[244:245], v6 offset:50176
v_mfma_f32_16x16x32_bf16 v[68:71], a[224:227], a[40:43], v[68:71]
ds_read_b64_tr_b16 a[248:249], v6 offset:51200
v_mfma_f32_16x16x32_bf16 v[68:71], a[232:235], a[44:47], v[68:71]
ds_read_b64_tr_b16 a[246:247], v6 offset:50688
v_mfma_f32_16x16x32_bf16 v[136:139], a[224:227], a[88:91], v[136:139]
ds_read_b64_tr_b16 a[250:251], v6 offset:51712
v_mfma_f32_16x16x32_bf16 v[136:139], a[232:235], a[92:95], v[136:139]
v_mad_i32_i24 v8, v12, s44, v8
v_mfma_f32_16x16x32_bf16 v[192:195], a[224:227], a[136:139], v[192:195]
ds_read_b64_tr_b16 a[252:253], v6 offset:52224
v_mfma_f32_16x16x32_bf16 v[192:195], a[232:235], a[140:143], v[192:195]
s_add_u32 m0, s39, 0
v_mfma_f32_16x16x32_bf16 v[96:99], a[224:227], a[184:187], v[96:99]
ds_read_b64_tr_b16 a[254:255], v6 offset:52736
v_mfma_f32_16x16x32_bf16 v[96:99], a[232:235], a[188:191], v[96:99]
s_waitcnt lgkmcnt(3)
v_mfma_f32_16x16x32_bf16 v[148:151], a[0:3], a[236:239], 0
ds_read_b64_tr_b16 a[224:225], v6 offset:53248
v_mfma_f32_16x16x32_bf16 v[148:151], a[4:7], a[244:247], v[148:151]
s_add_u32 s42, s37, 3648
buffer_load_dwordx4 v8, s[20:23], s42 offen offset:0 lds
v_mfma_f32_16x16x32_bf16 v[248:251], a[48:51], a[236:239], 0
ds_read_b64_tr_b16 a[226:227], v6 offset:53760
s_add_u32 s43, s37, 76352
v_mfma_f32_16x16x32_bf16 v[248:251], a[52:55], a[244:247], v[248:251]
buffer_load_dwordx4 v8, s[20:23], s43 offen offset:1024 lds
s_add_u32 s42, s37, 149056
v_mfma_f32_16x16x32_bf16 v[240:243], a[96:99], a[236:239], 0
ds_read_b64_tr_b16 a[232:233], v6 offset:54272
buffer_load_dwordx4 v8, s[20:23], s42 offen offset:2048 lds
v_mfma_f32_16x16x32_bf16 v[240:243], a[100:103], a[244:247], v[240:243]
v_cvt_pk_bf16_f32 v246, v68, v69
v_cvt_pk_bf16_f32 v247, v70, v71
v_mfma_f32_16x16x32_bf16 v[60:63], a[144:147], a[236:239], 0
ds_read_b64_tr_b16 a[234:235], v6 offset:54784
s_add_u32 s43, s37, 221760
v_mfma_f32_16x16x32_bf16 v[60:63], a[148:151], a[244:247], v[60:63]
buffer_load_dwordx4 v8, s[20:23], s43 offen offset:3072 lds
s_waitcnt lgkmcnt(4)
v_mfma_f32_16x16x32_bf16 v[148:151], a[8:11], a[248:251], v[148:151]
ds_read_b64_tr_b16 a[236:237], v6 offset:6144
v_cvt_pk_bf16_f32 v198, v136, v137
v_mfma_f32_16x16x32_bf16 v[148:151], a[12:15], a[252:255], v[148:151]
v_cvt_pk_bf16_f32 v199, v138, v139
v_mfma_f32_16x16x32_bf16 v[248:251], a[56:59], a[248:251], v[248:251]
ds_read_b64_tr_b16 a[238:239], v6 offset:6656
v_mfma_f32_16x16x32_bf16 v[248:251], a[60:63], a[252:255], v[248:251]
v_cvt_pk_bf16_f32 v74, v192, v193
v_mfma_f32_16x16x32_bf16 v[240:243], a[104:107], a[248:251], v[240:243]
ds_read_b64_tr_b16 a[244:245], v6 offset:7168
v_cvt_pk_bf16_f32 v75, v194, v195
v_mfma_f32_16x16x32_bf16 v[240:243], a[108:111], a[252:255], v[240:243]
v_cvt_pk_bf16_f32 v34, v96, v97
v_mfma_f32_16x16x32_bf16 v[60:63], a[152:155], a[248:251], v[60:63]
ds_read_b64_tr_b16 a[246:247], v6 offset:7680
v_mfma_f32_16x16x32_bf16 v[60:63], a[156:159], a[252:255], v[60:63]
s_waitcnt lgkmcnt(4)
v_mfma_f32_16x16x32_bf16 v[148:151], a[16:19], a[224:227], v[148:151]
ds_read_b64_tr_b16 a[248:249], v6 offset:8192
v_mfma_f32_16x16x32_bf16 v[148:151], a[20:23], a[232:235], v[148:151]
v_cvt_pk_bf16_f32 v35, v98, v99
v_mfma_f32_16x16x32_bf16 v[248:251], a[64:67], a[224:227], v[248:251]
ds_read_b64_tr_b16 a[250:251], v6 offset:8704
v_mfma_f32_16x16x32_bf16 v[248:251], a[68:71], a[232:235], v[248:251]
s_add_u32 m0, s39, 4096
v_mfma_f32_16x16x32_bf16 v[240:243], a[112:115], a[224:227], v[240:243]
ds_read_b64_tr_b16 a[252:253], v6 offset:9216
v_mfma_f32_16x16x32_bf16 v[240:243], a[116:119], a[232:235], v[240:243]
s_add_u32 s42, s37, 298560
v_mfma_f32_16x16x32_bf16 v[60:63], a[160:163], a[224:227], v[60:63]
ds_read_b64_tr_b16 a[254:255], v6 offset:9728
v_mfma_f32_16x16x32_bf16 v[60:63], a[164:167], a[232:235], v[60:63]
buffer_load_dwordx4 v8, s[20:23], s42 offen offset:0 lds
v_mfma_f32_16x16x32_bf16 v[180:183], v[244:247], v[64:67], v[180:183]
s_add_u32 s43, s37, 371264
v_mfma_f32_16x16x32_bf16 v[236:239], v[244:247], v[184:187], v[236:239]
buffer_load_dwordx4 v8, s[20:23], s43 offen offset:1024 lds
v_mfma_f32_16x16x32_bf16 v[204:207], v[244:247], v[128:131], v[204:207]
s_add_u32 m0, s39, 55296
v_mfma_f32_16x16x32_bf16 v[232:235], v[244:247], v[208:211], v[232:235]
s_add_u32 s42, s37, 446016
v_mfma_f32_16x16x32_bf16 v[164:167], v[196:199], v[64:67], v[164:167]
buffer_load_dwordx4 v8, s[20:23], s42 offen offset:0 lds
v_mfma_f32_16x16x32_bf16 v[220:223], v[196:199], v[184:187], v[220:223]
v_mfma_f32_16x16x32_bf16 v[168:171], v[196:199], v[128:131], v[168:171]
s_add_u32 s43, s37, 518720
v_mfma_f32_16x16x32_bf16 v[44:47], v[196:199], v[208:211], v[44:47]
buffer_load_dwordx4 v8, s[20:23], s43 offen offset:1024 lds
v_mfma_f32_16x16x32_bf16 v[144:147], v[72:75], v[64:67], v[144:147]
v_mfma_f32_16x16x32_bf16 v[108:111], v[72:75], v[184:187], v[108:111]
v_mfma_f32_16x16x32_bf16 v[112:115], v[72:75], v[128:131], v[112:115]
v_mfma_f32_16x16x32_bf16 v[252:255], v[72:75], v[208:211], v[252:255]
v_mfma_f32_16x16x32_bf16 v[224:227], v[32:35], v[64:67], v[224:227]
s_add_u32 s42, s37, 591424
v_mfma_f32_16x16x32_bf16 v[216:219], v[32:35], v[184:187], v[216:219]
buffer_load_dwordx4 v8, s[20:23], s42 offen offset:2048 lds
v_mfma_f32_16x16x32_bf16 v[40:43], v[32:35], v[128:131], v[40:43]
v_mfma_f32_16x16x32_bf16 v[104:107], v[32:35], v[208:211], v[104:107]
s_waitcnt lgkmcnt(4)
v_mfma_f32_16x16x32_bf16 v[148:151], a[24:27], a[236:239], v[148:151]
ds_read_b64_tr_b16 a[224:225], v6 offset:10240
v_mfma_f32_16x16x32_bf16 v[148:151], a[28:31], a[244:247], v[148:151]
v_mfma_f32_16x16x32_bf16 v[248:251], a[72:75], a[236:239], v[248:251]
ds_read_b64_tr_b16 a[226:227], v6 offset:10752
v_mfma_f32_16x16x32_bf16 v[248:251], a[76:79], a[244:247], v[248:251]
s_add_u32 s43, s37, 664128
v_mfma_f32_16x16x32_bf16 v[240:243], a[120:123], a[236:239], v[240:243]
ds_read_b64_tr_b16 a[232:233], v6 offset:11264
v_mfma_f32_16x16x32_bf16 v[240:243], a[124:127], a[244:247], v[240:243]
buffer_load_dwordx4 v8, s[20:23], s43 offen offset:3072 lds
v_mfma_f32_16x16x32_bf16 v[60:63], a[168:171], a[236:239], v[60:63]
ds_read_b64_tr_b16 a[234:235], v6 offset:11776
v_mfma_f32_16x16x32_bf16 v[60:63], a[172:175], a[244:247], v[60:63]
s_waitcnt lgkmcnt(4)
v_mfma_f32_16x16x32_bf16 v[148:151], a[32:35], a[248:251], v[148:151]
ds_read_b64_tr_b16 a[236:237], v7 offset:49152
v_mfma_f32_16x16x32_bf16 v[148:151], a[36:39], a[252:255], v[148:151]
v_max3_f32 v2, v180, v181, v182
v_mfma_f32_16x16x32_bf16 v[248:251], a[80:83], a[248:251], v[248:251]
ds_read_b64_tr_b16 a[238:239], v7 offset:49664
v_mfma_f32_16x16x32_bf16 v[248:251], a[84:87], a[252:255], v[248:251]
v_max3_f32 v2, v2, v183, v164
v_mfma_f32_16x16x32_bf16 v[240:243], a[128:131], a[248:251], v[240:243]
ds_read_b64_tr_b16 a[244:245], v7 offset:50176
v_mfma_f32_16x16x32_bf16 v[240:243], a[132:135], a[252:255], v[240:243]
s_add_u32 m0, s39, 59392
v_mfma_f32_16x16x32_bf16 v[60:63], a[176:179], a[248:251], v[60:63]
ds_read_b64_tr_b16 a[246:247], v7 offset:50688
v_mfma_f32_16x16x32_bf16 v[60:63], a[180:183], a[252:255], v[60:63]
s_waitcnt lgkmcnt(4)
v_mfma_f32_16x16x32_bf16 v[148:151], a[40:43], a[224:227], v[148:151]
ds_read_b64_tr_b16 a[248:249], v7 offset:51200
v_mfma_f32_16x16x32_bf16 v[148:151], a[44:47], a[232:235], v[148:151]
s_add_u32 s42, s37, 740928
v_mfma_f32_16x16x32_bf16 v[248:251], a[88:91], a[224:227], v[248:251]
ds_read_b64_tr_b16 a[250:251], v7 offset:51712
v_mfma_f32_16x16x32_bf16 v[248:251], a[92:95], a[232:235], v[248:251]
buffer_load_dwordx4 v8, s[20:23], s42 offen offset:0 lds
v_mfma_f32_16x16x32_bf16 v[240:243], a[136:139], a[224:227], v[240:243]
ds_read_b64_tr_b16 a[252:253], v7 offset:52224
v_mfma_f32_16x16x32_bf16 v[240:243], a[140:143], a[232:235], v[240:243]
v_max3_f32 v2, v2, v165, v166
v_mfma_f32_16x16x32_bf16 v[60:63], a[184:187], a[224:227], v[60:63]
ds_read_b64_tr_b16 a[254:255], v7 offset:52736
v_mfma_f32_16x16x32_bf16 v[60:63], a[188:191], a[232:235], v[60:63]
v_max_f32 v2, v2, v167
s_waitcnt lgkmcnt(4)
v_mfma_f32_16x16x32_bf16 v[88:91], a[0:3], a[236:239], 0
ds_read_b64_tr_b16 a[224:225], v7 offset:53248
v_add_f32 v2, v2, v11
v_mfma_f32_16x16x32_bf16 v[88:91], a[4:7], a[244:247], v[88:91]
v_max3_f32 v28, v144, v145, v146
s_add_u32 s43, s37, 813632
v_mfma_f32_16x16x32_bf16 v[36:39], a[48:51], a[236:239], 0
ds_read_b64_tr_b16 a[226:227], v7 offset:53760
buffer_load_dwordx4 v8, s[20:23], s43 offen offset:1024 lds
v_mfma_f32_16x16x32_bf16 v[36:39], a[52:55], a[244:247], v[36:39]
v_max3_f32 v28, v28, v147, v224
v_max3_f32 v28, v28, v225, v226
v_mfma_f32_16x16x32_bf16 v[124:127], a[96:99], a[236:239], 0
ds_read_b64_tr_b16 a[232:233], v7 offset:54272
v_max_f32 v28, v28, v227
v_mfma_f32_16x16x32_bf16 v[124:127], a[100:103], a[244:247], v[124:127]
v_add_f32 v28, v28, v23
v_max_f32 v2, v2, v28
v_mfma_f32_16x16x32_bf16 v[228:231], a[144:147], a[236:239], 0
ds_read_b64_tr_b16 a[234:235], v7 offset:54784
v_max3_f32 v4, v236, v237, v238
v_mfma_f32_16x16x32_bf16 v[228:231], a[148:151], a[244:247], v[228:231]
v_max3_f32 v4, v4, v239, v220
s_waitcnt lgkmcnt(4)
v_mfma_f32_16x16x32_bf16 v[88:91], a[8:11], a[248:251], v[88:91]
ds_read_b64_tr_b16 a[236:237], v7 offset:6144
v_max3_f32 v4, v4, v221, v222
v_mfma_f32_16x16x32_bf16 v[88:91], a[12:15], a[252:255], v[88:91]
v_max_f32 v4, v4, v223
v_add_f32 v4, v4, v11
v_mfma_f32_16x16x32_bf16 v[36:39], a[56:59], a[248:251], v[36:39]
ds_read_b64_tr_b16 a[238:239], v7 offset:6656
v_max3_f32 v29, v108, v109, v110
v_mfma_f32_16x16x32_bf16 v[36:39], a[60:63], a[252:255], v[36:39]
v_max3_f32 v29, v29, v111, v216
v_max3_f32 v29, v29, v217, v218
v_mfma_f32_16x16x32_bf16 v[124:127], a[104:107], a[248:251], v[124:127]
ds_read_b64_tr_b16 a[244:245], v7 offset:7168
v_max_f32 v29, v29, v219
v_mfma_f32_16x16x32_bf16 v[124:127], a[108:111], a[252:255], v[124:127]
v_add_f32 v29, v29, v23
v_max_f32 v4, v4, v29
v_mfma_f32_16x16x32_bf16 v[228:231], a[152:155], a[248:251], v[228:231]
ds_read_b64_tr_b16 a[246:247], v7 offset:7680
v_max3_f32 v19, v112, v113, v114
v_mfma_f32_16x16x32_bf16 v[228:231], a[156:159], a[252:255], v[228:231]
v_cvt_pk_bf16_f32 v188, v148, v149
s_waitcnt lgkmcnt(4)
v_mfma_f32_16x16x32_bf16 v[88:91], a[16:19], a[224:227], v[88:91]
ds_read_b64_tr_b16 a[248:249], v7 offset:8192
v_cvt_pk_bf16_f32 v189, v150, v151
v_mfma_f32_16x16x32_bf16 v[88:91], a[20:23], a[232:235], v[88:91]
v_cvt_pk_bf16_f32 v190, v248, v249
v_cvt_pk_bf16_f32 v191, v250, v251
v_mfma_f32_16x16x32_bf16 v[36:39], a[64:67], a[224:227], v[36:39]
ds_read_b64_tr_b16 a[250:251], v7 offset:8704
v_cvt_pk_bf16_f32 v132, v240, v241
v_mfma_f32_16x16x32_bf16 v[36:39], a[68:71], a[232:235], v[36:39]
v_cvt_pk_bf16_f32 v133, v242, v243
v_mfma_f32_16x16x32_bf16 v[124:127], a[112:115], a[224:227], v[124:127]
ds_read_b64_tr_b16 a[252:253], v7 offset:9216
v_mfma_f32_16x16x32_bf16 v[124:127], a[116:119], a[232:235], v[124:127]
v_cvt_pk_bf16_f32 v134, v60, v61
v_mfma_f32_16x16x32_bf16 v[228:231], a[160:163], a[224:227], v[228:231]
ds_read_b64_tr_b16 a[254:255], v7 offset:9728
v_mfma_f32_16x16x32_bf16 v[228:231], a[164:167], a[232:235], v[228:231]
s_waitcnt lgkmcnt(4)
v_mfma_f32_16x16x32_bf16 v[88:91], a[24:27], a[236:239], v[88:91]
ds_read_b64_tr_b16 a[224:225], v7 offset:10240
v_cvt_pk_bf16_f32 v135, v62, v63
v_mfma_f32_16x16x32_bf16 v[88:91], a[28:31], a[244:247], v[88:91]
v_max3_f32 v19, v19, v115, v40
v_mfma_f32_16x16x32_bf16 v[36:39], a[72:75], a[236:239], v[36:39]
ds_read_b64_tr_b16 a[226:227], v7 offset:10752
v_max3_f32 v19, v19, v41, v42
v_mfma_f32_16x16x32_bf16 v[36:39], a[76:79], a[244:247], v[36:39]
v_max_f32 v19, v19, v43
v_mfma_f32_16x16x32_bf16 v[124:127], a[120:123], a[236:239], v[124:127]
ds_read_b64_tr_b16 a[232:233], v7 offset:11264
v_mfma_f32_16x16x32_bf16 v[124:127], a[124:127], a[244:247], v[124:127]
v_add_f32 v19, v19, v11
v_mfma_f32_16x16x32_bf16 v[228:231], a[168:171], a[236:239], v[228:231]
ds_read_b64_tr_b16 a[234:235], v7 offset:11776
v_max3_f32 v31, v204, v205, v206
v_mfma_f32_16x16x32_bf16 v[228:231], a[172:175], a[244:247], v[228:231]
v_max3_f32 v31, v31, v207, v168
s_waitcnt lgkmcnt(4)
v_mfma_f32_16x16x32_bf16 v[88:91], a[32:35], a[248:251], v[88:91]
ds_read_b64_tr_b16 a[236:237], v17 offset:49152
v_mfma_f32_16x16x32_bf16 v[88:91], a[36:39], a[252:255], v[88:91]
v_max3_f32 v31, v31, v169, v170
v_mfma_f32_16x16x32_bf16 v[36:39], a[80:83], a[248:251], v[36:39]
ds_read_b64_tr_b16 a[238:239], v17 offset:49664
v_max_f32 v31, v31, v171
v_mfma_f32_16x16x32_bf16 v[36:39], a[84:87], a[252:255], v[36:39]
v_add_f32 v31, v31, v23
v_mfma_f32_16x16x32_bf16 v[124:127], a[128:131], a[248:251], v[124:127]
ds_read_b64_tr_b16 a[244:245], v17 offset:50176
v_mfma_f32_16x16x32_bf16 v[124:127], a[132:135], a[252:255], v[124:127]
v_max_f32 v19, v19, v31
v_mfma_f32_16x16x32_bf16 v[228:231], a[176:179], a[248:251], v[228:231]
ds_read_b64_tr_b16 a[246:247], v17 offset:50688
v_max3_f32 v3, v252, v253, v254
v_mfma_f32_16x16x32_bf16 v[228:231], a[180:183], a[252:255], v[228:231]
v_max3_f32 v3, v3, v255, v104
s_waitcnt lgkmcnt(4)
v_mfma_f32_16x16x32_bf16 v[88:91], a[40:43], a[224:227], v[88:91]
ds_read_b64_tr_b16 a[248:249], v17 offset:51200
v_mfma_f32_16x16x32_bf16 v[88:91], a[44:47], a[232:235], v[88:91]
v_max3_f32 v3, v3, v105, v106
v_mfma_f32_16x16x32_bf16 v[36:39], a[88:91], a[224:227], v[36:39]
ds_read_b64_tr_b16 a[250:251], v17 offset:51712
v_max_f32 v3, v3, v107
v_mfma_f32_16x16x32_bf16 v[36:39], a[92:95], a[232:235], v[36:39]
v_add_f32 v3, v3, v11
v_mfma_f32_16x16x32_bf16 v[124:127], a[136:139], a[224:227], v[124:127]
ds_read_b64_tr_b16 a[252:253], v17 offset:52224
v_max3_f32 v26, v232, v233, v234
v_mfma_f32_16x16x32_bf16 v[124:127], a[140:143], a[232:235], v[124:127]
v_max3_f32 v26, v26, v235, v44
v_mfma_f32_16x16x32_bf16 v[228:231], a[184:187], a[224:227], v[228:231]
ds_read_b64_tr_b16 a[254:255], v17 offset:52736
v_mfma_f32_16x16x32_bf16 v[228:231], a[188:191], a[232:235], v[228:231]
v_max3_f32 v26, v26, v45, v46
s_waitcnt lgkmcnt(4)
v_mfma_f32_16x16x32_bf16 v[212:215], a[0:3], a[236:239], 0
ds_read_b64_tr_b16 a[224:225], v17 offset:53248
v_max_f32 v26, v26, v47
v_mfma_f32_16x16x32_bf16 v[212:215], a[4:7], a[244:247], v[212:215]
v_add_f32 v26, v26, v23
v_max_f32 v3, v3, v26
v_mfma_f32_16x16x32_bf16 v[156:159], a[48:51], a[236:239], 0
ds_read_b64_tr_b16 a[226:227], v17 offset:53760
v_permlane32_swap_b32 v2, v4
v_mfma_f32_16x16x32_bf16 v[156:159], a[52:55], a[244:247], v[156:159]
v_max_f32 v15, v2, v4
v_permlane32_swap_b32 v19, v3
v_mfma_f32_16x16x32_bf16 v[84:87], a[96:99], a[236:239], 0
ds_read_b64_tr_b16 a[232:233], v17 offset:54272
v_max_f32 v24, v19, v3
v_mfma_f32_16x16x32_bf16 v[84:87], a[100:103], a[244:247], v[84:87]
v_cvt_pk_bf16_f32 v200, v88, v89
v_cvt_pk_bf16_f32 v201, v90, v91
v_mfma_f32_16x16x32_bf16 v[176:179], a[144:147], a[236:239], 0
ds_read_b64_tr_b16 a[234:235], v17 offset:54784
v_permlane16_swap_b32 v15, v24
v_mfma_f32_16x16x32_bf16 v[176:179], a[148:151], a[244:247], v[176:179]
v_max_f32 v27, v15, v24
s_waitcnt lgkmcnt(4)
v_mfma_f32_16x16x32_bf16 v[212:215], a[8:11], a[248:251], v[212:215]
ds_read_b64_tr_b16 a[236:237], v17 offset:6144
v_mov_b32 v30, v27
v_mfma_f32_16x16x32_bf16 v[212:215], a[12:15], a[252:255], v[212:215]
v_cvt_pk_bf16_f32 v202, v36, v37
v_cvt_pk_bf16_f32 v203, v38, v39
v_mfma_f32_16x16x32_bf16 v[156:159], a[56:59], a[248:251], v[156:159]
ds_read_b64_tr_b16 a[238:239], v17 offset:6656
v_permlane16_swap_b32 v27, v30
v_mfma_f32_16x16x32_bf16 v[156:159], a[60:63], a[252:255], v[156:159]
v_mov_b32 v25, v27
v_mov_b32 v20, v30
v_mfma_f32_16x16x32_bf16 v[84:87], a[104:107], a[248:251], v[84:87]
ds_read_b64_tr_b16 a[244:245], v17 offset:7168
v_mfma_f32_16x16x32_bf16 v[84:87], a[108:111], a[252:255], v[84:87]
v_permlane32_swap_b32 v27, v25
v_permlane32_swap_b32 v30, v20
v_mfma_f32_16x16x32_bf16 v[176:179], a[152:155], a[248:251], v[176:179]
ds_read_b64_tr_b16 a[246:247], v17 offset:7680
v_fma_f32 v21, -v27, s40, v13
v_mfma_f32_16x16x32_bf16 v[176:179], a[156:159], a[252:255], v[176:179]
v_fma_f32 v5, -v27, s40, v14
s_waitcnt lgkmcnt(4)
v_mfma_f32_16x16x32_bf16 v[212:215], a[16:19], a[224:227], v[212:215]
ds_read_b64_tr_b16 a[248:249], v17 offset:8192
v_fma_f32 v16, -v25, s40, v13
v_mfma_f32_16x16x32_bf16 v[212:215], a[20:23], a[232:235], v[212:215]
v_fma_f32 v22, -v25, s40, v14
v_cvt_pk_bf16_f32 v48, v124, v125
v_mfma_f32_16x16x32_bf16 v[156:159], a[64:67], a[224:227], v[156:159]
ds_read_b64_tr_b16 a[250:251], v17 offset:8704
v_cvt_pk_bf16_f32 v49, v126, v127
v_mfma_f32_16x16x32_bf16 v[156:159], a[68:71], a[232:235], v[156:159]
v_cvt_pk_bf16_f32 v50, v228, v229
v_cvt_pk_bf16_f32 v51, v230, v231
v_mfma_f32_16x16x32_bf16 v[84:87], a[112:115], a[224:227], v[84:87]
ds_read_b64_tr_b16 a[252:253], v17 offset:9216
v_fma_f32 v28, -v30, s40, v13
v_mfma_f32_16x16x32_bf16 v[84:87], a[116:119], a[232:235], v[84:87]
v_fma_f32 v29, -v30, s40, v14
v_mfma_f32_16x16x32_bf16 v[176:179], a[160:163], a[224:227], v[176:179]
ds_read_b64_tr_b16 a[254:255], v17 offset:9728
v_mfma_f32_16x16x32_bf16 v[176:179], a[164:167], a[232:235], v[176:179]
s_waitcnt lgkmcnt(4)
v_mfma_f32_16x16x32_bf16 v[212:215], a[24:27], a[236:239], v[212:215]
ds_read_b64_tr_b16 a[224:225], v17 offset:10240
v_mfma_f32_16x16x32_bf16 v[212:215], a[28:31], a[244:247], v[212:215]
v_fma_f32 v31, -v20, s40, v13
v_mfma_f32_16x16x32_bf16 v[156:159], a[72:75], a[236:239], v[156:159]
ds_read_b64_tr_b16 a[226:227], v17 offset:10752
v_mfma_f32_16x16x32_bf16 v[156:159], a[76:79], a[244:247], v[156:159]
v_fma_f32 v26, -v20, s40, v14
v_mfma_f32_16x16x32_bf16 v[84:87], a[120:123], a[236:239], v[84:87]
ds_read_b64_tr_b16 a[232:233], v17 offset:11264
v_mfma_f32_16x16x32_bf16 v[84:87], a[124:127], a[244:247], v[84:87]
v_fma_f32 v180, v180, s40, v21
v_mfma_f32_16x16x32_bf16 v[176:179], a[168:171], a[236:239], v[176:179]
ds_read_b64_tr_b16 a[234:235], v17 offset:11776
v_mfma_f32_16x16x32_bf16 v[176:179], a[172:175], a[244:247], v[176:179]
s_waitcnt lgkmcnt(4)
v_mfma_f32_16x16x32_bf16 v[212:215], a[32:35], a[248:251], v[212:215]
ds_read_b64_tr_b16 a[236:237], v18 offset:49152
v_fma_f32 v181, v181, s40, v21
v_mfma_f32_16x16x32_bf16 v[212:215], a[36:39], a[252:255], v[212:215]
v_exp_f32 v180, v180
v_mfma_f32_16x16x32_bf16 v[156:159], a[80:83], a[248:251], v[156:159]
ds_read_b64_tr_b16 a[238:239], v18 offset:49664
v_fma_f32 v182, v182, s40, v21
v_mfma_f32_16x16x32_bf16 v[156:159], a[84:87], a[252:255], v[156:159]
v_exp_f32 v181, v181
v_mfma_f32_16x16x32_bf16 v[84:87], a[128:131], a[248:251], v[84:87]
ds_read_b64_tr_b16 a[244:245], v18 offset:50176
v_fma_f32 v183, v183, s40, v21
v_mfma_f32_16x16x32_bf16 v[84:87], a[132:135], a[252:255], v[84:87]
v_exp_f32 v182, v182
v_mfma_f32_16x16x32_bf16 v[176:179], a[176:179], a[248:251], v[176:179]
ds_read_b64_tr_b16 a[246:247], v18 offset:50688
v_add_f32 v2, v180, v181
v_mfma_f32_16x16x32_bf16 v[176:179], a[180:183], a[252:255], v[176:179]
s_waitcnt lgkmcnt(4)
v_mfma_f32_16x16x32_bf16 v[212:215], a[40:43], a[224:227], v[212:215]
ds_read_b64_tr_b16 a[248:249], v18 offset:51200
v_fma_f32 v164, v164, s40, v21
v_mfma_f32_16x16x32_bf16 v[212:215], a[44:47], a[232:235], v[212:215]
v_exp_f32 v183, v183
v_mfma_f32_16x16x32_bf16 v[156:159], a[88:91], a[224:227], v[156:159]
ds_read_b64_tr_b16 a[250:251], v18 offset:51712
v_add_f32 v4, v182, v183
v_mfma_f32_16x16x32_bf16 v[156:159], a[92:95], a[232:235], v[156:159]
v_exp_f32 v164, v164
v_mfma_f32_16x16x32_bf16 v[84:87], a[136:139], a[224:227], v[84:87]
ds_read_b64_tr_b16 a[252:253], v18 offset:52224
v_mfma_f32_16x16x32_bf16 v[84:87], a[140:143], a[232:235], v[84:87]
v_fma_f32 v165, v165, s40, v21
v_mfma_f32_16x16x32_bf16 v[176:179], a[184:187], a[224:227], v[176:179]
ds_read_b64_tr_b16 a[254:255], v18 offset:52736
v_mfma_f32_16x16x32_bf16 v[176:179], a[188:191], a[232:235], v[176:179]
v_fma_f32 v166, v166, s40, v21
s_waitcnt lgkmcnt(4)
v_mfma_f32_16x16x32_bf16 v[52:55], a[0:3], a[236:239], 0
ds_read_b64_tr_b16 a[224:225], v18 offset:53248
v_fma_f32 v167, v167, s40, v21
v_mfma_f32_16x16x32_bf16 v[52:55], a[4:7], a[244:247], v[52:55]
v_exp_f32 v165, v165
v_mfma_f32_16x16x32_bf16 v[172:175], a[48:51], a[236:239], 0
ds_read_b64_tr_b16 a[226:227], v18 offset:53760
v_add_f32 v2, v2, v164
v_mfma_f32_16x16x32_bf16 v[172:175], a[52:55], a[244:247], v[172:175]
v_exp_f32 v166, v166
v_mfma_f32_16x16x32_bf16 v[140:143], a[96:99], a[236:239], 0
ds_read_b64_tr_b16 a[232:233], v18 offset:54272
v_add_f32 v2, v2, v165
v_mfma_f32_16x16x32_bf16 v[140:143], a[100:103], a[244:247], v[140:143]
v_exp_f32 v167, v167
v_mfma_f32_16x16x32_bf16 v[160:163], a[144:147], a[236:239], 0
ds_read_b64_tr_b16 a[234:235], v18 offset:54784
v_add_f32 v4, v4, v166
v_mfma_f32_16x16x32_bf16 v[160:163], a[148:151], a[244:247], v[160:163]
v_add_f32 v4, v4, v167
s_waitcnt lgkmcnt(4)
v_mfma_f32_16x16x32_bf16 v[52:55], a[8:11], a[248:251], v[52:55]
ds_read_b64_tr_b16 a[236:237], v18 offset:6144
v_fma_f32 v144, v144, s40, v5
v_mfma_f32_16x16x32_bf16 v[52:55], a[12:15], a[252:255], v[52:55]
v_exp_f32 v144, v144
v_mfma_f32_16x16x32_bf16 v[172:175], a[56:59], a[248:251], v[172:175]
ds_read_b64_tr_b16 a[238:239], v18 offset:6656
v_fma_f32 v145, v145, s40, v5
v_mfma_f32_16x16x32_bf16 v[172:175], a[60:63], a[252:255], v[172:175]
v_exp_f32 v145, v145
v_mfma_f32_16x16x32_bf16 v[140:143], a[104:107], a[248:251], v[140:143]
ds_read_b64_tr_b16 a[244:245], v18 offset:7168
v_fma_f32 v146, v146, s40, v5
v_mfma_f32_16x16x32_bf16 v[140:143], a[108:111], a[252:255], v[140:143]
v_exp_f32 v146, v146
v_mfma_f32_16x16x32_bf16 v[160:163], a[152:155], a[248:251], v[160:163]
ds_read_b64_tr_b16 a[246:247], v18 offset:7680
v_fma_f32 v147, v147, s40, v5
v_mfma_f32_16x16x32_bf16 v[160:163], a[156:159], a[252:255], v[160:163]
v_add_f32 v2, v2, v144
s_waitcnt lgkmcnt(4)
v_mfma_f32_16x16x32_bf16 v[52:55], a[16:19], a[224:227], v[52:55]
ds_read_b64_tr_b16 a[248:249], v18 offset:8192
v_add_f32 v2, v2, v145
v_mfma_f32_16x16x32_bf16 v[52:55], a[20:23], a[232:235], v[52:55]
v_exp_f32 v147, v147
v_mfma_f32_16x16x32_bf16 v[172:175], a[64:67], a[224:227], v[172:175]
ds_read_b64_tr_b16 a[250:251], v18 offset:8704
v_add_f32 v4, v4, v146
v_mfma_f32_16x16x32_bf16 v[172:175], a[68:71], a[232:235], v[172:175]
v_cvt_pk_bf16_f32 v100, v212, v213
v_cvt_pk_bf16_f32 v101, v214, v215
v_mfma_f32_16x16x32_bf16 v[140:143], a[112:115], a[224:227], v[140:143]
ds_read_b64_tr_b16 a[252:253], v18 offset:9216
v_cvt_pk_bf16_f32 v102, v156, v157
v_mfma_f32_16x16x32_bf16 v[140:143], a[116:119], a[232:235], v[140:143]
v_cvt_pk_bf16_f32 v103, v158, v159
v_cvt_pk_bf16_f32 v80, v84, v85
v_mfma_f32_16x16x32_bf16 v[160:163], a[160:163], a[224:227], v[160:163]
ds_read_b64_tr_b16 a[254:255], v18 offset:9728
v_cvt_pk_bf16_f32 v81, v86, v87
v_mfma_f32_16x16x32_bf16 v[160:163], a[164:167], a[232:235], v[160:163]
v_cvt_pk_bf16_f32 v82, v176, v177
s_waitcnt lgkmcnt(4)
v_mfma_f32_16x16x32_bf16 v[52:55], a[24:27], a[236:239], v[52:55]
ds_read_b64_tr_b16 a[224:225], v18 offset:10240
v_cvt_pk_bf16_f32 v83, v178, v179
v_mfma_f32_16x16x32_bf16 v[52:55], a[28:31], a[244:247], v[52:55]
v_add_f32 v4, v4, v147
v_mfma_f32_16x16x32_bf16 v[172:175], a[72:75], a[236:239], v[172:175]
ds_read_b64_tr_b16 a[226:227], v18 offset:10752
v_mfma_f32_16x16x32_bf16 v[172:175], a[76:79], a[244:247], v[172:175]
v_fma_f32 v224, v224, s40, v5
v_mfma_f32_16x16x32_bf16 v[140:143], a[120:123], a[236:239], v[140:143]
ds_read_b64_tr_b16 a[232:233], v18 offset:11264
v_fma_f32 v225, v225, s40, v5
v_mfma_f32_16x16x32_bf16 v[140:143], a[124:127], a[244:247], v[140:143]
v_exp_f32 v224, v224
v_mfma_f32_16x16x32_bf16 v[160:163], a[168:171], a[236:239], v[160:163]
ds_read_b64_tr_b16 a[234:235], v18 offset:11776
v_mfma_f32_16x16x32_bf16 v[160:163], a[172:175], a[244:247], v[160:163]
v_fma_f32 v226, v226, s40, v5
s_waitcnt lgkmcnt(4)
v_mfma_f32_16x16x32_bf16 v[52:55], a[32:35], a[248:251], v[52:55]
v_exp_f32 v225, v225
v_mfma_f32_16x16x32_bf16 v[52:55], a[36:39], a[252:255], v[52:55]
v_exp_f32 v226, v226
v_mfma_f32_16x16x32_bf16 v[172:175], a[80:83], a[248:251], v[172:175]
v_fma_f32 v227, v227, s40, v5
v_mfma_f32_16x16x32_bf16 v[172:175], a[84:87], a[252:255], v[172:175]
s_waitcnt vmcnt(0) lgkmcnt(0)
s_barrier
v_mfma_f32_16x16x32_bf16 v[140:143], a[128:131], a[248:251], v[140:143]
ds_read_b64_tr_b16 a[236:237], v17 offset:0
v_add_f32 v2, v2, v224
v_mfma_f32_16x16x32_bf16 v[140:143], a[132:135], a[252:255], v[140:143]
ds_read_b64_tr_b16 a[238:239], v17 offset:512
v_add_f32 v2, v2, v225
v_mfma_f32_16x16x32_bf16 v[160:163], a[176:179], a[248:251], v[160:163]
v_exp_f32 v227, v227
v_mfma_f32_16x16x32_bf16 v[160:163], a[180:183], a[252:255], v[160:163]
ds_read_b64_tr_b16 a[244:245], v17 offset:1024
v_mfma_f32_16x16x32_bf16 v[52:55], a[40:43], a[224:227], v[52:55]
ds_read_b64_tr_b16 a[248:249], v17 offset:2048
v_add_f32 v4, v4, v226
v_mfma_f32_16x16x32_bf16 v[52:55], a[44:47], a[232:235], v[52:55]
ds_read_b64_tr_b16 a[246:247], v17 offset:1536
v_add_f32 v4, v4, v227
v_mfma_f32_16x16x32_bf16 v[172:175], a[88:91], a[224:227], v[172:175]
ds_read_b64_tr_b16 a[250:251], v17 offset:2560
v_add_f32 v2, v2, v4
v_mfma_f32_16x16x32_bf16 v[172:175], a[92:95], a[232:235], v[172:175]
v_fma_f32 v236, v236, s40, v16
v_fma_f32 v237, v237, s40, v16
v_mfma_f32_16x16x32_bf16 v[140:143], a[136:139], a[224:227], v[140:143]
ds_read_b64_tr_b16 a[252:253], v17 offset:3072
v_fma_f32 v238, v238, s40, v16
v_mfma_f32_16x16x32_bf16 v[140:143], a[140:143], a[232:235], v[140:143]
v_exp_f32 v236, v236
v_mfma_f32_16x16x32_bf16 v[160:163], a[184:187], a[224:227], v[160:163]
ds_read_b64_tr_b16 a[254:255], v17 offset:3584
s_mov_b32 s44, -1408
v_mfma_f32_16x16x32_bf16 v[160:163], a[188:191], a[232:235], v[160:163]
v_mad_i32_i24 v8, v12, s44, v8
s_waitcnt lgkmcnt(3)
v_mfma_f32_16x16x32_bf16 v[56:59], a[0:3], a[236:239], 0
ds_read_b64_tr_b16 a[224:225], v17 offset:4096
s_add_u32 m0, s39, 49152
v_mfma_f32_16x16x32_bf16 v[56:59], a[4:7], a[244:247], v[56:59]
v_exp_f32 v237, v237
v_mfma_f32_16x16x32_bf16 v[76:79], a[48:51], a[236:239], 0
ds_read_b64_tr_b16 a[226:227], v17 offset:4608
s_add_u32 s42, s37, 3712
v_mfma_f32_16x16x32_bf16 v[76:79], a[52:55], a[244:247], v[76:79]
buffer_load_dwordx4 v8, s[20:23], s42 offen offset:0 lds
v_fma_f32 v239, v239, s40, v16
v_mfma_f32_16x16x32_bf16 v[152:155], a[96:99], a[236:239], 0
ds_read_b64_tr_b16 a[232:233], v17 offset:5120
v_add_f32 v19, v236, v237
v_mfma_f32_16x16x32_bf16 v[152:155], a[100:103], a[244:247], v[152:155]
v_exp_f32 v238, v238
v_mfma_f32_16x16x32_bf16 v[116:119], a[144:147], a[236:239], 0
ds_read_b64_tr_b16 a[234:235], v17 offset:5632
s_add_u32 s43, s37, 76416
v_mfma_f32_16x16x32_bf16 v[116:119], a[148:151], a[244:247], v[116:119]
buffer_load_dwordx4 v8, s[20:23], s43 offen offset:1024 lds
s_waitcnt lgkmcnt(4)
v_mfma_f32_16x16x32_bf16 v[56:59], a[8:11], a[248:251], v[56:59]
ds_read_b64_tr_b16 a[236:237], v17 offset:55296
v_fma_f32 v220, v220, s40, v16
v_mfma_f32_16x16x32_bf16 v[56:59], a[12:15], a[252:255], v[56:59]
v_exp_f32 v239, v239
v_mfma_f32_16x16x32_bf16 v[76:79], a[56:59], a[248:251], v[76:79]
ds_read_b64_tr_b16 a[238:239], v17 offset:55808
v_add_f32 v3, v238, v239
v_mfma_f32_16x16x32_bf16 v[76:79], a[60:63], a[252:255], v[76:79]
v_exp_f32 v220, v220
v_mfma_f32_16x16x32_bf16 v[152:155], a[104:107], a[248:251], v[152:155]
ds_read_b64_tr_b16 a[244:245], v17 offset:56320
v_fma_f32 v221, v221, s40, v16
v_mfma_f32_16x16x32_bf16 v[152:155], a[108:111], a[252:255], v[152:155]
v_exp_f32 v221, v221
v_mfma_f32_16x16x32_bf16 v[116:119], a[152:155], a[248:251], v[116:119]
ds_read_b64_tr_b16 a[246:247], v17 offset:56832
s_add_u32 s42, s37, 149120
v_mfma_f32_16x16x32_bf16 v[116:119], a[156:159], a[252:255], v[116:119]
buffer_load_dwordx4 v8, s[20:23], s42 offen offset:2048 lds
s_waitcnt lgkmcnt(4)
v_mfma_f32_16x16x32_bf16 v[56:59], a[16:19], a[224:227], v[56:59]
ds_read_b64_tr_b16 a[248:249], v17 offset:57344
v_fma_f32 v222, v222, s40, v16
v_mfma_f32_16x16x32_bf16 v[56:59], a[20:23], a[232:235], v[56:59]
v_exp_f32 v222, v222
v_mfma_f32_16x16x32_bf16 v[76:79], a[64:67], a[224:227], v[76:79]
ds_read_b64_tr_b16 a[250:251], v17 offset:57856
v_fma_f32 v223, v223, s40, v16
v_mfma_f32_16x16x32_bf16 v[76:79], a[68:71], a[232:235], v[76:79]
v_exp_f32 v223, v223
v_mfma_f32_16x16x32_bf16 v[152:155], a[112:115], a[224:227], v[152:155]
ds_read_b64_tr_b16 a[252:253], v17 offset:58368
v_add_f32 v19, v19, v220
v_mfma_f32_16x16x32_bf16 v[152:155], a[116:119], a[232:235], v[152:155]
s_add_u32 s43, s37, 221824
buffer_load_dwordx4 v8, s[20:23], s43 offen offset:3072 lds
v_mfma_f32_16x16x32_bf16 v[116:119], a[160:163], a[224:227], v[116:119]
ds_read_b64_tr_b16 a[254:255], v17 offset:58880
v_add_f32 v19, v19, v221
v_mfma_f32_16x16x32_bf16 v[116:119], a[164:167], a[232:235], v[116:119]
v_add_f32 v3, v3, v222
s_waitcnt lgkmcnt(4)
v_mfma_f32_16x16x32_bf16 v[56:59], a[24:27], a[236:239], v[56:59]
ds_read_b64_tr_b16 a[224:225], v17 offset:59392
v_add_f32 v3, v3, v223
v_mfma_f32_16x16x32_bf16 v[56:59], a[28:31], a[244:247], v[56:59]
v_cvt_pk_bf16_f32 v68, v52, v53
v_cvt_pk_bf16_f32 v69, v54, v55
v_mfma_f32_16x16x32_bf16 v[76:79], a[72:75], a[236:239], v[76:79]
ds_read_b64_tr_b16 a[226:227], v17 offset:59904
v_cvt_pk_bf16_f32 v70, v172, v173
v_mfma_f32_16x16x32_bf16 v[76:79], a[76:79], a[244:247], v[76:79]
v_cvt_pk_bf16_f32 v71, v174, v175
v_cvt_pk_bf16_f32 v136, v140, v141
v_mfma_f32_16x16x32_bf16 v[152:155], a[120:123], a[236:239], v[152:155]
ds_read_b64_tr_b16 a[232:233], v17 offset:60416
v_cvt_pk_bf16_f32 v137, v142, v143
v_mfma_f32_16x16x32_bf16 v[152:155], a[124:127], a[244:247], v[152:155]
v_cvt_pk_bf16_f32 v138, v160, v161
v_cvt_pk_bf16_f32 v139, v162, v163
v_mfma_f32_16x16x32_bf16 v[116:119], a[168:171], a[236:239], v[116:119]
ds_read_b64_tr_b16 a[234:235], v17 offset:60928
v_fma_f32 v108, v108, s40, v22
v_mfma_f32_16x16x32_bf16 v[116:119], a[172:175], a[244:247], v[116:119]
s_add_u32 m0, s39, 53248
s_waitcnt lgkmcnt(4)
v_mfma_f32_16x16x32_bf16 v[56:59], a[32:35], a[248:251], v[56:59]
ds_read_b64_tr_b16 a[236:237], v18 offset:0
s_add_u32 s42, s37, 298624
v_mfma_f32_16x16x32_bf16 v[56:59], a[36:39], a[252:255], v[56:59]
buffer_load_dwordx4 v8, s[20:23], s42 offen offset:0 lds
v_fma_f32 v109, v109, s40, v22
v_mfma_f32_16x16x32_bf16 v[76:79], a[80:83], a[248:251], v[76:79]
ds_read_b64_tr_b16 a[238:239], v18 offset:512
v_fma_f32 v110, v110, s40, v22
v_mfma_f32_16x16x32_bf16 v[76:79], a[84:87], a[252:255], v[76:79]
v_exp_f32 v108, v108
v_mfma_f32_16x16x32_bf16 v[152:155], a[128:131], a[248:251], v[152:155]
ds_read_b64_tr_b16 a[244:245], v18 offset:1024
s_add_u32 s43, s37, 371328
v_mfma_f32_16x16x32_bf16 v[152:155], a[132:135], a[252:255], v[152:155]
v_exp_f32 v109, v109
v_mfma_f32_16x16x32_bf16 v[116:119], a[176:179], a[248:251], v[116:119]
ds_read_b64_tr_b16 a[246:247], v18 offset:1536
buffer_load_dwordx4 v8, s[20:23], s43 offen offset:1024 lds
v_mfma_f32_16x16x32_bf16 v[116:119], a[180:183], a[252:255], v[116:119]
v_fma_f32 v111, v111, s40, v22
s_waitcnt lgkmcnt(4)
v_mfma_f32_16x16x32_bf16 v[56:59], a[40:43], a[224:227], v[56:59]
ds_read_b64_tr_b16 a[248:249], v18 offset:2048
v_add_f32 v19, v19, v108
v_mfma_f32_16x16x32_bf16 v[56:59], a[44:47], a[232:235], v[56:59]
v_exp_f32 v110, v110
v_mfma_f32_16x16x32_bf16 v[76:79], a[88:91], a[224:227], v[76:79]
ds_read_b64_tr_b16 a[250:251], v18 offset:2560
v_add_f32 v19, v19, v109
v_mfma_f32_16x16x32_bf16 v[76:79], a[92:95], a[232:235], v[76:79]
v_exp_f32 v111, v111
v_mfma_f32_16x16x32_bf16 v[152:155], a[136:139], a[224:227], v[152:155]
ds_read_b64_tr_b16 a[252:253], v18 offset:3072
s_add_u32 m0, s39, 6144
v_mfma_f32_16x16x32_bf16 v[152:155], a[140:143], a[232:235], v[152:155]
s_add_u32 s42, s37, 446080
buffer_load_dwordx4 v8, s[20:23], s42 offen offset:0 lds
v_mfma_f32_16x16x32_bf16 v[116:119], a[184:187], a[224:227], v[116:119]
ds_read_b64_tr_b16 a[254:255], v18 offset:3584
v_add_f32 v3, v3, v110
v_mfma_f32_16x16x32_bf16 v[116:119], a[188:191], a[232:235], v[116:119]
v_add_f32 v3, v3, v111
s_waitcnt lgkmcnt(4)
v_mfma_f32_16x16x32_bf16 v[192:195], a[0:3], a[236:239], 0
ds_read_b64_tr_b16 a[224:225], v18 offset:4096
v_fma_f32 v216, v216, s40, v22
v_mfma_f32_16x16x32_bf16 v[192:195], a[4:7], a[244:247], v[192:195]
v_exp_f32 v216, v216
v_mfma_f32_16x16x32_bf16 v[96:99], a[48:51], a[236:239], 0
ds_read_b64_tr_b16 a[226:227], v18 offset:4608
v_fma_f32 v217, v217, s40, v22
v_mfma_f32_16x16x32_bf16 v[96:99], a[52:55], a[244:247], v[96:99]
s_add_u32 s43, s37, 518784
buffer_load_dwordx4 v8, s[20:23], s43 offen offset:1024 lds
v_mfma_f32_16x16x32_bf16 v[244:247], a[96:99], a[236:239], 0
ds_read_b64_tr_b16 a[232:233], v18 offset:5120
v_fma_f32 v218, v218, s40, v22
v_mfma_f32_16x16x32_bf16 v[244:247], a[100:103], a[244:247], v[244:247]
v_exp_f32 v217, v217
v_mfma_f32_16x16x32_bf16 v[196:199], a[144:147], a[236:239], 0
ds_read_b64_tr_b16 a[234:235], v18 offset:5632
v_fma_f32 v219, v219, s40, v22
v_mfma_f32_16x16x32_bf16 v[196:199], a[148:151], a[244:247], v[196:199]
s_add_u32 s42, s37, 591488
s_waitcnt lgkmcnt(4)
v_mfma_f32_16x16x32_bf16 v[192:195], a[8:11], a[248:251], v[192:195]
ds_read_b64_tr_b16 a[236:237], v18 offset:55296
buffer_load_dwordx4 v8, s[20:23], s42 offen offset:2048 lds
v_mfma_f32_16x16x32_bf16 v[192:195], a[12:15], a[252:255], v[192:195]
v_exp_f32 v218, v218
v_mfma_f32_16x16x32_bf16 v[96:99], a[56:59], a[248:251], v[96:99]
ds_read_b64_tr_b16 a[238:239], v18 offset:55808
v_add_f32 v19, v19, v216
v_mfma_f32_16x16x32_bf16 v[96:99], a[60:63], a[252:255], v[96:99]
v_exp_f32 v219, v219
v_mfma_f32_16x16x32_bf16 v[244:247], a[104:107], a[248:251], v[244:247]
ds_read_b64_tr_b16 a[244:245], v18 offset:56320
v_add_f32 v19, v19, v217
v_mfma_f32_16x16x32_bf16 v[244:247], a[108:111], a[252:255], v[244:247]
v_add_f32 v3, v3, v218
v_add_f32 v3, v3, v219
v_mfma_f32_16x16x32_bf16 v[196:199], a[152:155], a[248:251], v[196:199]
ds_read_b64_tr_b16 a[246:247], v18 offset:56832
s_add_u32 s43, s37, 664192
v_mfma_f32_16x16x32_bf16 v[196:199], a[156:159], a[252:255], v[196:199]
buffer_load_dwordx4 v8, s[20:23], s43 offen offset:3072 lds
s_waitcnt lgkmcnt(4)
v_mfma_f32_16x16x32_bf16 v[192:195], a[16:19], a[224:227], v[192:195]
ds_read_b64_tr_b16 a[248:249], v18 offset:57344
v_add_f32 v19, v19, v3
v_mfma_f32_16x16x32_bf16 v[192:195], a[20:23], a[232:235], v[192:195]
v_fma_f32 v204, v204, s40, v29
v_fma_f32 v205, v205, s40, v29
v_mfma_f32_16x16x32_bf16 v[96:99], a[64:67], a[224:227], v[96:99]
ds_read_b64_tr_b16 a[250:251], v18 offset:57856
s_add_u32 m0, s39, 10240
v_mfma_f32_16x16x32_bf16 v[96:99], a[68:71], a[232:235], v[96:99]
v_exp_f32 v204, v204
v_mfma_f32_16x16x32_bf16 v[244:247], a[112:115], a[224:227], v[244:247]
ds_read_b64_tr_b16 a[252:253], v18 offset:58368
s_add_u32 s42, s37, 740992
v_mfma_f32_16x16x32_bf16 v[244:247], a[116:119], a[232:235], v[244:247]
v_exp_f32 v205, v205
v_mfma_f32_16x16x32_bf16 v[196:199], a[160:163], a[224:227], v[196:199]
ds_read_b64_tr_b16 a[254:255], v18 offset:58880
buffer_load_dwordx4 v8, s[20:23], s42 offen offset:0 lds
v_mfma_f32_16x16x32_bf16 v[196:199], a[164:167], a[232:235], v[196:199]
v_fma_f32 v206, v206, s40, v29
s_waitcnt lgkmcnt(4)
v_mfma_f32_16x16x32_bf16 v[192:195], a[24:27], a[236:239], v[192:195]
ds_read_b64_tr_b16 a[224:225], v18 offset:59392
v_fma_f32 v207, v207, s40, v29
v_mfma_f32_16x16x32_bf16 v[192:195], a[28:31], a[244:247], v[192:195]
v_exp_f32 v206, v206
v_mfma_f32_16x16x32_bf16 v[96:99], a[72:75], a[236:239], v[96:99]
ds_read_b64_tr_b16 a[226:227], v18 offset:59904
s_add_u32 s43, s37, 813696
v_mfma_f32_16x16x32_bf16 v[96:99], a[76:79], a[244:247], v[96:99]
v_exp_f32 v207, v207
v_mfma_f32_16x16x32_bf16 v[244:247], a[120:123], a[236:239], v[244:247]
ds_read_b64_tr_b16 a[232:233], v18 offset:60416
buffer_load_dwordx4 v8, s[20:23], s43 offen offset:1024 lds
v_mfma_f32_16x16x32_bf16 v[244:247], a[124:127], a[244:247], v[244:247]
v_add_f32 v15, v204, v205
v_add_f32 v24, v206, v207
v_mfma_f32_16x16x32_bf16 v[196:199], a[168:171], a[236:239], v[196:199]
ds_read_b64_tr_b16 a[234:235], v18 offset:60928
v_fma_f32 v168, v168, s40, v29
v_mfma_f32_16x16x32_bf16 v[196:199], a[172:175], a[244:247], v[196:199]
v_cvt_pk_bf16_f32 v72, v56, v57
s_waitcnt lgkmcnt(4)
v_mfma_f32_16x16x32_bf16 v[192:195], a[32:35], a[248:251], v[192:195]
ds_read_b64_tr_b16 a[236:237], v6 offset:0
v_cvt_pk_bf16_f32 v73, v58, v59
v_mfma_f32_16x16x32_bf16 v[192:195], a[36:39], a[252:255], v[192:195]
v_exp_f32 v168, v168
v_mfma_f32_16x16x32_bf16 v[96:99], a[80:83], a[248:251], v[96:99]
ds_read_b64_tr_b16 a[238:239], v6 offset:512
v_cvt_pk_bf16_f32 v74, v76, v77
v_mfma_f32_16x16x32_bf16 v[96:99], a[84:87], a[252:255], v[96:99]
v_cvt_pk_bf16_f32 v75, v78, v79
v_cvt_pk_bf16_f32 v64, v152, v153
v_mfma_f32_16x16x32_bf16 v[244:247], a[128:131], a[248:251], v[244:247]
ds_read_b64_tr_b16 a[244:245], v6 offset:1024
v_cvt_pk_bf16_f32 v65, v154, v155
v_mfma_f32_16x16x32_bf16 v[244:247], a[132:135], a[252:255], v[244:247]
v_cvt_pk_bf16_f32 v66, v116, v117
v_cvt_pk_bf16_f32 v67, v118, v119
v_mfma_f32_16x16x32_bf16 v[196:199], a[176:179], a[248:251], v[196:199]
ds_read_b64_tr_b16 a[246:247], v6 offset:1536
v_fma_f32 v169, v169, s40, v29
v_mfma_f32_16x16x32_bf16 v[196:199], a[180:183], a[252:255], v[196:199]
v_fma_f32 v170, v170, s40, v29
s_waitcnt lgkmcnt(4)
v_mfma_f32_16x16x32_bf16 v[192:195], a[40:43], a[224:227], v[192:195]
ds_read_b64_tr_b16 a[248:249], v6 offset:2048
v_fma_f32 v171, v171, s40, v29
v_mfma_f32_16x16x32_bf16 v[192:195], a[44:47], a[232:235], v[192:195]
v_exp_f32 v169, v169
v_mfma_f32_16x16x32_bf16 v[96:99], a[88:91], a[224:227], v[96:99]
ds_read_b64_tr_b16 a[250:251], v6 offset:2560
v_add_f32 v15, v15, v168
v_mfma_f32_16x16x32_bf16 v[96:99], a[92:95], a[232:235], v[96:99]
v_exp_f32 v170, v170
v_mfma_f32_16x16x32_bf16 v[244:247], a[136:139], a[224:227], v[244:247]
ds_read_b64_tr_b16 a[252:253], v6 offset:3072
v_add_f32 v15, v15, v169
v_mfma_f32_16x16x32_bf16 v[244:247], a[140:143], a[232:235], v[244:247]
v_exp_f32 v171, v171
v_mfma_f32_16x16x32_bf16 v[196:199], a[184:187], a[224:227], v[196:199]
ds_read_b64_tr_b16 a[254:255], v6 offset:3584
v_add_f32 v24, v24, v170
v_mfma_f32_16x16x32_bf16 v[196:199], a[188:191], a[232:235], v[196:199]
v_add_f32 v24, v24, v171
s_waitcnt lgkmcnt(4)
v_mfma_f32_16x16x32_bf16 v[184:187], a[236:239], a[0:3], 0
ds_read_b64_tr_b16 a[224:225], v6 offset:4096
v_fma_f32 v112, v112, s40, v28
v_mfma_f32_16x16x32_bf16 v[184:187], a[244:247], a[4:7], v[184:187]
v_exp_f32 v112, v112
v_mfma_f32_16x16x32_bf16 v[128:131], a[236:239], a[48:51], 0
ds_read_b64_tr_b16 a[226:227], v6 offset:4608
v_fma_f32 v113, v113, s40, v28
v_mfma_f32_16x16x32_bf16 v[128:131], a[244:247], a[52:55], v[128:131]
v_exp_f32 v113, v113
v_mfma_f32_16x16x32_bf16 v[208:211], a[236:239], a[96:99], 0
ds_read_b64_tr_b16 a[232:233], v6 offset:5120
v_fma_f32 v114, v114, s40, v28
v_mfma_f32_16x16x32_bf16 v[208:211], a[244:247], a[100:103], v[208:211]
v_exp_f32 v114, v114
v_mfma_f32_16x16x32_bf16 v[32:35], a[236:239], a[144:147], 0
ds_read_b64_tr_b16 a[234:235], v6 offset:5632
v_fma_f32 v115, v115, s40, v28
v_mfma_f32_16x16x32_bf16 v[32:35], a[244:247], a[148:151], v[32:35]
v_add_f32 v15, v15, v112
s_waitcnt lgkmcnt(4)
v_mfma_f32_16x16x32_bf16 v[184:187], a[248:251], a[8:11], v[184:187]
ds_read_b64_tr_b16 a[236:237], v6 offset:55296
v_add_f32 v15, v15, v113
v_mfma_f32_16x16x32_bf16 v[184:187], a[252:255], a[12:15], v[184:187]
v_exp_f32 v115, v115
v_mfma_f32_16x16x32_bf16 v[128:131], a[248:251], a[56:59], v[128:131]
ds_read_b64_tr_b16 a[238:239], v6 offset:55808
v_add_f32 v24, v24, v114
v_mfma_f32_16x16x32_bf16 v[128:131], a[252:255], a[60:63], v[128:131]
v_add_f32 v24, v24, v115
v_fma_f32 v40, v40, s40, v28
v_mfma_f32_16x16x32_bf16 v[208:211], a[248:251], a[104:107], v[208:211]
ds_read_b64_tr_b16 a[244:245], v6 offset:56320
v_fma_f32 v41, v41, s40, v28
v_mfma_f32_16x16x32_bf16 v[208:211], a[252:255], a[108:111], v[208:211]
v_exp_f32 v40, v40
v_mfma_f32_16x16x32_bf16 v[32:35], a[248:251], a[152:155], v[32:35]
ds_read_b64_tr_b16 a[246:247], v6 offset:56832
v_fma_f32 v42, v42, s40, v28
v_mfma_f32_16x16x32_bf16 v[32:35], a[252:255], a[156:159], v[32:35]
v_fma_f32 v43, v43, s40, v28
s_waitcnt lgkmcnt(4)
v_mfma_f32_16x16x32_bf16 v[184:187], a[224:227], a[16:19], v[184:187]
ds_read_b64_tr_b16 a[248:249], v6 offset:57344
v_add_f32 v15, v15, v40
v_mfma_f32_16x16x32_bf16 v[184:187], a[232:235], a[20:23], v[184:187]
v_exp_f32 v41, v41
v_mfma_f32_16x16x32_bf16 v[128:131], a[224:227], a[64:67], v[128:131]
ds_read_b64_tr_b16 a[250:251], v6 offset:57856
v_add_f32 v15, v15, v41
v_mfma_f32_16x16x32_bf16 v[128:131], a[232:235], a[68:71], v[128:131]
v_exp_f32 v42, v42
v_mfma_f32_16x16x32_bf16 v[208:211], a[224:227], a[112:115], v[208:211]
ds_read_b64_tr_b16 a[252:253], v6 offset:58368
v_add_f32 v24, v24, v42
v_mfma_f32_16x16x32_bf16 v[208:211], a[232:235], a[116:119], v[208:211]
v_exp_f32 v43, v43
v_mfma_f32_16x16x32_bf16 v[32:35], a[224:227], a[160:163], v[32:35]
ds_read_b64_tr_b16 a[254:255], v6 offset:58880
v_add_f32 v24, v24, v43
v_mfma_f32_16x16x32_bf16 v[32:35], a[232:235], a[164:167], v[32:35]
v_add_f32 v15, v15, v24
s_waitcnt lgkmcnt(4)
v_mfma_f32_16x16x32_bf16 v[184:187], a[236:239], a[24:27], v[184:187]
ds_read_b64_tr_b16 a[224:225], v6 offset:59392
v_fma_f32 v232, v232, s40, v26
v_mfma_f32_16x16x32_bf16 v[184:187], a[244:247], a[28:31], v[184:187]
v_exp_f32 v232, v232
v_mfma_f32_16x16x32_bf16 v[128:131], a[236:239], a[72:75], v[128:131]
ds_read_b64_tr_b16 a[226:227], v6 offset:59904
v_cvt_pk_bf16_f32 v148, v192, v193
v_mfma_f32_16x16x32_bf16 v[128:131], a[244:247], a[76:79], v[128:131]
v_cvt_pk_bf16_f32 v149, v194, v195
v_cvt_pk_bf16_f32 v150, v96, v97
v_mfma_f32_16x16x32_bf16 v[208:211], a[236:239], a[120:123], v[208:211]
ds_read_b64_tr_b16 a[232:233], v6 offset:60416
v_cvt_pk_bf16_f32 v151, v98, v99
v_mfma_f32_16x16x32_bf16 v[208:211], a[244:247], a[124:127], v[208:211]
v_cvt_pk_bf16_f32 v248, v244, v245
v_cvt_pk_bf16_f32 v249, v246, v247
v_mfma_f32_16x16x32_bf16 v[32:35], a[236:239], a[168:171], v[32:35]
ds_read_b64_tr_b16 a[234:235], v6 offset:60928
v_cvt_pk_bf16_f32 v250, v196, v197
v_mfma_f32_16x16x32_bf16 v[32:35], a[244:247], a[172:175], v[32:35]
v_cvt_pk_bf16_f32 v251, v198, v199
s_waitcnt lgkmcnt(4)
v_mfma_f32_16x16x32_bf16 v[184:187], a[248:251], a[32:35], v[184:187]
ds_read_b64_tr_b16 a[236:237], v7 offset:0
v_fma_f32 v233, v233, s40, v26
v_mfma_f32_16x16x32_bf16 v[184:187], a[252:255], a[36:39], v[184:187]
v_exp_f32 v233, v233
v_mfma_f32_16x16x32_bf16 v[128:131], a[248:251], a[80:83], v[128:131]
ds_read_b64_tr_b16 a[238:239], v7 offset:512
v_fma_f32 v234, v234, s40, v26
v_mfma_f32_16x16x32_bf16 v[128:131], a[252:255], a[84:87], v[128:131]
v_exp_f32 v234, v234
v_mfma_f32_16x16x32_bf16 v[208:211], a[248:251], a[128:131], v[208:211]
ds_read_b64_tr_b16 a[244:245], v7 offset:1024
v_fma_f32 v235, v235, s40, v26
v_mfma_f32_16x16x32_bf16 v[208:211], a[252:255], a[132:135], v[208:211]
v_exp_f32 v235, v235
v_mfma_f32_16x16x32_bf16 v[32:35], a[248:251], a[176:179], v[32:35]
ds_read_b64_tr_b16 a[246:247], v7 offset:1536
v_add_f32 v27, v232, v233
v_mfma_f32_16x16x32_bf16 v[32:35], a[252:255], a[180:183], v[32:35]
v_add_f32 v25, v234, v235
s_waitcnt lgkmcnt(4)
v_mfma_f32_16x16x32_bf16 v[184:187], a[224:227], a[40:43], v[184:187]
ds_read_b64_tr_b16 a[248:249], v7 offset:2048
v_fma_f32 v44, v44, s40, v26
v_mfma_f32_16x16x32_bf16 v[184:187], a[232:235], a[44:47], v[184:187]
v_exp_f32 v44, v44
v_mfma_f32_16x16x32_bf16 v[128:131], a[224:227], a[88:91], v[128:131]
ds_read_b64_tr_b16 a[250:251], v7 offset:2560
v_fma_f32 v45, v45, s40, v26
v_mfma_f32_16x16x32_bf16 v[128:131], a[232:235], a[92:95], v[128:131]
v_exp_f32 v45, v45
v_mfma_f32_16x16x32_bf16 v[208:211], a[224:227], a[136:139], v[208:211]
ds_read_b64_tr_b16 a[252:253], v7 offset:3072
v_fma_f32 v46, v46, s40, v26
v_mfma_f32_16x16x32_bf16 v[208:211], a[232:235], a[140:143], v[208:211]
v_exp_f32 v46, v46
v_mfma_f32_16x16x32_bf16 v[32:35], a[224:227], a[184:187], v[32:35]
ds_read_b64_tr_b16 a[254:255], v7 offset:3584
v_fma_f32 v47, v47, s40, v26
v_mfma_f32_16x16x32_bf16 v[32:35], a[232:235], a[188:191], v[32:35]
v_add_f32 v27, v27, v44
s_waitcnt lgkmcnt(4)
v_mfma_f32_16x16x32_bf16 v[240:243], a[236:239], a[0:3], 0
ds_read_b64_tr_b16 a[224:225], v7 offset:4096
v_add_f32 v27, v27, v45
v_mfma_f32_16x16x32_bf16 v[240:243], a[244:247], a[4:7], v[240:243]
v_exp_f32 v47, v47
v_mfma_f32_16x16x32_bf16 v[60:63], a[236:239], a[48:51], 0
ds_read_b64_tr_b16 a[226:227], v7 offset:4608
v_add_f32 v25, v25, v46
v_mfma_f32_16x16x32_bf16 v[60:63], a[244:247], a[52:55], v[60:63]
v_add_f32 v25, v25, v47
v_fma_f32 v252, v252, s40, v31
v_mfma_f32_16x16x32_bf16 v[88:91], a[236:239], a[96:99], 0
ds_read_b64_tr_b16 a[232:233], v7 offset:5120
v_fma_f32 v253, v253, s40, v31
v_mfma_f32_16x16x32_bf16 v[88:91], a[244:247], a[100:103], v[88:91]
v_exp_f32 v252, v252
v_mfma_f32_16x16x32_bf16 v[36:39], a[236:239], a[144:147], 0
ds_read_b64_tr_b16 a[234:235], v7 offset:5632
v_fma_f32 v254, v254, s40, v31
v_mfma_f32_16x16x32_bf16 v[36:39], a[244:247], a[148:151], v[36:39]
v_fma_f32 v255, v255, s40, v31
s_waitcnt lgkmcnt(4)
v_mfma_f32_16x16x32_bf16 v[240:243], a[248:251], a[8:11], v[240:243]
ds_read_b64_tr_b16 a[236:237], v7 offset:55296
v_add_f32 v27, v27, v252
v_mfma_f32_16x16x32_bf16 v[240:243], a[252:255], a[12:15], v[240:243]
v_exp_f32 v253, v253
v_mfma_f32_16x16x32_bf16 v[60:63], a[248:251], a[56:59], v[60:63]
ds_read_b64_tr_b16 a[238:239], v7 offset:55808
v_add_f32 v27, v27, v253
v_mfma_f32_16x16x32_bf16 v[60:63], a[252:255], a[60:63], v[60:63]
v_exp_f32 v254, v254
v_mfma_f32_16x16x32_bf16 v[88:91], a[248:251], a[104:107], v[88:91]
ds_read_b64_tr_b16 a[244:245], v7 offset:56320
v_add_f32 v25, v25, v254
v_mfma_f32_16x16x32_bf16 v[88:91], a[252:255], a[108:111], v[88:91]
v_exp_f32 v255, v255
v_mfma_f32_16x16x32_bf16 v[36:39], a[248:251], a[152:155], v[36:39]
ds_read_b64_tr_b16 a[246:247], v7 offset:56832
v_add_f32 v25, v25, v255
v_mfma_f32_16x16x32_bf16 v[36:39], a[252:255], a[156:159], v[36:39]
v_fma_f32 v104, v104, s40, v31
s_waitcnt lgkmcnt(4)
v_mfma_f32_16x16x32_bf16 v[240:243], a[224:227], a[16:19], v[240:243]
ds_read_b64_tr_b16 a[248:249], v7 offset:57344
v_fma_f32 v105, v105, s40, v31
v_mfma_f32_16x16x32_bf16 v[240:243], a[232:235], a[20:23], v[240:243]
v_exp_f32 v104, v104
v_mfma_f32_16x16x32_bf16 v[60:63], a[224:227], a[64:67], v[60:63]
ds_read_b64_tr_b16 a[250:251], v7 offset:57856
v_cvt_pk_bf16_f32 v124, v184, v185
v_mfma_f32_16x16x32_bf16 v[60:63], a[232:235], a[68:71], v[60:63]
v_exp_f32 v105, v105
v_mfma_f32_16x16x32_bf16 v[88:91], a[224:227], a[112:115], v[88:91]
ds_read_b64_tr_b16 a[252:253], v7 offset:58368
v_cvt_pk_bf16_f32 v125, v186, v187
v_mfma_f32_16x16x32_bf16 v[88:91], a[232:235], a[116:119], v[88:91]
v_cvt_pk_bf16_f32 v228, v128, v129
v_cvt_pk_bf16_f32 v229, v130, v131
v_mfma_f32_16x16x32_bf16 v[36:39], a[224:227], a[160:163], v[36:39]
ds_read_b64_tr_b16 a[254:255], v7 offset:58880
v_cvt_pk_bf16_f32 v212, v208, v209
v_mfma_f32_16x16x32_bf16 v[36:39], a[232:235], a[164:167], v[36:39]
v_cvt_pk_bf16_f32 v213, v210, v211
s_waitcnt lgkmcnt(4)
v_mfma_f32_16x16x32_bf16 v[240:243], a[236:239], a[24:27], v[240:243]
ds_read_b64_tr_b16 a[224:225], v7 offset:59392
v_cvt_pk_bf16_f32 v156, v32, v33
v_mfma_f32_16x16x32_bf16 v[240:243], a[244:247], a[28:31], v[240:243]
v_cvt_pk_bf16_f32 v157, v34, v35
v_fma_f32 v106, v106, s40, v31
v_mfma_f32_16x16x32_bf16 v[60:63], a[236:239], a[72:75], v[60:63]
ds_read_b64_tr_b16 a[226:227], v7 offset:59904
v_fma_f32 v107, v107, s40, v31
v_mfma_f32_16x16x32_bf16 v[60:63], a[244:247], a[76:79], v[60:63]
v_exp_f32 v106, v106
v_mfma_f32_16x16x32_bf16 v[88:91], a[236:239], a[120:123], v[88:91]
ds_read_b64_tr_b16 a[232:233], v7 offset:60416
v_add_f32 v27, v27, v104
v_mfma_f32_16x16x32_bf16 v[88:91], a[244:247], a[124:127], v[88:91]
v_exp_f32 v107, v107
v_mfma_f32_16x16x32_bf16 v[36:39], a[236:239], a[168:171], v[36:39]
ds_read_b64_tr_b16 a[234:235], v7 offset:60928
v_mfma_f32_16x16x32_bf16 v[36:39], a[244:247], a[172:175], v[36:39]
v_add_f32 v27, v27, v105
s_waitcnt lgkmcnt(4)
v_mfma_f32_16x16x32_bf16 v[240:243], a[248:251], a[32:35], v[240:243]
v_add_f32 v25, v25, v106
v_add_f32 v25, v25, v107
v_mfma_f32_16x16x32_bf16 v[240:243], a[252:255], a[36:39], v[240:243]
v_add_f32 v27, v27, v25
v_mfma_f32_16x16x32_bf16 v[60:63], a[248:251], a[80:83], v[60:63]
v_permlane32_swap_b32 v2, v19
v_add_f32 v30, v2, v19
v_mfma_f32_16x16x32_bf16 v[60:63], a[252:255], a[84:87], v[60:63]
s_waitcnt vmcnt(0) lgkmcnt(0)
s_barrier
v_mfma_f32_16x16x32_bf16 v[88:91], a[248:251], a[128:131], v[88:91]
ds_read_b64_tr_b16 a[236:237], v6 offset:49152
v_permlane32_swap_b32 v15, v27
v_mfma_f32_16x16x32_bf16 v[88:91], a[252:255], a[132:135], v[88:91]
ds_read_b64_tr_b16 a[238:239], v6 offset:49664
v_add_f32 v20, v15, v27
v_mfma_f32_16x16x32_bf16 v[36:39], a[248:251], a[176:179], v[36:39]
s_add_u32 m0, s39, 0
v_mfma_f32_16x16x32_bf16 v[36:39], a[252:255], a[180:183], v[36:39]
ds_read_b64_tr_b16 a[244:245], v6 offset:50176
v_mfma_f32_16x16x32_bf16 v[240:243], a[224:227], a[40:43], v[240:243]
ds_read_b64_tr_b16 a[248:249], v6 offset:51200
v_permlane16_swap_b32 v30, v20
v_mfma_f32_16x16x32_bf16 v[240:243], a[232:235], a[44:47], v[240:243]
ds_read_b64_tr_b16 a[246:247], v6 offset:50688
v_add_f32 v21, v30, v20
v_mfma_f32_16x16x32_bf16 v[60:63], a[224:227], a[88:91], v[60:63]
ds_read_b64_tr_b16 a[250:251], v6 offset:51712
s_add_u32 s42, s37, 4480
v_mfma_f32_16x16x32_bf16 v[60:63], a[232:235], a[92:95], v[60:63]
v_rcp_f32 v21, v21
v_mfma_f32_16x16x32_bf16 v[88:91], a[224:227], a[136:139], v[88:91]
ds_read_b64_tr_b16 a[252:253], v6 offset:52224
v_mov_b32 v5, v21
v_mfma_f32_16x16x32_bf16 v[88:91], a[232:235], a[140:143], v[88:91]
buffer_load_dwordx4 v8, s[20:23], s42 offen offset:0 lds
v_mfma_f32_16x16x32_bf16 v[36:39], a[224:227], a[184:187], v[36:39]
ds_read_b64_tr_b16 a[254:255], v6 offset:52736
v_permlane16_swap_b32 v21, v5
v_mfma_f32_16x16x32_bf16 v[36:39], a[232:235], a[188:191], v[36:39]
v_mov_b32 v4, v21
s_waitcnt lgkmcnt(3)
v_mfma_f32_16x16x32_bf16 v[84:87], a[236:239], a[0:3], 0
ds_read_b64_tr_b16 a[224:225], v6 offset:53248
v_mov_b32 v16, v5
v_mfma_f32_16x16x32_bf16 v[84:87], a[244:247], a[4:7], v[84:87]
v_permlane32_swap_b32 v21, v4
v_mul_f32 v180, v180, v21
v_mfma_f32_16x16x32_bf16 v[176:179], a[236:239], a[48:51], 0
ds_read_b64_tr_b16 a[226:227], v6 offset:53760
v_permlane32_swap_b32 v5, v16
v_mfma_f32_16x16x32_bf16 v[176:179], a[244:247], a[52:55], v[176:179]
v_mul_f32 v181, v181, v21
s_add_u32 s43, s37, 77184
v_mfma_f32_16x16x32_bf16 v[52:55], a[236:239], a[96:99], 0
ds_read_b64_tr_b16 a[232:233], v6 offset:54272
buffer_load_dwordx4 v8, s[20:23], s43 offen offset:1024 lds
v_mfma_f32_16x16x32_bf16 v[52:55], a[244:247], a[100:103], v[52:55]
v_mul_f32 v182, v182, v21
v_mul_f32 v183, v183, v21
v_mfma_f32_16x16x32_bf16 v[172:175], a[236:239], a[144:147], 0
ds_read_b64_tr_b16 a[234:235], v6 offset:54784
v_cvt_pk_bf16_f32 v140, v180, v181
v_mfma_f32_16x16x32_bf16 v[172:175], a[244:247], a[148:151], v[172:175]
v_cvt_pk_bf16_f32 v141, v182, v183
s_waitcnt lgkmcnt(4)
v_mfma_f32_16x16x32_bf16 v[84:87], a[248:251], a[8:11], v[84:87]
ds_read_b64_tr_b16 a[236:237], v6 offset:6144
v_mul_f32 v164, v164, v21
v_mfma_f32_16x16x32_bf16 v[84:87], a[252:255], a[12:15], v[84:87]
s_add_u32 s42, s37, 149888
buffer_load_dwordx4 v8, s[20:23], s42 offen offset:2048 lds
v_mfma_f32_16x16x32_bf16 v[176:179], a[248:251], a[56:59], v[176:179]
ds_read_b64_tr_b16 a[238:239], v6 offset:6656
v_mul_f32 v165, v165, v21
v_mfma_f32_16x16x32_bf16 v[176:179], a[252:255], a[60:63], v[176:179]
v_mul_f32 v166, v166, v21
v_mul_f32 v167, v167, v21
v_mfma_f32_16x16x32_bf16 v[52:55], a[248:251], a[104:107], v[52:55]
ds_read_b64_tr_b16 a[244:245], v6 offset:7168
v_cvt_pk_bf16_f32 v142, v164, v165
v_mfma_f32_16x16x32_bf16 v[52:55], a[252:255], a[108:111], v[52:55]
s_add_u32 s43, s37, 222592
buffer_load_dwordx4 v8, s[20:23], s43 offen offset:3072 lds
v_mfma_f32_16x16x32_bf16 v[172:175], a[248:251], a[152:155], v[172:175]
ds_read_b64_tr_b16 a[246:247], v6 offset:7680
v_cvt_pk_bf16_f32 v143, v166, v167
v_mfma_f32_16x16x32_bf16 v[172:175], a[252:255], a[156:159], v[172:175]
v_mul_f32 v144, v144, v21
s_waitcnt lgkmcnt(4)
v_mfma_f32_16x16x32_bf16 v[84:87], a[224:227], a[16:19], v[84:87]
ds_read_b64_tr_b16 a[248:249], v6 offset:8192
v_mul_f32 v145, v145, v21
v_mfma_f32_16x16x32_bf16 v[84:87], a[232:235], a[20:23], v[84:87]
v_mul_f32 v146, v146, v21
v_cvt_pk_bf16_f32 v126, v240, v241
v_mfma_f32_16x16x32_bf16 v[176:179], a[224:227], a[64:67], v[176:179]
ds_read_b64_tr_b16 a[250:251], v6 offset:8704
v_cvt_pk_bf16_f32 v127, v242, v243
v_mfma_f32_16x16x32_bf16 v[176:179], a[232:235], a[68:71], v[176:179]
v_cvt_pk_bf16_f32 v230, v60, v61
v_cvt_pk_bf16_f32 v231, v62, v63
v_mfma_f32_16x16x32_bf16 v[52:55], a[224:227], a[112:115], v[52:55]
ds_read_b64_tr_b16 a[252:253], v6 offset:9216
v_cvt_pk_bf16_f32 v214, v88, v89
v_mfma_f32_16x16x32_bf16 v[52:55], a[232:235], a[116:119], v[52:55]
v_cvt_pk_bf16_f32 v215, v90, v91
v_cvt_pk_bf16_f32 v158, v36, v37
v_mfma_f32_16x16x32_bf16 v[172:175], a[224:227], a[160:163], v[172:175]
ds_read_b64_tr_b16 a[254:255], v6 offset:9728
v_cvt_pk_bf16_f32 v159, v38, v39
v_mfma_f32_16x16x32_bf16 v[172:175], a[232:235], a[164:167], v[172:175]
v_mul_f32 v147, v147, v21
s_waitcnt lgkmcnt(4)
v_mfma_f32_16x16x32_bf16 v[84:87], a[236:239], a[24:27], v[84:87]
ds_read_b64_tr_b16 a[224:225], v6 offset:10240
s_add_u32 m0, s39, 4096
v_mfma_f32_16x16x32_bf16 v[84:87], a[244:247], a[28:31], v[84:87]
s_add_u32 s42, s37, 299392
buffer_load_dwordx4 v8, s[20:23], s42 offen offset:0 lds
v_mfma_f32_16x16x32_bf16 v[176:179], a[236:239], a[72:75], v[176:179]
ds_read_b64_tr_b16 a[226:227], v6 offset:10752
v_cvt_pk_bf16_f32 v160, v144, v145
v_mfma_f32_16x16x32_bf16 v[176:179], a[244:247], a[76:79], v[176:179]
v_cvt_pk_bf16_f32 v161, v146, v147
v_mul_f32 v224, v224, v21
v_mfma_f32_16x16x32_bf16 v[52:55], a[236:239], a[120:123], v[52:55]
ds_read_b64_tr_b16 a[232:233], v6 offset:11264
v_mul_f32 v225, v225, v21
v_mfma_f32_16x16x32_bf16 v[52:55], a[244:247], a[124:127], v[52:55]
v_mul_f32 v226, v226, v21
s_add_u32 s43, s37, 372096
v_mfma_f32_16x16x32_bf16 v[172:175], a[236:239], a[168:171], v[172:175]
ds_read_b64_tr_b16 a[234:235], v6 offset:11776
buffer_load_dwordx4 v8, s[20:23], s43 offen offset:1024 lds
v_mfma_f32_16x16x32_bf16 v[172:175], a[244:247], a[172:175], v[172:175]
v_mul_f32 v227, v227, v21
s_waitcnt lgkmcnt(4)
v_mfma_f32_16x16x32_bf16 v[84:87], a[248:251], a[32:35], v[84:87]
ds_read_b64_tr_b16 a[236:237], v7 offset:49152
v_cvt_pk_bf16_f32 v162, v224, v225
v_mfma_f32_16x16x32_bf16 v[84:87], a[252:255], a[36:39], v[84:87]
v_cvt_pk_bf16_f32 v163, v226, v227
v_mul_f32 v236, v236, v4
v_mfma_f32_16x16x32_bf16 v[176:179], a[248:251], a[80:83], v[176:179]
ds_read_b64_tr_b16 a[238:239], v7 offset:49664
s_add_u32 m0, s39, 55296
v_mfma_f32_16x16x32_bf16 v[176:179], a[252:255], a[84:87], v[176:179]
s_add_u32 s42, s37, 446848
buffer_load_dwordx4 v8, s[20:23], s42 offen offset:0 lds
v_mfma_f32_16x16x32_bf16 v[52:55], a[248:251], a[128:131], v[52:55]
ds_read_b64_tr_b16 a[244:245], v7 offset:50176
v_mul_f32 v237, v237, v4
v_mfma_f32_16x16x32_bf16 v[52:55], a[252:255], a[132:135], v[52:55]
v_mul_f32 v238, v238, v4
v_mul_f32 v239, v239, v4
v_mfma_f32_16x16x32_bf16 v[172:175], a[248:251], a[176:179], v[172:175]
ds_read_b64_tr_b16 a[246:247], v7 offset:50688
v_cvt_pk_bf16_f32 v56, v236, v237
v_mfma_f32_16x16x32_bf16 v[172:175], a[252:255], a[180:183], v[172:175]
v_cvt_pk_bf16_f32 v57, v238, v239
s_waitcnt lgkmcnt(4)
v_mfma_f32_16x16x32_bf16 v[84:87], a[224:227], a[40:43], v[84:87]
ds_read_b64_tr_b16 a[248:249], v7 offset:51200
s_add_u32 s43, s37, 519552
v_mfma_f32_16x16x32_bf16 v[84:87], a[232:235], a[44:47], v[84:87]
buffer_load_dwordx4 v8, s[20:23], s43 offen offset:1024 lds
v_mul_f32 v220, v220, v4
v_mfma_f32_16x16x32_bf16 v[176:179], a[224:227], a[88:91], v[176:179]
ds_read_b64_tr_b16 a[250:251], v7 offset:51712
v_mul_f32 v221, v221, v4
v_mfma_f32_16x16x32_bf16 v[176:179], a[232:235], a[92:95], v[176:179]
v_mul_f32 v222, v222, v4
v_mul_f32 v223, v223, v4
v_mfma_f32_16x16x32_bf16 v[52:55], a[224:227], a[136:139], v[52:55]
ds_read_b64_tr_b16 a[252:253], v7 offset:52224
s_add_u32 s42, s37, 592256
v_mfma_f32_16x16x32_bf16 v[52:55], a[232:235], a[140:143], v[52:55]
buffer_load_dwordx4 v8, s[20:23], s42 offen offset:2048 lds
v_cvt_pk_bf16_f32 v58, v220, v221
v_mfma_f32_16x16x32_bf16 v[172:175], a[224:227], a[184:187], v[172:175]
ds_read_b64_tr_b16 a[254:255], v7 offset:52736
v_cvt_pk_bf16_f32 v59, v222, v223
v_mfma_f32_16x16x32_bf16 v[172:175], a[232:235], a[188:191], v[172:175]
v_mul_f32 v108, v108, v4
s_waitcnt lgkmcnt(4)
v_mfma_f32_16x16x32_bf16 v[76:79], a[236:239], a[0:3], 0
ds_read_b64_tr_b16 a[224:225], v7 offset:53248
v_mul_f32 v109, v109, v4
v_mfma_f32_16x16x32_bf16 v[76:79], a[244:247], a[4:7], v[76:79]
v_mul_f32 v110, v110, v4
s_add_u32 s43, s37, 664960
v_mfma_f32_16x16x32_bf16 v[152:155], a[236:239], a[48:51], 0
ds_read_b64_tr_b16 a[226:227], v7 offset:53760
buffer_load_dwordx4 v8, s[20:23], s43 offen offset:3072 lds
v_mfma_f32_16x16x32_bf16 v[152:155], a[244:247], a[52:55], v[152:155]
v_mul_f32 v111, v111, v4
v_cvt_pk_bf16_f32 v116, v108, v109
v_mfma_f32_16x16x32_bf16 v[192:195], a[236:239], a[96:99], 0
ds_read_b64_tr_b16 a[232:233], v7 offset:54272
v_cvt_pk_bf16_f32 v117, v110, v111
v_mfma_f32_16x16x32_bf16 v[192:195], a[244:247], a[100:103], v[192:195]
v_mul_f32 v216, v216, v4
s_add_u32 m0, s39, 59392
v_mfma_f32_16x16x32_bf16 v[96:99], a[236:239], a[144:147], 0
ds_read_b64_tr_b16 a[234:235], v7 offset:54784
s_add_u32 s42, s37, 741760
v_mfma_f32_16x16x32_bf16 v[96:99], a[244:247], a[148:151], v[96:99]
buffer_load_dwordx4 v8, s[20:23], s42 offen offset:0 lds
s_waitcnt lgkmcnt(4)
v_mfma_f32_16x16x32_bf16 v[76:79], a[248:251], a[8:11], v[76:79]
ds_read_b64_tr_b16 a[236:237], v7 offset:6144
v_mul_f32 v217, v217, v4
v_mfma_f32_16x16x32_bf16 v[76:79], a[252:255], a[12:15], v[76:79]
v_mul_f32 v218, v218, v4
v_mul_f32 v219, v219, v4
v_mfma_f32_16x16x32_bf16 v[152:155], a[248:251], a[56:59], v[152:155]
ds_read_b64_tr_b16 a[238:239], v7 offset:6656
v_cvt_pk_bf16_f32 v118, v216, v217
v_mfma_f32_16x16x32_bf16 v[152:155], a[252:255], a[60:63], v[152:155]
v_cvt_pk_bf16_f32 v119, v218, v219
s_add_u32 s43, s37, 814464
v_mfma_f32_16x16x32_bf16 v[192:195], a[248:251], a[104:107], v[192:195]
ds_read_b64_tr_b16 a[244:245], v7 offset:7168
buffer_load_dwordx4 v8, s[20:23], s43 offen offset:1024 lds
v_mfma_f32_16x16x32_bf16 v[192:195], a[252:255], a[108:111], v[192:195]
v_mul_f32 v204, v204, v5
v_mul_f32 v205, v205, v5
v_mfma_f32_16x16x32_bf16 v[96:99], a[248:251], a[152:155], v[96:99]
ds_read_b64_tr_b16 a[246:247], v7 offset:7680
v_mul_f32 v206, v206, v5
v_mfma_f32_16x16x32_bf16 v[96:99], a[252:255], a[156:159], v[96:99]
v_mul_f32 v207, v207, v5
s_waitcnt lgkmcnt(4)
v_mfma_f32_16x16x32_bf16 v[76:79], a[224:227], a[16:19], v[76:79]
ds_read_b64_tr_b16 a[248:249], v7 offset:8192
v_cvt_pk_bf16_f32 v244, v84, v85
v_mfma_f32_16x16x32_bf16 v[76:79], a[232:235], a[20:23], v[76:79]
v_cvt_pk_bf16_f32 v245, v86, v87
v_cvt_pk_bf16_f32 v196, v176, v177
v_mfma_f32_16x16x32_bf16 v[152:155], a[224:227], a[64:67], v[152:155]
ds_read_b64_tr_b16 a[250:251], v7 offset:8704
v_cvt_pk_bf16_f32 v197, v178, v179
v_mfma_f32_16x16x32_bf16 v[152:155], a[232:235], a[68:71], v[152:155]
v_cvt_pk_bf16_f32 v184, v52, v53
v_cvt_pk_bf16_f32 v185, v54, v55
v_mfma_f32_16x16x32_bf16 v[192:195], a[224:227], a[112:115], v[192:195]
ds_read_b64_tr_b16 a[252:253], v7 offset:9216
v_cvt_pk_bf16_f32 v128, v172, v173
v_mfma_f32_16x16x32_bf16 v[192:195], a[232:235], a[116:119], v[192:195]
v_cvt_pk_bf16_f32 v129, v174, v175
v_cvt_pk_bf16_f32 v208, v204, v205
v_mfma_f32_16x16x32_bf16 v[96:99], a[224:227], a[160:163], v[96:99]
ds_read_b64_tr_b16 a[254:255], v7 offset:9728
v_cvt_pk_bf16_f32 v209, v206, v207
v_mfma_f32_16x16x32_bf16 v[96:99], a[232:235], a[164:167], v[96:99]
s_waitcnt lgkmcnt(4)
v_mfma_f32_16x16x32_bf16 v[76:79], a[236:239], a[24:27], v[76:79]
ds_read_b64_tr_b16 a[224:225], v7 offset:10240
v_mfma_f32_16x16x32_bf16 v[76:79], a[244:247], a[28:31], v[76:79]
v_mul_f32 v168, v168, v5
v_mfma_f32_16x16x32_bf16 v[152:155], a[236:239], a[72:75], v[152:155]
ds_read_b64_tr_b16 a[226:227], v7 offset:10752
v_mul_f32 v169, v169, v5
v_mfma_f32_16x16x32_bf16 v[152:155], a[244:247], a[76:79], v[152:155]
v_mul_f32 v170, v170, v5
v_mul_f32 v171, v171, v5
v_mfma_f32_16x16x32_bf16 v[192:195], a[236:239], a[120:123], v[192:195]
ds_read_b64_tr_b16 a[232:233], v7 offset:11264
v_cvt_pk_bf16_f32 v210, v168, v169
v_mfma_f32_16x16x32_bf16 v[192:195], a[244:247], a[124:127], v[192:195]
v_cvt_pk_bf16_f32 v211, v170, v171
v_mfma_f32_16x16x32_bf16 v[96:99], a[236:239], a[168:171], v[96:99]
ds_read_b64_tr_b16 a[234:235], v7 offset:11776
v_mfma_f32_16x16x32_bf16 v[96:99], a[244:247], a[172:175], v[96:99]
s_waitcnt lgkmcnt(4)
v_mfma_f32_16x16x32_bf16 v[76:79], a[248:251], a[32:35], v[76:79]
ds_read_b64_tr_b16 a[236:237], v17 offset:49152
v_mfma_f32_16x16x32_bf16 v[76:79], a[252:255], a[36:39], v[76:79]
v_mul_f32 v112, v112, v5
v_mfma_f32_16x16x32_bf16 v[152:155], a[248:251], a[80:83], v[152:155]
ds_read_b64_tr_b16 a[238:239], v17 offset:49664
v_mul_f32 v113, v113, v5
v_mfma_f32_16x16x32_bf16 v[152:155], a[252:255], a[84:87], v[152:155]
v_mul_f32 v114, v114, v5
v_mul_f32 v115, v115, v5
v_mfma_f32_16x16x32_bf16 v[192:195], a[248:251], a[128:131], v[192:195]
ds_read_b64_tr_b16 a[244:245], v17 offset:50176
v_cvt_pk_bf16_f32 v32, v112, v113
v_mfma_f32_16x16x32_bf16 v[192:195], a[252:255], a[132:135], v[192:195]
v_cvt_pk_bf16_f32 v33, v114, v115
v_mfma_f32_16x16x32_bf16 v[96:99], a[248:251], a[176:179], v[96:99]
ds_read_b64_tr_b16 a[246:247], v17 offset:50688
v_mfma_f32_16x16x32_bf16 v[96:99], a[252:255], a[180:183], v[96:99]
s_waitcnt lgkmcnt(4)
v_mfma_f32_16x16x32_bf16 v[76:79], a[224:227], a[40:43], v[76:79]
ds_read_b64_tr_b16 a[248:249], v17 offset:51200
v_mul_f32 v40, v40, v5
v_mfma_f32_16x16x32_bf16 v[76:79], a[232:235], a[44:47], v[76:79]
v_mul_f32 v41, v41, v5
v_mfma_f32_16x16x32_bf16 v[152:155], a[224:227], a[88:91], v[152:155]
ds_read_b64_tr_b16 a[250:251], v17 offset:51712
v_mul_f32 v42, v42, v5
v_mfma_f32_16x16x32_bf16 v[152:155], a[232:235], a[92:95], v[152:155]
v_mul_f32 v43, v43, v5
v_cvt_pk_bf16_f32 v34, v40, v41
v_mfma_f32_16x16x32_bf16 v[192:195], a[224:227], a[136:139], v[192:195]
ds_read_b64_tr_b16 a[252:253], v17 offset:52224
v_cvt_pk_bf16_f32 v35, v42, v43
v_mfma_f32_16x16x32_bf16 v[192:195], a[232:235], a[140:143], v[192:195]
v_mul_f32 v232, v232, v16
v_mfma_f32_16x16x32_bf16 v[96:99], a[224:227], a[184:187], v[96:99]
ds_read_b64_tr_b16 a[254:255], v17 offset:52736
v_mfma_f32_16x16x32_bf16 v[96:99], a[232:235], a[188:191], v[96:99]
s_waitcnt lgkmcnt(4)
v_mfma_f32_16x16x32_bf16 v[180:183], a[236:239], a[0:3], 0
ds_read_b64_tr_b16 a[224:225], v17 offset:53248
v_mul_f32 v233, v233, v16
v_mfma_f32_16x16x32_bf16 v[180:183], a[244:247], a[4:7], v[180:183]
v_mul_f32 v234, v234, v16
v_mul_f32 v235, v235, v16
v_mfma_f32_16x16x32_bf16 v[164:167], a[236:239], a[48:51], 0
ds_read_b64_tr_b16 a[226:227], v17 offset:53760
v_cvt_pk_bf16_f32 v240, v232, v233
v_mfma_f32_16x16x32_bf16 v[164:167], a[244:247], a[52:55], v[164:167]
v_cvt_pk_bf16_f32 v241, v234, v235
v_mul_f32 v44, v44, v16
v_mfma_f32_16x16x32_bf16 v[60:63], a[236:239], a[96:99], 0
ds_read_b64_tr_b16 a[232:233], v17 offset:54272
v_mul_f32 v45, v45, v16
v_mfma_f32_16x16x32_bf16 v[60:63], a[244:247], a[100:103], v[60:63]
v_mul_f32 v46, v46, v16
v_mul_f32 v47, v47, v16
v_mfma_f32_16x16x32_bf16 v[88:91], a[236:239], a[144:147], 0
ds_read_b64_tr_b16 a[234:235], v17 offset:54784
v_cvt_pk_bf16_f32 v242, v44, v45
v_mfma_f32_16x16x32_bf16 v[88:91], a[244:247], a[148:151], v[88:91]
v_cvt_pk_bf16_f32 v243, v46, v47
s_waitcnt lgkmcnt(4)
v_mfma_f32_16x16x32_bf16 v[180:183], a[248:251], a[8:11], v[180:183]
ds_read_b64_tr_b16 a[236:237], v17 offset:6144
v_mul_f32 v252, v252, v16
v_mfma_f32_16x16x32_bf16 v[180:183], a[252:255], a[12:15], v[180:183]
v_mul_f32 v253, v253, v16
v_cvt_pk_bf16_f32 v246, v76, v77
v_mfma_f32_16x16x32_bf16 v[164:167], a[248:251], a[56:59], v[164:167]
ds_read_b64_tr_b16 a[238:239], v17 offset:6656
v_cvt_pk_bf16_f32 v247, v78, v79
v_mfma_f32_16x16x32_bf16 v[164:167], a[252:255], a[60:63], v[164:167]
v_mul_f32 v254, v254, v16
v_cvt_pk_bf16_f32 v198, v152, v153
v_mfma_f32_16x16x32_bf16 v[60:63], a[248:251], a[104:107], v[60:63]
ds_read_b64_tr_b16 a[244:245], v17 offset:7168
v_mul_f32 v255, v255, v16
v_mfma_f32_16x16x32_bf16 v[60:63], a[252:255], a[108:111], v[60:63]
v_cvt_pk_bf16_f32 v36, v252, v253
v_cvt_pk_bf16_f32 v199, v154, v155
v_mfma_f32_16x16x32_bf16 v[88:91], a[248:251], a[152:155], v[88:91]
ds_read_b64_tr_b16 a[246:247], v17 offset:7680
v_mfma_f32_16x16x32_bf16 v[88:91], a[252:255], a[156:159], v[88:91]
v_cvt_pk_bf16_f32 v186, v192, v193
s_waitcnt lgkmcnt(4)
v_mfma_f32_16x16x32_bf16 v[180:183], a[224:227], a[16:19], v[180:183]
ds_read_b64_tr_b16 a[248:249], v17 offset:8192
v_cvt_pk_bf16_f32 v187, v194, v195
v_mfma_f32_16x16x32_bf16 v[180:183], a[232:235], a[20:23], v[180:183]
v_cvt_pk_bf16_f32 v130, v96, v97
v_mfma_f32_16x16x32_bf16 v[164:167], a[224:227], a[64:67], v[164:167]
ds_read_b64_tr_b16 a[250:251], v17 offset:8704
v_mfma_f32_16x16x32_bf16 v[164:167], a[232:235], a[68:71], v[164:167]
v_cvt_pk_bf16_f32 v131, v98, v99
v_mfma_f32_16x16x32_bf16 v[60:63], a[224:227], a[112:115], v[60:63]
ds_read_b64_tr_b16 a[252:253], v17 offset:9216
v_cvt_pk_bf16_f32 v37, v254, v255
v_mfma_f32_16x16x32_bf16 v[60:63], a[232:235], a[116:119], v[60:63]
v_mul_f32 v104, v104, v16
v_mfma_f32_16x16x32_bf16 v[88:91], a[224:227], a[160:163], v[88:91]
ds_read_b64_tr_b16 a[254:255], v17 offset:9728
v_mfma_f32_16x16x32_bf16 v[88:91], a[232:235], a[164:167], v[88:91]
s_waitcnt lgkmcnt(4)
v_mfma_f32_16x16x32_bf16 v[180:183], a[236:239], a[24:27], v[180:183]
ds_read_b64_tr_b16 a[224:225], v17 offset:10240
v_mfma_f32_16x16x32_bf16 v[180:183], a[244:247], a[28:31], v[180:183]
v_mul_f32 v105, v105, v16
v_mfma_f32_16x16x32_bf16 v[164:167], a[236:239], a[72:75], v[164:167]
ds_read_b64_tr_b16 a[226:227], v17 offset:10752
v_mfma_f32_16x16x32_bf16 v[164:167], a[244:247], a[76:79], v[164:167]
v_mul_f32 v106, v106, v16
v_mfma_f32_16x16x32_bf16 v[60:63], a[236:239], a[120:123], v[60:63]
ds_read_b64_tr_b16 a[232:233], v17 offset:11264
v_mfma_f32_16x16x32_bf16 v[60:63], a[244:247], a[124:127], v[60:63]
v_mul_f32 v107, v107, v16
v_mfma_f32_16x16x32_bf16 v[88:91], a[236:239], a[168:171], v[88:91]
ds_read_b64_tr_b16 a[234:235], v17 offset:11776
v_mfma_f32_16x16x32_bf16 v[88:91], a[244:247], a[172:175], v[88:91]
s_waitcnt lgkmcnt(4)
v_mfma_f32_16x16x32_bf16 v[180:183], a[248:251], a[32:35], v[180:183]
ds_read_b64_tr_b16 a[236:237], v18 offset:49152
v_cvt_pk_bf16_f32 v38, v104, v105
v_mfma_f32_16x16x32_bf16 v[180:183], a[252:255], a[36:39], v[180:183]
v_cvt_pk_bf16_f32 v39, v106, v107
v_mfma_f32_16x16x32_bf16 v[164:167], a[248:251], a[80:83], v[164:167]
ds_read_b64_tr_b16 a[238:239], v18 offset:49664
v_mfma_f32_16x16x32_bf16 v[164:167], a[252:255], a[84:87], v[164:167]
v_mfma_f32_16x16x32_bf16 v[60:63], a[248:251], a[128:131], v[60:63]
ds_read_b64_tr_b16 a[244:245], v18 offset:50176
v_mfma_f32_16x16x32_bf16 v[60:63], a[252:255], a[132:135], v[60:63]
v_mfma_f32_16x16x32_bf16 v[88:91], a[248:251], a[176:179], v[88:91]
ds_read_b64_tr_b16 a[246:247], v18 offset:50688
v_mfma_f32_16x16x32_bf16 v[88:91], a[252:255], a[180:183], v[88:91]
s_waitcnt lgkmcnt(4)
v_mfma_f32_16x16x32_bf16 v[180:183], a[224:227], a[40:43], v[180:183]
ds_read_b64_tr_b16 a[248:249], v18 offset:51200
v_mfma_f32_16x16x32_bf16 v[180:183], a[232:235], a[44:47], v[180:183]
v_mfma_f32_16x16x32_bf16 v[164:167], a[224:227], a[88:91], v[164:167]
ds_read_b64_tr_b16 a[250:251], v18 offset:51712
v_mfma_f32_16x16x32_bf16 v[164:167], a[232:235], a[92:95], v[164:167]
v_mfma_f32_16x16x32_bf16 v[60:63], a[224:227], a[136:139], v[60:63]
ds_read_b64_tr_b16 a[252:253], v18 offset:52224
v_mfma_f32_16x16x32_bf16 v[60:63], a[232:235], a[140:143], v[60:63]
v_mfma_f32_16x16x32_bf16 v[88:91], a[224:227], a[184:187], v[88:91]
ds_read_b64_tr_b16 a[254:255], v18 offset:52736
v_mfma_f32_16x16x32_bf16 v[88:91], a[232:235], a[188:191], v[88:91]
v_mfma_f32_16x16x32_bf16 v[144:147], v[188:191], v[140:143], 0
v_cvt_pk_bf16_f32 v224, v180, v181
v_mfma_f32_16x16x32_bf16 v[144:147], v[132:135], v[160:163], v[144:147]
v_cvt_pk_bf16_f32 v225, v182, v183
v_mfma_f32_16x16x32_bf16 v[236:239], v[188:191], v[56:59], 0
v_cvt_pk_bf16_f32 v220, v164, v165
v_mfma_f32_16x16x32_bf16 v[236:239], v[132:135], v[116:119], v[236:239]
v_cvt_pk_bf16_f32 v221, v166, v167
v_mfma_f32_16x16x32_bf16 v[108:111], v[188:191], v[208:211], 0
v_cvt_pk_bf16_f32 v216, v60, v61
v_mfma_f32_16x16x32_bf16 v[108:111], v[132:135], v[32:35], v[108:111]
v_cvt_pk_bf16_f32 v217, v62, v63
v_mfma_f32_16x16x32_bf16 v[84:87], v[188:191], v[240:243], 0
v_cvt_pk_bf16_f32 v176, v88, v89
v_mfma_f32_16x16x32_bf16 v[84:87], v[132:135], v[36:39], v[84:87]
v_cvt_pk_bf16_f32 v177, v90, v91
v_mfma_f32_16x16x32_bf16 v[52:55], v[200:203], v[140:143], 0
v_cvt_pk_bf16_f32 v172, v144, v145
v_mfma_f32_16x16x32_bf16 v[52:55], v[48:51], v[160:163], v[52:55]
v_cvt_pk_bf16_f32 v173, v146, v147
v_mfma_f32_16x16x32_bf16 v[204:207], v[200:203], v[56:59], 0
v_cvt_pk_bf16_f32 v168, v236, v237
v_mfma_f32_16x16x32_bf16 v[204:207], v[48:51], v[116:119], v[204:207]
v_cvt_pk_bf16_f32 v169, v238, v239
v_mfma_f32_16x16x32_bf16 v[112:115], v[200:203], v[208:211], 0
v_cvt_pk_bf16_f32 v40, v108, v109
v_mfma_f32_16x16x32_bf16 v[112:115], v[48:51], v[32:35], v[112:115]
v_cvt_pk_bf16_f32 v41, v110, v111
v_mfma_f32_16x16x32_bf16 v[232:235], v[200:203], v[240:243], 0
v_cvt_pk_bf16_f32 v44, v84, v85
v_mfma_f32_16x16x32_bf16 v[232:235], v[48:51], v[36:39], v[232:235]
v_cvt_pk_bf16_f32 v45, v86, v87
v_mfma_f32_16x16x32_bf16 v[76:79], v[100:103], v[140:143], 0
v_cvt_pk_bf16_f32 v174, v52, v53
v_mfma_f32_16x16x32_bf16 v[76:79], v[80:83], v[160:163], v[76:79]
v_cvt_pk_bf16_f32 v175, v54, v55
v_mfma_f32_16x16x32_bf16 v[152:155], v[100:103], v[56:59], 0
v_cvt_pk_bf16_f32 v170, v204, v205
v_mfma_f32_16x16x32_bf16 v[152:155], v[80:83], v[116:119], v[152:155]
v_cvt_pk_bf16_f32 v171, v206, v207
v_mfma_f32_16x16x32_bf16 v[192:195], v[100:103], v[208:211], 0
v_cvt_pk_bf16_f32 v42, v112, v113
v_mfma_f32_16x16x32_bf16 v[192:195], v[80:83], v[32:35], v[192:195]
v_cvt_pk_bf16_f32 v43, v114, v115
v_mfma_f32_16x16x32_bf16 v[96:99], v[100:103], v[240:243], 0
v_cvt_pk_bf16_f32 v46, v232, v233
v_mfma_f32_16x16x32_bf16 v[96:99], v[80:83], v[36:39], v[96:99]
v_cvt_pk_bf16_f32 v47, v234, v235
v_mfma_f32_16x16x32_bf16 v[252:255], v[68:71], v[140:143], 0
v_cvt_pk_bf16_f32 v104, v76, v77
v_mfma_f32_16x16x32_bf16 v[252:255], v[136:139], v[160:163], v[252:255]
v_cvt_pk_bf16_f32 v105, v78, v79
v_mfma_f32_16x16x32_bf16 v[180:183], v[68:71], v[56:59], 0
v_cvt_pk_bf16_f32 v164, v152, v153
v_mfma_f32_16x16x32_bf16 v[180:183], v[136:139], v[116:119], v[180:183]
v_cvt_pk_bf16_f32 v165, v154, v155
v_mfma_f32_16x16x32_bf16 v[60:63], v[68:71], v[208:211], 0
v_cvt_pk_bf16_f32 v188, v192, v193
v_mfma_f32_16x16x32_bf16 v[60:63], v[136:139], v[32:35], v[60:63]
v_cvt_pk_bf16_f32 v189, v194, v195
v_mfma_f32_16x16x32_bf16 v[132:135], v[68:71], v[240:243], 0
v_cvt_pk_bf16_f32 v88, v96, v97
v_mfma_f32_16x16x32_bf16 v[132:135], v[136:139], v[36:39], v[132:135]
v_cvt_pk_bf16_f32 v89, v98, v99
v_mfma_f32_16x16x32_bf16 v[144:147], v[72:75], v[140:143], 0
v_cvt_pk_bf16_f32 v106, v252, v253
v_mfma_f32_16x16x32_bf16 v[144:147], v[64:67], v[160:163], v[144:147]
v_cvt_pk_bf16_f32 v107, v254, v255
v_mfma_f32_16x16x32_bf16 v[236:239], v[72:75], v[56:59], 0
v_cvt_pk_bf16_f32 v166, v180, v181
v_mfma_f32_16x16x32_bf16 v[236:239], v[64:67], v[116:119], v[236:239]
v_cvt_pk_bf16_f32 v167, v182, v183
v_mfma_f32_16x16x32_bf16 v[108:111], v[72:75], v[208:211], 0
v_cvt_pk_bf16_f32 v190, v60, v61
v_mfma_f32_16x16x32_bf16 v[108:111], v[64:67], v[32:35], v[108:111]
v_cvt_pk_bf16_f32 v191, v62, v63
v_mfma_f32_16x16x32_bf16 v[200:203], v[72:75], v[240:243], 0
v_cvt_pk_bf16_f32 v90, v132, v133
v_mfma_f32_16x16x32_bf16 v[200:203], v[64:67], v[36:39], v[200:203]
v_cvt_pk_bf16_f32 v91, v134, v135
v_mfma_f32_16x16x32_bf16 v[48:51], v[148:151], v[140:143], 0
v_cvt_pk_bf16_f32 v84, v144, v145
v_mfma_f32_16x16x32_bf16 v[48:51], v[248:251], v[160:163], v[48:51]
v_cvt_pk_bf16_f32 v85, v146, v147
v_mfma_f32_16x16x32_bf16 v[52:55], v[148:151], v[56:59], 0
v_cvt_pk_bf16_f32 v204, v236, v237
v_mfma_f32_16x16x32_bf16 v[52:55], v[248:251], v[116:119], v[52:55]
v_cvt_pk_bf16_f32 v205, v238, v239
v_mfma_f32_16x16x32_bf16 v[112:115], v[148:151], v[208:211], 0
v_cvt_pk_bf16_f32 v100, v108, v109
v_mfma_f32_16x16x32_bf16 v[112:115], v[248:251], v[32:35], v[112:115]
v_cvt_pk_bf16_f32 v101, v110, v111
v_mfma_f32_16x16x32_bf16 v[80:83], v[148:151], v[240:243], 0
v_cvt_pk_bf16_f32 v232, v200, v201
v_mfma_f32_16x16x32_bf16 v[80:83], v[248:251], v[36:39], v[80:83]
s_waitcnt lgkmcnt(4)
v_mfma_f32_16x16x32_bf16 v[76:79], a[236:239], a[0:3], 0
ds_read_b64_tr_b16 a[224:225], v18 offset:53248
v_mfma_f32_16x16x32_bf16 v[76:79], a[244:247], a[4:7], v[76:79]
v_cvt_pk_bf16_f32 v233, v202, v203
v_mfma_f32_16x16x32_bf16 v[152:155], a[236:239], a[48:51], 0
ds_read_b64_tr_b16 a[226:227], v18 offset:53760
v_mfma_f32_16x16x32_bf16 v[152:155], a[244:247], a[52:55], v[152:155]
v_cvt_pk_bf16_f32 v86, v48, v49
v_mfma_f32_16x16x32_bf16 v[192:195], a[236:239], a[96:99], 0
ds_read_b64_tr_b16 a[232:233], v18 offset:54272
v_cvt_pk_bf16_f32 v87, v50, v51
v_mfma_f32_16x16x32_bf16 v[192:195], a[244:247], a[100:103], v[192:195]
v_cvt_pk_bf16_f32 v206, v52, v53
v_mfma_f32_16x16x32_bf16 v[68:71], a[236:239], a[144:147], 0
ds_read_b64_tr_b16 a[234:235], v18 offset:54784
v_cvt_pk_bf16_f32 v207, v54, v55
v_mfma_f32_16x16x32_bf16 v[68:71], a[244:247], a[148:151], v[68:71]
s_waitcnt lgkmcnt(4)
v_mfma_f32_16x16x32_bf16 v[76:79], a[248:251], a[8:11], v[76:79]
ds_read_b64_tr_b16 a[236:237], v18 offset:6144
v_mfma_f32_16x16x32_bf16 v[76:79], a[252:255], a[12:15], v[76:79]
v_cvt_pk_bf16_f32 v102, v112, v113
v_mfma_f32_16x16x32_bf16 v[152:155], a[248:251], a[56:59], v[152:155]
ds_read_b64_tr_b16 a[238:239], v18 offset:6656
v_mfma_f32_16x16x32_bf16 v[152:155], a[252:255], a[60:63], v[152:155]
v_cvt_pk_bf16_f32 v103, v114, v115
v_mfma_f32_16x16x32_bf16 v[192:195], a[248:251], a[104:107], v[192:195]
ds_read_b64_tr_b16 a[244:245], v18 offset:7168
v_mfma_f32_16x16x32_bf16 v[192:195], a[252:255], a[108:111], v[192:195]
v_cvt_pk_bf16_f32 v234, v80, v81
v_mfma_f32_16x16x32_bf16 v[68:71], a[248:251], a[152:155], v[68:71]
ds_read_b64_tr_b16 a[246:247], v18 offset:7680
v_mfma_f32_16x16x32_bf16 v[68:71], a[252:255], a[156:159], v[68:71]
s_waitcnt lgkmcnt(4)
v_mfma_f32_16x16x32_bf16 v[76:79], a[224:227], a[16:19], v[76:79]
ds_read_b64_tr_b16 a[248:249], v18 offset:8192
v_mfma_f32_16x16x32_bf16 v[76:79], a[232:235], a[20:23], v[76:79]
v_cvt_pk_bf16_f32 v235, v82, v83
v_mfma_f32_16x16x32_bf16 v[152:155], a[224:227], a[64:67], v[152:155]
ds_read_b64_tr_b16 a[250:251], v18 offset:8704
v_mfma_f32_16x16x32_bf16 v[152:155], a[232:235], a[68:71], v[152:155]
v_mfma_f32_16x16x32_bf16 v[192:195], a[224:227], a[112:115], v[192:195]
ds_read_b64_tr_b16 a[252:253], v18 offset:9216
v_mfma_f32_16x16x32_bf16 v[192:195], a[232:235], a[116:119], v[192:195]
v_mfma_f32_16x16x32_bf16 v[68:71], a[224:227], a[160:163], v[68:71]
ds_read_b64_tr_b16 a[254:255], v18 offset:9728
v_mfma_f32_16x16x32_bf16 v[68:71], a[232:235], a[164:167], v[68:71]
s_waitcnt lgkmcnt(4)
v_mfma_f32_16x16x32_bf16 v[76:79], a[236:239], a[24:27], v[76:79]
ds_read_b64_tr_b16 a[224:225], v18 offset:10240
v_mfma_f32_16x16x32_bf16 v[76:79], a[244:247], a[28:31], v[76:79]
v_mfma_f32_16x16x32_bf16 v[152:155], a[236:239], a[72:75], v[152:155]
ds_read_b64_tr_b16 a[226:227], v18 offset:10752
v_mfma_f32_16x16x32_bf16 v[152:155], a[244:247], a[76:79], v[152:155]
v_mfma_f32_16x16x32_bf16 v[192:195], a[236:239], a[120:123], v[192:195]
ds_read_b64_tr_b16 a[232:233], v18 offset:11264
v_mfma_f32_16x16x32_bf16 v[192:195], a[244:247], a[124:127], v[192:195]
v_mfma_f32_16x16x32_bf16 v[68:71], a[236:239], a[168:171], v[68:71]
ds_read_b64_tr_b16 a[234:235], v18 offset:11776
v_mfma_f32_16x16x32_bf16 v[68:71], a[244:247], a[172:175], v[68:71]
s_waitcnt lgkmcnt(4)
v_mfma_f32_16x16x32_bf16 v[76:79], a[248:251], a[32:35], v[76:79]
v_mfma_f32_16x16x32_bf16 v[76:79], a[252:255], a[36:39], v[76:79]
v_mfma_f32_16x16x32_bf16 v[152:155], a[248:251], a[80:83], v[152:155]
v_mfma_f32_16x16x32_bf16 v[152:155], a[252:255], a[84:87], v[152:155]
s_waitcnt vmcnt(0) lgkmcnt(0)
s_barrier
v_mfma_f32_16x16x32_bf16 v[192:195], a[248:251], a[128:131], v[192:195]
ds_read_b64_tr_b16 a[236:237], v6 offset:0
v_mfma_f32_16x16x32_bf16 v[192:195], a[252:255], a[132:135], v[192:195]
ds_read_b64_tr_b16 a[238:239], v6 offset:512
v_mfma_f32_16x16x32_bf16 v[68:71], a[248:251], a[176:179], v[68:71]
s_mov_b32 s44, 704
v_mfma_f32_16x16x32_bf16 v[68:71], a[252:255], a[180:183], v[68:71]
ds_read_b64_tr_b16 a[244:245], v6 offset:1024
v_mfma_f32_16x16x32_bf16 v[76:79], a[224:227], a[40:43], v[76:79]
ds_read_b64_tr_b16 a[248:249], v6 offset:2048
v_mfma_f32_16x16x32_bf16 v[76:79], a[232:235], a[44:47], v[76:79]
ds_read_b64_tr_b16 a[246:247], v6 offset:1536
v_mfma_f32_16x16x32_bf16 v[152:155], a[224:227], a[88:91], v[152:155]
ds_read_b64_tr_b16 a[250:251], v6 offset:2560
v_mfma_f32_16x16x32_bf16 v[152:155], a[232:235], a[92:95], v[152:155]
v_mad_i32_i24 v8, v12, s44, v8
v_mfma_f32_16x16x32_bf16 v[192:195], a[224:227], a[136:139], v[192:195]
ds_read_b64_tr_b16 a[252:253], v6 offset:3072
v_mfma_f32_16x16x32_bf16 v[192:195], a[232:235], a[140:143], v[192:195]
s_add_u32 m0, s39, 49152
v_mfma_f32_16x16x32_bf16 v[68:71], a[224:227], a[184:187], v[68:71]
ds_read_b64_tr_b16 a[254:255], v6 offset:3584
v_mfma_f32_16x16x32_bf16 v[68:71], a[232:235], a[188:191], v[68:71]
s_waitcnt lgkmcnt(3)
v_mfma_f32_16x16x32_bf16 v[136:139], a[236:239], a[0:3], 0
ds_read_b64_tr_b16 a[224:225], v6 offset:4096
v_mfma_f32_16x16x32_bf16 v[136:139], a[244:247], a[4:7], v[136:139]
s_add_u32 s42, s37, 4416
buffer_load_dwordx4 v8, s[20:23], s42 offen offset:0 lds
v_mfma_f32_16x16x32_bf16 v[96:99], a[236:239], a[48:51], 0
ds_read_b64_tr_b16 a[226:227], v6 offset:4608
s_add_u32 s43, s37, 77120
v_mfma_f32_16x16x32_bf16 v[96:99], a[244:247], a[52:55], v[96:99]
buffer_load_dwordx4 v8, s[20:23], s43 offen offset:1024 lds
s_add_u32 s42, s37, 149824
v_mfma_f32_16x16x32_bf16 v[252:255], a[236:239], a[96:99], 0
ds_read_b64_tr_b16 a[232:233], v6 offset:5120
buffer_load_dwordx4 v8, s[20:23], s42 offen offset:2048 lds
v_mfma_f32_16x16x32_bf16 v[252:255], a[244:247], a[100:103], v[252:255]
v_cvt_pk_bf16_f32 v226, v76, v77
v_cvt_pk_bf16_f32 v227, v78, v79
v_mfma_f32_16x16x32_bf16 v[180:183], a[236:239], a[144:147], 0
ds_read_b64_tr_b16 a[234:235], v6 offset:5632
s_add_u32 s43, s37, 222528
v_mfma_f32_16x16x32_bf16 v[180:183], a[244:247], a[148:151], v[180:183]
buffer_load_dwordx4 v8, s[20:23], s43 offen offset:3072 lds
s_waitcnt lgkmcnt(4)
v_mfma_f32_16x16x32_bf16 v[136:139], a[248:251], a[8:11], v[136:139]
ds_read_b64_tr_b16 a[236:237], v6 offset:55296
v_cvt_pk_bf16_f32 v222, v152, v153
v_mfma_f32_16x16x32_bf16 v[136:139], a[252:255], a[12:15], v[136:139]
v_cvt_pk_bf16_f32 v223, v154, v155
v_mfma_f32_16x16x32_bf16 v[96:99], a[248:251], a[56:59], v[96:99]
ds_read_b64_tr_b16 a[238:239], v6 offset:55808
v_mfma_f32_16x16x32_bf16 v[96:99], a[252:255], a[60:63], v[96:99]
v_cvt_pk_bf16_f32 v218, v192, v193
v_mfma_f32_16x16x32_bf16 v[252:255], a[248:251], a[104:107], v[252:255]
ds_read_b64_tr_b16 a[244:245], v6 offset:56320
v_cvt_pk_bf16_f32 v219, v194, v195
v_mfma_f32_16x16x32_bf16 v[252:255], a[252:255], a[108:111], v[252:255]
v_cvt_pk_bf16_f32 v178, v68, v69
v_mfma_f32_16x16x32_bf16 v[180:183], a[248:251], a[152:155], v[180:183]
ds_read_b64_tr_b16 a[246:247], v6 offset:56832
v_mfma_f32_16x16x32_bf16 v[180:183], a[252:255], a[156:159], v[180:183]
s_waitcnt lgkmcnt(4)
v_mfma_f32_16x16x32_bf16 v[136:139], a[224:227], a[16:19], v[136:139]
ds_read_b64_tr_b16 a[248:249], v6 offset:57344
v_mfma_f32_16x16x32_bf16 v[136:139], a[232:235], a[20:23], v[136:139]
v_cvt_pk_bf16_f32 v179, v70, v71
v_mfma_f32_16x16x32_bf16 v[96:99], a[224:227], a[64:67], v[96:99]
ds_read_b64_tr_b16 a[250:251], v6 offset:57856
v_mfma_f32_16x16x32_bf16 v[96:99], a[232:235], a[68:71], v[96:99]
s_add_u32 m0, s39, 53248
v_mfma_f32_16x16x32_bf16 v[252:255], a[224:227], a[112:115], v[252:255]
ds_read_b64_tr_b16 a[252:253], v6 offset:58368
v_mfma_f32_16x16x32_bf16 v[252:255], a[232:235], a[116:119], v[252:255]
s_add_u32 s42, s37, 299328
v_mfma_f32_16x16x32_bf16 v[180:183], a[224:227], a[160:163], v[180:183]
ds_read_b64_tr_b16 a[254:255], v6 offset:58880
v_mfma_f32_16x16x32_bf16 v[180:183], a[232:235], a[164:167], v[180:183]
s_waitcnt lgkmcnt(4)
v_mfma_f32_16x16x32_bf16 v[136:139], a[236:239], a[24:27], v[136:139]
ds_read_b64_tr_b16 a[224:225], v6 offset:59392
v_mfma_f32_16x16x32_bf16 v[136:139], a[244:247], a[28:31], v[136:139]
buffer_load_dwordx4 v8, s[20:23], s42 offen offset:0 lds
v_mfma_f32_16x16x32_bf16 v[96:99], a[236:239], a[72:75], v[96:99]
ds_read_b64_tr_b16 a[226:227], v6 offset:59904
v_mfma_f32_16x16x32_bf16 v[96:99], a[244:247], a[76:79], v[96:99]
s_add_u32 s43, s37, 372032
v_mfma_f32_16x16x32_bf16 v[252:255], a[236:239], a[120:123], v[252:255]
ds_read_b64_tr_b16 a[232:233], v6 offset:60416
v_mfma_f32_16x16x32_bf16 v[252:255], a[244:247], a[124:127], v[252:255]
buffer_load_dwordx4 v8, s[20:23], s43 offen offset:1024 lds
v_mfma_f32_16x16x32_bf16 v[180:183], a[236:239], a[168:171], v[180:183]
ds_read_b64_tr_b16 a[234:235], v6 offset:60928
v_mfma_f32_16x16x32_bf16 v[180:183], a[244:247], a[172:175], v[180:183]
s_waitcnt lgkmcnt(4)
v_mfma_f32_16x16x32_bf16 v[136:139], a[248:251], a[32:35], v[136:139]
ds_read_b64_tr_b16 a[236:237], v7 offset:0
v_mfma_f32_16x16x32_bf16 v[136:139], a[252:255], a[36:39], v[136:139]
s_add_u32 m0, s39, 6144
v_mfma_f32_16x16x32_bf16 v[96:99], a[248:251], a[80:83], v[96:99]
ds_read_b64_tr_b16 a[238:239], v7 offset:512
v_mfma_f32_16x16x32_bf16 v[96:99], a[252:255], a[84:87], v[96:99]
s_add_u32 s42, s37, 446784
v_mfma_f32_16x16x32_bf16 v[252:255], a[248:251], a[128:131], v[252:255]
ds_read_b64_tr_b16 a[244:245], v7 offset:1024
v_mfma_f32_16x16x32_bf16 v[252:255], a[252:255], a[132:135], v[252:255]
buffer_load_dwordx4 v8, s[20:23], s42 offen offset:0 lds
v_mfma_f32_16x16x32_bf16 v[180:183], a[248:251], a[176:179], v[180:183]
ds_read_b64_tr_b16 a[246:247], v7 offset:1536
v_mfma_f32_16x16x32_bf16 v[180:183], a[252:255], a[180:183], v[180:183]
s_waitcnt lgkmcnt(4)
v_mfma_f32_16x16x32_bf16 v[136:139], a[224:227], a[40:43], v[136:139]
ds_read_b64_tr_b16 a[248:249], v7 offset:2048
v_mfma_f32_16x16x32_bf16 v[136:139], a[232:235], a[44:47], v[136:139]
s_add_u32 s43, s37, 519488
v_mfma_f32_16x16x32_bf16 v[96:99], a[224:227], a[88:91], v[96:99]
ds_read_b64_tr_b16 a[250:251], v7 offset:2560
v_mfma_f32_16x16x32_bf16 v[96:99], a[232:235], a[92:95], v[96:99]
buffer_load_dwordx4 v8, s[20:23], s43 offen offset:1024 lds
v_mfma_f32_16x16x32_bf16 v[252:255], a[224:227], a[136:139], v[252:255]
ds_read_b64_tr_b16 a[252:253], v7 offset:3072
v_mfma_f32_16x16x32_bf16 v[252:255], a[232:235], a[140:143], v[252:255]
s_add_u32 s42, s37, 592192
v_mfma_f32_16x16x32_bf16 v[180:183], a[224:227], a[184:187], v[180:183]
ds_read_b64_tr_b16 a[254:255], v7 offset:3584
v_mfma_f32_16x16x32_bf16 v[180:183], a[232:235], a[188:191], v[180:183]
s_waitcnt lgkmcnt(4)
v_mfma_f32_16x16x32_bf16 v[60:63], a[236:239], a[0:3], 0
ds_read_b64_tr_b16 a[224:225], v7 offset:4096
v_mfma_f32_16x16x32_bf16 v[60:63], a[244:247], a[4:7], v[60:63]
buffer_load_dwordx4 v8, s[20:23], s42 offen offset:2048 lds
v_mfma_f32_16x16x32_bf16 v[72:75], a[236:239], a[48:51], 0
ds_read_b64_tr_b16 a[226:227], v7 offset:4608
s_add_u32 s43, s37, 664896
v_mfma_f32_16x16x32_bf16 v[72:75], a[244:247], a[52:55], v[72:75]
buffer_load_dwordx4 v8, s[20:23], s43 offen offset:3072 lds
s_add_u32 m0, s39, 10240
v_mfma_f32_16x16x32_bf16 v[64:67], a[236:239], a[96:99], 0
ds_read_b64_tr_b16 a[232:233], v7 offset:5120
s_add_u32 s42, s37, 741696
v_mfma_f32_16x16x32_bf16 v[64:67], a[244:247], a[100:103], v[64:67]
buffer_load_dwordx4 v8, s[20:23], s42 offen offset:0 lds
v_cvt_pk_bf16_f32 v132, v136, v137
v_mfma_f32_16x16x32_bf16 v[140:143], a[236:239], a[144:147], 0
ds_read_b64_tr_b16 a[234:235], v7 offset:5632
s_add_u32 s43, s37, 814400
v_mfma_f32_16x16x32_bf16 v[140:143], a[244:247], a[148:151], v[140:143]
buffer_load_dwordx4 v8, s[20:23], s43 offen offset:1024 lds
s_waitcnt lgkmcnt(4)
v_mfma_f32_16x16x32_bf16 v[60:63], a[248:251], a[8:11], v[60:63]
ds_read_b64_tr_b16 a[236:237], v7 offset:55296
v_cvt_pk_bf16_f32 v133, v138, v139
v_mfma_f32_16x16x32_bf16 v[60:63], a[252:255], a[12:15], v[60:63]
v_cvt_pk_bf16_f32 v160, v96, v97
v_cvt_pk_bf16_f32 v161, v98, v99
v_mfma_f32_16x16x32_bf16 v[72:75], a[248:251], a[56:59], v[72:75]
ds_read_b64_tr_b16 a[238:239], v7 offset:55808
v_mfma_f32_16x16x32_bf16 v[72:75], a[252:255], a[60:63], v[72:75]
v_cvt_pk_bf16_f32 v144, v252, v253
v_mfma_f32_16x16x32_bf16 v[64:67], a[248:251], a[104:107], v[64:67]
ds_read_b64_tr_b16 a[244:245], v7 offset:56320
v_mfma_f32_16x16x32_bf16 v[64:67], a[252:255], a[108:111], v[64:67]
v_cvt_pk_bf16_f32 v145, v254, v255
v_mfma_f32_16x16x32_bf16 v[140:143], a[248:251], a[152:155], v[140:143]
ds_read_b64_tr_b16 a[246:247], v7 offset:56832
v_mfma_f32_16x16x32_bf16 v[140:143], a[252:255], a[156:159], v[140:143]
s_waitcnt lgkmcnt(4)
v_mfma_f32_16x16x32_bf16 v[60:63], a[224:227], a[16:19], v[60:63]
ds_read_b64_tr_b16 a[248:249], v7 offset:57344
v_mfma_f32_16x16x32_bf16 v[60:63], a[232:235], a[20:23], v[60:63]
v_cvt_pk_bf16_f32 v56, v180, v181
v_mfma_f32_16x16x32_bf16 v[72:75], a[224:227], a[64:67], v[72:75]
ds_read_b64_tr_b16 a[250:251], v7 offset:57856
v_mfma_f32_16x16x32_bf16 v[72:75], a[232:235], a[68:71], v[72:75]
v_cvt_pk_bf16_f32 v57, v182, v183
v_mfma_f32_16x16x32_bf16 v[64:67], a[224:227], a[112:115], v[64:67]
ds_read_b64_tr_b16 a[252:253], v7 offset:58368
v_mfma_f32_16x16x32_bf16 v[64:67], a[232:235], a[116:119], v[64:67]
v_mfma_f32_16x16x32_bf16 v[140:143], a[224:227], a[160:163], v[140:143]
ds_read_b64_tr_b16 a[254:255], v7 offset:58880
v_mfma_f32_16x16x32_bf16 v[140:143], a[232:235], a[164:167], v[140:143]
s_waitcnt lgkmcnt(4)
v_mfma_f32_16x16x32_bf16 v[60:63], a[236:239], a[24:27], v[60:63]
ds_read_b64_tr_b16 a[224:225], v7 offset:59392
v_mfma_f32_16x16x32_bf16 v[60:63], a[244:247], a[28:31], v[60:63]
v_mfma_f32_16x16x32_bf16 v[72:75], a[236:239], a[72:75], v[72:75]
ds_read_b64_tr_b16 a[226:227], v7 offset:59904
v_mfma_f32_16x16x32_bf16 v[72:75], a[244:247], a[76:79], v[72:75]
v_mfma_f32_16x16x32_bf16 v[64:67], a[236:239], a[120:123], v[64:67]
ds_read_b64_tr_b16 a[232:233], v7 offset:60416
v_mfma_f32_16x16x32_bf16 v[64:67], a[244:247], a[124:127], v[64:67]
ds_read_b128 v[116:119], v9 offset:8928
v_mfma_f32_16x16x32_bf16 v[140:143], a[236:239], a[168:171], v[140:143]
ds_read_b64_tr_b16 a[234:235], v7 offset:60928
v_mfma_f32_16x16x32_bf16 v[140:143], a[244:247], a[172:175], v[140:143]
s_waitcnt lgkmcnt(5)
v_mfma_f32_16x16x32_bf16 v[60:63], a[248:251], a[32:35], v[60:63]
ds_read_b64_tr_b16 a[236:237], v17 offset:0
v_mfma_f32_16x16x32_bf16 v[60:63], a[252:255], a[36:39], v[60:63]
ds_read_b128 v[236:239], v9 offset:9024
v_mfma_f32_16x16x32_bf16 v[72:75], a[248:251], a[80:83], v[72:75]
ds_read_b64_tr_b16 a[238:239], v17 offset:512
v_mfma_f32_16x16x32_bf16 v[72:75], a[252:255], a[84:87], v[72:75]
ds_read_b128 v[208:211], v9 offset:9120
v_mfma_f32_16x16x32_bf16 v[64:67], a[248:251], a[128:131], v[64:67]
ds_read_b64_tr_b16 a[244:245], v17 offset:1024
v_mfma_f32_16x16x32_bf16 v[64:67], a[252:255], a[132:135], v[64:67]
ds_read_b128 v[32:35], v9 offset:9216
v_mfma_f32_16x16x32_bf16 v[140:143], a[248:251], a[176:179], v[140:143]
ds_read_b64_tr_b16 a[246:247], v17 offset:1536
v_mfma_f32_16x16x32_bf16 v[140:143], a[252:255], a[180:183], v[140:143]
ds_read_b128 v[108:111], v9 offset:8832
s_waitcnt lgkmcnt(8)
v_mfma_f32_16x16x32_bf16 v[60:63], a[224:227], a[40:43], v[60:63]
ds_read_b64_tr_b16 a[248:249], v17 offset:2048
v_mfma_f32_16x16x32_bf16 v[60:63], a[232:235], a[44:47], v[60:63]
ds_read_b128 v[148:151], v9 offset:8928
v_mfma_f32_16x16x32_bf16 v[72:75], a[224:227], a[88:91], v[72:75]
ds_read_b64_tr_b16 a[250:251], v17 offset:2560
v_mfma_f32_16x16x32_bf16 v[72:75], a[232:235], a[92:95], v[72:75]
ds_read_b128 v[240:243], v9 offset:9024
v_mfma_f32_16x16x32_bf16 v[64:67], a[224:227], a[136:139], v[64:67]
ds_read_b64_tr_b16 a[252:253], v17 offset:3072
v_mfma_f32_16x16x32_bf16 v[64:67], a[232:235], a[140:143], v[64:67]
ds_read_b128 v[248:251], v9 offset:9120
v_mfma_f32_16x16x32_bf16 v[140:143], a[224:227], a[184:187], v[140:143]
ds_read_b64_tr_b16 a[254:255], v17 offset:3584
v_mfma_f32_16x16x32_bf16 v[140:143], a[232:235], a[188:191], v[140:143]
ds_read_b128 v[36:39], v9 offset:8736
s_waitcnt lgkmcnt(9)
v_mfma_f32_16x16x32_bf16 v[200:203], a[236:239], a[0:3], 0
ds_read_b64_tr_b16 a[224:225], v17 offset:4096
ds_read_b128 v[48:51], v9 offset:8832
v_mfma_f32_16x16x32_bf16 v[200:203], a[244:247], a[4:7], v[200:203]
ds_read_b128 v[52:55], v9 offset:8928
v_cvt_pk_bf16_f32 v134, v60, v61
v_mfma_f32_16x16x32_bf16 v[112:115], a[236:239], a[48:51], 0
ds_read_b64_tr_b16 a[226:227], v17 offset:4608
v_cvt_pk_bf16_f32 v135, v62, v63
v_mfma_f32_16x16x32_bf16 v[112:115], a[244:247], a[52:55], v[112:115]
ds_read_b128 v[80:83], v9 offset:9024
v_cvt_pk_bf16_f32 v162, v72, v73
v_mfma_f32_16x16x32_bf16 v[76:79], a[236:239], a[96:99], 0
ds_read_b64_tr_b16 a[232:233], v17 offset:5120
v_cvt_pk_bf16_f32 v163, v74, v75
v_mfma_f32_16x16x32_bf16 v[76:79], a[244:247], a[100:103], v[76:79]
ds_read_b128 v[152:155], v9 offset:8640
v_cvt_pk_bf16_f32 v146, v64, v65
v_mfma_f32_16x16x32_bf16 v[192:195], a[236:239], a[144:147], 0
ds_read_b64_tr_b16 a[234:235], v17 offset:5632
v_cvt_pk_bf16_f32 v147, v66, v67
v_mfma_f32_16x16x32_bf16 v[192:195], a[244:247], a[148:151], v[192:195]
ds_read_b128 v[68:71], v9 offset:8736
s_waitcnt lgkmcnt(10)
v_mfma_f32_16x16x32_bf16 v[200:203], a[248:251], a[8:11], v[200:203]
ds_read_b64_tr_b16 a[236:237], v17 offset:55296
v_cvt_pk_bf16_f32 v58, v140, v141
v_mfma_f32_16x16x32_bf16 v[200:203], a[252:255], a[12:15], v[200:203]
ds_read_b128 v[136:139], v9 offset:8832
v_mfma_f32_16x16x32_bf16 v[112:115], a[248:251], a[56:59], v[112:115]
ds_read_b64_tr_b16 a[238:239], v17 offset:55808
v_mfma_f32_16x16x32_bf16 v[112:115], a[252:255], a[60:63], v[112:115]
ds_read_b128 v[96:99], v9 offset:8928
v_mfma_f32_16x16x32_bf16 v[76:79], a[248:251], a[104:107], v[76:79]
ds_read_b64_tr_b16 a[244:245], v17 offset:56320
v_mfma_f32_16x16x32_bf16 v[76:79], a[252:255], a[108:111], v[76:79]
v_cvt_pk_bf16_f32 v59, v142, v143
v_mfma_f32_16x16x32_bf16 v[192:195], a[248:251], a[152:155], v[192:195]
ds_read_b64_tr_b16 a[246:247], v17 offset:56832
v_mfma_f32_16x16x32_bf16 v[192:195], a[252:255], a[156:159], v[192:195]
s_waitcnt lgkmcnt(7)
v_mfma_f32_16x16x32_bf16 v[200:203], a[224:227], a[16:19], v[200:203]
ds_read_b64_tr_b16 a[248:249], v17 offset:57344
v_mfma_f32_16x16x32_bf16 v[200:203], a[232:235], a[20:23], v[200:203]
v_lshrrev_b32 v22, 5, v1
v_mfma_f32_16x16x32_bf16 v[112:115], a[224:227], a[64:67], v[112:115]
ds_read_b64_tr_b16 a[250:251], v17 offset:57856
v_mfma_f32_16x16x32_bf16 v[112:115], a[232:235], a[68:71], v[112:115]
v_mul_u32_u24 v22, 12288, v22
v_mfma_f32_16x16x32_bf16 v[76:79], a[224:227], a[112:115], v[76:79]
ds_read_b64_tr_b16 a[252:253], v17 offset:58368
v_mfma_f32_16x16x32_bf16 v[76:79], a[232:235], a[116:119], v[76:79]
v_bfe_u32 v3, v1, 2, 3
v_mfma_f32_16x16x32_bf16 v[192:195], a[224:227], a[160:163], v[192:195]
ds_read_b64_tr_b16 a[254:255], v17 offset:58880
v_mfma_f32_16x16x32_bf16 v[192:195], a[232:235], a[164:167], v[192:195]
v_lshl_add_u32 v22, v3, 7, v22
v_mfma_f32_16x16x32_bf16 v[116:119], v[132:135], v[244:247], v[116:119]
v_and_b32 v3, 3, v1
v_mfma_f32_16x16x32_bf16 v[236:239], v[132:135], v[196:199], v[236:239]
v_lshl_add_u32 v22, v3, 4, v22
v_mfma_f32_16x16x32_bf16 v[208:211], v[132:135], v[184:187], v[208:211]
v_bfe_u32 v29, v1, 3, 1
v_mfma_f32_16x16x32_bf16 v[32:35], v[132:135], v[128:131], v[32:35]
v_lshl_add_u32 v28, v29, 6, v22
v_mfma_f32_16x16x32_bf16 v[108:111], v[160:163], v[244:247], v[108:111]
v_xor_b32 v24, 64, v28
v_mfma_f32_16x16x32_bf16 v[148:151], v[160:163], v[196:199], v[148:151]
v_add_u32 v26, 49152, v28
v_mfma_f32_16x16x32_bf16 v[240:243], v[160:163], v[184:187], v[240:243]
v_add_u32 v31, 49152, v24
v_mfma_f32_16x16x32_bf16 v[248:251], v[160:163], v[128:131], v[248:251]
v_mfma_f32_16x16x32_bf16 v[36:39], v[144:147], v[244:247], v[36:39]
v_mfma_f32_16x16x32_bf16 v[48:51], v[144:147], v[196:199], v[48:51]
v_mfma_f32_16x16x32_bf16 v[52:55], v[144:147], v[184:187], v[52:55]
v_mfma_f32_16x16x32_bf16 v[80:83], v[144:147], v[128:131], v[80:83]
v_mfma_f32_16x16x32_bf16 v[152:155], v[56:59], v[244:247], v[152:155]
s_waitcnt lgkmcnt(10)
v_mfma_f32_16x16x32_bf16 v[68:71], v[56:59], v[196:199], v[68:71]
s_waitcnt lgkmcnt(8)
v_mfma_f32_16x16x32_bf16 v[136:139], v[56:59], v[184:187], v[136:139]
s_waitcnt lgkmcnt(6)
v_mfma_f32_16x16x32_bf16 v[96:99], v[56:59], v[128:131], v[96:99]
s_waitcnt lgkmcnt(4)
v_mfma_f32_16x16x32_bf16 v[200:203], a[236:239], a[24:27], v[200:203]
ds_read_b64_tr_b16 a[224:225], v17 offset:59392
v_mfma_f32_16x16x32_bf16 v[200:203], a[244:247], a[28:31], v[200:203]
v_mfma_f32_16x16x32_bf16 v[112:115], a[236:239], a[72:75], v[112:115]
ds_read_b64_tr_b16 a[226:227], v17 offset:59904
v_mfma_f32_16x16x32_bf16 v[112:115], a[244:247], a[76:79], v[112:115]
v_mfma_f32_16x16x32_bf16 v[76:79], a[236:239], a[120:123], v[76:79]
ds_read_b64_tr_b16 a[232:233], v17 offset:60416
v_mfma_f32_16x16x32_bf16 v[76:79], a[244:247], a[124:127], v[76:79]
v_mfma_f32_16x16x32_bf16 v[192:195], a[236:239], a[168:171], v[192:195]
ds_read_b64_tr_b16 a[234:235], v17 offset:60928
v_mfma_f32_16x16x32_bf16 v[192:195], a[244:247], a[172:175], v[192:195]
s_waitcnt lgkmcnt(4)
v_mfma_f32_16x16x32_bf16 v[200:203], a[248:251], a[32:35], v[200:203]
ds_read_b64_tr_b16 a[236:237], v18 offset:0
v_mfma_f32_16x16x32_bf16 v[200:203], a[252:255], a[36:39], v[200:203]
v_mfma_f32_16x16x32_bf16 v[112:115], a[248:251], a[80:83], v[112:115]
ds_read_b64_tr_b16 a[238:239], v18 offset:512
v_mfma_f32_16x16x32_bf16 v[112:115], a[252:255], a[84:87], v[112:115]
v_mfma_f32_16x16x32_bf16 v[76:79], a[248:251], a[128:131], v[76:79]
ds_read_b64_tr_b16 a[244:245], v18 offset:1024
v_mfma_f32_16x16x32_bf16 v[76:79], a[252:255], a[132:135], v[76:79]
v_mfma_f32_16x16x32_bf16 v[192:195], a[248:251], a[176:179], v[192:195]
ds_read_b64_tr_b16 a[246:247], v18 offset:1536
v_mfma_f32_16x16x32_bf16 v[192:195], a[252:255], a[180:183], v[192:195]
s_waitcnt lgkmcnt(4)
v_mfma_f32_16x16x32_bf16 v[200:203], a[224:227], a[40:43], v[200:203]
ds_read_b64_tr_b16 a[248:249], v18 offset:2048
v_mfma_f32_16x16x32_bf16 v[200:203], a[232:235], a[44:47], v[200:203]
v_mfma_f32_16x16x32_bf16 v[112:115], a[224:227], a[88:91], v[112:115]
ds_read_b64_tr_b16 a[250:251], v18 offset:2560
v_mfma_f32_16x16x32_bf16 v[112:115], a[232:235], a[92:95], v[112:115]
v_mfma_f32_16x16x32_bf16 v[76:79], a[224:227], a[136:139], v[76:79]
ds_read_b64_tr_b16 a[252:253], v18 offset:3072
v_mfma_f32_16x16x32_bf16 v[76:79], a[232:235], a[140:143], v[76:79]
v_mfma_f32_16x16x32_bf16 v[192:195], a[224:227], a[184:187], v[192:195]
ds_read_b64_tr_b16 a[254:255], v18 offset:3584
v_mfma_f32_16x16x32_bf16 v[192:195], a[232:235], a[188:191], v[192:195]
s_waitcnt lgkmcnt(4)
v_mfma_f32_16x16x32_bf16 v[252:255], a[236:239], a[0:3], 0
ds_read_b64_tr_b16 a[224:225], v18 offset:4096
v_mfma_f32_16x16x32_bf16 v[252:255], a[244:247], a[4:7], v[252:255]
v_cvt_pk_bf16_f32 v180, v200, v201
v_mfma_f32_16x16x32_bf16 v[60:63], a[236:239], a[48:51], 0
ds_read_b64_tr_b16 a[226:227], v18 offset:4608
v_mfma_f32_16x16x32_bf16 v[60:63], a[244:247], a[52:55], v[60:63]
v_cvt_pk_bf16_f32 v181, v202, v203
v_mfma_f32_16x16x32_bf16 v[72:75], a[236:239], a[96:99], 0
ds_read_b64_tr_b16 a[232:233], v18 offset:5120
v_mfma_f32_16x16x32_bf16 v[72:75], a[244:247], a[100:103], v[72:75]
v_cvt_pk_bf16_f32 v64, v112, v113
v_mfma_f32_16x16x32_bf16 v[140:143], a[236:239], a[144:147], 0
ds_read_b64_tr_b16 a[234:235], v18 offset:5632
v_cvt_pk_bf16_f32 v65, v114, v115
v_mfma_f32_16x16x32_bf16 v[140:143], a[244:247], a[148:151], v[140:143]
s_waitcnt lgkmcnt(4)
v_mfma_f32_16x16x32_bf16 v[252:255], a[248:251], a[8:11], v[252:255]
ds_read_b64_tr_b16 a[236:237], v18 offset:55296
v_mfma_f32_16x16x32_bf16 v[252:255], a[252:255], a[12:15], v[252:255]
v_cvt_pk_bf16_f32 v132, v76, v77
v_mfma_f32_16x16x32_bf16 v[60:63], a[248:251], a[56:59], v[60:63]
ds_read_b64_tr_b16 a[238:239], v18 offset:55808
v_mfma_f32_16x16x32_bf16 v[60:63], a[252:255], a[60:63], v[60:63]
v_cvt_pk_bf16_f32 v133, v78, v79
v_mfma_f32_16x16x32_bf16 v[72:75], a[248:251], a[104:107], v[72:75]
ds_read_b64_tr_b16 a[244:245], v18 offset:56320
v_mfma_f32_16x16x32_bf16 v[72:75], a[252:255], a[108:111], v[72:75]
v_cvt_pk_bf16_f32 v160, v192, v193
v_mfma_f32_16x16x32_bf16 v[140:143], a[248:251], a[152:155], v[140:143]
ds_read_b64_tr_b16 a[246:247], v18 offset:56832
v_mfma_f32_16x16x32_bf16 v[140:143], a[252:255], a[156:159], v[140:143]
s_waitcnt lgkmcnt(4)
v_mfma_f32_16x16x32_bf16 v[252:255], a[224:227], a[16:19], v[252:255]
ds_read_b64_tr_b16 a[248:249], v18 offset:57344
v_mfma_f32_16x16x32_bf16 v[252:255], a[232:235], a[20:23], v[252:255]
v_cvt_pk_bf16_f32 v161, v194, v195
v_mfma_f32_16x16x32_bf16 v[60:63], a[224:227], a[64:67], v[60:63]
ds_read_b64_tr_b16 a[250:251], v18 offset:57856
v_mfma_f32_16x16x32_bf16 v[60:63], a[232:235], a[68:71], v[60:63]
v_mfma_f32_16x16x32_bf16 v[72:75], a[224:227], a[112:115], v[72:75]
ds_read_b64_tr_b16 a[252:253], v18 offset:58368
v_mfma_f32_16x16x32_bf16 v[72:75], a[232:235], a[116:119], v[72:75]
v_mfma_f32_16x16x32_bf16 v[140:143], a[224:227], a[160:163], v[140:143]
ds_read_b64_tr_b16 a[254:255], v18 offset:58880
v_mfma_f32_16x16x32_bf16 v[140:143], a[232:235], a[164:167], v[140:143]
s_waitcnt lgkmcnt(4)
v_mfma_f32_16x16x32_bf16 v[252:255], a[236:239], a[24:27], v[252:255]
ds_read_b64_tr_b16 a[224:225], v18 offset:59392
v_mfma_f32_16x16x32_bf16 v[252:255], a[244:247], a[28:31], v[252:255]
v_mfma_f32_16x16x32_bf16 v[60:63], a[236:239], a[72:75], v[60:63]
ds_read_b64_tr_b16 a[226:227], v18 offset:59904
v_mfma_f32_16x16x32_bf16 v[60:63], a[244:247], a[76:79], v[60:63]
v_mfma_f32_16x16x32_bf16 v[72:75], a[236:239], a[120:123], v[72:75]
ds_read_b64_tr_b16 a[232:233], v18 offset:60416
v_mfma_f32_16x16x32_bf16 v[72:75], a[244:247], a[124:127], v[72:75]
v_mfma_f32_16x16x32_bf16 v[140:143], a[236:239], a[168:171], v[140:143]
ds_read_b64_tr_b16 a[234:235], v18 offset:60928
v_mfma_f32_16x16x32_bf16 v[140:143], a[244:247], a[172:175], v[140:143]
s_waitcnt lgkmcnt(4)
v_mfma_f32_16x16x32_bf16 v[252:255], a[248:251], a[32:35], v[252:255]
v_mfma_f32_16x16x32_bf16 v[252:255], a[252:255], a[36:39], v[252:255]
v_mfma_f32_16x16x32_bf16 v[60:63], a[248:251], a[80:83], v[60:63]
v_mfma_f32_16x16x32_bf16 v[60:63], a[252:255], a[84:87], v[60:63]
s_waitcnt vmcnt(0) lgkmcnt(0)
s_barrier
v_mfma_f32_16x16x32_bf16 v[72:75], a[248:251], a[128:131], v[72:75]
ds_read_b64_tr_b16 a[236:237], v6 offset:49152
v_mfma_f32_16x16x32_bf16 v[72:75], a[252:255], a[132:135], v[72:75]
ds_read_b64_tr_b16 a[238:239], v6 offset:49664
v_mfma_f32_16x16x32_bf16 v[140:143], a[248:251], a[176:179], v[140:143]
s_mov_b32 s44, -704
v_mfma_f32_16x16x32_bf16 v[140:143], a[252:255], a[180:183], v[140:143]
ds_read_b64_tr_b16 a[244:245], v6 offset:50176
v_mfma_f32_16x16x32_bf16 v[252:255], a[224:227], a[40:43], v[252:255]
ds_read_b64_tr_b16 a[248:249], v6 offset:51200
v_mfma_f32_16x16x32_bf16 v[252:255], a[232:235], a[44:47], v[252:255]
ds_read_b64_tr_b16 a[246:247], v6 offset:50688
v_mfma_f32_16x16x32_bf16 v[60:63], a[224:227], a[88:91], v[60:63]
ds_read_b64_tr_b16 a[250:251], v6 offset:51712
v_mfma_f32_16x16x32_bf16 v[60:63], a[232:235], a[92:95], v[60:63]
v_mad_i32_i24 v8, v12, s44, v8
v_mfma_f32_16x16x32_bf16 v[72:75], a[224:227], a[136:139], v[72:75]
ds_read_b64_tr_b16 a[252:253], v6 offset:52224
v_mfma_f32_16x16x32_bf16 v[72:75], a[232:235], a[140:143], v[72:75]
s_add_u32 m0, s39, 0
v_mfma_f32_16x16x32_bf16 v[140:143], a[224:227], a[184:187], v[140:143]
ds_read_b64_tr_b16 a[254:255], v6 offset:52736
v_mfma_f32_16x16x32_bf16 v[140:143], a[232:235], a[188:191], v[140:143]
s_waitcnt lgkmcnt(3)
v_mfma_f32_16x16x32_bf16 v[144:147], a[236:239], a[0:3], 0
ds_read_b64_tr_b16 a[224:225], v6 offset:53248
v_mfma_f32_16x16x32_bf16 v[144:147], a[244:247], a[4:7], v[144:147]
s_add_u32 s42, s37, 5248
buffer_load_dwordx4 v8, s[20:23], s42 offen offset:0 lds
v_mfma_f32_16x16x32_bf16 v[244:247], a[236:239], a[48:51], 0
ds_read_b64_tr_b16 a[226:227], v6 offset:53760
s_add_u32 s43, s37, 77952
v_mfma_f32_16x16x32_bf16 v[244:247], a[244:247], a[52:55], v[244:247]
buffer_load_dwordx4 v8, s[20:23], s43 offen offset:1024 lds
s_add_u32 s42, s37, 150656
v_mfma_f32_16x16x32_bf16 v[196:199], a[236:239], a[96:99], 0
ds_read_b64_tr_b16 a[232:233], v6 offset:54272
buffer_load_dwordx4 v8, s[20:23], s42 offen offset:2048 lds
v_mfma_f32_16x16x32_bf16 v[196:199], a[244:247], a[100:103], v[196:199]
v_cvt_pk_bf16_f32 v182, v252, v253
v_cvt_pk_bf16_f32 v183, v254, v255
v_mfma_f32_16x16x32_bf16 v[184:187], a[236:239], a[144:147], 0
ds_read_b64_tr_b16 a[234:235], v6 offset:54784
s_add_u32 s43, s37, 223360
v_mfma_f32_16x16x32_bf16 v[184:187], a[244:247], a[148:151], v[184:187]
buffer_load_dwordx4 v8, s[20:23], s43 offen offset:3072 lds
s_waitcnt lgkmcnt(4)
v_mfma_f32_16x16x32_bf16 v[144:147], a[248:251], a[8:11], v[144:147]
ds_read_b64_tr_b16 a[236:237], v6 offset:6144
v_cvt_pk_bf16_f32 v66, v60, v61
v_mfma_f32_16x16x32_bf16 v[144:147], a[252:255], a[12:15], v[144:147]
v_cvt_pk_bf16_f32 v67, v62, v63
v_mfma_f32_16x16x32_bf16 v[244:247], a[248:251], a[56:59], v[244:247]
ds_read_b64_tr_b16 a[238:239], v6 offset:6656
v_mfma_f32_16x16x32_bf16 v[244:247], a[252:255], a[60:63], v[244:247]
v_cvt_pk_bf16_f32 v134, v72, v73
v_mfma_f32_16x16x32_bf16 v[196:199], a[248:251], a[104:107], v[196:199]
ds_read_b64_tr_b16 a[244:245], v6 offset:7168
v_cvt_pk_bf16_f32 v135, v74, v75
v_mfma_f32_16x16x32_bf16 v[196:199], a[252:255], a[108:111], v[196:199]
v_cvt_pk_bf16_f32 v162, v140, v141
v_mfma_f32_16x16x32_bf16 v[184:187], a[248:251], a[152:155], v[184:187]
ds_read_b64_tr_b16 a[246:247], v6 offset:7680
v_mfma_f32_16x16x32_bf16 v[184:187], a[252:255], a[156:159], v[184:187]
s_waitcnt lgkmcnt(4)
v_mfma_f32_16x16x32_bf16 v[144:147], a[224:227], a[16:19], v[144:147]
ds_read_b64_tr_b16 a[248:249], v6 offset:8192
v_mfma_f32_16x16x32_bf16 v[144:147], a[232:235], a[20:23], v[144:147]
v_cvt_pk_bf16_f32 v163, v142, v143
v_mfma_f32_16x16x32_bf16 v[244:247], a[224:227], a[64:67], v[244:247]
ds_read_b64_tr_b16 a[250:251], v6 offset:8704
v_mfma_f32_16x16x32_bf16 v[244:247], a[232:235], a[68:71], v[244:247]
s_add_u32 m0, s39, 4096
v_mfma_f32_16x16x32_bf16 v[196:199], a[224:227], a[112:115], v[196:199]
ds_read_b64_tr_b16 a[252:253], v6 offset:9216
v_mfma_f32_16x16x32_bf16 v[196:199], a[232:235], a[116:119], v[196:199]
s_add_u32 s42, s37, 300160
v_mfma_f32_16x16x32_bf16 v[184:187], a[224:227], a[160:163], v[184:187]
ds_read_b64_tr_b16 a[254:255], v6 offset:9728
v_mfma_f32_16x16x32_bf16 v[184:187], a[232:235], a[164:167], v[184:187]
buffer_load_dwordx4 v8, s[20:23], s42 offen offset:0 lds
v_mfma_f32_16x16x32_bf16 v[116:119], v[180:183], v[224:227], v[116:119]
s_add_u32 s43, s37, 372864
v_mfma_f32_16x16x32_bf16 v[236:239], v[180:183], v[220:223], v[236:239]
buffer_load_dwordx4 v8, s[20:23], s43 offen offset:1024 lds
v_mfma_f32_16x16x32_bf16 v[208:211], v[180:183], v[216:219], v[208:211]
s_add_u32 m0, s39, 55296
v_mfma_f32_16x16x32_bf16 v[32:35], v[180:183], v[176:179], v[32:35]
s_add_u32 s42, s37, 447616
v_mfma_f32_16x16x32_bf16 v[108:111], v[64:67], v[224:227], v[108:111]
buffer_load_dwordx4 v8, s[20:23], s42 offen offset:0 lds
v_mfma_f32_16x16x32_bf16 v[148:151], v[64:67], v[220:223], v[148:151]
v_mfma_f32_16x16x32_bf16 v[240:243], v[64:67], v[216:219], v[240:243]
s_add_u32 s43, s37, 520320
v_mfma_f32_16x16x32_bf16 v[248:251], v[64:67], v[176:179], v[248:251]
buffer_load_dwordx4 v8, s[20:23], s43 offen offset:1024 lds
v_mfma_f32_16x16x32_bf16 v[36:39], v[132:135], v[224:227], v[36:39]
v_mfma_f32_16x16x32_bf16 v[48:51], v[132:135], v[220:223], v[48:51]
v_mfma_f32_16x16x32_bf16 v[52:55], v[132:135], v[216:219], v[52:55]
v_mfma_f32_16x16x32_bf16 v[80:83], v[132:135], v[176:179], v[80:83]
v_mfma_f32_16x16x32_bf16 v[152:155], v[160:163], v[224:227], v[152:155]
s_add_u32 s42, s37, 593024
v_mfma_f32_16x16x32_bf16 v[68:71], v[160:163], v[220:223], v[68:71]
buffer_load_dwordx4 v8, s[20:23], s42 offen offset:2048 lds
v_mfma_f32_16x16x32_bf16 v[136:139], v[160:163], v[216:219], v[136:139]
v_mfma_f32_16x16x32_bf16 v[96:99], v[160:163], v[176:179], v[96:99]
s_waitcnt lgkmcnt(4)
v_mfma_f32_16x16x32_bf16 v[144:147], a[236:239], a[24:27], v[144:147]
ds_read_b64_tr_b16 a[224:225], v6 offset:10240
v_mfma_f32_16x16x32_bf16 v[144:147], a[244:247], a[28:31], v[144:147]
v_mfma_f32_16x16x32_bf16 v[244:247], a[236:239], a[72:75], v[244:247]
ds_read_b64_tr_b16 a[226:227], v6 offset:10752
v_mfma_f32_16x16x32_bf16 v[244:247], a[244:247], a[76:79], v[244:247]
s_add_u32 s43, s37, 665728
v_mfma_f32_16x16x32_bf16 v[196:199], a[236:239], a[120:123], v[196:199]
ds_read_b64_tr_b16 a[232:233], v6 offset:11264
v_mfma_f32_16x16x32_bf16 v[196:199], a[244:247], a[124:127], v[196:199]
buffer_load_dwordx4 v8, s[20:23], s43 offen offset:3072 lds
v_mfma_f32_16x16x32_bf16 v[184:187], a[236:239], a[168:171], v[184:187]
ds_read_b64_tr_b16 a[234:235], v6 offset:11776
v_mfma_f32_16x16x32_bf16 v[184:187], a[244:247], a[172:175], v[184:187]
s_waitcnt lgkmcnt(4)
v_mfma_f32_16x16x32_bf16 v[144:147], a[248:251], a[32:35], v[144:147]
ds_read_b64_tr_b16 a[236:237], v7 offset:49152
v_mfma_f32_16x16x32_bf16 v[144:147], a[252:255], a[36:39], v[144:147]
s_add_u32 m0, s39, 59392
v_mfma_f32_16x16x32_bf16 v[244:247], a[248:251], a[80:83], v[244:247]
ds_read_b64_tr_b16 a[238:239], v7 offset:49664
v_mfma_f32_16x16x32_bf16 v[244:247], a[252:255], a[84:87], v[244:247]
s_add_u32 s42, s37, 742528
v_mfma_f32_16x16x32_bf16 v[196:199], a[248:251], a[128:131], v[196:199]
ds_read_b64_tr_b16 a[244:245], v7 offset:50176
v_mfma_f32_16x16x32_bf16 v[196:199], a[252:255], a[132:135], v[196:199]
buffer_load_dwordx4 v8, s[20:23], s42 offen offset:0 lds
v_mfma_f32_16x16x32_bf16 v[184:187], a[248:251], a[176:179], v[184:187]
ds_read_b64_tr_b16 a[246:247], v7 offset:50688
v_mfma_f32_16x16x32_bf16 v[184:187], a[252:255], a[180:183], v[184:187]
s_waitcnt lgkmcnt(4)
v_mfma_f32_16x16x32_bf16 v[144:147], a[224:227], a[40:43], v[144:147]
ds_read_b64_tr_b16 a[248:249], v7 offset:51200
v_mfma_f32_16x16x32_bf16 v[144:147], a[232:235], a[44:47], v[144:147]
s_add_u32 s43, s37, 815232
v_mfma_f32_16x16x32_bf16 v[244:247], a[224:227], a[88:91], v[244:247]
ds_read_b64_tr_b16 a[250:251], v7 offset:51712
v_mfma_f32_16x16x32_bf16 v[244:247], a[232:235], a[92:95], v[244:247]
buffer_load_dwordx4 v8, s[20:23], s43 offen offset:1024 lds
v_mfma_f32_16x16x32_bf16 v[196:199], a[224:227], a[136:139], v[196:199]
ds_read_b64_tr_b16 a[252:253], v7 offset:52224
v_mfma_f32_16x16x32_bf16 v[196:199], a[232:235], a[140:143], v[196:199]
v_mfma_f32_16x16x32_bf16 v[184:187], a[224:227], a[184:187], v[184:187]
ds_read_b64_tr_b16 a[254:255], v7 offset:52736
v_mfma_f32_16x16x32_bf16 v[184:187], a[232:235], a[188:191], v[184:187]
s_waitcnt lgkmcnt(4)
v_mfma_f32_16x16x32_bf16 v[128:131], a[236:239], a[0:3], 0
ds_read_b64_tr_b16 a[224:225], v7 offset:53248
v_mfma_f32_16x16x32_bf16 v[128:131], a[244:247], a[4:7], v[128:131]
v_cvt_pk_bf16_f32 v56, v144, v145
v_mfma_f32_16x16x32_bf16 v[200:203], a[236:239], a[48:51], 0
ds_read_b64_tr_b16 a[226:227], v7 offset:53760
v_mfma_f32_16x16x32_bf16 v[200:203], a[244:247], a[52:55], v[200:203]
v_cvt_pk_bf16_f32 v57, v146, v147
v_mfma_f32_16x16x32_bf16 v[112:115], a[236:239], a[96:99], 0
ds_read_b64_tr_b16 a[232:233], v7 offset:54272
v_mfma_f32_16x16x32_bf16 v[112:115], a[244:247], a[100:103], v[112:115]
v_cvt_pk_bf16_f32 v76, v244, v245
v_mfma_f32_16x16x32_bf16 v[192:195], a[236:239], a[144:147], 0
ds_read_b64_tr_b16 a[234:235], v7 offset:54784
v_cvt_pk_bf16_f32 v77, v246, v247
v_mfma_f32_16x16x32_bf16 v[192:195], a[244:247], a[148:151], v[192:195]
s_waitcnt lgkmcnt(4)
v_mfma_f32_16x16x32_bf16 v[128:131], a[248:251], a[8:11], v[128:131]
ds_read_b64_tr_b16 a[236:237], v7 offset:6144
v_mfma_f32_16x16x32_bf16 v[128:131], a[252:255], a[12:15], v[128:131]
v_cvt_pk_bf16_f32 v252, v196, v197
v_mfma_f32_16x16x32_bf16 v[200:203], a[248:251], a[56:59], v[200:203]
ds_read_b64_tr_b16 a[238:239], v7 offset:6656
v_mfma_f32_16x16x32_bf16 v[200:203], a[252:255], a[60:63], v[200:203]
v_cvt_pk_bf16_f32 v253, v198, v199
v_mfma_f32_16x16x32_bf16 v[112:115], a[248:251], a[104:107], v[112:115]
ds_read_b64_tr_b16 a[244:245], v7 offset:7168
v_mfma_f32_16x16x32_bf16 v[112:115], a[252:255], a[108:111], v[112:115]
v_cvt_pk_bf16_f32 v60, v184, v185
v_mfma_f32_16x16x32_bf16 v[192:195], a[248:251], a[152:155], v[192:195]
ds_read_b64_tr_b16 a[246:247], v7 offset:7680
v_mfma_f32_16x16x32_bf16 v[192:195], a[252:255], a[156:159], v[192:195]
s_waitcnt lgkmcnt(4)
v_mfma_f32_16x16x32_bf16 v[128:131], a[224:227], a[16:19], v[128:131]
ds_read_b64_tr_b16 a[248:249], v7 offset:8192
v_mfma_f32_16x16x32_bf16 v[128:131], a[232:235], a[20:23], v[128:131]
v_cvt_pk_bf16_f32 v61, v186, v187
v_mfma_f32_16x16x32_bf16 v[200:203], a[224:227], a[64:67], v[200:203]
ds_read_b64_tr_b16 a[250:251], v7 offset:8704
v_mfma_f32_16x16x32_bf16 v[200:203], a[232:235], a[68:71], v[200:203]
v_mfma_f32_16x16x32_bf16 v[112:115], a[224:227], a[112:115], v[112:115]
ds_read_b64_tr_b16 a[252:253], v7 offset:9216
v_mfma_f32_16x16x32_bf16 v[112:115], a[232:235], a[116:119], v[112:115]
v_mfma_f32_16x16x32_bf16 v[192:195], a[224:227], a[160:163], v[192:195]
ds_read_b64_tr_b16 a[254:255], v7 offset:9728
v_mfma_f32_16x16x32_bf16 v[192:195], a[232:235], a[164:167], v[192:195]
s_waitcnt lgkmcnt(4)
v_mfma_f32_16x16x32_bf16 v[128:131], a[236:239], a[24:27], v[128:131]
ds_read_b64_tr_b16 a[224:225], v7 offset:10240
v_mfma_f32_16x16x32_bf16 v[128:131], a[244:247], a[28:31], v[128:131]
v_mfma_f32_16x16x32_bf16 v[200:203], a[236:239], a[72:75], v[200:203]
ds_read_b64_tr_b16 a[226:227], v7 offset:10752
v_mfma_f32_16x16x32_bf16 v[200:203], a[244:247], a[76:79], v[200:203]
v_mfma_f32_16x16x32_bf16 v[112:115], a[236:239], a[120:123], v[112:115]
ds_read_b64_tr_b16 a[232:233], v7 offset:11264
v_mfma_f32_16x16x32_bf16 v[112:115], a[244:247], a[124:127], v[112:115]
v_mfma_f32_16x16x32_bf16 v[192:195], a[236:239], a[168:171], v[192:195]
ds_read_b64_tr_b16 a[234:235], v7 offset:11776
v_mfma_f32_16x16x32_bf16 v[192:195], a[244:247], a[172:175], v[192:195]
s_waitcnt lgkmcnt(4)
v_mfma_f32_16x16x32_bf16 v[128:131], a[248:251], a[32:35], v[128:131]
ds_read_b64_tr_b16 a[236:237], v17 offset:49152
v_mfma_f32_16x16x32_bf16 v[128:131], a[252:255], a[36:39], v[128:131]
v_mfma_f32_16x16x32_bf16 v[200:203], a[248:251], a[80:83], v[200:203]
ds_read_b64_tr_b16 a[238:239], v17 offset:49664
v_mfma_f32_16x16x32_bf16 v[200:203], a[252:255], a[84:87], v[200:203]
v_mfma_f32_16x16x32_bf16 v[112:115], a[248:251], a[128:131], v[112:115]
ds_read_b64_tr_b16 a[244:245], v17 offset:50176
v_mfma_f32_16x16x32_bf16 v[112:115], a[252:255], a[132:135], v[112:115]
v_mfma_f32_16x16x32_bf16 v[192:195], a[248:251], a[176:179], v[192:195]
ds_read_b64_tr_b16 a[246:247], v17 offset:50688
v_mfma_f32_16x16x32_bf16 v[192:195], a[252:255], a[180:183], v[192:195]
s_waitcnt lgkmcnt(4)
v_mfma_f32_16x16x32_bf16 v[128:131], a[224:227], a[40:43], v[128:131]
ds_read_b64_tr_b16 a[248:249], v17 offset:51200
v_mfma_f32_16x16x32_bf16 v[128:131], a[232:235], a[44:47], v[128:131]
v_mfma_f32_16x16x32_bf16 v[200:203], a[224:227], a[88:91], v[200:203]
ds_read_b64_tr_b16 a[250:251], v17 offset:51712
v_mfma_f32_16x16x32_bf16 v[200:203], a[232:235], a[92:95], v[200:203]
v_mfma_f32_16x16x32_bf16 v[112:115], a[224:227], a[136:139], v[112:115]
ds_read_b64_tr_b16 a[252:253], v17 offset:52224
v_mfma_f32_16x16x32_bf16 v[112:115], a[232:235], a[140:143], v[112:115]
v_mfma_f32_16x16x32_bf16 v[192:195], a[224:227], a[184:187], v[192:195]
ds_read_b64_tr_b16 a[254:255], v17 offset:52736
v_mfma_f32_16x16x32_bf16 v[192:195], a[232:235], a[188:191], v[192:195]
s_waitcnt lgkmcnt(4)
v_mfma_f32_16x16x32_bf16 v[72:75], a[0:3], a[236:239], 0
ds_read_b64_tr_b16 a[224:225], v17 offset:53248
v_mfma_f32_16x16x32_bf16 v[72:75], a[4:7], a[244:247], v[72:75]
v_cvt_pk_bf16_f32 v58, v128, v129
v_mfma_f32_16x16x32_bf16 v[140:143], a[48:51], a[236:239], 0
ds_read_b64_tr_b16 a[226:227], v17 offset:53760
v_mfma_f32_16x16x32_bf16 v[140:143], a[52:55], a[244:247], v[140:143]
v_cvt_pk_bf16_f32 v59, v130, v131
v_mfma_f32_16x16x32_bf16 v[180:183], a[96:99], a[236:239], 0
ds_read_b64_tr_b16 a[232:233], v17 offset:54272
v_mfma_f32_16x16x32_bf16 v[180:183], a[100:103], a[244:247], v[180:183]
v_cvt_pk_bf16_f32 v78, v200, v201
v_mfma_f32_16x16x32_bf16 v[64:67], a[144:147], a[236:239], 0
ds_read_b64_tr_b16 a[234:235], v17 offset:54784
v_cvt_pk_bf16_f32 v79, v202, v203
v_mfma_f32_16x16x32_bf16 v[64:67], a[148:151], a[244:247], v[64:67]
s_waitcnt lgkmcnt(4)
v_mfma_f32_16x16x32_bf16 v[72:75], a[8:11], a[248:251], v[72:75]
ds_read_b64_tr_b16 a[236:237], v17 offset:6144
v_mfma_f32_16x16x32_bf16 v[72:75], a[12:15], a[252:255], v[72:75]
v_cvt_pk_bf16_f32 v254, v112, v113
v_mfma_f32_16x16x32_bf16 v[140:143], a[56:59], a[248:251], v[140:143]
ds_read_b64_tr_b16 a[238:239], v17 offset:6656
v_mfma_f32_16x16x32_bf16 v[140:143], a[60:63], a[252:255], v[140:143]
v_cvt_pk_bf16_f32 v255, v114, v115
v_mfma_f32_16x16x32_bf16 v[180:183], a[104:107], a[248:251], v[180:183]
ds_read_b64_tr_b16 a[244:245], v17 offset:7168
v_mfma_f32_16x16x32_bf16 v[180:183], a[108:111], a[252:255], v[180:183]
v_cvt_pk_bf16_f32 v62, v192, v193
v_mfma_f32_16x16x32_bf16 v[64:67], a[152:155], a[248:251], v[64:67]
ds_read_b64_tr_b16 a[246:247], v17 offset:7680
v_mfma_f32_16x16x32_bf16 v[64:67], a[156:159], a[252:255], v[64:67]
s_waitcnt lgkmcnt(4)
v_mfma_f32_16x16x32_bf16 v[72:75], a[16:19], a[224:227], v[72:75]
ds_read_b64_tr_b16 a[248:249], v17 offset:8192
v_mfma_f32_16x16x32_bf16 v[72:75], a[20:23], a[232:235], v[72:75]
v_cvt_pk_bf16_f32 v63, v194, v195
v_mfma_f32_16x16x32_bf16 v[140:143], a[64:67], a[224:227], v[140:143]
ds_read_b64_tr_b16 a[250:251], v17 offset:8704
v_mfma_f32_16x16x32_bf16 v[140:143], a[68:71], a[232:235], v[140:143]
v_mfma_f32_16x16x32_bf16 v[180:183], a[112:115], a[224:227], v[180:183]
ds_read_b64_tr_b16 a[252:253], v17 offset:9216
v_mfma_f32_16x16x32_bf16 v[180:183], a[116:119], a[232:235], v[180:183]
v_mfma_f32_16x16x32_bf16 v[64:67], a[160:163], a[224:227], v[64:67]
ds_read_b64_tr_b16 a[254:255], v17 offset:9728
v_mfma_f32_16x16x32_bf16 v[64:67], a[164:167], a[232:235], v[64:67]
v_mfma_f32_16x16x32_bf16 v[116:119], v[56:59], v[124:127], v[116:119]
v_mfma_f32_16x16x32_bf16 v[236:239], v[56:59], v[228:231], v[236:239]
v_mfma_f32_16x16x32_bf16 v[208:211], v[56:59], v[212:215], v[208:211]
v_mfma_f32_16x16x32_bf16 v[32:35], v[56:59], v[156:159], v[32:35]
v_mfma_f32_16x16x32_bf16 v[108:111], v[76:79], v[124:127], v[108:111]
v_mfma_f32_16x16x32_bf16 v[148:151], v[76:79], v[228:231], v[148:151]
v_mfma_f32_16x16x32_bf16 v[240:243], v[76:79], v[212:215], v[240:243]
v_mfma_f32_16x16x32_bf16 v[248:251], v[76:79], v[156:159], v[248:251]
v_mfma_f32_16x16x32_bf16 v[36:39], v[252:255], v[124:127], v[36:39]
v_mfma_f32_16x16x32_bf16 v[48:51], v[252:255], v[228:231], v[48:51]
v_mfma_f32_16x16x32_bf16 v[52:55], v[252:255], v[212:215], v[52:55]
v_mfma_f32_16x16x32_bf16 v[80:83], v[252:255], v[156:159], v[80:83]
v_mfma_f32_16x16x32_bf16 v[152:155], v[60:63], v[124:127], v[152:155]
v_mfma_f32_16x16x32_bf16 v[68:71], v[60:63], v[228:231], v[68:71]
v_mfma_f32_16x16x32_bf16 v[136:139], v[60:63], v[212:215], v[136:139]
v_mfma_f32_16x16x32_bf16 v[96:99], v[60:63], v[156:159], v[96:99]
s_waitcnt lgkmcnt(4)
v_mfma_f32_16x16x32_bf16 v[72:75], a[24:27], a[236:239], v[72:75]
ds_read_b64_tr_b16 a[224:225], v17 offset:10240
v_mfma_f32_16x16x32_bf16 v[72:75], a[28:31], a[244:247], v[72:75]
v_mfma_f32_16x16x32_bf16 v[140:143], a[72:75], a[236:239], v[140:143]
ds_read_b64_tr_b16 a[226:227], v17 offset:10752
v_mfma_f32_16x16x32_bf16 v[140:143], a[76:79], a[244:247], v[140:143]
v_mfma_f32_16x16x32_bf16 v[180:183], a[120:123], a[236:239], v[180:183]
ds_read_b64_tr_b16 a[232:233], v17 offset:11264
v_mfma_f32_16x16x32_bf16 v[180:183], a[124:127], a[244:247], v[180:183]
v_mfma_f32_16x16x32_bf16 v[64:67], a[168:171], a[236:239], v[64:67]
ds_read_b64_tr_b16 a[234:235], v17 offset:11776
v_mfma_f32_16x16x32_bf16 v[64:67], a[172:175], a[244:247], v[64:67]
s_waitcnt lgkmcnt(4)
v_mfma_f32_16x16x32_bf16 v[72:75], a[32:35], a[248:251], v[72:75]
ds_read_b64_tr_b16 a[236:237], v18 offset:49152
v_mfma_f32_16x16x32_bf16 v[72:75], a[36:39], a[252:255], v[72:75]
v_max3_f32 v25, v116, v117, v118
v_mfma_f32_16x16x32_bf16 v[140:143], a[80:83], a[248:251], v[140:143]
ds_read_b64_tr_b16 a[238:239], v18 offset:49664
v_mfma_f32_16x16x32_bf16 v[140:143], a[84:87], a[252:255], v[140:143]
v_max3_f32 v25, v25, v119, v108
v_mfma_f32_16x16x32_bf16 v[180:183], a[128:131], a[248:251], v[180:183]
ds_read_b64_tr_b16 a[244:245], v18 offset:50176
v_mfma_f32_16x16x32_bf16 v[180:183], a[132:135], a[252:255], v[180:183]
v_max3_f32 v25, v25, v109, v110
v_mfma_f32_16x16x32_bf16 v[64:67], a[176:179], a[248:251], v[64:67]
ds_read_b64_tr_b16 a[246:247], v18 offset:50688
v_mfma_f32_16x16x32_bf16 v[64:67], a[180:183], a[252:255], v[64:67]
s_waitcnt lgkmcnt(4)
v_mfma_f32_16x16x32_bf16 v[72:75], a[40:43], a[224:227], v[72:75]
ds_read_b64_tr_b16 a[248:249], v18 offset:51200
v_mfma_f32_16x16x32_bf16 v[72:75], a[44:47], a[232:235], v[72:75]
v_max_f32 v25, v25, v111
v_mfma_f32_16x16x32_bf16 v[140:143], a[88:91], a[224:227], v[140:143]
ds_read_b64_tr_b16 a[250:251], v18 offset:51712
v_mfma_f32_16x16x32_bf16 v[140:143], a[92:95], a[232:235], v[140:143]
v_add_f32 v25, v25, v11
v_mfma_f32_16x16x32_bf16 v[180:183], a[136:139], a[224:227], v[180:183]
ds_read_b64_tr_b16 a[252:253], v18 offset:52224
v_mfma_f32_16x16x32_bf16 v[180:183], a[140:143], a[232:235], v[180:183]
v_max3_f32 v2, v36, v37, v38
v_mfma_f32_16x16x32_bf16 v[64:67], a[184:187], a[224:227], v[64:67]
ds_read_b64_tr_b16 a[254:255], v18 offset:52736
v_mfma_f32_16x16x32_bf16 v[64:67], a[188:191], a[232:235], v[64:67]
s_waitcnt lgkmcnt(4)
v_mfma_f32_16x16x32_bf16 v[132:135], a[0:3], a[236:239], 0
ds_read_b64_tr_b16 a[224:225], v18 offset:53248
v_max3_f32 v2, v2, v39, v152
v_mfma_f32_16x16x32_bf16 v[132:135], a[4:7], a[244:247], v[132:135]
v_max3_f32 v2, v2, v153, v154
v_max_f32 v2, v2, v155
v_mfma_f32_16x16x32_bf16 v[224:227], a[48:51], a[236:239], 0
ds_read_b64_tr_b16 a[226:227], v18 offset:53760
v_add_f32 v2, v2, v23
v_mfma_f32_16x16x32_bf16 v[224:227], a[52:55], a[244:247], v[224:227]
v_max_f32 v25, v25, v2
v_max3_f32 v19, v236, v237, v238
v_mfma_f32_16x16x32_bf16 v[220:223], a[96:99], a[236:239], 0
ds_read_b64_tr_b16 a[232:233], v18 offset:54272
v_max3_f32 v19, v19, v239, v148
v_mfma_f32_16x16x32_bf16 v[220:223], a[100:103], a[244:247], v[220:223]
v_max3_f32 v19, v19, v149, v150
v_max_f32 v19, v19, v151
v_mfma_f32_16x16x32_bf16 v[216:219], a[144:147], a[236:239], 0
ds_read_b64_tr_b16 a[234:235], v18 offset:54784
v_add_f32 v19, v19, v11
v_mfma_f32_16x16x32_bf16 v[216:219], a[148:151], a[244:247], v[216:219]
v_max3_f32 v15, v48, v49, v50
s_waitcnt lgkmcnt(4)
v_mfma_f32_16x16x32_bf16 v[132:135], a[8:11], a[248:251], v[132:135]
ds_read_b64_tr_b16 a[236:237], v18 offset:6144
v_max3_f32 v15, v15, v51, v68
v_mfma_f32_16x16x32_bf16 v[132:135], a[12:15], a[252:255], v[132:135]
v_max3_f32 v15, v15, v69, v70
v_max_f32 v15, v15, v71
v_mfma_f32_16x16x32_bf16 v[224:227], a[56:59], a[248:251], v[224:227]
ds_read_b64_tr_b16 a[238:239], v18 offset:6656
v_add_f32 v15, v15, v23
v_mfma_f32_16x16x32_bf16 v[224:227], a[60:63], a[252:255], v[224:227]
v_max_f32 v19, v19, v15
v_max3_f32 v27, v52, v53, v54
v_mfma_f32_16x16x32_bf16 v[220:223], a[104:107], a[248:251], v[220:223]
ds_read_b64_tr_b16 a[244:245], v18 offset:7168
v_max3_f32 v27, v27, v55, v136
v_mfma_f32_16x16x32_bf16 v[220:223], a[108:111], a[252:255], v[220:223]
v_max3_f32 v27, v27, v137, v138
v_max_f32 v27, v27, v139
v_mfma_f32_16x16x32_bf16 v[216:219], a[152:155], a[248:251], v[216:219]
ds_read_b64_tr_b16 a[246:247], v18 offset:7680
v_add_f32 v27, v27, v11
v_mfma_f32_16x16x32_bf16 v[216:219], a[156:159], a[252:255], v[216:219]
v_max3_f32 v30, v208, v209, v210
s_waitcnt lgkmcnt(4)
v_mfma_f32_16x16x32_bf16 v[132:135], a[16:19], a[224:227], v[132:135]
ds_read_b64_tr_b16 a[248:249], v18 offset:8192
v_max3_f32 v30, v30, v211, v240
v_mfma_f32_16x16x32_bf16 v[132:135], a[20:23], a[232:235], v[132:135]
v_max3_f32 v30, v30, v241, v242
v_cvt_pk_bf16_f32 v176, v72, v73
v_mfma_f32_16x16x32_bf16 v[224:227], a[64:67], a[224:227], v[224:227]
ds_read_b64_tr_b16 a[250:251], v18 offset:8704
v_cvt_pk_bf16_f32 v177, v74, v75
v_mfma_f32_16x16x32_bf16 v[224:227], a[68:71], a[232:235], v[224:227]
v_cvt_pk_bf16_f32 v178, v140, v141
v_cvt_pk_bf16_f32 v179, v142, v143
v_mfma_f32_16x16x32_bf16 v[220:223], a[112:115], a[224:227], v[220:223]
ds_read_b64_tr_b16 a[252:253], v18 offset:9216
v_cvt_pk_bf16_f32 v160, v180, v181
v_mfma_f32_16x16x32_bf16 v[220:223], a[116:119], a[232:235], v[220:223]
v_cvt_pk_bf16_f32 v161, v182, v183
v_mfma_f32_16x16x32_bf16 v[216:219], a[160:163], a[224:227], v[216:219]
ds_read_b64_tr_b16 a[254:255], v18 offset:9728
v_cvt_pk_bf16_f32 v162, v64, v65
v_mfma_f32_16x16x32_bf16 v[216:219], a[164:167], a[232:235], v[216:219]
s_waitcnt lgkmcnt(4)
v_mfma_f32_16x16x32_bf16 v[132:135], a[24:27], a[236:239], v[132:135]
ds_read_b64_tr_b16 a[224:225], v18 offset:10240
v_cvt_pk_bf16_f32 v163, v66, v67
v_mfma_f32_16x16x32_bf16 v[132:135], a[28:31], a[244:247], v[132:135]
v_max_f32 v30, v30, v243
v_mfma_f32_16x16x32_bf16 v[224:227], a[72:75], a[236:239], v[224:227]
ds_read_b64_tr_b16 a[226:227], v18 offset:10752
v_add_f32 v30, v30, v23
v_mfma_f32_16x16x32_bf16 v[224:227], a[76:79], a[244:247], v[224:227]
v_max_f32 v27, v27, v30
v_mfma_f32_16x16x32_bf16 v[220:223], a[120:123], a[236:239], v[220:223]
ds_read_b64_tr_b16 a[232:233], v18 offset:11264
v_max3_f32 v20, v80, v81, v82
v_mfma_f32_16x16x32_bf16 v[220:223], a[124:127], a[244:247], v[220:223]
v_max3_f32 v20, v20, v83, v96
v_mfma_f32_16x16x32_bf16 v[216:219], a[168:171], a[236:239], v[216:219]
ds_read_b64_tr_b16 a[234:235], v18 offset:11776
v_max3_f32 v20, v20, v97, v98
v_mfma_f32_16x16x32_bf16 v[216:219], a[172:175], a[244:247], v[216:219]
v_max_f32 v20, v20, v99
s_waitcnt lgkmcnt(4)
v_mfma_f32_16x16x32_bf16 v[132:135], a[32:35], a[248:251], v[132:135]
v_add_f32 v20, v20, v11
v_mfma_f32_16x16x32_bf16 v[132:135], a[36:39], a[252:255], v[132:135]
v_max3_f32 v21, v32, v33, v34
v_mfma_f32_16x16x32_bf16 v[224:227], a[80:83], a[248:251], v[224:227]
v_max3_f32 v21, v21, v35, v248
v_mfma_f32_16x16x32_bf16 v[224:227], a[84:87], a[252:255], v[224:227]
s_waitcnt vmcnt(0) lgkmcnt(0)
s_barrier
v_mfma_f32_16x16x32_bf16 v[220:223], a[128:131], a[248:251], v[220:223]
ds_read_b64_tr_b16 a[236:237], v6 offset:0
v_max3_f32 v21, v21, v249, v250
v_mfma_f32_16x16x32_bf16 v[220:223], a[132:135], a[252:255], v[220:223]
ds_read_b64_tr_b16 a[238:239], v6 offset:512
v_max_f32 v21, v21, v251
v_mfma_f32_16x16x32_bf16 v[216:219], a[176:179], a[248:251], v[216:219]
v_add_f32 v21, v21, v23
v_max_f32 v20, v20, v21
v_mfma_f32_16x16x32_bf16 v[216:219], a[180:183], a[252:255], v[216:219]
ds_read_b64_tr_b16 a[244:245], v6 offset:1024
v_mfma_f32_16x16x32_bf16 v[132:135], a[40:43], a[224:227], v[132:135]
ds_read_b64_tr_b16 a[248:249], v6 offset:2048
v_permlane32_swap_b32 v25, v19
v_mfma_f32_16x16x32_bf16 v[132:135], a[44:47], a[232:235], v[132:135]
ds_read_b64_tr_b16 a[246:247], v6 offset:1536
v_max_f32 v4, v25, v19
v_mfma_f32_16x16x32_bf16 v[224:227], a[88:91], a[224:227], v[224:227]
ds_read_b64_tr_b16 a[250:251], v6 offset:2560
v_permlane32_swap_b32 v27, v20
v_mfma_f32_16x16x32_bf16 v[224:227], a[92:95], a[232:235], v[224:227]
v_max_f32 v5, v27, v20
v_lshrrev_b32 v16, 3, v1
v_mfma_f32_16x16x32_bf16 v[220:223], a[136:139], a[224:227], v[220:223]
ds_read_b64_tr_b16 a[252:253], v6 offset:3072
v_mul_u32_u24 v16, 768, v16
v_mfma_f32_16x16x32_bf16 v[220:223], a[140:143], a[232:235], v[220:223]
v_permlane16_swap_b32 v4, v5
v_max_f32 v9, v4, v5
v_mfma_f32_16x16x32_bf16 v[216:219], a[184:187], a[224:227], v[216:219]
ds_read_b64_tr_b16 a[254:255], v6 offset:3584
v_mov_b32 v3, v9
v_mfma_f32_16x16x32_bf16 v[216:219], a[188:191], a[232:235], v[216:219]
v_bfe_u32 v22, v1, 4, 1
s_waitcnt lgkmcnt(3)
v_mfma_f32_16x16x32_bf16 v[144:147], a[0:3], a[236:239], 0
ds_read_b64_tr_b16 a[224:225], v6 offset:4096
v_permlane16_swap_b32 v9, v3
v_mfma_f32_16x16x32_bf16 v[144:147], a[4:7], a[244:247], v[144:147]
v_mov_b32 v29, v9
v_mov_b32 v12, v3
v_mfma_f32_16x16x32_bf16 v[244:247], a[48:51], a[236:239], 0
ds_read_b64_tr_b16 a[226:227], v6 offset:4608
v_lshlrev_b32 v22, 2, v22
v_mfma_f32_16x16x32_bf16 v[244:247], a[52:55], a[244:247], v[244:247]
v_permlane32_swap_b32 v9, v29
v_permlane32_swap_b32 v3, v12
v_mfma_f32_16x16x32_bf16 v[196:199], a[96:99], a[236:239], 0
ds_read_b64_tr_b16 a[232:233], v6 offset:5120
v_and_b32 v2, 7, v1
v_mfma_f32_16x16x32_bf16 v[196:199], a[100:103], a[244:247], v[196:199]
v_xor_b32 v2, v2, v22
v_lshl_add_u32 v8, v2, 4, v16
v_mfma_f32_16x16x32_bf16 v[184:187], a[144:147], a[236:239], 0
ds_read_b64_tr_b16 a[234:235], v6 offset:5632
s_add_u32 m0, s39, 49152
v_mfma_f32_16x16x32_bf16 v[184:187], a[148:151], a[244:247], v[184:187]
s_add_u32 s42, s38, 3072
s_waitcnt lgkmcnt(4)
v_mfma_f32_16x16x32_bf16 v[144:147], a[8:11], a[248:251], v[144:147]
ds_read_b64_tr_b16 a[236:237], v6 offset:55296
buffer_load_dwordx4 v8, s[24:27], s42 offen offset:0 lds
v_mfma_f32_16x16x32_bf16 v[144:147], a[12:15], a[252:255], v[144:147]
v_fma_f32 v15, -v9, s40, v13
v_fma_f32 v30, -v9, s40, v14
v_mfma_f32_16x16x32_bf16 v[244:247], a[56:59], a[248:251], v[244:247]
ds_read_b64_tr_b16 a[238:239], v6 offset:55808
v_fma_f32 v11, -v29, s40, v13
v_mfma_f32_16x16x32_bf16 v[244:247], a[60:63], a[252:255], v[244:247]
v_fma_f32 v23, -v29, s40, v14
v_fma_f32 v21, -v3, s40, v13
v_mfma_f32_16x16x32_bf16 v[196:199], a[104:107], a[248:251], v[196:199]
ds_read_b64_tr_b16 a[244:245], v6 offset:56320
s_add_u32 s43, s38, 26624
v_mfma_f32_16x16x32_bf16 v[196:199], a[108:111], a[252:255], v[196:199]
buffer_load_dwordx4 v8, s[24:27], s43 offen offset:1024 lds
v_fma_f32 v25, -v3, s40, v14
v_mfma_f32_16x16x32_bf16 v[184:187], a[152:155], a[248:251], v[184:187]
ds_read_b64_tr_b16 a[246:247], v6 offset:56832
v_fma_f32 v19, -v12, s40, v13
v_mfma_f32_16x16x32_bf16 v[184:187], a[156:159], a[252:255], v[184:187]
v_fma_f32 v27, -v12, s40, v14
s_waitcnt lgkmcnt(4)
v_mfma_f32_16x16x32_bf16 v[144:147], a[16:19], a[224:227], v[144:147]
ds_read_b64_tr_b16 a[248:249], v6 offset:57344
v_fma_f32 v116, v116, s40, v15
v_mfma_f32_16x16x32_bf16 v[144:147], a[20:23], a[232:235], v[144:147]
v_exp_f32 v116, v116
v_mfma_f32_16x16x32_bf16 v[244:247], a[64:67], a[224:227], v[244:247]
ds_read_b64_tr_b16 a[250:251], v6 offset:57856
v_fma_f32 v117, v117, s40, v15
v_mfma_f32_16x16x32_bf16 v[244:247], a[68:71], a[232:235], v[244:247]
s_add_u32 s42, s38, 50176
buffer_load_dwordx4 v8, s[24:27], s42 offen offset:2048 lds
v_mfma_f32_16x16x32_bf16 v[196:199], a[112:115], a[224:227], v[196:199]
ds_read_b64_tr_b16 a[252:253], v6 offset:58368
v_fma_f32 v118, v118, s40, v15
v_mfma_f32_16x16x32_bf16 v[196:199], a[116:119], a[232:235], v[196:199]
v_exp_f32 v117, v117
v_mfma_f32_16x16x32_bf16 v[184:187], a[160:163], a[224:227], v[184:187]
ds_read_b64_tr_b16 a[254:255], v6 offset:58880
v_fma_f32 v119, v119, s40, v15
v_mfma_f32_16x16x32_bf16 v[184:187], a[164:167], a[232:235], v[184:187]
v_add_f32 v20, v116, v117
s_waitcnt lgkmcnt(4)
v_mfma_f32_16x16x32_bf16 v[144:147], a[24:27], a[236:239], v[144:147]
ds_read_b64_tr_b16 a[224:225], v6 offset:59392
s_add_u32 s43, s38, 73728
v_mfma_f32_16x16x32_bf16 v[144:147], a[28:31], a[244:247], v[144:147]
v_exp_f32 v118, v118
v_mfma_f32_16x16x32_bf16 v[244:247], a[72:75], a[236:239], v[244:247]
ds_read_b64_tr_b16 a[226:227], v6 offset:59904
buffer_load_dwordx4 v8, s[24:27], s43 offen offset:3072 lds
v_mfma_f32_16x16x32_bf16 v[244:247], a[76:79], a[244:247], v[244:247]
v_exp_f32 v119, v119
v_mfma_f32_16x16x32_bf16 v[196:199], a[120:123], a[236:239], v[196:199]
ds_read_b64_tr_b16 a[232:233], v6 offset:60416
v_add_f32 v4, v118, v119
v_mfma_f32_16x16x32_bf16 v[196:199], a[124:127], a[244:247], v[196:199]
v_fma_f32 v108, v108, s40, v15
v_fma_f32 v109, v109, s40, v15
v_mfma_f32_16x16x32_bf16 v[184:187], a[168:171], a[236:239], v[184:187]
ds_read_b64_tr_b16 a[234:235], v6 offset:60928
v_cvt_pk_bf16_f32 v128, v132, v133
v_mfma_f32_16x16x32_bf16 v[184:187], a[172:175], a[244:247], v[184:187]
v_cvt_pk_bf16_f32 v129, v134, v135
s_waitcnt lgkmcnt(4)
v_mfma_f32_16x16x32_bf16 v[144:147], a[32:35], a[248:251], v[144:147]
ds_read_b64_tr_b16 a[236:237], v7 offset:0
v_cvt_pk_bf16_f32 v130, v224, v225
v_mfma_f32_16x16x32_bf16 v[144:147], a[36:39], a[252:255], v[144:147]
v_exp_f32 v108, v108
v_mfma_f32_16x16x32_bf16 v[244:247], a[80:83], a[248:251], v[244:247]
ds_read_b64_tr_b16 a[238:239], v7 offset:512
v_cvt_pk_bf16_f32 v131, v226, v227
v_mfma_f32_16x16x32_bf16 v[244:247], a[84:87], a[252:255], v[244:247]
v_exp_f32 v109, v109
v_mfma_f32_16x16x32_bf16 v[196:199], a[128:131], a[248:251], v[196:199]
ds_read_b64_tr_b16 a[244:245], v7 offset:1024
v_cvt_pk_bf16_f32 v200, v220, v221
v_mfma_f32_16x16x32_bf16 v[196:199], a[132:135], a[252:255], v[196:199]
v_cvt_pk_bf16_f32 v201, v222, v223
v_cvt_pk_bf16_f32 v202, v216, v217
v_mfma_f32_16x16x32_bf16 v[184:187], a[176:179], a[248:251], v[184:187]
ds_read_b64_tr_b16 a[246:247], v7 offset:1536
v_cvt_pk_bf16_f32 v203, v218, v219
v_mfma_f32_16x16x32_bf16 v[184:187], a[180:183], a[252:255], v[184:187]
v_fma_f32 v110, v110, s40, v15
s_waitcnt lgkmcnt(4)
v_mfma_f32_16x16x32_bf16 v[144:147], a[40:43], a[224:227], v[144:147]
ds_read_b64_tr_b16 a[248:249], v7 offset:2048
s_add_u32 m0, s39, 53248
v_mfma_f32_16x16x32_bf16 v[144:147], a[44:47], a[232:235], v[144:147]
s_add_u32 s42, s38, 101376
buffer_load_dwordx4 v8, s[24:27], s42 offen offset:0 lds
v_mfma_f32_16x16x32_bf16 v[244:247], a[88:91], a[224:227], v[244:247]
ds_read_b64_tr_b16 a[250:251], v7 offset:2560
v_fma_f32 v111, v111, s40, v15
v_mfma_f32_16x16x32_bf16 v[244:247], a[92:95], a[232:235], v[244:247]
v_exp_f32 v110, v110
v_mfma_f32_16x16x32_bf16 v[196:199], a[136:139], a[224:227], v[196:199]
ds_read_b64_tr_b16 a[252:253], v7 offset:3072
v_add_f32 v20, v20, v108
v_mfma_f32_16x16x32_bf16 v[196:199], a[140:143], a[232:235], v[196:199]
v_exp_f32 v111, v111
v_mfma_f32_16x16x32_bf16 v[184:187], a[184:187], a[224:227], v[184:187]
ds_read_b64_tr_b16 a[254:255], v7 offset:3584
v_add_f32 v20, v20, v109
v_mfma_f32_16x16x32_bf16 v[184:187], a[188:191], a[232:235], v[184:187]
v_add_f32 v4, v4, v110
s_waitcnt lgkmcnt(4)
v_mfma_f32_16x16x32_bf16 v[112:115], a[0:3], a[236:239], 0
ds_read_b64_tr_b16 a[224:225], v7 offset:4096
s_add_u32 s43, s38, 124928
v_mfma_f32_16x16x32_bf16 v[112:115], a[4:7], a[244:247], v[112:115]
buffer_load_dwordx4 v8, s[24:27], s43 offen offset:1024 lds
v_add_f32 v4, v4, v111
v_mfma_f32_16x16x32_bf16 v[192:195], a[48:51], a[236:239], 0
ds_read_b64_tr_b16 a[226:227], v7 offset:4608
v_fma_f32 v36, v36, s40, v30
v_mfma_f32_16x16x32_bf16 v[192:195], a[52:55], a[244:247], v[192:195]
v_exp_f32 v36, v36
v_mfma_f32_16x16x32_bf16 v[56:59], a[96:99], a[236:239], 0
ds_read_b64_tr_b16 a[232:233], v7 offset:5120
v_fma_f32 v37, v37, s40, v30
v_mfma_f32_16x16x32_bf16 v[56:59], a[100:103], a[244:247], v[56:59]
v_exp_f32 v37, v37
v_mfma_f32_16x16x32_bf16 v[76:79], a[144:147], a[236:239], 0
ds_read_b64_tr_b16 a[234:235], v7 offset:5632
v_fma_f32 v38, v38, s40, v30
v_mfma_f32_16x16x32_bf16 v[76:79], a[148:151], a[244:247], v[76:79]
s_add_u32 m0, s39, 6144
s_waitcnt lgkmcnt(4)
v_mfma_f32_16x16x32_bf16 v[112:115], a[8:11], a[248:251], v[112:115]
ds_read_b64_tr_b16 a[236:237], v7 offset:55296
s_add_u32 s42, s38, 150528
v_mfma_f32_16x16x32_bf16 v[112:115], a[12:15], a[252:255], v[112:115]
buffer_load_dwordx4 v8, s[24:27], s42 offen offset:0 lds
v_fma_f32 v39, v39, s40, v30
v_mfma_f32_16x16x32_bf16 v[192:195], a[56:59], a[248:251], v[192:195]
ds_read_b64_tr_b16 a[238:239], v7 offset:55808
v_add_f32 v20, v20, v36
v_mfma_f32_16x16x32_bf16 v[192:195], a[60:63], a[252:255], v[192:195]
v_exp_f32 v38, v38
v_mfma_f32_16x16x32_bf16 v[56:59], a[104:107], a[248:251], v[56:59]
ds_read_b64_tr_b16 a[244:245], v7 offset:56320
v_add_f32 v20, v20, v37
v_mfma_f32_16x16x32_bf16 v[56:59], a[108:111], a[252:255], v[56:59]
v_exp_f32 v39, v39
v_mfma_f32_16x16x32_bf16 v[76:79], a[152:155], a[248:251], v[76:79]
ds_read_b64_tr_b16 a[246:247], v7 offset:56832
v_add_f32 v4, v4, v38
v_mfma_f32_16x16x32_bf16 v[76:79], a[156:159], a[252:255], v[76:79]
s_add_u32 s43, s38, 174080
s_waitcnt lgkmcnt(4)
v_mfma_f32_16x16x32_bf16 v[112:115], a[16:19], a[224:227], v[112:115]
ds_read_b64_tr_b16 a[248:249], v7 offset:57344
buffer_load_dwordx4 v8, s[24:27], s43 offen offset:1024 lds
v_mfma_f32_16x16x32_bf16 v[112:115], a[20:23], a[232:235], v[112:115]
v_add_f32 v4, v4, v39
v_fma_f32 v152, v152, s40, v30
v_mfma_f32_16x16x32_bf16 v[192:195], a[64:67], a[224:227], v[192:195]
ds_read_b64_tr_b16 a[250:251], v7 offset:57856
v_fma_f32 v153, v153, s40, v30
v_mfma_f32_16x16x32_bf16 v[192:195], a[68:71], a[232:235], v[192:195]
v_exp_f32 v152, v152
v_mfma_f32_16x16x32_bf16 v[56:59], a[112:115], a[224:227], v[56:59]
ds_read_b64_tr_b16 a[252:253], v7 offset:58368
v_fma_f32 v154, v154, s40, v30
v_mfma_f32_16x16x32_bf16 v[56:59], a[116:119], a[232:235], v[56:59]
v_exp_f32 v153, v153
v_mfma_f32_16x16x32_bf16 v[76:79], a[160:163], a[224:227], v[76:79]
ds_read_b64_tr_b16 a[254:255], v7 offset:58880
s_add_u32 s42, s38, 197632
v_mfma_f32_16x16x32_bf16 v[76:79], a[164:167], a[232:235], v[76:79]
buffer_load_dwordx4 v8, s[24:27], s42 offen offset:2048 lds
s_waitcnt lgkmcnt(4)
v_mfma_f32_16x16x32_bf16 v[112:115], a[24:27], a[236:239], v[112:115]
ds_read_b64_tr_b16 a[224:225], v7 offset:59392
v_fma_f32 v155, v155, s40, v30
v_mfma_f32_16x16x32_bf16 v[112:115], a[28:31], a[244:247], v[112:115]
v_exp_f32 v154, v154
v_mfma_f32_16x16x32_bf16 v[192:195], a[72:75], a[236:239], v[192:195]
ds_read_b64_tr_b16 a[226:227], v7 offset:59904
v_add_f32 v20, v20, v152
v_mfma_f32_16x16x32_bf16 v[192:195], a[76:79], a[244:247], v[192:195]
v_exp_f32 v155, v155
v_mfma_f32_16x16x32_bf16 v[56:59], a[120:123], a[236:239], v[56:59]
ds_read_b64_tr_b16 a[232:233], v7 offset:60416
v_add_f32 v20, v20, v153
v_mfma_f32_16x16x32_bf16 v[56:59], a[124:127], a[244:247], v[56:59]
v_add_f32 v4, v4, v154
s_add_u32 s43, s38, 221184
v_mfma_f32_16x16x32_bf16 v[76:79], a[168:171], a[236:239], v[76:79]
ds_read_b64_tr_b16 a[234:235], v7 offset:60928
buffer_load_dwordx4 v8, s[24:27], s43 offen offset:3072 lds
v_mfma_f32_16x16x32_bf16 v[76:79], a[172:175], a[244:247], v[76:79]
v_add_f32 v4, v4, v155
s_waitcnt lgkmcnt(4)
v_mfma_f32_16x16x32_bf16 v[112:115], a[32:35], a[248:251], v[112:115]
ds_read_b64_tr_b16 a[236:237], v17 offset:0
v_add_f32 v20, v20, v4
v_mfma_f32_16x16x32_bf16 v[112:115], a[36:39], a[252:255], v[112:115]
v_fma_f32 v236, v236, s40, v11
v_fma_f32 v237, v237, s40, v11
v_mfma_f32_16x16x32_bf16 v[192:195], a[80:83], a[248:251], v[192:195]
ds_read_b64_tr_b16 a[238:239], v17 offset:512
s_add_u32 m0, s39, 10240
v_mfma_f32_16x16x32_bf16 v[192:195], a[84:87], a[252:255], v[192:195]
v_exp_f32 v236, v236
v_mfma_f32_16x16x32_bf16 v[56:59], a[128:131], a[248:251], v[56:59]
ds_read_b64_tr_b16 a[244:245], v17 offset:1024
s_add_u32 s42, s38, 248832
v_mfma_f32_16x16x32_bf16 v[56:59], a[132:135], a[252:255], v[56:59]
v_exp_f32 v237, v237
v_mfma_f32_16x16x32_bf16 v[76:79], a[176:179], a[248:251], v[76:79]
ds_read_b64_tr_b16 a[246:247], v17 offset:1536
buffer_load_dwordx4 v8, s[24:27], s42 offen offset:0 lds
v_mfma_f32_16x16x32_bf16 v[76:79], a[180:183], a[252:255], v[76:79]
v_fma_f32 v238, v238, s40, v11
s_waitcnt lgkmcnt(4)
v_mfma_f32_16x16x32_bf16 v[112:115], a[40:43], a[224:227], v[112:115]
ds_read_b64_tr_b16 a[248:249], v17 offset:2048
v_fma_f32 v239, v239, s40, v11
v_mfma_f32_16x16x32_bf16 v[112:115], a[44:47], a[232:235], v[112:115]
v_exp_f32 v238, v238
v_mfma_f32_16x16x32_bf16 v[192:195], a[88:91], a[224:227], v[192:195]
ds_read_b64_tr_b16 a[250:251], v17 offset:2560
v_add_f32 v5, v236, v237
v_mfma_f32_16x16x32_bf16 v[192:195], a[92:95], a[232:235], v[192:195]
v_exp_f32 v239, v239
v_mfma_f32_16x16x32_bf16 v[56:59], a[136:139], a[224:227], v[56:59]
ds_read_b64_tr_b16 a[252:253], v17 offset:3072
v_add_f32 v22, v238, v239
v_mfma_f32_16x16x32_bf16 v[56:59], a[140:143], a[232:235], v[56:59]
s_add_u32 s43, s38, 272384
buffer_load_dwordx4 v8, s[24:27], s43 offen offset:1024 lds
v_mfma_f32_16x16x32_bf16 v[76:79], a[184:187], a[224:227], v[76:79]
ds_read_b64_tr_b16 a[254:255], v17 offset:3584
v_fma_f32 v148, v148, s40, v11
v_mfma_f32_16x16x32_bf16 v[76:79], a[188:191], a[232:235], v[76:79]
v_fma_f32 v149, v149, s40, v11
s_waitcnt lgkmcnt(4)
v_mfma_f32_16x16x32_bf16 v[252:255], a[0:3], a[236:239], 0
ds_read_b64_tr_b16 a[224:225], v17 offset:4096
v_fma_f32 v150, v150, s40, v11
v_mfma_f32_16x16x32_bf16 v[252:255], a[4:7], a[244:247], v[252:255]
v_exp_f32 v148, v148
v_mfma_f32_16x16x32_bf16 v[124:127], a[48:51], a[236:239], 0
ds_read_b64_tr_b16 a[226:227], v17 offset:4608
v_cvt_pk_bf16_f32 v228, v144, v145
v_mfma_f32_16x16x32_bf16 v[124:127], a[52:55], a[244:247], v[124:127]
v_exp_f32 v149, v149
v_mfma_f32_16x16x32_bf16 v[212:215], a[96:99], a[236:239], 0
ds_read_b64_tr_b16 a[232:233], v17 offset:5120
v_cvt_pk_bf16_f32 v229, v146, v147
v_mfma_f32_16x16x32_bf16 v[212:215], a[100:103], a[244:247], v[212:215]
v_cvt_pk_bf16_f32 v230, v244, v245
v_cvt_pk_bf16_f32 v231, v246, v247
v_mfma_f32_16x16x32_bf16 v[156:159], a[144:147], a[236:239], 0
ds_read_b64_tr_b16 a[234:235], v17 offset:5632
v_cvt_pk_bf16_f32 v60, v196, v197
v_mfma_f32_16x16x32_bf16 v[156:159], a[148:151], a[244:247], v[156:159]
v_cvt_pk_bf16_f32 v61, v198, v199
s_waitcnt lgkmcnt(4)
v_mfma_f32_16x16x32_bf16 v[252:255], a[8:11], a[248:251], v[252:255]
ds_read_b64_tr_b16 a[236:237], v17 offset:55296
v_cvt_pk_bf16_f32 v62, v184, v185
v_mfma_f32_16x16x32_bf16 v[252:255], a[12:15], a[252:255], v[252:255]
v_cvt_pk_bf16_f32 v63, v186, v187
v_fma_f32 v151, v151, s40, v11
v_mfma_f32_16x16x32_bf16 v[124:127], a[56:59], a[248:251], v[124:127]
ds_read_b64_tr_b16 a[238:239], v17 offset:55808
v_add_f32 v5, v5, v148
v_mfma_f32_16x16x32_bf16 v[124:127], a[60:63], a[252:255], v[124:127]
v_exp_f32 v150, v150
v_mfma_f32_16x16x32_bf16 v[212:215], a[104:107], a[248:251], v[212:215]
ds_read_b64_tr_b16 a[244:245], v17 offset:56320
v_add_f32 v5, v5, v149
v_mfma_f32_16x16x32_bf16 v[212:215], a[108:111], a[252:255], v[212:215]
v_exp_f32 v151, v151
v_mfma_f32_16x16x32_bf16 v[156:159], a[152:155], a[248:251], v[156:159]
ds_read_b64_tr_b16 a[246:247], v17 offset:56832
v_add_f32 v22, v22, v150
v_mfma_f32_16x16x32_bf16 v[156:159], a[156:159], a[252:255], v[156:159]
v_add_f32 v22, v22, v151
s_waitcnt lgkmcnt(4)
v_mfma_f32_16x16x32_bf16 v[252:255], a[16:19], a[224:227], v[252:255]
ds_read_b64_tr_b16 a[248:249], v17 offset:57344
v_fma_f32 v48, v48, s40, v23
v_mfma_f32_16x16x32_bf16 v[252:255], a[20:23], a[232:235], v[252:255]
v_exp_f32 v48, v48
v_mfma_f32_16x16x32_bf16 v[124:127], a[64:67], a[224:227], v[124:127]
ds_read_b64_tr_b16 a[250:251], v17 offset:57856
v_fma_f32 v49, v49, s40, v23
v_mfma_f32_16x16x32_bf16 v[124:127], a[68:71], a[232:235], v[124:127]
v_exp_f32 v49, v49
v_mfma_f32_16x16x32_bf16 v[212:215], a[112:115], a[224:227], v[212:215]
ds_read_b64_tr_b16 a[252:253], v17 offset:58368
v_fma_f32 v50, v50, s40, v23
v_mfma_f32_16x16x32_bf16 v[212:215], a[116:119], a[232:235], v[212:215]
v_exp_f32 v50, v50
v_mfma_f32_16x16x32_bf16 v[156:159], a[160:163], a[224:227], v[156:159]
ds_read_b64_tr_b16 a[254:255], v17 offset:58880
v_fma_f32 v51, v51, s40, v23
v_mfma_f32_16x16x32_bf16 v[156:159], a[164:167], a[232:235], v[156:159]
v_add_f32 v5, v5, v48
s_waitcnt lgkmcnt(4)
v_mfma_f32_16x16x32_bf16 v[252:255], a[24:27], a[236:239], v[252:255]
ds_read_b64_tr_b16 a[224:225], v17 offset:59392
v_add_f32 v5, v5, v49
v_mfma_f32_16x16x32_bf16 v[252:255], a[28:31], a[244:247], v[252:255]
v_exp_f32 v51, v51
v_mfma_f32_16x16x32_bf16 v[124:127], a[72:75], a[236:239], v[124:127]
ds_read_b64_tr_b16 a[226:227], v17 offset:59904
v_add_f32 v22, v22, v50
v_mfma_f32_16x16x32_bf16 v[124:127], a[76:79], a[244:247], v[124:127]
v_add_f32 v22, v22, v51
v_fma_f32 v68, v68, s40, v23
v_mfma_f32_16x16x32_bf16 v[212:215], a[120:123], a[236:239], v[212:215]
ds_read_b64_tr_b16 a[232:233], v17 offset:60416
v_fma_f32 v69, v69, s40, v23
v_mfma_f32_16x16x32_bf16 v[212:215], a[124:127], a[244:247], v[212:215]
v_exp_f32 v68, v68
v_mfma_f32_16x16x32_bf16 v[156:159], a[168:171], a[236:239], v[156:159]
ds_read_b64_tr_b16 a[234:235], v17 offset:60928
v_fma_f32 v70, v70, s40, v23
v_mfma_f32_16x16x32_bf16 v[156:159], a[172:175], a[244:247], v[156:159]
v_fma_f32 v71, v71, s40, v23
s_waitcnt lgkmcnt(4)
v_mfma_f32_16x16x32_bf16 v[252:255], a[32:35], a[248:251], v[252:255]
ds_read_b64_tr_b16 a[236:237], v18 offset:0
v_add_f32 v5, v5, v68
v_mfma_f32_16x16x32_bf16 v[252:255], a[36:39], a[252:255], v[252:255]
v_exp_f32 v69, v69
v_mfma_f32_16x16x32_bf16 v[124:127], a[80:83], a[248:251], v[124:127]
ds_read_b64_tr_b16 a[238:239], v18 offset:512
v_add_f32 v5, v5, v69
v_mfma_f32_16x16x32_bf16 v[124:127], a[84:87], a[252:255], v[124:127]
v_exp_f32 v70, v70
v_mfma_f32_16x16x32_bf16 v[212:215], a[128:131], a[248:251], v[212:215]
ds_read_b64_tr_b16 a[244:245], v18 offset:1024
v_add_f32 v22, v22, v70
v_mfma_f32_16x16x32_bf16 v[212:215], a[132:135], a[252:255], v[212:215]
v_exp_f32 v71, v71
v_mfma_f32_16x16x32_bf16 v[156:159], a[176:179], a[248:251], v[156:159]
ds_read_b64_tr_b16 a[246:247], v18 offset:1536
v_add_f32 v22, v22, v71
v_mfma_f32_16x16x32_bf16 v[156:159], a[180:183], a[252:255], v[156:159]
v_add_f32 v5, v5, v22
s_waitcnt lgkmcnt(4)
v_mfma_f32_16x16x32_bf16 v[252:255], a[40:43], a[224:227], v[252:255]
ds_read_b64_tr_b16 a[248:249], v18 offset:2048
v_fma_f32 v208, v208, s40, v25
v_mfma_f32_16x16x32_bf16 v[252:255], a[44:47], a[232:235], v[252:255]
v_exp_f32 v208, v208
v_mfma_f32_16x16x32_bf16 v[124:127], a[88:91], a[224:227], v[124:127]
ds_read_b64_tr_b16 a[250:251], v18 offset:2560
v_fma_f32 v209, v209, s40, v25
v_mfma_f32_16x16x32_bf16 v[124:127], a[92:95], a[232:235], v[124:127]
v_exp_f32 v209, v209
v_mfma_f32_16x16x32_bf16 v[212:215], a[136:139], a[224:227], v[212:215]
ds_read_b64_tr_b16 a[252:253], v18 offset:3072
v_fma_f32 v210, v210, s40, v25
v_mfma_f32_16x16x32_bf16 v[212:215], a[140:143], a[232:235], v[212:215]
v_exp_f32 v210, v210
v_mfma_f32_16x16x32_bf16 v[156:159], a[184:187], a[224:227], v[156:159]
ds_read_b64_tr_b16 a[254:255], v18 offset:3584
v_fma_f32 v211, v211, s40, v25
v_mfma_f32_16x16x32_bf16 v[156:159], a[188:191], a[232:235], v[156:159]
v_add_f32 v16, v208, v209
s_waitcnt lgkmcnt(4)
v_mfma_f32_16x16x32_bf16 v[72:75], a[0:3], a[236:239], 0
ds_read_b64_tr_b16 a[224:225], v18 offset:4096
v_fma_f32 v240, v240, s40, v25
v_mfma_f32_16x16x32_bf16 v[72:75], a[4:7], a[244:247], v[72:75]
v_exp_f32 v211, v211
v_mfma_f32_16x16x32_bf16 v[140:143], a[48:51], a[236:239], 0
ds_read_b64_tr_b16 a[226:227], v18 offset:4608
v_add_f32 v2, v210, v211
v_mfma_f32_16x16x32_bf16 v[140:143], a[52:55], a[244:247], v[140:143]
v_exp_f32 v240, v240
v_mfma_f32_16x16x32_bf16 v[180:183], a[96:99], a[236:239], 0
ds_read_b64_tr_b16 a[232:233], v18 offset:5120
v_fma_f32 v241, v241, s40, v25
v_mfma_f32_16x16x32_bf16 v[180:183], a[100:103], a[244:247], v[180:183]
v_exp_f32 v241, v241
v_mfma_f32_16x16x32_bf16 v[64:67], a[144:147], a[236:239], 0
ds_read_b64_tr_b16 a[234:235], v18 offset:5632
v_fma_f32 v242, v242, s40, v25
v_mfma_f32_16x16x32_bf16 v[64:67], a[148:151], a[244:247], v[64:67]
v_cvt_pk_bf16_f32 v132, v112, v113
s_waitcnt lgkmcnt(4)
v_mfma_f32_16x16x32_bf16 v[72:75], a[8:11], a[248:251], v[72:75]
ds_read_b64_tr_b16 a[236:237], v18 offset:55296
v_cvt_pk_bf16_f32 v133, v114, v115
v_mfma_f32_16x16x32_bf16 v[72:75], a[12:15], a[252:255], v[72:75]
v_exp_f32 v242, v242
v_mfma_f32_16x16x32_bf16 v[140:143], a[56:59], a[248:251], v[140:143]
ds_read_b64_tr_b16 a[238:239], v18 offset:55808
v_cvt_pk_bf16_f32 v134, v192, v193
v_mfma_f32_16x16x32_bf16 v[140:143], a[60:63], a[252:255], v[140:143]
v_cvt_pk_bf16_f32 v135, v194, v195
v_cvt_pk_bf16_f32 v224, v56, v57
v_mfma_f32_16x16x32_bf16 v[180:183], a[104:107], a[248:251], v[180:183]
ds_read_b64_tr_b16 a[244:245], v18 offset:56320
v_cvt_pk_bf16_f32 v225, v58, v59
v_mfma_f32_16x16x32_bf16 v[180:183], a[108:111], a[252:255], v[180:183]
v_cvt_pk_bf16_f32 v226, v76, v77
v_cvt_pk_bf16_f32 v227, v78, v79
v_mfma_f32_16x16x32_bf16 v[64:67], a[152:155], a[248:251], v[64:67]
ds_read_b64_tr_b16 a[246:247], v18 offset:56832
v_fma_f32 v243, v243, s40, v25
v_mfma_f32_16x16x32_bf16 v[64:67], a[156:159], a[252:255], v[64:67]
v_add_f32 v16, v16, v240
s_waitcnt lgkmcnt(4)
v_mfma_f32_16x16x32_bf16 v[72:75], a[16:19], a[224:227], v[72:75]
ds_read_b64_tr_b16 a[12:13], v18 offset:57344
v_add_f32 v16, v16, v241
v_mfma_f32_16x16x32_bf16 v[72:75], a[20:23], a[232:235], v[72:75]
ds_read_b128 a[0:3], v10 offset:0
v_add_f32 v2, v2, v242
v_mfma_f32_16x16x32_bf16 v[140:143], a[64:67], a[224:227], v[140:143]
ds_read_b64_tr_b16 a[14:15], v18 offset:57856
ds_read_b128 a[48:51], v10 offset:1024
v_mfma_f32_16x16x32_bf16 v[140:143], a[68:71], a[232:235], v[140:143]
ds_read_b128 a[96:99], v10 offset:2048
v_fma_f32 v52, v52, s40, v21
v_mfma_f32_16x16x32_bf16 v[180:183], a[112:115], a[224:227], v[180:183]
ds_read_b64_tr_b16 a[60:61], v18 offset:58368
ds_read_b128 a[144:147], v10 offset:3072
v_mfma_f32_16x16x32_bf16 v[180:183], a[116:119], a[232:235], v[180:183]
ds_read_b128 a[4:7], v10 offset:4096
v_fma_f32 v53, v53, s40, v21
v_mfma_f32_16x16x32_bf16 v[64:67], a[160:163], a[224:227], v[64:67]
ds_read_b64_tr_b16 a[62:63], v18 offset:58880
ds_read_b128 a[52:55], v10 offset:5120
v_mfma_f32_16x16x32_bf16 v[64:67], a[164:167], a[232:235], v[64:67]
ds_read_b128 a[100:103], v10 offset:6144
s_waitcnt lgkmcnt(11)
v_mfma_f32_16x16x32_bf16 v[72:75], a[24:27], a[236:239], v[72:75]
ds_read_b64_tr_b16 a[108:109], v18 offset:59392
ds_read_b128 a[148:151], v10 offset:7168
v_mfma_f32_16x16x32_bf16 v[72:75], a[28:31], a[244:247], v[72:75]
ds_read_b128 a[8:11], v10 offset:8192
v_fma_f32 v54, v54, s40, v21
v_mfma_f32_16x16x32_bf16 v[140:143], a[72:75], a[236:239], v[140:143]
ds_read_b64_tr_b16 a[110:111], v18 offset:59904
ds_read_b128 a[56:59], v10 offset:9216
v_mfma_f32_16x16x32_bf16 v[140:143], a[76:79], a[244:247], v[140:143]
ds_read_b128 a[104:107], v10 offset:10240
v_fma_f32 v55, v55, s40, v21
v_mfma_f32_16x16x32_bf16 v[180:183], a[120:123], a[236:239], v[180:183]
ds_read_b64_tr_b16 a[248:249], v18 offset:60416
ds_read_b128 a[152:155], v10 offset:11264
v_mfma_f32_16x16x32_bf16 v[180:183], a[124:127], a[244:247], v[180:183]
v_exp_f32 v243, v243
v_mfma_f32_16x16x32_bf16 v[64:67], a[168:171], a[236:239], v[64:67]
ds_read_b64_tr_b16 a[250:251], v18 offset:60928
v_add_f32 v2, v2, v243
v_mfma_f32_16x16x32_bf16 v[64:67], a[172:175], a[244:247], v[64:67]
v_fma_f32 v136, v136, s40, v21
s_waitcnt lgkmcnt(11)
v_mfma_f32_16x16x32_bf16 v[72:75], a[32:35], a[12:15], v[72:75]
v_exp_f32 v52, v52
v_mfma_f32_16x16x32_bf16 v[72:75], a[36:39], a[60:63], v[72:75]
v_exp_f32 v53, v53
v_mfma_f32_16x16x32_bf16 v[140:143], a[80:83], a[12:15], v[140:143]
v_exp_f32 v54, v54
v_mfma_f32_16x16x32_bf16 v[140:143], a[84:87], a[60:63], v[140:143]
s_waitcnt vmcnt(0) lgkmcnt(0)
s_barrier
v_mfma_f32_16x16x32_bf16 v[180:183], a[128:131], a[12:15], v[180:183]
ds_read_b64_tr_b16 a[156:157], v26 offset:0
v_add_f32 v16, v16, v52
v_mfma_f32_16x16x32_bf16 v[180:183], a[132:135], a[60:63], v[180:183]
ds_read_b64_tr_b16 a[158:159], v26 offset:24576
v_add_f32 v16, v16, v53
v_mfma_f32_16x16x32_bf16 v[64:67], a[176:179], a[12:15], v[64:67]
v_exp_f32 v55, v55
v_mfma_f32_16x16x32_bf16 v[64:67], a[180:183], a[60:63], v[64:67]
ds_read_b64_tr_b16 a[252:253], v26 offset:1024
v_mfma_f32_16x16x32_bf16 v[72:75], a[40:43], a[108:111], v[72:75]
ds_read_b64_tr_b16 a[16:17], v26 offset:2048
v_add_f32 v2, v2, v54
v_mfma_f32_16x16x32_bf16 v[72:75], a[44:47], a[248:251], v[72:75]
ds_read_b64_tr_b16 a[254:255], v26 offset:25600
v_add_f32 v2, v2, v55
v_mfma_f32_16x16x32_bf16 v[140:143], a[88:91], a[108:111], v[140:143]
ds_read_b64_tr_b16 a[18:19], v26 offset:26624
v_fma_f32 v137, v137, s40, v21
v_mfma_f32_16x16x32_bf16 v[140:143], a[92:95], a[248:251], v[140:143]
v_exp_f32 v136, v136
v_mfma_f32_16x16x32_bf16 v[180:183], a[136:139], a[108:111], v[180:183]
ds_read_b64_tr_b16 a[20:21], v26 offset:3072
v_fma_f32 v138, v138, s40, v21
v_mfma_f32_16x16x32_bf16 v[180:183], a[140:143], a[248:251], v[180:183]
v_exp_f32 v137, v137
v_mfma_f32_16x16x32_bf16 v[64:67], a[184:187], a[108:111], v[64:67]
ds_read_b64_tr_b16 a[22:23], v26 offset:27648
v_fma_f32 v139, v139, s40, v21
v_mfma_f32_16x16x32_bf16 v[64:67], a[188:191], a[248:251], v[64:67]
v_add_f32 v16, v16, v136
s_waitcnt lgkmcnt(3)
v_mfma_f32_16x16x32_bf16 v[220:223], a[156:159], a[0:3], 0
ds_read_b64_tr_b16 a[64:65], v26 offset:4096
v_add_f32 v16, v16, v137
v_mfma_f32_16x16x32_bf16 v[220:223], a[252:255], a[4:7], v[220:223]
v_exp_f32 v138, v138
v_mfma_f32_16x16x32_bf16 v[216:219], a[156:159], a[48:51], 0
ds_read_b64_tr_b16 a[66:67], v26 offset:28672
v_add_f32 v2, v2, v138
v_mfma_f32_16x16x32_bf16 v[216:219], a[252:255], a[52:55], v[216:219]
v_exp_f32 v139, v139
v_mfma_f32_16x16x32_bf16 v[144:147], a[156:159], a[96:99], 0
ds_read_b64_tr_b16 a[68:69], v26 offset:5120
v_add_f32 v2, v2, v139
v_mfma_f32_16x16x32_bf16 v[144:147], a[252:255], a[100:103], v[144:147]
v_add_f32 v16, v16, v2
v_fma_f32 v32, v32, s40, v27
v_mfma_f32_16x16x32_bf16 v[244:247], a[156:159], a[144:147], 0
ds_read_b64_tr_b16 a[70:71], v26 offset:29696
v_fma_f32 v33, v33, s40, v27
v_mfma_f32_16x16x32_bf16 v[244:247], a[252:255], a[148:151], v[244:247]
v_fma_f32 v34, v34, s40, v27
s_waitcnt lgkmcnt(4)
v_mfma_f32_16x16x32_bf16 v[220:223], a[16:19], a[8:11], v[220:223]
ds_read_b64_tr_b16 a[112:113], v28 offset:6144
v_fma_f32 v35, v35, s40, v27
v_mfma_f32_16x16x32_bf16 v[220:223], a[20:23], a[192:195], v[220:223]
v_exp_f32 v32, v32
v_mfma_f32_16x16x32_bf16 v[216:219], a[16:19], a[56:59], v[216:219]
ds_read_b64_tr_b16 a[114:115], v28 offset:30720
v_fma_f32 v248, v248, s40, v27
v_mfma_f32_16x16x32_bf16 v[216:219], a[20:23], a[196:199], v[216:219]
v_exp_f32 v33, v33
v_mfma_f32_16x16x32_bf16 v[144:147], a[16:19], a[104:107], v[144:147]
ds_read_b64_tr_b16 a[116:117], v28 offset:7168
v_add_f32 v9, v32, v33
v_mfma_f32_16x16x32_bf16 v[144:147], a[20:23], a[200:203], v[144:147]
v_exp_f32 v34, v34
v_mfma_f32_16x16x32_bf16 v[244:247], a[16:19], a[152:155], v[244:247]
ds_read_b64_tr_b16 a[118:119], v28 offset:31744
v_fma_f32 v249, v249, s40, v27
v_mfma_f32_16x16x32_bf16 v[244:247], a[20:23], a[208:211], v[244:247]
v_fma_f32 v250, v250, s40, v27
s_waitcnt lgkmcnt(4)
v_mfma_f32_16x16x32_bf16 v[220:223], a[64:67], a[204:207], v[220:223]
ds_read_b64_tr_b16 a[160:161], v26 offset:8
v_fma_f32 v251, v251, s40, v27
v_mfma_f32_16x16x32_bf16 v[220:223], a[68:71], a[228:231], v[220:223]
v_exp_f32 v35, v35
v_mfma_f32_16x16x32_bf16 v[216:219], a[64:67], a[212:215], v[216:219]
ds_read_b64_tr_b16 a[162:163], v26 offset:24584
v_add_f32 v29, v34, v35
v_mfma_f32_16x16x32_bf16 v[216:219], a[68:71], a[240:243], v[216:219]
v_exp_f32 v248, v248
v_mfma_f32_16x16x32_bf16 v[144:147], a[64:67], a[216:219], v[144:147]
ds_read_b64_tr_b16 a[224:225], v26 offset:1032
v_cvt_pk_bf16_f32 v196, v252, v253
v_mfma_f32_16x16x32_bf16 v[144:147], a[68:71], v[120:123], v[144:147]
v_exp_f32 v249, v249
v_mfma_f32_16x16x32_bf16 v[244:247], a[64:67], a[220:223], v[244:247]
ds_read_b64_tr_b16 a[226:227], v26 offset:25608
v_cvt_pk_bf16_f32 v197, v254, v255
v_mfma_f32_16x16x32_bf16 v[244:247], a[68:71], v[92:95], v[244:247]
v_cvt_pk_bf16_f32 v198, v124, v125
s_waitcnt lgkmcnt(4)
v_mfma_f32_16x16x32_bf16 v[220:223], a[112:115], v[172:175], v[220:223]
ds_read_b64_tr_b16 a[164:165], v26 offset:2056
v_cvt_pk_bf16_f32 v199, v126, v127
v_mfma_f32_16x16x32_bf16 v[220:223], a[116:119], v[104:107], v[220:223]
v_exp_f32 v250, v250
v_mfma_f32_16x16x32_bf16 v[216:219], a[112:115], v[168:171], v[216:219]
ds_read_b64_tr_b16 a[166:167], v26 offset:26632
v_cvt_pk_bf16_f32 v184, v212, v213
v_mfma_f32_16x16x32_bf16 v[216:219], a[116:119], v[164:167], v[216:219]
v_cvt_pk_bf16_f32 v185, v214, v215
v_cvt_pk_bf16_f32 v186, v156, v157
v_mfma_f32_16x16x32_bf16 v[144:147], a[112:115], v[40:43], v[144:147]
ds_read_b64_tr_b16 a[232:233], v26 offset:3080
v_cvt_pk_bf16_f32 v187, v158, v159
v_mfma_f32_16x16x32_bf16 v[144:147], a[116:119], v[188:191], v[144:147]
v_exp_f32 v251, v251
v_mfma_f32_16x16x32_bf16 v[244:247], a[112:115], v[44:47], v[244:247]
ds_read_b64_tr_b16 a[234:235], v26 offset:27656
v_add_f32 v9, v9, v248
v_mfma_f32_16x16x32_bf16 v[244:247], a[116:119], v[88:91], v[244:247]
v_add_f32 v9, v9, v249
s_waitcnt lgkmcnt(4)
v_mfma_f32_16x16x32_bf16 v[112:115], a[160:163], a[0:3], 0
ds_read_b64_tr_b16 a[24:25], v26 offset:4104
v_add_f32 v29, v29, v250
v_mfma_f32_16x16x32_bf16 v[112:115], a[224:227], a[4:7], v[112:115]
v_add_f32 v29, v29, v251
v_fma_f32 v80, v80, s40, v19
v_mfma_f32_16x16x32_bf16 v[192:195], a[160:163], a[48:51], 0
ds_read_b64_tr_b16 a[26:27], v26 offset:28680
v_fma_f32 v81, v81, s40, v19
v_mfma_f32_16x16x32_bf16 v[192:195], a[224:227], a[52:55], v[192:195]
v_exp_f32 v80, v80
v_mfma_f32_16x16x32_bf16 v[56:59], a[160:163], a[96:99], 0
ds_read_b64_tr_b16 a[28:29], v26 offset:5128
v_fma_f32 v82, v82, s40, v19
v_mfma_f32_16x16x32_bf16 v[56:59], a[224:227], a[100:103], v[56:59]
v_exp_f32 v81, v81
v_mfma_f32_16x16x32_bf16 v[76:79], a[160:163], a[144:147], 0
ds_read_b64_tr_b16 a[30:31], v26 offset:29704
v_fma_f32 v83, v83, s40, v19
v_mfma_f32_16x16x32_bf16 v[76:79], a[224:227], a[148:151], v[76:79]
v_add_f32 v9, v9, v80
s_waitcnt lgkmcnt(4)
v_mfma_f32_16x16x32_bf16 v[112:115], a[164:167], a[8:11], v[112:115]
ds_read_b64_tr_b16 a[72:73], v28 offset:6152
v_add_f32 v9, v9, v81
v_mfma_f32_16x16x32_bf16 v[112:115], a[232:235], a[192:195], v[112:115]
v_exp_f32 v82, v82
v_mfma_f32_16x16x32_bf16 v[192:195], a[164:167], a[56:59], v[192:195]
ds_read_b64_tr_b16 a[74:75], v28 offset:30728
v_add_f32 v29, v29, v82
v_mfma_f32_16x16x32_bf16 v[192:195], a[232:235], a[196:199], v[192:195]
v_exp_f32 v83, v83
v_mfma_f32_16x16x32_bf16 v[56:59], a[164:167], a[104:107], v[56:59]
ds_read_b64_tr_b16 a[76:77], v28 offset:7176
v_add_f32 v29, v29, v83
v_mfma_f32_16x16x32_bf16 v[56:59], a[232:235], a[200:203], v[56:59]
v_fma_f32 v96, v96, s40, v19
v_fma_f32 v97, v97, s40, v19
v_mfma_f32_16x16x32_bf16 v[76:79], a[164:167], a[152:155], v[76:79]
ds_read_b64_tr_b16 a[78:79], v28 offset:31752
v_fma_f32 v98, v98, s40, v19
v_mfma_f32_16x16x32_bf16 v[76:79], a[232:235], a[208:211], v[76:79]
v_fma_f32 v99, v99, s40, v19
s_waitcnt lgkmcnt(4)
v_mfma_f32_16x16x32_bf16 v[112:115], a[24:27], a[204:207], v[112:115]
ds_read_b64_tr_b16 a[120:121], v31 offset:0
s_add_u32 m0, s39, 0
v_mfma_f32_16x16x32_bf16 v[112:115], a[28:31], a[228:231], v[112:115]
v_exp_f32 v96, v96
v_mfma_f32_16x16x32_bf16 v[192:195], a[24:27], a[212:215], v[192:195]
ds_read_b64_tr_b16 a[122:123], v31 offset:24576
s_add_u32 s42, s38, 3200
v_mfma_f32_16x16x32_bf16 v[192:195], a[28:31], a[240:243], v[192:195]
v_exp_f32 v97, v97
v_mfma_f32_16x16x32_bf16 v[56:59], a[24:27], a[216:219], v[56:59]
ds_read_b64_tr_b16 a[124:125], v31 offset:1024
buffer_load_dwordx4 v8, s[24:27], s42 offen offset:0 lds
v_mfma_f32_16x16x32_bf16 v[56:59], a[28:31], v[120:123], v[56:59]
v_exp_f32 v98, v98
v_mfma_f32_16x16x32_bf16 v[76:79], a[24:27], a[220:223], v[76:79]
ds_read_b64_tr_b16 a[126:127], v31 offset:25600
v_add_f32 v9, v9, v96
v_mfma_f32_16x16x32_bf16 v[76:79], a[28:31], v[92:95], v[76:79]
v_add_f32 v9, v9, v97
s_waitcnt lgkmcnt(4)
v_mfma_f32_16x16x32_bf16 v[112:115], a[72:75], v[172:175], v[112:115]
ds_read_b64_tr_b16 a[168:169], v31 offset:2048
v_add_f32 v29, v29, v98
v_mfma_f32_16x16x32_bf16 v[112:115], a[76:79], v[104:107], v[112:115]
v_exp_f32 v99, v99
v_mfma_f32_16x16x32_bf16 v[192:195], a[72:75], v[168:171], v[192:195]
ds_read_b64_tr_b16 a[170:171], v31 offset:26624
v_add_f32 v29, v29, v99
v_mfma_f32_16x16x32_bf16 v[192:195], a[76:79], v[164:167], v[192:195]
v_add_f32 v9, v9, v29
v_permlane32_swap_b32 v20, v5
v_mfma_f32_16x16x32_bf16 v[56:59], a[72:75], v[40:43], v[56:59]
ds_read_b64_tr_b16 a[236:237], v31 offset:3072
v_add_f32 v3, v20, v5
v_mfma_f32_16x16x32_bf16 v[56:59], a[76:79], v[188:191], v[56:59]
v_permlane32_swap_b32 v16, v9
v_add_f32 v13, v16, v9
v_mfma_f32_16x16x32_bf16 v[76:79], a[72:75], v[44:47], v[76:79]
ds_read_b64_tr_b16 a[238:239], v31 offset:27648
s_add_u32 s43, s38, 26752
v_mfma_f32_16x16x32_bf16 v[76:79], a[76:79], v[88:91], v[76:79]
v_permlane16_swap_b32 v3, v13
s_waitcnt lgkmcnt(4)
v_mfma_f32_16x16x32_bf16 a[172:175], a[120:123], a[0:3], 0
ds_read_b64_tr_b16 a[244:245], v31 offset:4096
v_add_f32 v14, v3, v13
v_mfma_f32_16x16x32_bf16 a[172:175], a[124:127], a[4:7], a[172:175]
buffer_load_dwordx4 v8, s[24:27], s43 offen offset:1024 lds
s_add_u32 s42, s38, 50304
v_mfma_f32_16x16x32_bf16 a[32:35], a[120:123], a[48:51], 0
ds_read_b64_tr_b16 a[246:247], v31 offset:28672
buffer_load_dwordx4 v8, s[24:27], s42 offen offset:2048 lds
v_mfma_f32_16x16x32_bf16 a[32:35], a[124:127], a[52:55], a[32:35]
v_rcp_f32 v14, v14
v_mfma_f32_16x16x32_bf16 a[36:39], a[120:123], a[96:99], 0
ds_read_b64_tr_b16 a[80:81], v31 offset:5120
v_mov_b32 v12, v14
v_mfma_f32_16x16x32_bf16 a[36:39], a[124:127], a[100:103], a[36:39]
s_add_u32 s43, s38, 73856
buffer_load_dwordx4 v8, s[24:27], s43 offen offset:3072 lds
v_mfma_f32_16x16x32_bf16 a[84:87], a[120:123], a[144:147], 0
ds_read_b64_tr_b16 a[82:83], v31 offset:29696
v_permlane16_swap_b32 v14, v12
v_mfma_f32_16x16x32_bf16 a[84:87], a[124:127], a[148:151], a[84:87]
v_mov_b32 v15, v14
s_waitcnt lgkmcnt(4)
v_mfma_f32_16x16x32_bf16 a[172:175], a[168:171], a[8:11], a[172:175]
ds_read_b64_tr_b16 a[128:129], v24 offset:6144
v_mov_b32 v30, v12
v_mfma_f32_16x16x32_bf16 a[172:175], a[236:239], a[192:195], a[172:175]
v_permlane32_swap_b32 v14, v15
v_mul_f32 v116, v116, v14
v_mfma_f32_16x16x32_bf16 a[32:35], a[168:171], a[56:59], a[32:35]
ds_read_b64_tr_b16 a[130:131], v24 offset:30720
v_permlane32_swap_b32 v12, v30
v_mfma_f32_16x16x32_bf16 a[32:35], a[236:239], a[196:199], a[32:35]
v_mul_f32 v117, v117, v14
v_mul_f32 v118, v118, v14
v_mfma_f32_16x16x32_bf16 a[36:39], a[168:171], a[104:107], a[36:39]
ds_read_b64_tr_b16 a[132:133], v24 offset:7168
v_mul_f32 v119, v119, v14
v_mfma_f32_16x16x32_bf16 a[36:39], a[236:239], a[200:203], a[36:39]
v_cvt_pk_bf16_f32 v252, v116, v117
v_cvt_pk_bf16_f32 v124, v72, v73
v_mfma_f32_16x16x32_bf16 a[84:87], a[168:171], a[152:155], a[84:87]
ds_read_b64_tr_b16 a[134:135], v24 offset:31744
v_cvt_pk_bf16_f32 v125, v74, v75
v_mfma_f32_16x16x32_bf16 a[84:87], a[236:239], a[208:211], a[84:87]
v_cvt_pk_bf16_f32 v126, v140, v141
s_waitcnt lgkmcnt(4)
v_mfma_f32_16x16x32_bf16 a[172:175], a[244:247], a[204:207], a[172:175]
ds_read_b64_tr_b16 a[176:177], v31 offset:8
v_cvt_pk_bf16_f32 v127, v142, v143
v_mfma_f32_16x16x32_bf16 a[172:175], a[80:83], a[228:231], a[172:175]
v_cvt_pk_bf16_f32 v212, v180, v181
v_cvt_pk_bf16_f32 v213, v182, v183
v_mfma_f32_16x16x32_bf16 a[32:35], a[244:247], a[212:215], a[32:35]
ds_read_b64_tr_b16 a[178:179], v31 offset:24584
v_cvt_pk_bf16_f32 v214, v64, v65
v_mfma_f32_16x16x32_bf16 a[32:35], a[80:83], a[240:243], a[32:35]
v_cvt_pk_bf16_f32 v215, v66, v67
v_cvt_pk_bf16_f32 v253, v118, v119
v_mfma_f32_16x16x32_bf16 a[36:39], a[244:247], a[216:219], a[36:39]
ds_read_b64_tr_b16 a[12:13], v31 offset:1032
s_add_u32 m0, s39, 4096
v_mfma_f32_16x16x32_bf16 a[36:39], a[80:83], v[120:123], a[36:39]
s_add_u32 s42, s38, 101504
buffer_load_dwordx4 v8, s[24:27], s42 offen offset:0 lds
v_mfma_f32_16x16x32_bf16 a[84:87], a[244:247], a[220:223], a[84:87]
ds_read_b64_tr_b16 a[14:15], v31 offset:25608
v_mul_f32 v108, v108, v14
v_mfma_f32_16x16x32_bf16 a[84:87], a[80:83], v[92:95], a[84:87]
v_mul_f32 v109, v109, v14
s_waitcnt lgkmcnt(4)
v_mfma_f32_16x16x32_bf16 a[172:175], a[128:131], v[172:175], a[172:175]
ds_read_b64_tr_b16 a[180:181], v31 offset:2056
v_mul_f32 v110, v110, v14
v_mfma_f32_16x16x32_bf16 a[172:175], a[132:135], v[104:107], a[172:175]
v_mul_f32 v111, v111, v14
v_cvt_pk_bf16_f32 v254, v108, v109
v_mfma_f32_16x16x32_bf16 a[32:35], a[128:131], v[168:171], a[32:35]
ds_read_b64_tr_b16 a[182:183], v31 offset:26632
v_cvt_pk_bf16_f32 v255, v110, v111
v_mfma_f32_16x16x32_bf16 a[32:35], a[132:135], v[164:167], a[32:35]
s_add_u32 s43, s38, 125056
buffer_load_dwordx4 v8, s[24:27], s43 offen offset:1024 lds
v_mfma_f32_16x16x32_bf16 a[36:39], a[128:131], v[40:43], a[36:39]
ds_read_b64_tr_b16 a[60:61], v31 offset:3080
v_mul_f32 v36, v36, v14
v_mfma_f32_16x16x32_bf16 a[36:39], a[132:135], v[188:191], a[36:39]
v_mul_f32 v37, v37, v14
v_mul_f32 v38, v38, v14
v_mfma_f32_16x16x32_bf16 a[84:87], a[128:131], v[44:47], a[84:87]
ds_read_b64_tr_b16 a[62:63], v31 offset:27656
v_mul_f32 v39, v39, v14
v_mfma_f32_16x16x32_bf16 a[84:87], a[132:135], v[88:91], a[84:87]
v_cvt_pk_bf16_f32 v156, v36, v37
s_waitcnt lgkmcnt(4)
v_mfma_f32_16x16x32_bf16 a[40:43], a[176:179], a[0:3], 0
ds_read_b64_tr_b16 a[44:45], v31 offset:4104
v_cvt_pk_bf16_f32 v157, v38, v39
v_mfma_f32_16x16x32_bf16 a[40:43], a[12:15], a[4:7], a[40:43]
s_add_u32 m0, s39, 55296
s_add_u32 s42, s38, 150656
v_mfma_f32_16x16x32_bf16 a[88:91], a[176:179], a[48:51], 0
ds_read_b64_tr_b16 a[46:47], v31 offset:28680
buffer_load_dwordx4 v8, s[24:27], s42 offen offset:0 lds
v_mfma_f32_16x16x32_bf16 a[88:91], a[12:15], a[52:55], a[88:91]
v_mul_f32 v152, v152, v14
v_mul_f32 v153, v153, v14
v_mfma_f32_16x16x32_bf16 a[92:95], a[176:179], a[96:99], 0
ds_read_b64_tr_b16 a[136:137], v31 offset:5128
v_mul_f32 v154, v154, v14
v_mfma_f32_16x16x32_bf16 a[92:95], a[12:15], a[100:103], a[92:95]
v_mul_f32 v155, v155, v14
v_cvt_pk_bf16_f32 v158, v152, v153
v_mfma_f32_16x16x32_bf16 a[140:143], a[176:179], a[144:147], 0
ds_read_b64_tr_b16 a[138:139], v31 offset:29704
v_cvt_pk_bf16_f32 v159, v154, v155
v_mfma_f32_16x16x32_bf16 a[140:143], a[12:15], a[148:151], a[140:143]
s_add_u32 s43, s38, 174208
s_waitcnt lgkmcnt(4)
v_mfma_f32_16x16x32_bf16 a[40:43], a[180:183], a[8:11], a[40:43]
ds_read_b64_tr_b16 a[184:185], v24 offset:6152
buffer_load_dwordx4 v8, s[24:27], s43 offen offset:1024 lds
v_mfma_f32_16x16x32_bf16 a[40:43], a[60:63], a[192:195], a[40:43]
v_mul_f32 v236, v236, v15
v_mul_f32 v237, v237, v15
v_mfma_f32_16x16x32_bf16 a[88:91], a[180:183], a[56:59], a[88:91]
ds_read_b64_tr_b16 a[186:187], v24 offset:30728
v_mul_f32 v238, v238, v15
v_mfma_f32_16x16x32_bf16 a[88:91], a[60:63], a[196:199], a[88:91]
v_mul_f32 v239, v239, v15
v_cvt_pk_bf16_f32 v72, v236, v237
v_mfma_f32_16x16x32_bf16 a[92:95], a[180:183], a[104:107], a[92:95]
ds_read_b64_tr_b16 a[108:109], v24 offset:7176
v_cvt_pk_bf16_f32 v73, v238, v239
v_mfma_f32_16x16x32_bf16 a[92:95], a[60:63], a[200:203], a[92:95]
s_add_u32 s42, s38, 197760
buffer_load_dwordx4 v8, s[24:27], s42 offen offset:2048 lds
v_mfma_f32_16x16x32_bf16 a[140:143], a[180:183], a[152:155], a[140:143]
ds_read_b64_tr_b16 a[110:111], v24 offset:31752
v_mul_f32 v148, v148, v15
v_mfma_f32_16x16x32_bf16 a[140:143], a[60:63], a[208:211], a[140:143]
v_mul_f32 v149, v149, v15
s_waitcnt lgkmcnt(4)
v_mfma_f32_16x16x32_bf16 a[40:43], a[44:47], a[204:207], a[40:43]
ds_read_b64_tr_b16 a[188:189], v28 offset:8192
v_mul_f32 v150, v150, v15
v_mfma_f32_16x16x32_bf16 a[40:43], a[136:139], a[228:231], a[40:43]
v_mul_f32 v151, v151, v15
v_cvt_pk_bf16_f32 v74, v148, v149
v_mfma_f32_16x16x32_bf16 a[88:91], a[44:47], a[212:215], a[88:91]
ds_read_b64_tr_b16 a[190:191], v28 offset:32768
v_cvt_pk_bf16_f32 v75, v150, v151
v_mfma_f32_16x16x32_bf16 a[88:91], a[136:139], a[240:243], a[88:91]
s_add_u32 s43, s38, 221312
buffer_load_dwordx4 v8, s[24:27], s43 offen offset:3072 lds
v_mfma_f32_16x16x32_bf16 a[92:95], a[44:47], a[216:219], a[92:95]
ds_read_b64_tr_b16 a[248:249], v28 offset:9216
v_mul_f32 v48, v48, v15
v_mfma_f32_16x16x32_bf16 a[92:95], a[136:139], v[120:123], a[92:95]
v_mul_f32 v49, v49, v15
v_mul_f32 v50, v50, v15
v_mfma_f32_16x16x32_bf16 a[140:143], a[44:47], a[220:223], a[140:143]
ds_read_b64_tr_b16 a[250:251], v28 offset:33792
v_mul_f32 v51, v51, v15
v_mfma_f32_16x16x32_bf16 a[140:143], a[136:139], v[92:95], a[140:143]
v_cvt_pk_bf16_f32 v140, v48, v49
s_waitcnt lgkmcnt(4)
v_mfma_f32_16x16x32_bf16 a[40:43], a[184:187], v[172:175], a[40:43]
ds_read_b64_tr_b16 a[156:157], v28 offset:10240
v_cvt_pk_bf16_f32 v141, v50, v51
v_mfma_f32_16x16x32_bf16 a[40:43], a[108:111], v[104:107], a[40:43]
s_add_u32 m0, s39, 59392
s_add_u32 s42, s38, 248960
v_mfma_f32_16x16x32_bf16 a[88:91], a[184:187], v[168:171], a[88:91]
ds_read_b64_tr_b16 a[158:159], v28 offset:34816
buffer_load_dwordx4 v8, s[24:27], s42 offen offset:0 lds
v_mfma_f32_16x16x32_bf16 a[88:91], a[108:111], v[164:167], a[88:91]
v_mul_f32 v68, v68, v15
v_mul_f32 v69, v69, v15
v_mfma_f32_16x16x32_bf16 a[92:95], a[184:187], v[40:43], a[92:95]
ds_read_b64_tr_b16 a[252:253], v28 offset:11264
v_mul_f32 v70, v70, v15
v_mfma_f32_16x16x32_bf16 a[92:95], a[108:111], v[188:191], a[92:95]
v_mul_f32 v71, v71, v15
v_cvt_pk_bf16_f32 v142, v68, v69
v_mfma_f32_16x16x32_bf16 a[140:143], a[184:187], v[44:47], a[140:143]
ds_read_b64_tr_b16 a[254:255], v28 offset:35840
v_cvt_pk_bf16_f32 v143, v70, v71
v_mfma_f32_16x16x32_bf16 a[140:143], a[108:111], v[88:91], a[140:143]
s_add_u32 s43, s38, 272512
buffer_load_dwordx4 v8, s[24:27], s43 offen offset:1024 lds
v_mfma_f32_16x16x32_bf16 v[180:183], v[176:179], v[252:255], 0
v_mul_f32 v208, v208, v12
v_mul_f32 v209, v209, v12
v_mfma_f32_16x16x32_bf16 v[180:183], v[160:163], v[156:159], v[180:183]
v_mul_f32 v210, v210, v12
v_mul_f32 v211, v211, v12
v_mfma_f32_16x16x32_bf16 v[64:67], v[176:179], v[72:75], 0
v_cvt_pk_bf16_f32 v116, v208, v209
v_cvt_pk_bf16_f32 v117, v210, v211
v_mfma_f32_16x16x32_bf16 v[64:67], v[160:163], v[140:143], v[64:67]
v_mul_f32 v240, v240, v12
v_mul_f32 v241, v241, v12
v_cvt_pk_bf16_f32 v118, v240, v241
v_mul_f32 v242, v242, v12
v_mul_f32 v243, v243, v12
v_cvt_pk_bf16_f32 v119, v242, v243
s_nop 1
v_mfma_f32_16x16x32_bf16 v[108:111], v[176:179], v[116:119], 0
v_mul_f32 v52, v52, v12
v_mul_f32 v53, v53, v12
v_cvt_pk_bf16_f32 v36, v52, v53
v_mul_f32 v54, v54, v12
v_mul_f32 v55, v55, v12
v_cvt_pk_bf16_f32 v37, v54, v55
v_mul_f32 v136, v136, v12
v_mul_f32 v137, v137, v12
v_cvt_pk_bf16_f32 v38, v136, v137
v_mul_f32 v138, v138, v12
v_mul_f32 v139, v139, v12
v_cvt_pk_bf16_f32 v39, v138, v139
s_nop 1
v_mfma_f32_16x16x32_bf16 v[108:111], v[160:163], v[36:39], v[108:111]
v_mul_f32 v32, v32, v30
v_mul_f32 v33, v33, v30
v_cvt_pk_bf16_f32 v152, v32, v33
v_mul_f32 v34, v34, v30
v_mul_f32 v35, v35, v30
v_cvt_pk_bf16_f32 v153, v34, v35
v_mul_f32 v248, v248, v30
v_mul_f32 v249, v249, v30
v_cvt_pk_bf16_f32 v154, v248, v249
v_mul_f32 v250, v250, v30
v_mul_f32 v251, v251, v30
v_cvt_pk_bf16_f32 v155, v250, v251
s_nop 1
v_mfma_f32_16x16x32_bf16 v[236:239], v[176:179], v[152:155], 0
v_mul_f32 v80, v80, v30
v_mul_f32 v81, v81, v30
v_cvt_pk_bf16_f32 v148, v80, v81
v_mul_f32 v82, v82, v30
v_mul_f32 v83, v83, v30
v_cvt_pk_bf16_f32 v149, v82, v83
v_mul_f32 v96, v96, v30
v_mul_f32 v97, v97, v30
v_cvt_pk_bf16_f32 v150, v96, v97
v_mul_f32 v98, v98, v30
v_mul_f32 v99, v99, v30
v_cvt_pk_bf16_f32 v151, v98, v99
s_nop 1
v_mfma_f32_16x16x32_bf16 v[236:239], v[160:163], v[148:151], v[236:239]
v_mfma_f32_16x16x32_bf16 v[48:51], v[128:131], v[252:255], 0
v_cvt_pk_bf16_f32 v68, v180, v181
v_mfma_f32_16x16x32_bf16 v[48:51], v[200:203], v[156:159], v[48:51]
v_cvt_pk_bf16_f32 v69, v182, v183
v_mfma_f32_16x16x32_bf16 v[208:211], v[128:131], v[72:75], 0
v_cvt_pk_bf16_f32 v240, v64, v65
v_mfma_f32_16x16x32_bf16 v[208:211], v[200:203], v[140:143], v[208:211]
v_cvt_pk_bf16_f32 v241, v66, v67
v_mfma_f32_16x16x32_bf16 v[52:55], v[128:131], v[116:119], 0
v_cvt_pk_bf16_f32 v136, v108, v109
v_mfma_f32_16x16x32_bf16 v[52:55], v[200:203], v[36:39], v[52:55]
v_cvt_pk_bf16_f32 v137, v110, v111
v_mfma_f32_16x16x32_bf16 v[32:35], v[128:131], v[152:155], 0
v_cvt_pk_bf16_f32 v248, v236, v237
v_mfma_f32_16x16x32_bf16 v[32:35], v[200:203], v[148:151], v[32:35]
v_cvt_pk_bf16_f32 v249, v238, v239
v_mfma_f32_16x16x32_bf16 v[176:179], v[228:231], v[252:255], 0
v_cvt_pk_bf16_f32 v70, v48, v49
v_mfma_f32_16x16x32_bf16 v[176:179], v[60:63], v[156:159], v[176:179]
v_cvt_pk_bf16_f32 v71, v50, v51
v_mfma_f32_16x16x32_bf16 v[80:83], v[228:231], v[72:75], 0
v_cvt_pk_bf16_f32 v242, v208, v209
v_mfma_f32_16x16x32_bf16 v[80:83], v[60:63], v[140:143], v[80:83]
v_cvt_pk_bf16_f32 v243, v210, v211
v_mfma_f32_16x16x32_bf16 v[96:99], v[228:231], v[116:119], 0
v_cvt_pk_bf16_f32 v138, v52, v53
v_mfma_f32_16x16x32_bf16 v[96:99], v[60:63], v[36:39], v[96:99]
v_cvt_pk_bf16_f32 v139, v54, v55
v_mfma_f32_16x16x32_bf16 v[160:163], v[228:231], v[152:155], 0
v_cvt_pk_bf16_f32 v250, v32, v33
v_mfma_f32_16x16x32_bf16 v[160:163], v[60:63], v[148:151], v[160:163]
v_cvt_pk_bf16_f32 v251, v34, v35
v_mfma_f32_16x16x32_bf16 v[180:183], v[132:135], v[252:255], 0
v_cvt_pk_bf16_f32 v64, v176, v177
v_mfma_f32_16x16x32_bf16 v[180:183], v[224:227], v[156:159], v[180:183]
v_cvt_pk_bf16_f32 v65, v178, v179
v_mfma_f32_16x16x32_bf16 v[108:111], v[132:135], v[72:75], 0
v_cvt_pk_bf16_f32 v128, v80, v81
v_mfma_f32_16x16x32_bf16 v[108:111], v[224:227], v[140:143], v[108:111]
v_cvt_pk_bf16_f32 v129, v82, v83
v_mfma_f32_16x16x32_bf16 v[200:203], v[132:135], v[116:119], 0
v_cvt_pk_bf16_f32 v236, v96, v97
v_mfma_f32_16x16x32_bf16 v[200:203], v[224:227], v[36:39], v[200:203]
v_cvt_pk_bf16_f32 v237, v98, v99
v_mfma_f32_16x16x32_bf16 v[48:51], v[132:135], v[152:155], 0
v_cvt_pk_bf16_f32 v208, v160, v161
v_mfma_f32_16x16x32_bf16 v[48:51], v[224:227], v[148:151], v[48:51]
v_cvt_pk_bf16_f32 v209, v162, v163
v_mfma_f32_16x16x32_bf16 v[52:55], v[196:199], v[252:255], 0
v_cvt_pk_bf16_f32 v66, v180, v181
v_mfma_f32_16x16x32_bf16 v[52:55], v[184:187], v[156:159], v[52:55]
v_cvt_pk_bf16_f32 v67, v182, v183
v_mfma_f32_16x16x32_bf16 v[228:231], v[196:199], v[72:75], 0
v_cvt_pk_bf16_f32 v130, v108, v109
v_mfma_f32_16x16x32_bf16 v[228:231], v[184:187], v[140:143], v[228:231]
v_cvt_pk_bf16_f32 v131, v110, v111
v_mfma_f32_16x16x32_bf16 v[60:63], v[196:199], v[116:119], 0
v_cvt_pk_bf16_f32 v238, v200, v201
v_mfma_f32_16x16x32_bf16 v[60:63], v[184:187], v[36:39], v[60:63]
v_cvt_pk_bf16_f32 v239, v202, v203
v_mfma_f32_16x16x32_bf16 v[32:35], v[196:199], v[152:155], 0
v_cvt_pk_bf16_f32 v210, v48, v49
v_mfma_f32_16x16x32_bf16 v[32:35], v[184:187], v[148:151], v[32:35]
v_cvt_pk_bf16_f32 v211, v50, v51
v_mfma_f32_16x16x32_bf16 v[176:179], v[124:127], v[252:255], 0
v_cvt_pk_bf16_f32 v80, v52, v53
v_mfma_f32_16x16x32_bf16 v[176:179], v[212:215], v[156:159], v[176:179]
v_cvt_pk_bf16_f32 v81, v54, v55
v_mfma_f32_16x16x32_bf16 v[96:99], v[124:127], v[72:75], 0
v_cvt_pk_bf16_f32 v132, v228, v229
v_mfma_f32_16x16x32_bf16 v[96:99], v[212:215], v[140:143], v[96:99]
v_cvt_pk_bf16_f32 v133, v230, v231
v_mfma_f32_16x16x32_bf16 v[224:227], v[124:127], v[116:119], 0
v_cvt_pk_bf16_f32 v160, v60, v61
v_mfma_f32_16x16x32_bf16 v[224:227], v[212:215], v[36:39], v[224:227]
v_cvt_pk_bf16_f32 v161, v62, v63
v_mfma_f32_16x16x32_bf16 v[180:183], v[124:127], v[152:155], 0
v_cvt_pk_bf16_f32 v108, v32, v33
v_mfma_f32_16x16x32_bf16 v[180:183], v[212:215], v[148:151], v[180:183]
s_waitcnt lgkmcnt(4)
v_mfma_f32_16x16x32_bf16 v[220:223], a[188:191], v[84:87], v[220:223]
ds_read_b64_tr_b16 a[16:17], v28 offset:8200
v_cvt_pk_bf16_f32 v82, v176, v177
v_mfma_f32_16x16x32_bf16 v[220:223], a[248:251], v[68:71], v[220:223]
v_cvt_pk_bf16_f32 v83, v178, v179
v_mfma_f32_16x16x32_bf16 v[216:219], a[188:191], v[204:207], v[216:219]
ds_read_b64_tr_b16 a[18:19], v28 offset:32776
v_cvt_pk_bf16_f32 v134, v96, v97
v_mfma_f32_16x16x32_bf16 v[216:219], a[248:251], v[240:243], v[216:219]
v_cvt_pk_bf16_f32 v135, v98, v99
v_mfma_f32_16x16x32_bf16 v[144:147], a[188:191], v[100:103], v[144:147]
ds_read_b64_tr_b16 a[20:21], v28 offset:9224
v_cvt_pk_bf16_f32 v162, v224, v225
v_mfma_f32_16x16x32_bf16 v[144:147], a[248:251], v[136:139], v[144:147]
v_cvt_pk_bf16_f32 v163, v226, v227
v_mfma_f32_16x16x32_bf16 v[244:247], a[188:191], v[232:235], v[244:247]
ds_read_b64_tr_b16 a[22:23], v28 offset:33800
v_cvt_pk_bf16_f32 v109, v34, v35
v_mfma_f32_16x16x32_bf16 v[244:247], a[248:251], v[248:251], v[244:247]
v_cvt_pk_bf16_f32 v110, v180, v181
s_waitcnt lgkmcnt(4)
v_mfma_f32_16x16x32_bf16 v[220:223], a[156:159], v[64:67], v[220:223]
ds_read_b64_tr_b16 a[64:65], v28 offset:10248
v_mfma_f32_16x16x32_bf16 v[220:223], a[252:255], v[80:83], v[220:223]
v_cvt_pk_bf16_f32 v111, v182, v183
v_mfma_f32_16x16x32_bf16 v[216:219], a[156:159], v[128:131], v[216:219]
ds_read_b64_tr_b16 a[66:67], v28 offset:34824
v_mfma_f32_16x16x32_bf16 v[216:219], a[252:255], v[132:135], v[216:219]
v_and_b32 v4, 7, v1
v_mfma_f32_16x16x32_bf16 v[144:147], a[156:159], v[236:239], v[144:147]
ds_read_b64_tr_b16 a[68:69], v28 offset:11272
v_mfma_f32_16x16x32_bf16 v[144:147], a[252:255], v[160:163], v[144:147]
s_lshl_b32 s41, s14, 3
v_mfma_f32_16x16x32_bf16 v[244:247], a[156:159], v[208:211], v[244:247]
ds_read_b64_tr_b16 a[70:71], v28 offset:35848
v_mfma_f32_16x16x32_bf16 v[244:247], a[252:255], v[108:111], v[244:247]
s_waitcnt lgkmcnt(4)
v_mfma_f32_16x16x32_bf16 v[112:115], a[16:19], v[84:87], v[112:115]
ds_read_b64_tr_b16 a[112:113], v24 offset:8192
v_mfma_f32_16x16x32_bf16 v[112:115], a[20:23], v[68:71], v[112:115]
v_cvt_pk_bf16_f32 v200, v220, v221
v_mfma_f32_16x16x32_bf16 v[192:195], a[16:19], v[204:207], v[192:195]
ds_read_b64_tr_b16 a[114:115], v24 offset:32768
v_cvt_pk_bf16_f32 v201, v222, v223
v_mfma_f32_16x16x32_bf16 v[192:195], a[20:23], v[240:243], v[192:195]
v_cvt_pk_bf16_f32 v196, v216, v217
v_mfma_f32_16x16x32_bf16 v[56:59], a[16:19], v[100:103], v[56:59]
ds_read_b64_tr_b16 a[116:117], v24 offset:9216
v_cvt_pk_bf16_f32 v197, v218, v219
v_mfma_f32_16x16x32_bf16 v[56:59], a[20:23], v[136:139], v[56:59]
v_cvt_pk_bf16_f32 v184, v144, v145
v_mfma_f32_16x16x32_bf16 v[76:79], a[16:19], v[232:235], v[76:79]
ds_read_b64_tr_b16 a[118:119], v24 offset:33792
v_cvt_pk_bf16_f32 v185, v146, v147
v_mfma_f32_16x16x32_bf16 v[76:79], a[20:23], v[248:251], v[76:79]
s_waitcnt lgkmcnt(4)
v_mfma_f32_16x16x32_bf16 v[112:115], a[64:67], v[64:67], v[112:115]
ds_read_b64_tr_b16 a[160:161], v24 offset:10240
v_mfma_f32_16x16x32_bf16 v[112:115], a[68:71], v[80:83], v[112:115]
v_cvt_pk_bf16_f32 v48, v244, v245
v_mfma_f32_16x16x32_bf16 v[192:195], a[64:67], v[128:131], v[192:195]
ds_read_b64_tr_b16 a[162:163], v24 offset:34816
v_mfma_f32_16x16x32_bf16 v[192:195], a[68:71], v[132:135], v[192:195]
v_cvt_pk_bf16_f32 v49, v246, v247
v_mfma_f32_16x16x32_bf16 v[56:59], a[64:67], v[236:239], v[56:59]
ds_read_b64_tr_b16 a[224:225], v24 offset:11264
v_mfma_f32_16x16x32_bf16 v[56:59], a[68:71], v[160:163], v[56:59]
s_add_u32 s41, s41, 4
v_mfma_f32_16x16x32_bf16 v[76:79], a[64:67], v[208:211], v[76:79]
ds_read_b64_tr_b16 a[226:227], v24 offset:35840
v_mfma_f32_16x16x32_bf16 v[76:79], a[68:71], v[108:111], v[76:79]
s_waitcnt lgkmcnt(4)
v_mfma_f32_16x16x32_bf16 a[172:175], a[112:115], v[84:87], a[172:175]
ds_read_b64_tr_b16 a[164:165], v24 offset:8200
v_mfma_f32_16x16x32_bf16 a[172:175], a[116:119], v[68:71], a[172:175]
v_cvt_pk_bf16_f32 v202, v112, v113
v_mfma_f32_16x16x32_bf16 a[32:35], a[112:115], v[204:207], a[32:35]
ds_read_b64_tr_b16 a[166:167], v24 offset:32776
v_cvt_pk_bf16_f32 v203, v114, v115
v_mfma_f32_16x16x32_bf16 a[32:35], a[116:119], v[240:243], a[32:35]
v_cvt_pk_bf16_f32 v198, v192, v193
v_mfma_f32_16x16x32_bf16 a[36:39], a[112:115], v[100:103], a[36:39]
ds_read_b64_tr_b16 a[232:233], v24 offset:9224
v_cvt_pk_bf16_f32 v199, v194, v195
v_mfma_f32_16x16x32_bf16 a[36:39], a[116:119], v[136:139], a[36:39]
v_cvt_pk_bf16_f32 v186, v56, v57
v_mfma_f32_16x16x32_bf16 a[84:87], a[112:115], v[232:235], a[84:87]
ds_read_b64_tr_b16 a[234:235], v24 offset:33800
v_cvt_pk_bf16_f32 v187, v58, v59
v_mfma_f32_16x16x32_bf16 a[84:87], a[116:119], v[248:251], a[84:87]
s_waitcnt lgkmcnt(4)
v_mfma_f32_16x16x32_bf16 a[172:175], a[160:163], v[64:67], a[172:175]
ds_read_b64_tr_b16 a[24:25], v24 offset:10248
v_mfma_f32_16x16x32_bf16 a[172:175], a[224:227], v[80:83], a[172:175]
v_cvt_pk_bf16_f32 v50, v76, v77
v_mfma_f32_16x16x32_bf16 a[32:35], a[160:163], v[128:131], a[32:35]
ds_read_b64_tr_b16 a[26:27], v24 offset:34824
v_mfma_f32_16x16x32_bf16 a[32:35], a[224:227], v[132:135], a[32:35]
v_cvt_pk_bf16_f32 v51, v78, v79
v_mfma_f32_16x16x32_bf16 a[36:39], a[160:163], v[236:239], a[36:39]
ds_read_b64_tr_b16 a[28:29], v24 offset:11272
v_mfma_f32_16x16x32_bf16 a[36:39], a[224:227], v[160:163], a[36:39]
v_add_u32 v4, s41, v4
v_mfma_f32_16x16x32_bf16 a[84:87], a[160:163], v[208:211], a[84:87]
ds_read_b64_tr_b16 a[30:31], v24 offset:35848
v_mfma_f32_16x16x32_bf16 a[84:87], a[224:227], v[108:111], a[84:87]
s_waitcnt lgkmcnt(4)
v_mfma_f32_16x16x32_bf16 a[40:43], a[164:167], v[84:87], a[40:43]
v_accvgpr_read_b32 v252, a172
v_accvgpr_read_b32 v253, a173
v_mfma_f32_16x16x32_bf16 a[40:43], a[232:235], v[68:71], a[40:43]
v_accvgpr_read_b32 v254, a174
v_accvgpr_read_b32 v255, a175
v_mfma_f32_16x16x32_bf16 a[88:91], a[164:167], v[204:207], a[88:91]
v_accvgpr_read_b32 v156, a32
v_accvgpr_read_b32 v157, a33
v_mfma_f32_16x16x32_bf16 a[88:91], a[232:235], v[240:243], a[88:91]
s_waitcnt vmcnt(0) lgkmcnt(0)
s_barrier
v_mfma_f32_16x16x32_bf16 a[92:95], a[164:167], v[100:103], a[92:95]
ds_read_b64_tr_b16 a[72:73], v28 offset:0
s_add_u32 m0, s39, 49152
v_mfma_f32_16x16x32_bf16 a[92:95], a[232:235], v[136:139], a[92:95]
ds_read_b64_tr_b16 a[74:75], v28 offset:24576
s_add_u32 s42, s38, 3328
v_mfma_f32_16x16x32_bf16 a[140:143], a[164:167], v[232:235], a[140:143]
buffer_load_dwordx4 v8, s[24:27], s42 offen offset:0 lds
v_accvgpr_read_b32 v158, a34
v_mfma_f32_16x16x32_bf16 a[140:143], a[232:235], v[248:251], a[140:143]
ds_read_b64_tr_b16 a[76:77], v28 offset:1024
v_mfma_f32_16x16x32_bf16 a[40:43], a[24:27], v[64:67], a[40:43]
ds_read_b64_tr_b16 a[120:121], v28 offset:2048
v_accvgpr_read_b32 v159, a35
v_mfma_f32_16x16x32_bf16 a[40:43], a[28:31], v[80:83], a[40:43]
ds_read_b64_tr_b16 a[78:79], v28 offset:25600
v_accvgpr_read_b32 v52, a36
v_mfma_f32_16x16x32_bf16 a[88:91], a[24:27], v[128:131], a[88:91]
ds_read_b64_tr_b16 a[122:123], v28 offset:26624
s_add_u32 s43, s38, 26880
v_mfma_f32_16x16x32_bf16 a[88:91], a[28:31], v[132:135], a[88:91]
buffer_load_dwordx4 v8, s[24:27], s43 offen offset:1024 lds
v_accvgpr_read_b32 v53, a37
v_mfma_f32_16x16x32_bf16 a[92:95], a[24:27], v[236:239], a[92:95]
ds_read_b64_tr_b16 a[124:125], v28 offset:3072
v_accvgpr_read_b32 v54, a38
v_mfma_f32_16x16x32_bf16 a[92:95], a[28:31], v[160:163], a[92:95]
v_accvgpr_read_b32 v55, a39
v_accvgpr_read_b32 v72, a84
v_mfma_f32_16x16x32_bf16 a[140:143], a[24:27], v[208:211], a[140:143]
ds_read_b64_tr_b16 a[126:127], v28 offset:27648
v_accvgpr_read_b32 v73, a85
v_mfma_f32_16x16x32_bf16 a[140:143], a[28:31], v[108:111], a[140:143]
v_accvgpr_read_b32 v74, a86
s_waitcnt lgkmcnt(3)
v_mfma_f32_16x16x32_bf16 v[140:143], a[72:75], a[0:3], 0
ds_read_b64_tr_b16 a[168:169], v28 offset:4096
v_accvgpr_read_b32 v75, a87
v_mfma_f32_16x16x32_bf16 v[140:143], a[76:79], a[4:7], v[140:143]
v_cvt_pk_bf16_f32 v228, v252, v253
v_cvt_pk_bf16_f32 v229, v254, v255
v_mfma_f32_16x16x32_bf16 v[116:119], a[72:75], a[48:51], 0
ds_read_b64_tr_b16 a[170:171], v28 offset:28672
v_cvt_pk_bf16_f32 v36, v156, v157
v_mfma_f32_16x16x32_bf16 v[116:119], a[76:79], a[52:55], v[116:119]
v_cvt_pk_bf16_f32 v37, v158, v159
v_cvt_pk_bf16_f32 v60, v52, v53
v_mfma_f32_16x16x32_bf16 v[124:127], a[72:75], a[96:99], 0
ds_read_b64_tr_b16 a[236:237], v28 offset:5120
v_cvt_pk_bf16_f32 v61, v54, v55
v_mfma_f32_16x16x32_bf16 v[124:127], a[76:79], a[100:103], v[124:127]
v_cvt_pk_bf16_f32 v152, v72, v73
v_cvt_pk_bf16_f32 v153, v74, v75
v_mfma_f32_16x16x32_bf16 v[212:215], a[72:75], a[144:147], 0
ds_read_b64_tr_b16 a[238:239], v28 offset:29696
s_add_u32 s42, s38, 50432
v_mfma_f32_16x16x32_bf16 v[212:215], a[76:79], a[148:151], v[212:215]
buffer_load_dwordx4 v8, s[24:27], s42 offen offset:2048 lds
s_waitcnt lgkmcnt(4)
v_mfma_f32_16x16x32_bf16 v[140:143], a[120:123], a[8:11], v[140:143]
ds_read_b64_tr_b16 a[244:245], v26 offset:6144
s_add_u32 s43, s38, 73984
v_mfma_f32_16x16x32_bf16 v[140:143], a[124:127], a[192:195], v[140:143]
buffer_load_dwordx4 v8, s[24:27], s43 offen offset:3072 lds
v_accvgpr_read_b32 v148, a40
v_mfma_f32_16x16x32_bf16 v[116:119], a[120:123], a[56:59], v[116:119]
ds_read_b64_tr_b16 a[246:247], v26 offset:30720
v_accvgpr_read_b32 v149, a41
v_mfma_f32_16x16x32_bf16 v[116:119], a[124:127], a[196:199], v[116:119]
v_accvgpr_read_b32 v150, a42
v_accvgpr_read_b32 v151, a43
v_mfma_f32_16x16x32_bf16 v[124:127], a[120:123], a[104:107], v[124:127]
ds_read_b64_tr_b16 a[80:81], v26 offset:7168
v_accvgpr_read_b32 v176, a88
v_mfma_f32_16x16x32_bf16 v[124:127], a[124:127], a[200:203], v[124:127]
v_accvgpr_read_b32 v177, a89
v_accvgpr_read_b32 v178, a90
v_mfma_f32_16x16x32_bf16 v[212:215], a[120:123], a[152:155], v[212:215]
ds_read_b64_tr_b16 a[82:83], v26 offset:31744
v_accvgpr_read_b32 v179, a91
v_mfma_f32_16x16x32_bf16 v[212:215], a[124:127], a[208:211], v[212:215]
v_accvgpr_read_b32 v96, a92
s_waitcnt lgkmcnt(4)
v_mfma_f32_16x16x32_bf16 v[140:143], a[168:171], a[204:207], v[140:143]
ds_read_b64_tr_b16 a[128:129], v26 offset:8192
v_accvgpr_read_b32 v97, a93
v_mfma_f32_16x16x32_bf16 v[140:143], a[236:239], a[228:231], v[140:143]
v_accvgpr_read_b32 v98, a94
v_accvgpr_read_b32 v99, a95
v_mfma_f32_16x16x32_bf16 v[116:119], a[168:171], a[212:215], v[116:119]
ds_read_b64_tr_b16 a[130:131], v26 offset:32768
v_accvgpr_read_b32 v224, a140
v_mfma_f32_16x16x32_bf16 v[116:119], a[236:239], a[240:243], v[116:119]
v_accvgpr_read_b32 v225, a141
v_accvgpr_read_b32 v226, a142
v_mfma_f32_16x16x32_bf16 v[124:127], a[168:171], a[216:219], v[124:127]
ds_read_b64_tr_b16 a[132:133], v26 offset:9216
v_accvgpr_read_b32 v227, a143
v_mfma_f32_16x16x32_bf16 v[124:127], a[236:239], v[120:123], v[124:127]
v_cvt_pk_bf16_f32 v230, v148, v149
v_cvt_pk_bf16_f32 v231, v150, v151
v_mfma_f32_16x16x32_bf16 v[212:215], a[168:171], a[220:223], v[212:215]
ds_read_b64_tr_b16 a[134:135], v26 offset:33792
v_cvt_pk_bf16_f32 v38, v176, v177
v_mfma_f32_16x16x32_bf16 v[212:215], a[236:239], v[92:95], v[212:215]
v_cvt_pk_bf16_f32 v39, v178, v179
s_waitcnt lgkmcnt(4)
v_mfma_f32_16x16x32_bf16 v[140:143], a[244:247], v[172:175], v[140:143]
ds_read_b64_tr_b16 a[176:177], v26 offset:10240
v_cvt_pk_bf16_f32 v62, v96, v97
v_mfma_f32_16x16x32_bf16 v[140:143], a[80:83], v[104:107], v[140:143]
v_cvt_pk_bf16_f32 v63, v98, v99
v_cvt_pk_bf16_f32 v154, v224, v225
v_mfma_f32_16x16x32_bf16 v[116:119], a[244:247], v[168:171], v[116:119]
ds_read_b64_tr_b16 a[178:179], v26 offset:34816
v_cvt_pk_bf16_f32 v155, v226, v227
v_mfma_f32_16x16x32_bf16 v[116:119], a[80:83], v[164:167], v[116:119]
s_add_u32 m0, s39, 53248
s_add_u32 s42, s38, 101632
v_mfma_f32_16x16x32_bf16 v[124:127], a[244:247], v[40:43], v[124:127]
ds_read_b64_tr_b16 a[12:13], v26 offset:11264
buffer_load_dwordx4 v8, s[24:27], s42 offen offset:0 lds
v_mfma_f32_16x16x32_bf16 v[124:127], a[80:83], v[188:191], v[124:127]
s_add_u32 s43, s38, 125184
buffer_load_dwordx4 v8, s[24:27], s43 offen offset:1024 lds
v_mfma_f32_16x16x32_bf16 v[212:215], a[244:247], v[44:47], v[212:215]
ds_read_b64_tr_b16 a[14:15], v26 offset:35840
s_add_u32 m0, s39, 6144
v_mfma_f32_16x16x32_bf16 v[212:215], a[80:83], v[88:91], v[212:215]
s_add_u32 s42, s38, 150784
s_waitcnt lgkmcnt(4)
v_mfma_f32_16x16x32_bf16 v[140:143], a[128:131], v[84:87], v[140:143]
ds_read_b64_tr_b16 a[180:181], v28 offset:8
buffer_load_dwordx4 v8, s[24:27], s42 offen offset:0 lds
v_mfma_f32_16x16x32_bf16 v[140:143], a[132:135], v[68:71], v[140:143]
s_add_u32 s43, s38, 174336
v_mfma_f32_16x16x32_bf16 v[116:119], a[128:131], v[204:207], v[116:119]
ds_read_b64_tr_b16 a[182:183], v28 offset:24584
v_mfma_f32_16x16x32_bf16 v[116:119], a[132:135], v[240:243], v[116:119]
buffer_load_dwordx4 v8, s[24:27], s43 offen offset:1024 lds
v_mfma_f32_16x16x32_bf16 v[124:127], a[128:131], v[100:103], v[124:127]
ds_read_b64_tr_b16 a[60:61], v28 offset:1032
v_mfma_f32_16x16x32_bf16 v[124:127], a[132:135], v[136:139], v[124:127]
s_add_u32 s42, s38, 197888
v_mfma_f32_16x16x32_bf16 v[212:215], a[128:131], v[232:235], v[212:215]
ds_read_b64_tr_b16 a[62:63], v28 offset:25608
v_mfma_f32_16x16x32_bf16 v[212:215], a[132:135], v[248:251], v[212:215]
s_waitcnt lgkmcnt(4)
v_mfma_f32_16x16x32_bf16 v[140:143], a[176:179], v[64:67], v[140:143]
ds_read_b64_tr_b16 a[44:45], v28 offset:2056
v_mfma_f32_16x16x32_bf16 v[140:143], a[12:15], v[80:83], v[140:143]
buffer_load_dwordx4 v8, s[24:27], s42 offen offset:2048 lds
v_mfma_f32_16x16x32_bf16 v[116:119], a[176:179], v[128:131], v[116:119]
ds_read_b64_tr_b16 a[46:47], v28 offset:26632
v_mfma_f32_16x16x32_bf16 v[116:119], a[12:15], v[132:135], v[116:119]
s_add_u32 s43, s38, 221440
v_mfma_f32_16x16x32_bf16 v[124:127], a[176:179], v[236:239], v[124:127]
ds_read_b64_tr_b16 a[136:137], v28 offset:3080
v_mfma_f32_16x16x32_bf16 v[124:127], a[12:15], v[160:163], v[124:127]
buffer_load_dwordx4 v8, s[24:27], s43 offen offset:3072 lds
v_mfma_f32_16x16x32_bf16 v[212:215], a[176:179], v[208:211], v[212:215]
ds_read_b64_tr_b16 a[138:139], v28 offset:27656
v_mfma_f32_16x16x32_bf16 v[212:215], a[12:15], v[108:111], v[212:215]
s_waitcnt lgkmcnt(4)
v_mfma_f32_16x16x32_bf16 v[32:35], a[180:183], a[0:3], 0
ds_read_b64_tr_b16 a[184:185], v28 offset:4104
s_add_u32 m0, s39, 10240
v_mfma_f32_16x16x32_bf16 v[32:35], a[60:63], a[4:7], v[32:35]
s_add_u32 s42, s38, 249088
buffer_load_dwordx4 v8, s[24:27], s42 offen offset:0 lds
v_mfma_f32_16x16x32_bf16 v[180:183], a[180:183], a[48:51], 0
ds_read_b64_tr_b16 a[186:187], v28 offset:28680
v_and_b32 v4, 255, v4
v_mfma_f32_16x16x32_bf16 v[180:183], a[60:63], a[52:55], v[180:183]
v_mul_u32_u24 v4, 768, v4
v_lshrrev_b32 v11, 4, v1
v_mfma_f32_16x16x32_bf16 v[220:223], a[180:183], a[96:99], 0
ds_read_b64_tr_b16 a[108:109], v28 offset:5128
v_lshl_add_u32 v4, v11, 4, v4
v_mfma_f32_16x16x32_bf16 v[220:223], a[60:63], a[100:103], v[220:223]
v_bfe_u32 v11, v1, 3, 1
s_lshl_b32 s41, s15, 3
v_mfma_f32_16x16x32_bf16 v[216:219], a[180:183], a[144:147], 0
ds_read_b64_tr_b16 a[110:111], v28 offset:29704
s_add_u32 s41, s41, 4
v_mfma_f32_16x16x32_bf16 v[216:219], a[60:63], a[148:151], v[216:219]
v_add_u32 v11, s41, v11
s_waitcnt lgkmcnt(4)
v_mfma_f32_16x16x32_bf16 v[32:35], a[44:47], a[8:11], v[32:35]
ds_read_b64_tr_b16 a[188:189], v26 offset:6152
s_mov_b32 s41, 196608
v_mfma_f32_16x16x32_bf16 v[32:35], a[136:139], a[192:195], v[32:35]
v_add_u32 v23, 0, v11
v_and_b32 v23, 255, v23
v_mfma_f32_16x16x32_bf16 v[180:183], a[44:47], a[56:59], v[180:183]
ds_read_b64_tr_b16 a[190:191], v26 offset:30728
v_mul_lo_u32 v23, v23, s41
v_mfma_f32_16x16x32_bf16 v[180:183], a[136:139], a[196:199], v[180:183]
v_add_u32 v22, v23, v4
buffer_store_dwordx4 v[200:203], v22, s[32:35], 0 offen offset:0 sc1
v_mfma_f32_16x16x32_bf16 v[220:223], a[44:47], a[104:107], v[220:223]
ds_read_b64_tr_b16 a[248:249], v26 offset:7176
s_add_u32 s43, s38, 272640
v_mfma_f32_16x16x32_bf16 v[220:223], a[136:139], a[200:203], v[220:223]
buffer_load_dwordx4 v8, s[24:27], s43 offen offset:1024 lds
v_cvt_pk_bf16_f32 v144, v140, v141
v_mfma_f32_16x16x32_bf16 v[216:219], a[44:47], a[152:155], v[216:219]
ds_read_b64_tr_b16 a[250:251], v26 offset:31752
v_cvt_pk_bf16_f32 v145, v142, v143
v_mfma_f32_16x16x32_bf16 v[216:219], a[136:139], a[208:211], v[216:219]
v_cvt_pk_bf16_f32 v244, v116, v117
s_waitcnt lgkmcnt(4)
v_mfma_f32_16x16x32_bf16 v[32:35], a[184:187], a[204:207], v[32:35]
ds_read_b64_tr_b16 a[156:157], v26 offset:8200
v_cvt_pk_bf16_f32 v245, v118, v119
v_mfma_f32_16x16x32_bf16 v[32:35], a[108:111], a[228:231], v[32:35]
v_cvt_pk_bf16_f32 v112, v124, v125
v_mfma_f32_16x16x32_bf16 v[180:183], a[184:187], a[212:215], v[180:183]
ds_read_b64_tr_b16 a[158:159], v26 offset:32776
v_mfma_f32_16x16x32_bf16 v[180:183], a[108:111], a[240:243], v[180:183]
v_cvt_pk_bf16_f32 v113, v126, v127
v_mfma_f32_16x16x32_bf16 v[220:223], a[184:187], a[216:219], v[220:223]
ds_read_b64_tr_b16 a[252:253], v26 offset:9224
v_mfma_f32_16x16x32_bf16 v[220:223], a[108:111], v[120:123], v[220:223]
v_cvt_pk_bf16_f32 v192, v212, v213
v_mfma_f32_16x16x32_bf16 v[216:219], a[184:187], a[220:223], v[216:219]
ds_read_b64_tr_b16 a[254:255], v26 offset:33800
v_mfma_f32_16x16x32_bf16 v[216:219], a[108:111], v[92:95], v[216:219]
s_waitcnt lgkmcnt(4)
v_mfma_f32_16x16x32_bf16 v[32:35], a[188:191], v[172:175], v[32:35]
ds_read_b64_tr_b16 a[16:17], v26 offset:10248
v_cvt_pk_bf16_f32 v193, v214, v215
v_mfma_f32_16x16x32_bf16 v[32:35], a[248:251], v[104:107], v[32:35]
buffer_store_dwordx4 v[228:231], v22, s[32:35], 0 offen offset:64 sc1
v_mfma_f32_16x16x32_bf16 v[180:183], a[188:191], v[168:171], v[180:183]
ds_read_b64_tr_b16 a[18:19], v26 offset:34824
v_mfma_f32_16x16x32_bf16 v[180:183], a[248:251], v[164:167], v[180:183]
v_add_u32 v23, 2, v11
v_mfma_f32_16x16x32_bf16 v[220:223], a[188:191], v[40:43], v[220:223]
ds_read_b64_tr_b16 a[20:21], v26 offset:11272
v_mfma_f32_16x16x32_bf16 v[220:223], a[248:251], v[188:191], v[220:223]
v_and_b32 v23, 255, v23
v_mfma_f32_16x16x32_bf16 v[216:219], a[188:191], v[44:47], v[216:219]
ds_read_b64_tr_b16 a[22:23], v26 offset:35848
v_mfma_f32_16x16x32_bf16 v[216:219], a[248:251], v[88:91], v[216:219]
s_waitcnt lgkmcnt(4)
v_mfma_f32_16x16x32_bf16 v[32:35], a[156:159], v[84:87], v[32:35]
ds_read_b64_tr_b16 a[64:65], v24 offset:0
v_mfma_f32_16x16x32_bf16 v[32:35], a[252:255], v[68:71], v[32:35]
v_mul_lo_u32 v23, v23, s41
v_mfma_f32_16x16x32_bf16 v[180:183], a[156:159], v[204:207], v[180:183]
ds_read_b64_tr_b16 a[66:67], v24 offset:24576
v_mfma_f32_16x16x32_bf16 v[180:183], a[252:255], v[240:243], v[180:183]
v_add_u32 v25, v23, v4
v_mfma_f32_16x16x32_bf16 v[220:223], a[156:159], v[100:103], v[220:223]
ds_read_b64_tr_b16 a[68:69], v24 offset:1024
v_mfma_f32_16x16x32_bf16 v[220:223], a[252:255], v[136:139], v[220:223]
buffer_store_dwordx4 v[196:199], v25, s[32:35], 0 offen offset:0 sc1
v_mfma_f32_16x16x32_bf16 v[216:219], a[156:159], v[232:235], v[216:219]
ds_read_b64_tr_b16 a[70:71], v24 offset:25600
v_mfma_f32_16x16x32_bf16 v[216:219], a[252:255], v[248:251], v[216:219]
s_waitcnt lgkmcnt(4)
v_mfma_f32_16x16x32_bf16 v[32:35], a[16:19], v[64:67], v[32:35]
ds_read_b64_tr_b16 a[112:113], v24 offset:2048
v_mfma_f32_16x16x32_bf16 v[32:35], a[20:23], v[80:83], v[32:35]
v_add_u32 v23, 4, v11
v_mfma_f32_16x16x32_bf16 v[180:183], a[16:19], v[128:131], v[180:183]
ds_read_b64_tr_b16 a[114:115], v24 offset:26624
v_mfma_f32_16x16x32_bf16 v[180:183], a[20:23], v[132:135], v[180:183]
v_and_b32 v23, 255, v23
v_mfma_f32_16x16x32_bf16 v[220:223], a[16:19], v[236:239], v[220:223]
ds_read_b64_tr_b16 a[116:117], v24 offset:3072
v_mfma_f32_16x16x32_bf16 v[220:223], a[20:23], v[160:163], v[220:223]
v_mul_lo_u32 v23, v23, s41
v_mfma_f32_16x16x32_bf16 v[216:219], a[16:19], v[208:211], v[216:219]
ds_read_b64_tr_b16 a[118:119], v24 offset:27648
v_mfma_f32_16x16x32_bf16 v[216:219], a[20:23], v[108:111], v[216:219]
s_waitcnt lgkmcnt(4)
v_mfma_f32_16x16x32_bf16 v[56:59], a[64:67], a[0:3], 0
ds_read_b64_tr_b16 a[160:161], v24 offset:4096
v_mfma_f32_16x16x32_bf16 v[56:59], a[68:71], a[4:7], v[56:59]
v_cvt_pk_bf16_f32 v146, v32, v33
v_mfma_f32_16x16x32_bf16 v[76:79], a[64:67], a[48:51], 0
ds_read_b64_tr_b16 a[162:163], v24 offset:28672
v_mfma_f32_16x16x32_bf16 v[76:79], a[68:71], a[52:55], v[76:79]
v_cvt_pk_bf16_f32 v147, v34, v35
v_mfma_f32_16x16x32_bf16 v[252:255], a[64:67], a[96:99], 0
ds_read_b64_tr_b16 a[224:225], v24 offset:5120
v_cvt_pk_bf16_f32 v246, v180, v181
v_mfma_f32_16x16x32_bf16 v[252:255], a[68:71], a[100:103], v[252:255]
v_cvt_pk_bf16_f32 v247, v182, v183
v_mfma_f32_16x16x32_bf16 v[156:159], a[64:67], a[144:147], 0
ds_read_b64_tr_b16 a[226:227], v24 offset:29696
v_cvt_pk_bf16_f32 v114, v220, v221
v_mfma_f32_16x16x32_bf16 v[156:159], a[68:71], a[148:151], v[156:159]
buffer_store_dwordx4 v[36:39], v25, s[32:35], 0 offen offset:64 sc1
s_waitcnt lgkmcnt(4)
v_mfma_f32_16x16x32_bf16 v[56:59], a[112:115], a[8:11], v[56:59]
ds_read_b64_tr_b16 a[172:173], v31 offset:6144
v_mfma_f32_16x16x32_bf16 v[56:59], a[116:119], a[192:195], v[56:59]
v_cvt_pk_bf16_f32 v115, v222, v223
v_mfma_f32_16x16x32_bf16 v[76:79], a[112:115], a[56:59], v[76:79]
ds_read_b64_tr_b16 a[174:175], v31 offset:30720
v_mfma_f32_16x16x32_bf16 v[76:79], a[116:119], a[196:199], v[76:79]
v_cvt_pk_bf16_f32 v194, v216, v217
v_mfma_f32_16x16x32_bf16 v[252:255], a[112:115], a[104:107], v[252:255]
ds_read_b64_tr_b16 a[164:165], v31 offset:7168
v_mfma_f32_16x16x32_bf16 v[252:255], a[116:119], a[200:203], v[252:255]
v_cvt_pk_bf16_f32 v195, v218, v219
v_mfma_f32_16x16x32_bf16 v[156:159], a[112:115], a[152:155], v[156:159]
ds_read_b64_tr_b16 a[166:167], v31 offset:31744
v_mfma_f32_16x16x32_bf16 v[156:159], a[116:119], a[208:211], v[156:159]
s_waitcnt lgkmcnt(4)
v_mfma_f32_16x16x32_bf16 v[56:59], a[160:163], a[204:207], v[56:59]
ds_read_b64_tr_b16 a[232:233], v31 offset:8192
v_mfma_f32_16x16x32_bf16 v[56:59], a[224:227], a[228:231], v[56:59]
v_add_u32 v10, v23, v4
v_mfma_f32_16x16x32_bf16 v[76:79], a[160:163], a[212:215], v[76:79]
ds_read_b64_tr_b16 a[234:235], v31 offset:32768
v_mfma_f32_16x16x32_bf16 v[76:79], a[224:227], a[240:243], v[76:79]
v_add_u32 v23, 6, v11
v_mfma_f32_16x16x32_bf16 v[252:255], a[160:163], a[216:219], v[252:255]
ds_read_b64_tr_b16 a[32:33], v31 offset:9216
v_mfma_f32_16x16x32_bf16 v[252:255], a[224:227], v[120:123], v[252:255]
v_and_b32 v23, 255, v23
v_mfma_f32_16x16x32_bf16 v[156:159], a[160:163], a[220:223], v[156:159]
ds_read_b64_tr_b16 a[34:35], v31 offset:33792
v_mfma_f32_16x16x32_bf16 v[156:159], a[224:227], v[92:95], v[156:159]
s_waitcnt lgkmcnt(4)
v_mfma_f32_16x16x32_bf16 v[56:59], a[172:175], v[172:175], v[56:59]
ds_read_b64_tr_b16 a[36:37], v31 offset:10240
v_mfma_f32_16x16x32_bf16 v[56:59], a[164:167], v[104:107], v[56:59]
buffer_store_dwordx4 v[184:187], v10, s[32:35], 0 offen offset:0 sc1
v_mfma_f32_16x16x32_bf16 v[76:79], a[172:175], v[168:171], v[76:79]
ds_read_b64_tr_b16 a[38:39], v31 offset:34816
v_mfma_f32_16x16x32_bf16 v[76:79], a[164:167], v[164:167], v[76:79]
v_mul_lo_u32 v23, v23, s41
v_mfma_f32_16x16x32_bf16 v[252:255], a[172:175], v[40:43], v[252:255]
ds_read_b64_tr_b16 a[24:25], v31 offset:11264
v_mfma_f32_16x16x32_bf16 v[252:255], a[164:167], v[188:191], v[252:255]
v_add_u32 v21, v23, v4
v_mfma_f32_16x16x32_bf16 v[156:159], a[172:175], v[44:47], v[156:159]
ds_read_b64_tr_b16 a[26:27], v31 offset:35840
v_mfma_f32_16x16x32_bf16 v[156:159], a[164:167], v[88:91], v[156:159]
s_waitcnt lgkmcnt(4)
v_mfma_f32_16x16x32_bf16 v[56:59], a[232:235], v[84:87], v[56:59]
ds_read_b64_tr_b16 a[28:29], v24 offset:8
v_mfma_f32_16x16x32_bf16 v[56:59], a[32:35], v[68:71], v[56:59]
v_mfma_f32_16x16x32_bf16 v[76:79], a[232:235], v[204:207], v[76:79]
ds_read_b64_tr_b16 a[30:31], v24 offset:24584
v_mfma_f32_16x16x32_bf16 v[76:79], a[32:35], v[240:243], v[76:79]
v_mfma_f32_16x16x32_bf16 v[252:255], a[232:235], v[100:103], v[252:255]
ds_read_b64_tr_b16 a[84:85], v24 offset:1032
v_mfma_f32_16x16x32_bf16 v[252:255], a[32:35], v[136:139], v[252:255]
v_mfma_f32_16x16x32_bf16 v[156:159], a[232:235], v[232:235], v[156:159]
ds_read_b64_tr_b16 a[86:87], v24 offset:25608
v_mfma_f32_16x16x32_bf16 v[156:159], a[32:35], v[248:251], v[156:159]
s_waitcnt lgkmcnt(4)
v_mfma_f32_16x16x32_bf16 v[56:59], a[36:39], v[64:67], v[56:59]
ds_read_b64_tr_b16 a[72:73], v24 offset:2056
v_mfma_f32_16x16x32_bf16 v[56:59], a[24:27], v[80:83], v[56:59]
v_mfma_f32_16x16x32_bf16 v[76:79], a[36:39], v[128:131], v[76:79]
ds_read_b64_tr_b16 a[74:75], v24 offset:26632
v_mfma_f32_16x16x32_bf16 v[76:79], a[24:27], v[132:135], v[76:79]
buffer_store_dwordx4 v[60:63], v10, s[32:35], 0 offen offset:64 sc1
v_mfma_f32_16x16x32_bf16 v[252:255], a[36:39], v[236:239], v[252:255]
ds_read_b64_tr_b16 a[76:77], v24 offset:3080
v_mfma_f32_16x16x32_bf16 v[252:255], a[24:27], v[160:163], v[252:255]
v_mfma_f32_16x16x32_bf16 v[156:159], a[36:39], v[208:211], v[156:159]
ds_read_b64_tr_b16 a[78:79], v24 offset:27656
v_mfma_f32_16x16x32_bf16 v[156:159], a[24:27], v[108:111], v[156:159]
s_waitcnt lgkmcnt(4)
v_mfma_f32_16x16x32_bf16 v[52:55], a[28:31], a[0:3], 0
ds_read_b64_tr_b16 a[40:41], v24 offset:4104
v_mfma_f32_16x16x32_bf16 v[52:55], a[84:87], a[4:7], v[52:55]
v_cvt_pk_bf16_f32 v72, v56, v57
v_mfma_f32_16x16x32_bf16 v[148:151], a[28:31], a[48:51], 0
ds_read_b64_tr_b16 a[42:43], v24 offset:28680
v_mfma_f32_16x16x32_bf16 v[148:151], a[84:87], a[52:55], v[148:151]
v_cvt_pk_bf16_f32 v73, v58, v59
v_mfma_f32_16x16x32_bf16 v[176:179], a[28:31], a[96:99], 0
ds_read_b64_tr_b16 a[120:121], v24 offset:5128
v_mfma_f32_16x16x32_bf16 v[176:179], a[84:87], a[100:103], v[176:179]
v_cvt_pk_bf16_f32 v96, v76, v77
v_mfma_f32_16x16x32_bf16 v[224:227], a[28:31], a[144:147], 0
ds_read_b64_tr_b16 a[122:123], v24 offset:29704
v_cvt_pk_bf16_f32 v97, v78, v79
v_mfma_f32_16x16x32_bf16 v[224:227], a[84:87], a[148:151], v[224:227]
s_waitcnt lgkmcnt(4)
v_mfma_f32_16x16x32_bf16 v[52:55], a[72:75], a[8:11], v[52:55]
ds_read_b64_tr_b16 a[88:89], v31 offset:6152
v_mfma_f32_16x16x32_bf16 v[52:55], a[76:79], a[192:195], v[52:55]
v_cvt_pk_bf16_f32 v200, v252, v253
v_mfma_f32_16x16x32_bf16 v[148:151], a[72:75], a[56:59], v[148:151]
ds_read_b64_tr_b16 a[90:91], v31 offset:30728
v_mfma_f32_16x16x32_bf16 v[148:151], a[76:79], a[196:199], v[148:151]
v_cvt_pk_bf16_f32 v201, v254, v255
v_mfma_f32_16x16x32_bf16 v[176:179], a[72:75], a[104:107], v[176:179]
ds_read_b64_tr_b16 a[124:125], v31 offset:7176
v_mfma_f32_16x16x32_bf16 v[176:179], a[76:79], a[200:203], v[176:179]
v_cvt_pk_bf16_f32 v140, v156, v157
v_mfma_f32_16x16x32_bf16 v[224:227], a[72:75], a[152:155], v[224:227]
ds_read_b64_tr_b16 a[126:127], v31 offset:31752
v_mfma_f32_16x16x32_bf16 v[224:227], a[76:79], a[208:211], v[224:227]
s_waitcnt lgkmcnt(4)
v_mfma_f32_16x16x32_bf16 v[52:55], a[40:43], a[204:207], v[52:55]
ds_read_b64_tr_b16 a[92:93], v31 offset:8200
v_mfma_f32_16x16x32_bf16 v[52:55], a[120:123], a[228:231], v[52:55]
v_cvt_pk_bf16_f32 v141, v158, v159
v_mfma_f32_16x16x32_bf16 v[148:151], a[40:43], a[212:215], v[148:151]
ds_read_b64_tr_b16 a[94:95], v31 offset:32776
v_mfma_f32_16x16x32_bf16 v[148:151], a[120:123], a[240:243], v[148:151]
buffer_store_dwordx4 v[48:51], v21, s[32:35], 0 offen offset:0 sc1
v_mfma_f32_16x16x32_bf16 v[176:179], a[40:43], a[216:219], v[176:179]
ds_read_b64_tr_b16 a[140:141], v31 offset:9224
v_mfma_f32_16x16x32_bf16 v[176:179], a[120:123], v[120:123], v[176:179]
v_mfma_f32_16x16x32_bf16 v[224:227], a[40:43], a[220:223], v[224:227]
ds_read_b64_tr_b16 a[142:143], v31 offset:33800
v_mfma_f32_16x16x32_bf16 v[224:227], a[120:123], v[92:95], v[224:227]
s_waitcnt lgkmcnt(4)
v_mfma_f32_16x16x32_bf16 v[52:55], a[88:91], v[172:175], v[52:55]
ds_read_b64_tr_b16 a[168:169], v31 offset:10248
v_mfma_f32_16x16x32_bf16 v[52:55], a[124:127], v[104:107], v[52:55]
v_mfma_f32_16x16x32_bf16 v[148:151], a[88:91], v[168:171], v[148:151]
ds_read_b64_tr_b16 a[170:171], v31 offset:34824
v_mfma_f32_16x16x32_bf16 v[148:151], a[124:127], v[164:167], v[148:151]
v_mfma_f32_16x16x32_bf16 v[176:179], a[88:91], v[40:43], v[176:179]
ds_read_b64_tr_b16 a[236:237], v31 offset:11272
v_mfma_f32_16x16x32_bf16 v[176:179], a[124:127], v[188:191], v[176:179]
v_mfma_f32_16x16x32_bf16 v[224:227], a[88:91], v[44:47], v[224:227]
ds_read_b64_tr_b16 a[238:239], v31 offset:35848
v_mfma_f32_16x16x32_bf16 v[224:227], a[124:127], v[88:91], v[224:227]
s_waitcnt lgkmcnt(4)
v_mfma_f32_16x16x32_bf16 v[52:55], a[92:95], v[84:87], v[52:55]
buffer_store_dwordx4 v[152:155], v21, s[32:35], 0 offen offset:64 sc1
v_mfma_f32_16x16x32_bf16 v[52:55], a[140:143], v[68:71], v[52:55]
v_mfma_f32_16x16x32_bf16 v[148:151], a[92:95], v[204:207], v[148:151]
v_mfma_f32_16x16x32_bf16 v[148:151], a[140:143], v[240:243], v[148:151]
s_waitcnt vmcnt(7) lgkmcnt(0)
s_barrier
v_mfma_f32_16x16x32_bf16 v[176:179], a[92:95], v[100:103], v[176:179]
ds_read_b64_tr_b16 a[244:245], v26 offset:0
v_mfma_f32_16x16x32_bf16 v[176:179], a[140:143], v[136:139], v[176:179]
ds_read_b64_tr_b16 a[246:247], v26 offset:24576
v_mfma_f32_16x16x32_bf16 v[224:227], a[92:95], v[232:235], v[224:227]
s_add_u32 m0, s39, 0
v_mfma_f32_16x16x32_bf16 v[224:227], a[140:143], v[248:251], v[224:227]
ds_read_b64_tr_b16 a[80:81], v26 offset:1024
v_mfma_f32_16x16x32_bf16 v[52:55], a[168:171], v[64:67], v[52:55]
ds_read_b64_tr_b16 a[128:129], v26 offset:2048
v_mfma_f32_16x16x32_bf16 v[52:55], a[236:239], v[80:83], v[52:55]
ds_read_b64_tr_b16 a[82:83], v26 offset:25600
v_mfma_f32_16x16x32_bf16 v[148:151], a[168:171], v[128:131], v[148:151]
ds_read_b64_tr_b16 a[130:131], v26 offset:26624
v_mfma_f32_16x16x32_bf16 v[148:151], a[236:239], v[132:135], v[148:151]
s_add_u32 s42, s38, 3456
v_mfma_f32_16x16x32_bf16 v[176:179], a[168:171], v[236:239], v[176:179]
ds_read_b64_tr_b16 a[132:133], v26 offset:3072
v_mfma_f32_16x16x32_bf16 v[176:179], a[236:239], v[160:163], v[176:179]
buffer_load_dwordx4 v8, s[24:27], s42 offen offset:0 lds
v_mfma_f32_16x16x32_bf16 v[224:227], a[168:171], v[208:211], v[224:227]
ds_read_b64_tr_b16 a[134:135], v26 offset:27648
v_mfma_f32_16x16x32_bf16 v[224:227], a[236:239], v[108:111], v[224:227]
s_waitcnt lgkmcnt(3)
v_mfma_f32_16x16x32_bf16 v[116:119], a[244:247], a[0:3], 0
ds_read_b64_tr_b16 a[176:177], v26 offset:4096
v_mfma_f32_16x16x32_bf16 v[116:119], a[80:83], a[4:7], v[116:119]
s_add_u32 s43, s38, 27008
v_mfma_f32_16x16x32_bf16 v[124:127], a[244:247], a[48:51], 0
ds_read_b64_tr_b16 a[178:179], v26 offset:28672
buffer_load_dwordx4 v8, s[24:27], s43 offen offset:1024 lds
v_mfma_f32_16x16x32_bf16 v[124:127], a[80:83], a[52:55], v[124:127]
s_add_u32 s42, s38, 50560
buffer_load_dwordx4 v8, s[24:27], s42 offen offset:2048 lds
v_mfma_f32_16x16x32_bf16 v[212:215], a[244:247], a[96:99], 0
ds_read_b64_tr_b16 a[12:13], v26 offset:5120
v_cvt_pk_bf16_f32 v74, v52, v53
v_mfma_f32_16x16x32_bf16 v[212:215], a[80:83], a[100:103], v[212:215]
v_cvt_pk_bf16_f32 v75, v54, v55
v_mfma_f32_16x16x32_bf16 v[228:231], a[244:247], a[144:147], 0
ds_read_b64_tr_b16 a[14:15], v26 offset:29696
s_add_u32 s43, s38, 74112
v_mfma_f32_16x16x32_bf16 v[228:231], a[80:83], a[148:151], v[228:231]
buffer_load_dwordx4 v8, s[24:27], s43 offen offset:3072 lds
s_waitcnt lgkmcnt(4)
v_mfma_f32_16x16x32_bf16 v[116:119], a[128:131], a[8:11], v[116:119]
ds_read_b64_tr_b16 a[180:181], v28 offset:6144
v_cvt_pk_bf16_f32 v98, v148, v149
v_mfma_f32_16x16x32_bf16 v[116:119], a[132:135], a[192:195], v[116:119]
v_cvt_pk_bf16_f32 v99, v150, v151
v_mfma_f32_16x16x32_bf16 v[124:127], a[128:131], a[56:59], v[124:127]
ds_read_b64_tr_b16 a[182:183], v28 offset:30720
v_mfma_f32_16x16x32_bf16 v[124:127], a[132:135], a[196:199], v[124:127]
v_cvt_pk_bf16_f32 v202, v176, v177
v_mfma_f32_16x16x32_bf16 v[212:215], a[128:131], a[104:107], v[212:215]
ds_read_b64_tr_b16 a[60:61], v28 offset:7168
v_cvt_pk_bf16_f32 v203, v178, v179
v_mfma_f32_16x16x32_bf16 v[212:215], a[132:135], a[200:203], v[212:215]
v_cvt_pk_bf16_f32 v142, v224, v225
v_mfma_f32_16x16x32_bf16 v[228:231], a[128:131], a[152:155], v[228:231]
ds_read_b64_tr_b16 a[62:63], v28 offset:31744
v_mfma_f32_16x16x32_bf16 v[228:231], a[132:135], a[208:211], v[228:231]
s_waitcnt lgkmcnt(4)
v_mfma_f32_16x16x32_bf16 v[116:119], a[176:179], a[204:207], v[116:119]
ds_read_b64_tr_b16 a[44:45], v28 offset:8192
v_mfma_f32_16x16x32_bf16 v[116:119], a[12:15], a[228:231], v[116:119]
v_cvt_pk_bf16_f32 v143, v226, v227
v_mfma_f32_16x16x32_bf16 v[124:127], a[176:179], a[212:215], v[124:127]
ds_read_b64_tr_b16 a[46:47], v28 offset:32768
v_mfma_f32_16x16x32_bf16 v[124:127], a[12:15], a[240:243], v[124:127]
s_add_u32 m0, s39, 4096
v_mfma_f32_16x16x32_bf16 v[212:215], a[176:179], a[216:219], v[212:215]
ds_read_b64_tr_b16 a[136:137], v28 offset:9216
v_mfma_f32_16x16x32_bf16 v[212:215], a[12:15], v[120:123], v[212:215]
s_add_u32 s42, s38, 101760
v_mfma_f32_16x16x32_bf16 v[228:231], a[176:179], a[220:223], v[228:231]
ds_read_b64_tr_b16 a[138:139], v28 offset:33792
v_mfma_f32_16x16x32_bf16 v[228:231], a[12:15], v[92:95], v[228:231]
s_waitcnt lgkmcnt(4)
v_mfma_f32_16x16x32_bf16 v[116:119], a[180:183], v[172:175], v[116:119]
ds_read_b64_tr_b16 a[184:185], v28 offset:10240
v_mfma_f32_16x16x32_bf16 v[116:119], a[60:63], v[104:107], v[116:119]
buffer_load_dwordx4 v8, s[24:27], s42 offen offset:0 lds
v_mfma_f32_16x16x32_bf16 v[124:127], a[180:183], v[168:171], v[124:127]
ds_read_b64_tr_b16 a[186:187], v28 offset:34816
v_mfma_f32_16x16x32_bf16 v[124:127], a[60:63], v[164:167], v[124:127]
s_add_u32 s43, s38, 125312
v_mfma_f32_16x16x32_bf16 v[212:215], a[180:183], v[40:43], v[212:215]
ds_read_b64_tr_b16 a[108:109], v28 offset:11264
v_mfma_f32_16x16x32_bf16 v[212:215], a[60:63], v[188:191], v[212:215]
buffer_load_dwordx4 v8, s[24:27], s43 offen offset:1024 lds
v_mfma_f32_16x16x32_bf16 v[228:231], a[180:183], v[44:47], v[228:231]
ds_read_b64_tr_b16 a[110:111], v28 offset:35840
v_mfma_f32_16x16x32_bf16 v[228:231], a[60:63], v[88:91], v[228:231]
s_waitcnt lgkmcnt(4)
v_mfma_f32_16x16x32_bf16 v[116:119], a[44:47], v[84:87], v[116:119]
ds_read_b64_tr_b16 a[188:189], v26 offset:8
v_mfma_f32_16x16x32_bf16 v[116:119], a[136:139], v[68:71], v[116:119]
s_add_u32 m0, s39, 55296
v_mfma_f32_16x16x32_bf16 v[124:127], a[44:47], v[204:207], v[124:127]
ds_read_b64_tr_b16 a[190:191], v26 offset:24584
v_mfma_f32_16x16x32_bf16 v[124:127], a[136:139], v[240:243], v[124:127]
s_add_u32 s42, s38, 150912
v_mfma_f32_16x16x32_bf16 v[212:215], a[44:47], v[100:103], v[212:215]
ds_read_b64_tr_b16 a[248:249], v26 offset:1032
v_mfma_f32_16x16x32_bf16 v[212:215], a[136:139], v[136:139], v[212:215]
buffer_load_dwordx4 v8, s[24:27], s42 offen offset:0 lds
v_mfma_f32_16x16x32_bf16 v[228:231], a[44:47], v[232:235], v[228:231]
ds_read_b64_tr_b16 a[250:251], v26 offset:25608
v_mfma_f32_16x16x32_bf16 v[228:231], a[136:139], v[248:251], v[228:231]
s_waitcnt lgkmcnt(4)
v_mfma_f32_16x16x32_bf16 v[116:119], a[184:187], v[64:67], v[116:119]
ds_read_b64_tr_b16 a[156:157], v26 offset:2056
v_mfma_f32_16x16x32_bf16 v[116:119], a[108:111], v[80:83], v[116:119]
s_add_u32 s43, s38, 174464
v_mfma_f32_16x16x32_bf16 v[124:127], a[184:187], v[128:131], v[124:127]
ds_read_b64_tr_b16 a[158:159], v26 offset:26632
v_mfma_f32_16x16x32_bf16 v[124:127], a[108:111], v[132:135], v[124:127]
buffer_load_dwordx4 v8, s[24:27], s43 offen offset:1024 lds
v_mfma_f32_16x16x32_bf16 v[212:215], a[184:187], v[236:239], v[212:215]
ds_read_b64_tr_b16 a[252:253], v26 offset:3080
v_mfma_f32_16x16x32_bf16 v[212:215], a[108:111], v[160:163], v[212:215]
s_add_u32 s42, s38, 198016
v_mfma_f32_16x16x32_bf16 v[228:231], a[184:187], v[208:211], v[228:231]
ds_read_b64_tr_b16 a[254:255], v26 offset:27656
v_mfma_f32_16x16x32_bf16 v[228:231], a[108:111], v[108:111], v[228:231]
s_waitcnt lgkmcnt(4)
v_mfma_f32_16x16x32_bf16 v[196:199], a[188:191], a[0:3], 0
ds_read_b64_tr_b16 a[16:17], v26 offset:4104
v_mfma_f32_16x16x32_bf16 v[196:199], a[248:251], a[4:7], v[196:199]
buffer_load_dwordx4 v8, s[24:27], s42 offen offset:2048 lds
s_add_u32 s43, s38, 221568
v_mfma_f32_16x16x32_bf16 v[32:35], a[188:191], a[48:51], 0
ds_read_b64_tr_b16 a[18:19], v26 offset:28680
buffer_load_dwordx4 v8, s[24:27], s43 offen offset:3072 lds
v_mfma_f32_16x16x32_bf16 v[32:35], a[248:251], a[52:55], v[32:35]
s_add_u32 m0, s39, 59392
s_add_u32 s42, s38, 249216
v_mfma_f32_16x16x32_bf16 v[180:183], a[188:191], a[96:99], 0
ds_read_b64_tr_b16 a[20:21], v26 offset:5128
buffer_load_dwordx4 v8, s[24:27], s42 offen offset:0 lds
v_mfma_f32_16x16x32_bf16 v[180:183], a[248:251], a[100:103], v[180:183]
buffer_store_dwordx4 v[144:147], v22, s[32:35], 0 offen offset:128 sc1
v_cvt_pk_bf16_f32 v36, v116, v117
v_mfma_f32_16x16x32_bf16 v[220:223], a[188:191], a[144:147], 0
ds_read_b64_tr_b16 a[22:23], v26 offset:29704
s_add_u32 s43, s38, 272768
v_mfma_f32_16x16x32_bf16 v[220:223], a[248:251], a[148:151], v[220:223]
buffer_load_dwordx4 v8, s[24:27], s43 offen offset:1024 lds
s_waitcnt lgkmcnt(4)
v_mfma_f32_16x16x32_bf16 v[196:199], a[156:159], a[8:11], v[196:199]
ds_read_b64_tr_b16 a[64:65], v28 offset:6152
v_cvt_pk_bf16_f32 v37, v118, v119
v_mfma_f32_16x16x32_bf16 v[196:199], a[252:255], a[192:195], v[196:199]
v_cvt_pk_bf16_f32 v216, v124, v125
v_cvt_pk_bf16_f32 v217, v126, v127
v_mfma_f32_16x16x32_bf16 v[32:35], a[156:159], a[56:59], v[32:35]
ds_read_b64_tr_b16 a[66:67], v28 offset:30728
v_mfma_f32_16x16x32_bf16 v[32:35], a[252:255], a[196:199], v[32:35]
v_cvt_pk_bf16_f32 v184, v212, v213
v_mfma_f32_16x16x32_bf16 v[180:183], a[156:159], a[104:107], v[180:183]
ds_read_b64_tr_b16 a[68:69], v28 offset:7176
v_mfma_f32_16x16x32_bf16 v[180:183], a[252:255], a[200:203], v[180:183]
v_cvt_pk_bf16_f32 v185, v214, v215
v_mfma_f32_16x16x32_bf16 v[220:223], a[156:159], a[152:155], v[220:223]
ds_read_b64_tr_b16 a[70:71], v28 offset:31752
v_mfma_f32_16x16x32_bf16 v[220:223], a[252:255], a[208:211], v[220:223]
s_waitcnt lgkmcnt(4)
v_mfma_f32_16x16x32_bf16 v[196:199], a[16:19], a[204:207], v[196:199]
ds_read_b64_tr_b16 a[112:113], v28 offset:8200
v_mfma_f32_16x16x32_bf16 v[196:199], a[20:23], a[228:231], v[196:199]
v_cvt_pk_bf16_f32 v60, v228, v229
v_mfma_f32_16x16x32_bf16 v[32:35], a[16:19], a[212:215], v[32:35]
ds_read_b64_tr_b16 a[114:115], v28 offset:32776
v_mfma_f32_16x16x32_bf16 v[32:35], a[20:23], a[240:243], v[32:35]
v_cvt_pk_bf16_f32 v61, v230, v231
v_mfma_f32_16x16x32_bf16 v[180:183], a[16:19], a[216:219], v[180:183]
ds_read_b64_tr_b16 a[116:117], v28 offset:9224
v_mfma_f32_16x16x32_bf16 v[180:183], a[20:23], v[120:123], v[180:183]
buffer_store_dwordx4 v[72:75], v22, s[32:35], 0 offen offset:192 sc1
v_mfma_f32_16x16x32_bf16 v[220:223], a[16:19], a[220:223], v[220:223]
ds_read_b64_tr_b16 a[118:119], v28 offset:33800
v_mfma_f32_16x16x32_bf16 v[220:223], a[20:23], v[92:95], v[220:223]
s_waitcnt lgkmcnt(4)
v_mfma_f32_16x16x32_bf16 v[196:199], a[64:67], v[172:175], v[196:199]
ds_read_b64_tr_b16 a[160:161], v28 offset:10248
v_mfma_f32_16x16x32_bf16 v[196:199], a[68:71], v[104:107], v[196:199]
v_mfma_f32_16x16x32_bf16 v[32:35], a[64:67], v[168:171], v[32:35]
ds_read_b64_tr_b16 a[162:163], v28 offset:34824
v_mfma_f32_16x16x32_bf16 v[32:35], a[68:71], v[164:167], v[32:35]
v_mfma_f32_16x16x32_bf16 v[180:183], a[64:67], v[40:43], v[180:183]
ds_read_b64_tr_b16 a[224:225], v28 offset:11272
v_mfma_f32_16x16x32_bf16 v[180:183], a[68:71], v[188:191], v[180:183]
v_mfma_f32_16x16x32_bf16 v[220:223], a[64:67], v[44:47], v[220:223]
ds_read_b64_tr_b16 a[226:227], v28 offset:35848
v_mfma_f32_16x16x32_bf16 v[220:223], a[68:71], v[88:91], v[220:223]
s_waitcnt lgkmcnt(4)
v_mfma_f32_16x16x32_bf16 v[196:199], a[112:115], v[84:87], v[196:199]
ds_read_b64_tr_b16 a[172:173], v31 offset:0
v_mfma_f32_16x16x32_bf16 v[196:199], a[116:119], v[68:71], v[196:199]
v_mfma_f32_16x16x32_bf16 v[32:35], a[112:115], v[204:207], v[32:35]
ds_read_b64_tr_b16 a[174:175], v31 offset:24576
v_mfma_f32_16x16x32_bf16 v[32:35], a[116:119], v[240:243], v[32:35]
v_mfma_f32_16x16x32_bf16 v[180:183], a[112:115], v[100:103], v[180:183]
ds_read_b64_tr_b16 a[164:165], v31 offset:1024
v_mfma_f32_16x16x32_bf16 v[180:183], a[116:119], v[136:139], v[180:183]
buffer_store_dwordx4 v[244:247], v25, s[32:35], 0 offen offset:128 sc1
v_mfma_f32_16x16x32_bf16 v[220:223], a[112:115], v[232:235], v[220:223]
ds_read_b64_tr_b16 a[166:167], v31 offset:25600
v_mfma_f32_16x16x32_bf16 v[220:223], a[116:119], v[248:251], v[220:223]
s_waitcnt lgkmcnt(4)
v_mfma_f32_16x16x32_bf16 v[196:199], a[160:163], v[64:67], v[196:199]
ds_read_b64_tr_b16 a[232:233], v31 offset:2048
v_mfma_f32_16x16x32_bf16 v[196:199], a[224:227], v[80:83], v[196:199]
v_mfma_f32_16x16x32_bf16 v[32:35], a[160:163], v[128:131], v[32:35]
ds_read_b64_tr_b16 a[234:235], v31 offset:26624
v_mfma_f32_16x16x32_bf16 v[32:35], a[224:227], v[132:135], v[32:35]
v_mfma_f32_16x16x32_bf16 v[180:183], a[160:163], v[236:239], v[180:183]
ds_read_b64_tr_b16 a[32:33], v31 offset:3072
v_mfma_f32_16x16x32_bf16 v[180:183], a[224:227], v[160:163], v[180:183]
v_mfma_f32_16x16x32_bf16 v[220:223], a[160:163], v[208:211], v[220:223]
ds_read_b64_tr_b16 a[34:35], v31 offset:27648
v_mfma_f32_16x16x32_bf16 v[220:223], a[224:227], v[108:111], v[220:223]
s_waitcnt lgkmcnt(4)
v_mfma_f32_16x16x32_bf16 v[56:59], a[172:175], a[0:3], 0
ds_read_b64_tr_b16 a[36:37], v31 offset:4096
v_mfma_f32_16x16x32_bf16 v[56:59], a[164:167], a[4:7], v[56:59]
v_cvt_pk_bf16_f32 v38, v196, v197
v_mfma_f32_16x16x32_bf16 v[76:79], a[172:175], a[48:51], 0
ds_read_b64_tr_b16 a[38:39], v31 offset:28672
v_mfma_f32_16x16x32_bf16 v[76:79], a[164:167], a[52:55], v[76:79]
v_cvt_pk_bf16_f32 v39, v198, v199
v_mfma_f32_16x16x32_bf16 v[252:255], a[172:175], a[96:99], 0
ds_read_b64_tr_b16 a[24:25], v31 offset:5120
v_mfma_f32_16x16x32_bf16 v[252:255], a[164:167], a[100:103], v[252:255]
v_cvt_pk_bf16_f32 v218, v32, v33
v_mfma_f32_16x16x32_bf16 v[156:159], a[172:175], a[144:147], 0
ds_read_b64_tr_b16 a[26:27], v31 offset:29696
v_cvt_pk_bf16_f32 v219, v34, v35
v_mfma_f32_16x16x32_bf16 v[156:159], a[164:167], a[148:151], v[156:159]
buffer_store_dwordx4 v[96:99], v25, s[32:35], 0 offen offset:192 sc1
s_waitcnt lgkmcnt(4)
v_mfma_f32_16x16x32_bf16 v[56:59], a[232:235], a[8:11], v[56:59]
ds_read_b64_tr_b16 a[28:29], v24 offset:6144
v_mfma_f32_16x16x32_bf16 v[56:59], a[32:35], a[192:195], v[56:59]
v_cvt_pk_bf16_f32 v186, v180, v181
v_mfma_f32_16x16x32_bf16 v[76:79], a[232:235], a[56:59], v[76:79]
ds_read_b64_tr_b16 a[30:31], v24 offset:30720
v_mfma_f32_16x16x32_bf16 v[76:79], a[32:35], a[196:199], v[76:79]
v_cvt_pk_bf16_f32 v187, v182, v183
v_mfma_f32_16x16x32_bf16 v[252:255], a[232:235], a[104:107], v[252:255]
ds_read_b64_tr_b16 a[84:85], v24 offset:7168
v_mfma_f32_16x16x32_bf16 v[252:255], a[32:35], a[200:203], v[252:255]
v_cvt_pk_bf16_f32 v62, v220, v221
v_mfma_f32_16x16x32_bf16 v[156:159], a[232:235], a[152:155], v[156:159]
ds_read_b64_tr_b16 a[86:87], v24 offset:31744
v_mfma_f32_16x16x32_bf16 v[156:159], a[32:35], a[208:211], v[156:159]
s_waitcnt lgkmcnt(4)
v_mfma_f32_16x16x32_bf16 v[56:59], a[36:39], a[204:207], v[56:59]
ds_read_b64_tr_b16 a[72:73], v24 offset:8192
v_mfma_f32_16x16x32_bf16 v[56:59], a[24:27], a[228:231], v[56:59]
v_cvt_pk_bf16_f32 v63, v222, v223
v_mfma_f32_16x16x32_bf16 v[76:79], a[36:39], a[212:215], v[76:79]
ds_read_b64_tr_b16 a[74:75], v24 offset:32768
v_mfma_f32_16x16x32_bf16 v[76:79], a[24:27], a[240:243], v[76:79]
v_mfma_f32_16x16x32_bf16 v[252:255], a[36:39], a[216:219], v[252:255]
ds_read_b64_tr_b16 a[76:77], v24 offset:9216
v_mfma_f32_16x16x32_bf16 v[252:255], a[24:27], v[120:123], v[252:255]
v_mfma_f32_16x16x32_bf16 v[156:159], a[36:39], a[220:223], v[156:159]
ds_read_b64_tr_b16 a[78:79], v24 offset:33792
v_mfma_f32_16x16x32_bf16 v[156:159], a[24:27], v[92:95], v[156:159]
s_waitcnt lgkmcnt(4)
v_mfma_f32_16x16x32_bf16 v[56:59], a[28:31], v[172:175], v[56:59]
ds_read_b64_tr_b16 a[40:41], v24 offset:10240
v_mfma_f32_16x16x32_bf16 v[56:59], a[84:87], v[104:107], v[56:59]
buffer_store_dwordx4 v[112:115], v10, s[32:35], 0 offen offset:128 sc1
v_mfma_f32_16x16x32_bf16 v[76:79], a[28:31], v[168:171], v[76:79]
ds_read_b64_tr_b16 a[42:43], v24 offset:34816
v_mfma_f32_16x16x32_bf16 v[76:79], a[84:87], v[164:167], v[76:79]
v_mfma_f32_16x16x32_bf16 v[252:255], a[28:31], v[40:43], v[252:255]
ds_read_b64_tr_b16 a[120:121], v24 offset:11264
v_mfma_f32_16x16x32_bf16 v[252:255], a[84:87], v[188:191], v[252:255]
v_mfma_f32_16x16x32_bf16 v[156:159], a[28:31], v[44:47], v[156:159]
ds_read_b64_tr_b16 a[122:123], v24 offset:35840
v_mfma_f32_16x16x32_bf16 v[156:159], a[84:87], v[88:91], v[156:159]
s_waitcnt lgkmcnt(4)
v_mfma_f32_16x16x32_bf16 v[56:59], a[72:75], v[84:87], v[56:59]
ds_read_b64_tr_b16 a[88:89], v31 offset:8
v_mfma_f32_16x16x32_bf16 v[56:59], a[76:79], v[68:71], v[56:59]
v_mfma_f32_16x16x32_bf16 v[76:79], a[72:75], v[204:207], v[76:79]
ds_read_b64_tr_b16 a[90:91], v31 offset:24584
v_mfma_f32_16x16x32_bf16 v[76:79], a[76:79], v[240:243], v[76:79]
v_mfma_f32_16x16x32_bf16 v[252:255], a[72:75], v[100:103], v[252:255]
ds_read_b64_tr_b16 a[124:125], v31 offset:1032
v_mfma_f32_16x16x32_bf16 v[252:255], a[76:79], v[136:139], v[252:255]
v_mfma_f32_16x16x32_bf16 v[156:159], a[72:75], v[232:235], v[156:159]
ds_read_b64_tr_b16 a[126:127], v31 offset:25608
v_mfma_f32_16x16x32_bf16 v[156:159], a[76:79], v[248:251], v[156:159]
s_waitcnt lgkmcnt(4)
v_mfma_f32_16x16x32_bf16 v[56:59], a[40:43], v[64:67], v[56:59]
ds_read_b64_tr_b16 a[92:93], v31 offset:2056
v_mfma_f32_16x16x32_bf16 v[56:59], a[120:123], v[80:83], v[56:59]
v_mfma_f32_16x16x32_bf16 v[76:79], a[40:43], v[128:131], v[76:79]
ds_read_b64_tr_b16 a[94:95], v31 offset:26632
v_mfma_f32_16x16x32_bf16 v[76:79], a[120:123], v[132:135], v[76:79]
buffer_store_dwordx4 v[200:203], v10, s[32:35], 0 offen offset:192 sc1
v_mfma_f32_16x16x32_bf16 v[252:255], a[40:43], v[236:239], v[252:255]
ds_read_b64_tr_b16 a[140:141], v31 offset:3080
v_mfma_f32_16x16x32_bf16 v[252:255], a[120:123], v[160:163], v[252:255]
v_mfma_f32_16x16x32_bf16 v[156:159], a[40:43], v[208:211], v[156:159]
ds_read_b64_tr_b16 a[142:143], v31 offset:27656
v_mfma_f32_16x16x32_bf16 v[156:159], a[120:123], v[108:111], v[156:159]
s_waitcnt lgkmcnt(4)
v_mfma_f32_16x16x32_bf16 v[48:51], a[88:91], a[0:3], 0
ds_read_b64_tr_b16 a[168:169], v31 offset:4104
v_mfma_f32_16x16x32_bf16 v[48:51], a[124:127], a[4:7], v[48:51]
v_cvt_pk_bf16_f32 v152, v56, v57
v_mfma_f32_16x16x32_bf16 v[52:55], a[88:91], a[48:51], 0
ds_read_b64_tr_b16 a[170:171], v31 offset:28680
v_mfma_f32_16x16x32_bf16 v[52:55], a[124:127], a[52:55], v[52:55]
v_cvt_pk_bf16_f32 v153, v58, v59
v_mfma_f32_16x16x32_bf16 v[148:151], a[88:91], a[96:99], 0
ds_read_b64_tr_b16 a[236:237], v31 offset:5128
v_mfma_f32_16x16x32_bf16 v[148:151], a[124:127], a[100:103], v[148:151]
v_cvt_pk_bf16_f32 v176, v76, v77
v_mfma_f32_16x16x32_bf16 v[224:227], a[88:91], a[144:147], 0
ds_read_b64_tr_b16 a[238:239], v31 offset:29704
v_cvt_pk_bf16_f32 v177, v78, v79
v_mfma_f32_16x16x32_bf16 v[224:227], a[124:127], a[148:151], v[224:227]
s_waitcnt lgkmcnt(4)
v_mfma_f32_16x16x32_bf16 v[48:51], a[92:95], a[8:11], v[48:51]
ds_read_b64_tr_b16 a[244:245], v24 offset:6152
v_mfma_f32_16x16x32_bf16 v[48:51], a[140:143], a[192:195], v[48:51]
v_cvt_pk_bf16_f32 v144, v252, v253
v_mfma_f32_16x16x32_bf16 v[52:55], a[92:95], a[56:59], v[52:55]
ds_read_b64_tr_b16 a[246:247], v24 offset:30728
v_mfma_f32_16x16x32_bf16 v[52:55], a[140:143], a[196:199], v[52:55]
v_cvt_pk_bf16_f32 v145, v254, v255
v_mfma_f32_16x16x32_bf16 v[148:151], a[92:95], a[104:107], v[148:151]
ds_read_b64_tr_b16 a[80:81], v24 offset:7176
v_mfma_f32_16x16x32_bf16 v[148:151], a[140:143], a[200:203], v[148:151]
v_cvt_pk_bf16_f32 v116, v156, v157
v_mfma_f32_16x16x32_bf16 v[224:227], a[92:95], a[152:155], v[224:227]
ds_read_b64_tr_b16 a[82:83], v24 offset:31752
v_mfma_f32_16x16x32_bf16 v[224:227], a[140:143], a[208:211], v[224:227]
s_waitcnt lgkmcnt(4)
v_mfma_f32_16x16x32_bf16 v[48:51], a[168:171], a[204:207], v[48:51]
ds_read_b64_tr_b16 a[128:129], v24 offset:8200
v_mfma_f32_16x16x32_bf16 v[48:51], a[236:239], a[228:231], v[48:51]
v_cvt_pk_bf16_f32 v117, v158, v159
v_mfma_f32_16x16x32_bf16 v[52:55], a[168:171], a[212:215], v[52:55]
ds_read_b64_tr_b16 a[130:131], v24 offset:32776
v_mfma_f32_16x16x32_bf16 v[52:55], a[236:239], a[240:243], v[52:55]
buffer_store_dwordx4 v[192:195], v21, s[32:35], 0 offen offset:128 sc1
v_mfma_f32_16x16x32_bf16 v[148:151], a[168:171], a[216:219], v[148:151]
ds_read_b64_tr_b16 a[132:133], v24 offset:9224
v_mfma_f32_16x16x32_bf16 v[148:151], a[236:239], v[120:123], v[148:151]
v_mfma_f32_16x16x32_bf16 v[224:227], a[168:171], a[220:223], v[224:227]
ds_read_b64_tr_b16 a[134:135], v24 offset:33800
v_mfma_f32_16x16x32_bf16 v[224:227], a[236:239], v[92:95], v[224:227]
s_waitcnt lgkmcnt(4)
v_mfma_f32_16x16x32_bf16 v[48:51], a[244:247], v[172:175], v[48:51]
ds_read_b64_tr_b16 a[176:177], v24 offset:10248
v_mfma_f32_16x16x32_bf16 v[48:51], a[80:83], v[104:107], v[48:51]
v_mfma_f32_16x16x32_bf16 v[52:55], a[244:247], v[168:171], v[52:55]
ds_read_b64_tr_b16 a[178:179], v24 offset:34824
v_mfma_f32_16x16x32_bf16 v[52:55], a[80:83], v[164:167], v[52:55]
v_mfma_f32_16x16x32_bf16 v[148:151], a[244:247], v[40:43], v[148:151]
ds_read_b64_tr_b16 a[12:13], v24 offset:11272
v_mfma_f32_16x16x32_bf16 v[148:151], a[80:83], v[188:191], v[148:151]
v_mfma_f32_16x16x32_bf16 v[224:227], a[244:247], v[44:47], v[224:227]
ds_read_b64_tr_b16 a[14:15], v24 offset:35848
v_mfma_f32_16x16x32_bf16 v[224:227], a[80:83], v[88:91], v[224:227]
s_waitcnt lgkmcnt(4)
v_mfma_f32_16x16x32_bf16 v[48:51], a[128:131], v[84:87], v[48:51]
buffer_store_dwordx4 v[140:143], v21, s[32:35], 0 offen offset:192 sc1
v_mfma_f32_16x16x32_bf16 v[48:51], a[132:135], v[68:71], v[48:51]
v_mfma_f32_16x16x32_bf16 v[52:55], a[128:131], v[204:207], v[52:55]
v_mfma_f32_16x16x32_bf16 v[52:55], a[132:135], v[240:243], v[52:55]
s_waitcnt vmcnt(7) lgkmcnt(0)
s_barrier
v_mfma_f32_16x16x32_bf16 v[148:151], a[128:131], v[100:103], v[148:151]
ds_read_b64_tr_b16 a[180:181], v28 offset:0
v_mfma_f32_16x16x32_bf16 v[148:151], a[132:135], v[136:139], v[148:151]
ds_read_b64_tr_b16 a[182:183], v28 offset:24576
v_mfma_f32_16x16x32_bf16 v[224:227], a[128:131], v[232:235], v[224:227]
s_add_u32 m0, s39, 49152
v_mfma_f32_16x16x32_bf16 v[224:227], a[132:135], v[248:251], v[224:227]
ds_read_b64_tr_b16 a[60:61], v28 offset:1024
v_mfma_f32_16x16x32_bf16 v[48:51], a[176:179], v[64:67], v[48:51]
ds_read_b64_tr_b16 a[44:45], v28 offset:2048
v_mfma_f32_16x16x32_bf16 v[48:51], a[12:15], v[80:83], v[48:51]
ds_read_b64_tr_b16 a[62:63], v28 offset:25600
v_mfma_f32_16x16x32_bf16 v[52:55], a[176:179], v[128:131], v[52:55]
ds_read_b64_tr_b16 a[46:47], v28 offset:26624
v_mfma_f32_16x16x32_bf16 v[52:55], a[12:15], v[132:135], v[52:55]
s_add_u32 s42, s38, 3584
v_mfma_f32_16x16x32_bf16 v[148:151], a[176:179], v[236:239], v[148:151]
ds_read_b64_tr_b16 a[136:137], v28 offset:3072
v_mfma_f32_16x16x32_bf16 v[148:151], a[12:15], v[160:163], v[148:151]
buffer_load_dwordx4 v8, s[24:27], s42 offen offset:0 lds
v_mfma_f32_16x16x32_bf16 v[224:227], a[176:179], v[208:211], v[224:227]
ds_read_b64_tr_b16 a[138:139], v28 offset:27648
v_mfma_f32_16x16x32_bf16 v[224:227], a[12:15], v[108:111], v[224:227]
s_waitcnt lgkmcnt(3)
v_mfma_f32_16x16x32_bf16 v[124:127], a[180:183], a[0:3], 0
ds_read_b64_tr_b16 a[184:185], v28 offset:4096
v_mfma_f32_16x16x32_bf16 v[124:127], a[60:63], a[4:7], v[124:127]
s_add_u32 s43, s38, 27136
v_mfma_f32_16x16x32_bf16 v[212:215], a[180:183], a[48:51], 0
ds_read_b64_tr_b16 a[186:187], v28 offset:28672
buffer_load_dwordx4 v8, s[24:27], s43 offen offset:1024 lds
v_mfma_f32_16x16x32_bf16 v[212:215], a[60:63], a[52:55], v[212:215]
s_add_u32 s42, s38, 50688
buffer_load_dwordx4 v8, s[24:27], s42 offen offset:2048 lds
v_mfma_f32_16x16x32_bf16 v[228:231], a[180:183], a[96:99], 0
ds_read_b64_tr_b16 a[108:109], v28 offset:5120
v_cvt_pk_bf16_f32 v154, v48, v49
v_mfma_f32_16x16x32_bf16 v[228:231], a[60:63], a[100:103], v[228:231]
v_cvt_pk_bf16_f32 v155, v50, v51
v_mfma_f32_16x16x32_bf16 v[72:75], a[180:183], a[144:147], 0
ds_read_b64_tr_b16 a[110:111], v28 offset:29696
s_add_u32 s43, s38, 74240
v_mfma_f32_16x16x32_bf16 v[72:75], a[60:63], a[148:151], v[72:75]
buffer_load_dwordx4 v8, s[24:27], s43 offen offset:3072 lds
s_waitcnt lgkmcnt(4)
v_mfma_f32_16x16x32_bf16 v[124:127], a[44:47], a[8:11], v[124:127]
ds_read_b64_tr_b16 a[188:189], v26 offset:6144
v_cvt_pk_bf16_f32 v178, v52, v53
v_mfma_f32_16x16x32_bf16 v[124:127], a[136:139], a[192:195], v[124:127]
v_cvt_pk_bf16_f32 v179, v54, v55
v_mfma_f32_16x16x32_bf16 v[212:215], a[44:47], a[56:59], v[212:215]
ds_read_b64_tr_b16 a[190:191], v26 offset:30720
v_mfma_f32_16x16x32_bf16 v[212:215], a[136:139], a[196:199], v[212:215]
v_cvt_pk_bf16_f32 v146, v148, v149
v_mfma_f32_16x16x32_bf16 v[228:231], a[44:47], a[104:107], v[228:231]
ds_read_b64_tr_b16 a[248:249], v26 offset:7168
v_cvt_pk_bf16_f32 v147, v150, v151
v_mfma_f32_16x16x32_bf16 v[228:231], a[136:139], a[200:203], v[228:231]
v_cvt_pk_bf16_f32 v118, v224, v225
v_mfma_f32_16x16x32_bf16 v[72:75], a[44:47], a[152:155], v[72:75]
ds_read_b64_tr_b16 a[250:251], v26 offset:31744
v_mfma_f32_16x16x32_bf16 v[72:75], a[136:139], a[208:211], v[72:75]
s_waitcnt lgkmcnt(4)
v_mfma_f32_16x16x32_bf16 v[124:127], a[184:187], a[204:207], v[124:127]
ds_read_b64_tr_b16 a[156:157], v26 offset:8192
v_mfma_f32_16x16x32_bf16 v[124:127], a[108:111], a[228:231], v[124:127]
v_cvt_pk_bf16_f32 v119, v226, v227
v_mfma_f32_16x16x32_bf16 v[212:215], a[184:187], a[212:215], v[212:215]
ds_read_b64_tr_b16 a[158:159], v26 offset:32768
v_mfma_f32_16x16x32_bf16 v[212:215], a[108:111], a[240:243], v[212:215]
s_add_u32 m0, s39, 53248
v_mfma_f32_16x16x32_bf16 v[228:231], a[184:187], a[216:219], v[228:231]
ds_read_b64_tr_b16 a[252:253], v26 offset:9216
v_mfma_f32_16x16x32_bf16 v[228:231], a[108:111], v[120:123], v[228:231]
s_add_u32 s42, s38, 101888
v_mfma_f32_16x16x32_bf16 v[72:75], a[184:187], a[220:223], v[72:75]
ds_read_b64_tr_b16 a[254:255], v26 offset:33792
v_mfma_f32_16x16x32_bf16 v[72:75], a[108:111], v[92:95], v[72:75]
s_waitcnt lgkmcnt(4)
v_mfma_f32_16x16x32_bf16 v[124:127], a[188:191], v[172:175], v[124:127]
ds_read_b64_tr_b16 a[16:17], v26 offset:10240
v_mfma_f32_16x16x32_bf16 v[124:127], a[248:251], v[104:107], v[124:127]
buffer_load_dwordx4 v8, s[24:27], s42 offen offset:0 lds
v_mfma_f32_16x16x32_bf16 v[212:215], a[188:191], v[168:171], v[212:215]
ds_read_b64_tr_b16 a[18:19], v26 offset:34816
v_mfma_f32_16x16x32_bf16 v[212:215], a[248:251], v[164:167], v[212:215]
s_add_u32 s43, s38, 125440
v_mfma_f32_16x16x32_bf16 v[228:231], a[188:191], v[40:43], v[228:231]
ds_read_b64_tr_b16 a[20:21], v26 offset:11264
v_mfma_f32_16x16x32_bf16 v[228:231], a[248:251], v[188:191], v[228:231]
buffer_load_dwordx4 v8, s[24:27], s43 offen offset:1024 lds
v_mfma_f32_16x16x32_bf16 v[72:75], a[188:191], v[44:47], v[72:75]
ds_read_b64_tr_b16 a[22:23], v26 offset:35840
v_mfma_f32_16x16x32_bf16 v[72:75], a[248:251], v[88:91], v[72:75]
s_waitcnt lgkmcnt(4)
v_mfma_f32_16x16x32_bf16 v[124:127], a[156:159], v[84:87], v[124:127]
ds_read_b64_tr_b16 a[64:65], v28 offset:8
v_mfma_f32_16x16x32_bf16 v[124:127], a[252:255], v[68:71], v[124:127]
s_add_u32 m0, s39, 6144
v_mfma_f32_16x16x32_bf16 v[212:215], a[156:159], v[204:207], v[212:215]
ds_read_b64_tr_b16 a[66:67], v28 offset:24584
v_mfma_f32_16x16x32_bf16 v[212:215], a[252:255], v[240:243], v[212:215]
s_add_u32 s42, s38, 151040
v_mfma_f32_16x16x32_bf16 v[228:231], a[156:159], v[100:103], v[228:231]
ds_read_b64_tr_b16 a[68:69], v28 offset:1032
v_mfma_f32_16x16x32_bf16 v[228:231], a[252:255], v[136:139], v[228:231]
buffer_load_dwordx4 v8, s[24:27], s42 offen offset:0 lds
v_mfma_f32_16x16x32_bf16 v[72:75], a[156:159], v[232:235], v[72:75]
ds_read_b64_tr_b16 a[70:71], v28 offset:25608
v_mfma_f32_16x16x32_bf16 v[72:75], a[252:255], v[248:251], v[72:75]
s_waitcnt lgkmcnt(4)
v_mfma_f32_16x16x32_bf16 v[124:127], a[16:19], v[64:67], v[124:127]
ds_read_b64_tr_b16 a[112:113], v28 offset:2056
v_mfma_f32_16x16x32_bf16 v[124:127], a[20:23], v[80:83], v[124:127]
s_add_u32 s43, s38, 174592
v_mfma_f32_16x16x32_bf16 v[212:215], a[16:19], v[128:131], v[212:215]
ds_read_b64_tr_b16 a[114:115], v28 offset:26632
v_mfma_f32_16x16x32_bf16 v[212:215], a[20:23], v[132:135], v[212:215]
buffer_load_dwordx4 v8, s[24:27], s43 offen offset:1024 lds
v_mfma_f32_16x16x32_bf16 v[228:231], a[16:19], v[236:239], v[228:231]
ds_read_b64_tr_b16 a[116:117], v28 offset:3080
v_mfma_f32_16x16x32_bf16 v[228:231], a[20:23], v[160:163], v[228:231]
s_add_u32 s42, s38, 198144
v_mfma_f32_16x16x32_bf16 v[72:75], a[16:19], v[208:211], v[72:75]
ds_read_b64_tr_b16 a[118:119], v28 offset:27656
v_mfma_f32_16x16x32_bf16 v[72:75], a[20:23], v[108:111], v[72:75]
s_waitcnt lgkmcnt(4)
v_mfma_f32_16x16x32_bf16 v[244:247], a[64:67], a[0:3], 0
ds_read_b64_tr_b16 a[160:161], v28 offset:4104
v_mfma_f32_16x16x32_bf16 v[244:247], a[68:71], a[4:7], v[244:247]
buffer_load_dwordx4 v8, s[24:27], s42 offen offset:2048 lds
s_add_u32 s43, s38, 221696
v_mfma_f32_16x16x32_bf16 v[196:199], a[64:67], a[48:51], 0
ds_read_b64_tr_b16 a[162:163], v28 offset:28680
buffer_load_dwordx4 v8, s[24:27], s43 offen offset:3072 lds
v_mfma_f32_16x16x32_bf16 v[196:199], a[68:71], a[52:55], v[196:199]
s_add_u32 m0, s39, 10240
s_add_u32 s42, s38, 249344
v_mfma_f32_16x16x32_bf16 v[32:35], a[64:67], a[96:99], 0
ds_read_b64_tr_b16 a[224:225], v28 offset:5128
buffer_load_dwordx4 v8, s[24:27], s42 offen offset:0 lds
v_mfma_f32_16x16x32_bf16 v[32:35], a[68:71], a[100:103], v[32:35]
buffer_store_dwordx4 v[36:39], v22, s[32:35], 0 offen offset:256 sc1
v_cvt_pk_bf16_f32 v96, v124, v125
v_mfma_f32_16x16x32_bf16 v[180:183], a[64:67], a[144:147], 0
ds_read_b64_tr_b16 a[226:227], v28 offset:29704
s_add_u32 s43, s38, 272896
v_mfma_f32_16x16x32_bf16 v[180:183], a[68:71], a[148:151], v[180:183]
buffer_load_dwordx4 v8, s[24:27], s43 offen offset:1024 lds
s_waitcnt lgkmcnt(4)
v_mfma_f32_16x16x32_bf16 v[244:247], a[112:115], a[8:11], v[244:247]
ds_read_b64_tr_b16 a[172:173], v26 offset:6152
v_cvt_pk_bf16_f32 v97, v126, v127
v_mfma_f32_16x16x32_bf16 v[244:247], a[116:119], a[192:195], v[244:247]
v_cvt_pk_bf16_f32 v220, v212, v213
v_cvt_pk_bf16_f32 v221, v214, v215
v_mfma_f32_16x16x32_bf16 v[196:199], a[112:115], a[56:59], v[196:199]
ds_read_b64_tr_b16 a[174:175], v26 offset:30728
v_mfma_f32_16x16x32_bf16 v[196:199], a[116:119], a[196:199], v[196:199]
v_cvt_pk_bf16_f32 v112, v228, v229
v_mfma_f32_16x16x32_bf16 v[32:35], a[112:115], a[104:107], v[32:35]
ds_read_b64_tr_b16 a[164:165], v26 offset:7176
v_mfma_f32_16x16x32_bf16 v[32:35], a[116:119], a[200:203], v[32:35]
v_cvt_pk_bf16_f32 v113, v230, v231
v_mfma_f32_16x16x32_bf16 v[180:183], a[112:115], a[152:155], v[180:183]
ds_read_b64_tr_b16 a[166:167], v26 offset:31752
v_mfma_f32_16x16x32_bf16 v[180:183], a[116:119], a[208:211], v[180:183]
s_waitcnt lgkmcnt(4)
v_mfma_f32_16x16x32_bf16 v[244:247], a[160:163], a[204:207], v[244:247]
ds_read_b64_tr_b16 a[232:233], v26 offset:8200
v_mfma_f32_16x16x32_bf16 v[244:247], a[224:227], a[228:231], v[244:247]
v_cvt_pk_bf16_f32 v200, v72, v73
v_mfma_f32_16x16x32_bf16 v[196:199], a[160:163], a[212:215], v[196:199]
ds_read_b64_tr_b16 a[234:235], v26 offset:32776
v_mfma_f32_16x16x32_bf16 v[196:199], a[224:227], a[240:243], v[196:199]
v_cvt_pk_bf16_f32 v201, v74, v75
v_mfma_f32_16x16x32_bf16 v[32:35], a[160:163], a[216:219], v[32:35]
ds_read_b64_tr_b16 a[32:33], v26 offset:9224
v_mfma_f32_16x16x32_bf16 v[32:35], a[224:227], v[120:123], v[32:35]
buffer_store_dwordx4 v[152:155], v22, s[32:35], 0 offen offset:320 sc1
v_mfma_f32_16x16x32_bf16 v[180:183], a[160:163], a[220:223], v[180:183]
ds_read_b64_tr_b16 a[34:35], v26 offset:33800
v_mfma_f32_16x16x32_bf16 v[180:183], a[224:227], v[92:95], v[180:183]
s_waitcnt lgkmcnt(4)
v_mfma_f32_16x16x32_bf16 v[244:247], a[172:175], v[172:175], v[244:247]
ds_read_b64_tr_b16 a[36:37], v26 offset:10248
v_mfma_f32_16x16x32_bf16 v[244:247], a[164:167], v[104:107], v[244:247]
v_mfma_f32_16x16x32_bf16 v[196:199], a[172:175], v[168:171], v[196:199]
ds_read_b64_tr_b16 a[38:39], v26 offset:34824
v_mfma_f32_16x16x32_bf16 v[196:199], a[164:167], v[164:167], v[196:199]
v_mfma_f32_16x16x32_bf16 v[32:35], a[172:175], v[40:43], v[32:35]
ds_read_b64_tr_b16 a[24:25], v26 offset:11272
v_mfma_f32_16x16x32_bf16 v[32:35], a[164:167], v[188:191], v[32:35]
v_mfma_f32_16x16x32_bf16 v[180:183], a[172:175], v[44:47], v[180:183]
ds_read_b64_tr_b16 a[26:27], v26 offset:35848
v_mfma_f32_16x16x32_bf16 v[180:183], a[164:167], v[88:91], v[180:183]
s_waitcnt lgkmcnt(4)
v_mfma_f32_16x16x32_bf16 v[244:247], a[232:235], v[84:87], v[244:247]
ds_read_b64_tr_b16 a[28:29], v24 offset:0
v_mfma_f32_16x16x32_bf16 v[244:247], a[32:35], v[68:71], v[244:247]
v_mfma_f32_16x16x32_bf16 v[196:199], a[232:235], v[204:207], v[196:199]
ds_read_b64_tr_b16 a[30:31], v24 offset:24576
v_mfma_f32_16x16x32_bf16 v[196:199], a[32:35], v[240:243], v[196:199]
v_mfma_f32_16x16x32_bf16 v[32:35], a[232:235], v[100:103], v[32:35]
ds_read_b64_tr_b16 a[84:85], v24 offset:1024
v_mfma_f32_16x16x32_bf16 v[32:35], a[32:35], v[136:139], v[32:35]
buffer_store_dwordx4 v[216:219], v25, s[32:35], 0 offen offset:256 sc1
v_mfma_f32_16x16x32_bf16 v[180:183], a[232:235], v[232:235], v[180:183]
ds_read_b64_tr_b16 a[86:87], v24 offset:25600
v_mfma_f32_16x16x32_bf16 v[180:183], a[32:35], v[248:251], v[180:183]
s_waitcnt lgkmcnt(4)
v_mfma_f32_16x16x32_bf16 v[244:247], a[36:39], v[64:67], v[244:247]
ds_read_b64_tr_b16 a[72:73], v24 offset:2048
v_mfma_f32_16x16x32_bf16 v[244:247], a[24:27], v[80:83], v[244:247]
v_mfma_f32_16x16x32_bf16 v[196:199], a[36:39], v[128:131], v[196:199]
ds_read_b64_tr_b16 a[74:75], v24 offset:26624
v_mfma_f32_16x16x32_bf16 v[196:199], a[24:27], v[132:135], v[196:199]
v_mfma_f32_16x16x32_bf16 v[32:35], a[36:39], v[236:239], v[32:35]
ds_read_b64_tr_b16 a[76:77], v24 offset:3072
v_mfma_f32_16x16x32_bf16 v[32:35], a[24:27], v[160:163], v[32:35]
v_mfma_f32_16x16x32_bf16 v[180:183], a[36:39], v[208:211], v[180:183]
ds_read_b64_tr_b16 a[78:79], v24 offset:27648
v_mfma_f32_16x16x32_bf16 v[180:183], a[24:27], v[108:111], v[180:183]
s_waitcnt lgkmcnt(4)
v_mfma_f32_16x16x32_bf16 v[56:59], a[28:31], a[0:3], 0
ds_read_b64_tr_b16 a[40:41], v24 offset:4096
v_mfma_f32_16x16x32_bf16 v[56:59], a[84:87], a[4:7], v[56:59]
v_cvt_pk_bf16_f32 v98, v244, v245
v_mfma_f32_16x16x32_bf16 v[76:79], a[28:31], a[48:51], 0
ds_read_b64_tr_b16 a[42:43], v24 offset:28672
v_mfma_f32_16x16x32_bf16 v[76:79], a[84:87], a[52:55], v[76:79]
v_cvt_pk_bf16_f32 v99, v246, v247
v_mfma_f32_16x16x32_bf16 v[252:255], a[28:31], a[96:99], 0
ds_read_b64_tr_b16 a[120:121], v24 offset:5120
v_mfma_f32_16x16x32_bf16 v[252:255], a[84:87], a[100:103], v[252:255]
v_cvt_pk_bf16_f32 v222, v196, v197
v_mfma_f32_16x16x32_bf16 v[156:159], a[28:31], a[144:147], 0
ds_read_b64_tr_b16 a[122:123], v24 offset:29696
v_cvt_pk_bf16_f32 v223, v198, v199
v_mfma_f32_16x16x32_bf16 v[156:159], a[84:87], a[148:151], v[156:159]
buffer_store_dwordx4 v[176:179], v25, s[32:35], 0 offen offset:320 sc1
s_waitcnt lgkmcnt(4)
v_mfma_f32_16x16x32_bf16 v[56:59], a[72:75], a[8:11], v[56:59]
ds_read_b64_tr_b16 a[88:89], v31 offset:6144
v_mfma_f32_16x16x32_bf16 v[56:59], a[76:79], a[192:195], v[56:59]
v_cvt_pk_bf16_f32 v114, v32, v33
v_mfma_f32_16x16x32_bf16 v[76:79], a[72:75], a[56:59], v[76:79]
ds_read_b64_tr_b16 a[90:91], v31 offset:30720
v_mfma_f32_16x16x32_bf16 v[76:79], a[76:79], a[196:199], v[76:79]
v_cvt_pk_bf16_f32 v115, v34, v35
v_mfma_f32_16x16x32_bf16 v[252:255], a[72:75], a[104:107], v[252:255]
ds_read_b64_tr_b16 a[124:125], v31 offset:7168
v_mfma_f32_16x16x32_bf16 v[252:255], a[76:79], a[200:203], v[252:255]
v_cvt_pk_bf16_f32 v202, v180, v181
v_mfma_f32_16x16x32_bf16 v[156:159], a[72:75], a[152:155], v[156:159]
ds_read_b64_tr_b16 a[126:127], v31 offset:31744
v_mfma_f32_16x16x32_bf16 v[156:159], a[76:79], a[208:211], v[156:159]
s_waitcnt lgkmcnt(4)
v_mfma_f32_16x16x32_bf16 v[56:59], a[40:43], a[204:207], v[56:59]
ds_read_b64_tr_b16 a[92:93], v31 offset:8192
v_mfma_f32_16x16x32_bf16 v[56:59], a[120:123], a[228:231], v[56:59]
v_cvt_pk_bf16_f32 v203, v182, v183
v_mfma_f32_16x16x32_bf16 v[76:79], a[40:43], a[212:215], v[76:79]
ds_read_b64_tr_b16 a[94:95], v31 offset:32768
v_mfma_f32_16x16x32_bf16 v[76:79], a[120:123], a[240:243], v[76:79]
v_mfma_f32_16x16x32_bf16 v[252:255], a[40:43], a[216:219], v[252:255]
ds_read_b64_tr_b16 a[140:141], v31 offset:9216
v_mfma_f32_16x16x32_bf16 v[252:255], a[120:123], v[120:123], v[252:255]
v_mfma_f32_16x16x32_bf16 v[156:159], a[40:43], a[220:223], v[156:159]
ds_read_b64_tr_b16 a[142:143], v31 offset:33792
v_mfma_f32_16x16x32_bf16 v[156:159], a[120:123], v[92:95], v[156:159]
s_waitcnt lgkmcnt(4)
v_mfma_f32_16x16x32_bf16 v[56:59], a[88:91], v[172:175], v[56:59]
ds_read_b64_tr_b16 a[168:169], v31 offset:10240
v_mfma_f32_16x16x32_bf16 v[56:59], a[124:127], v[104:107], v[56:59]
buffer_store_dwordx4 v[184:187], v10, s[32:35], 0 offen offset:256 sc1
v_mfma_f32_16x16x32_bf16 v[76:79], a[88:91], v[168:171], v[76:79]
ds_read_b64_tr_b16 a[170:171], v31 offset:34816
v_mfma_f32_16x16x32_bf16 v[76:79], a[124:127], v[164:167], v[76:79]
v_mfma_f32_16x16x32_bf16 v[252:255], a[88:91], v[40:43], v[252:255]
ds_read_b64_tr_b16 a[236:237], v31 offset:11264
v_mfma_f32_16x16x32_bf16 v[252:255], a[124:127], v[188:191], v[252:255]
v_mfma_f32_16x16x32_bf16 v[156:159], a[88:91], v[44:47], v[156:159]
ds_read_b64_tr_b16 a[238:239], v31 offset:35840
v_mfma_f32_16x16x32_bf16 v[156:159], a[124:127], v[88:91], v[156:159]
s_waitcnt lgkmcnt(4)
v_mfma_f32_16x16x32_bf16 v[56:59], a[92:95], v[84:87], v[56:59]
ds_read_b64_tr_b16 a[244:245], v24 offset:8
v_mfma_f32_16x16x32_bf16 v[56:59], a[140:143], v[68:71], v[56:59]
v_mfma_f32_16x16x32_bf16 v[76:79], a[92:95], v[204:207], v[76:79]
ds_read_b64_tr_b16 a[246:247], v24 offset:24584
v_mfma_f32_16x16x32_bf16 v[76:79], a[140:143], v[240:243], v[76:79]
v_mfma_f32_16x16x32_bf16 v[252:255], a[92:95], v[100:103], v[252:255]
ds_read_b64_tr_b16 a[80:81], v24 offset:1032
v_mfma_f32_16x16x32_bf16 v[252:255], a[140:143], v[136:139], v[252:255]
v_mfma_f32_16x16x32_bf16 v[156:159], a[92:95], v[232:235], v[156:159]
ds_read_b64_tr_b16 a[82:83], v24 offset:25608
v_mfma_f32_16x16x32_bf16 v[156:159], a[140:143], v[248:251], v[156:159]
s_waitcnt lgkmcnt(4)
v_mfma_f32_16x16x32_bf16 v[56:59], a[168:171], v[64:67], v[56:59]
ds_read_b64_tr_b16 a[128:129], v24 offset:2056
v_mfma_f32_16x16x32_bf16 v[56:59], a[236:239], v[80:83], v[56:59]
v_mfma_f32_16x16x32_bf16 v[76:79], a[168:171], v[128:131], v[76:79]
ds_read_b64_tr_b16 a[130:131], v24 offset:26632
v_mfma_f32_16x16x32_bf16 v[76:79], a[236:239], v[132:135], v[76:79]
buffer_store_dwordx4 v[144:147], v10, s[32:35], 0 offen offset:320 sc1
v_mfma_f32_16x16x32_bf16 v[252:255], a[168:171], v[236:239], v[252:255]
ds_read_b64_tr_b16 a[132:133], v24 offset:3080
v_mfma_f32_16x16x32_bf16 v[252:255], a[236:239], v[160:163], v[252:255]
v_mfma_f32_16x16x32_bf16 v[156:159], a[168:171], v[208:211], v[156:159]
ds_read_b64_tr_b16 a[134:135], v24 offset:27656
v_mfma_f32_16x16x32_bf16 v[156:159], a[236:239], v[108:111], v[156:159]
s_waitcnt lgkmcnt(4)
v_mfma_f32_16x16x32_bf16 v[192:195], a[244:247], a[0:3], 0
ds_read_b64_tr_b16 a[176:177], v24 offset:4104
v_mfma_f32_16x16x32_bf16 v[192:195], a[80:83], a[4:7], v[192:195]
v_cvt_pk_bf16_f32 v140, v56, v57
v_mfma_f32_16x16x32_bf16 v[48:51], a[244:247], a[48:51], 0
ds_read_b64_tr_b16 a[178:179], v24 offset:28680
v_mfma_f32_16x16x32_bf16 v[48:51], a[80:83], a[52:55], v[48:51]
v_cvt_pk_bf16_f32 v141, v58, v59
v_mfma_f32_16x16x32_bf16 v[52:55], a[244:247], a[96:99], 0
ds_read_b64_tr_b16 a[12:13], v24 offset:5128
v_mfma_f32_16x16x32_bf16 v[52:55], a[80:83], a[100:103], v[52:55]
v_cvt_pk_bf16_f32 v148, v76, v77
v_mfma_f32_16x16x32_bf16 v[224:227], a[244:247], a[144:147], 0
ds_read_b64_tr_b16 a[14:15], v24 offset:29704
v_cvt_pk_bf16_f32 v149, v78, v79
v_mfma_f32_16x16x32_bf16 v[224:227], a[80:83], a[148:151], v[224:227]
s_waitcnt lgkmcnt(4)
v_mfma_f32_16x16x32_bf16 v[192:195], a[128:131], a[8:11], v[192:195]
ds_read_b64_tr_b16 a[180:181], v31 offset:6152
v_mfma_f32_16x16x32_bf16 v[192:195], a[132:135], a[192:195], v[192:195]
v_cvt_pk_bf16_f32 v36, v252, v253
v_mfma_f32_16x16x32_bf16 v[48:51], a[128:131], a[56:59], v[48:51]
ds_read_b64_tr_b16 a[182:183], v31 offset:30728
v_mfma_f32_16x16x32_bf16 v[48:51], a[132:135], a[196:199], v[48:51]
v_cvt_pk_bf16_f32 v37, v254, v255
v_mfma_f32_16x16x32_bf16 v[52:55], a[128:131], a[104:107], v[52:55]
ds_read_b64_tr_b16 a[60:61], v31 offset:7176
v_mfma_f32_16x16x32_bf16 v[52:55], a[132:135], a[200:203], v[52:55]
v_cvt_pk_bf16_f32 v124, v156, v157
v_mfma_f32_16x16x32_bf16 v[224:227], a[128:131], a[152:155], v[224:227]
ds_read_b64_tr_b16 a[62:63], v31 offset:31752
v_mfma_f32_16x16x32_bf16 v[224:227], a[132:135], a[208:211], v[224:227]
s_waitcnt lgkmcnt(4)
v_mfma_f32_16x16x32_bf16 v[192:195], a[176:179], a[204:207], v[192:195]
ds_read_b64_tr_b16 a[44:45], v31 offset:8200
v_mfma_f32_16x16x32_bf16 v[192:195], a[12:15], a[228:231], v[192:195]
v_cvt_pk_bf16_f32 v125, v158, v159
v_mfma_f32_16x16x32_bf16 v[48:51], a[176:179], a[212:215], v[48:51]
ds_read_b64_tr_b16 a[46:47], v31 offset:32776
v_mfma_f32_16x16x32_bf16 v[48:51], a[12:15], a[240:243], v[48:51]
buffer_store_dwordx4 v[60:63], v21, s[32:35], 0 offen offset:256 sc1
v_mfma_f32_16x16x32_bf16 v[52:55], a[176:179], a[216:219], v[52:55]
ds_read_b64_tr_b16 a[136:137], v31 offset:9224
v_mfma_f32_16x16x32_bf16 v[52:55], a[12:15], v[120:123], v[52:55]
v_mfma_f32_16x16x32_bf16 v[224:227], a[176:179], a[220:223], v[224:227]
ds_read_b64_tr_b16 a[138:139], v31 offset:33800
v_mfma_f32_16x16x32_bf16 v[224:227], a[12:15], v[92:95], v[224:227]
s_waitcnt lgkmcnt(4)
v_mfma_f32_16x16x32_bf16 v[192:195], a[180:183], v[172:175], v[192:195]
ds_read_b64_tr_b16 a[184:185], v31 offset:10248
v_mfma_f32_16x16x32_bf16 v[192:195], a[60:63], v[104:107], v[192:195]
v_mfma_f32_16x16x32_bf16 v[48:51], a[180:183], v[168:171], v[48:51]
ds_read_b64_tr_b16 a[186:187], v31 offset:34824
v_mfma_f32_16x16x32_bf16 v[48:51], a[60:63], v[164:167], v[48:51]
v_mfma_f32_16x16x32_bf16 v[52:55], a[180:183], v[40:43], v[52:55]
ds_read_b64_tr_b16 a[108:109], v31 offset:11272
v_mfma_f32_16x16x32_bf16 v[52:55], a[60:63], v[188:191], v[52:55]
v_mfma_f32_16x16x32_bf16 v[224:227], a[180:183], v[44:47], v[224:227]
ds_read_b64_tr_b16 a[110:111], v31 offset:35848
v_mfma_f32_16x16x32_bf16 v[224:227], a[60:63], v[88:91], v[224:227]
s_waitcnt lgkmcnt(4)
v_mfma_f32_16x16x32_bf16 v[192:195], a[44:47], v[84:87], v[192:195]
buffer_store_dwordx4 v[116:119], v21, s[32:35], 0 offen offset:320 sc1
v_mfma_f32_16x16x32_bf16 v[192:195], a[136:139], v[68:71], v[192:195]
v_mfma_f32_16x16x32_bf16 v[48:51], a[44:47], v[204:207], v[48:51]
v_mfma_f32_16x16x32_bf16 v[48:51], a[136:139], v[240:243], v[48:51]
s_waitcnt vmcnt(7) lgkmcnt(0)
s_barrier
v_mfma_f32_16x16x32_bf16 v[52:55], a[44:47], v[100:103], v[52:55]
ds_read_b64_tr_b16 a[188:189], v26 offset:0
v_mfma_f32_16x16x32_bf16 v[52:55], a[136:139], v[136:139], v[52:55]
ds_read_b64_tr_b16 a[190:191], v26 offset:24576
v_mfma_f32_16x16x32_bf16 v[224:227], a[44:47], v[232:235], v[224:227]
s_add_u32 m0, s39, 0
v_mfma_f32_16x16x32_bf16 v[224:227], a[136:139], v[248:251], v[224:227]
ds_read_b64_tr_b16 a[248:249], v26 offset:1024
v_mfma_f32_16x16x32_bf16 v[192:195], a[184:187], v[64:67], v[192:195]
ds_read_b64_tr_b16 a[156:157], v26 offset:2048
v_mfma_f32_16x16x32_bf16 v[192:195], a[108:111], v[80:83], v[192:195]
ds_read_b64_tr_b16 a[250:251], v26 offset:25600
v_mfma_f32_16x16x32_bf16 v[48:51], a[184:187], v[128:131], v[48:51]
ds_read_b64_tr_b16 a[158:159], v26 offset:26624
v_mfma_f32_16x16x32_bf16 v[48:51], a[108:111], v[132:135], v[48:51]
s_add_u32 s42, s38, 3712
v_mfma_f32_16x16x32_bf16 v[52:55], a[184:187], v[236:239], v[52:55]
ds_read_b64_tr_b16 a[252:253], v26 offset:3072
v_mfma_f32_16x16x32_bf16 v[52:55], a[108:111], v[160:163], v[52:55]
buffer_load_dwordx4 v8, s[24:27], s42 offen offset:0 lds
v_mfma_f32_16x16x32_bf16 v[224:227], a[184:187], v[208:211], v[224:227]
ds_read_b64_tr_b16 a[254:255], v26 offset:27648
v_mfma_f32_16x16x32_bf16 v[224:227], a[108:111], v[108:111], v[224:227]
s_waitcnt lgkmcnt(3)
v_mfma_f32_16x16x32_bf16 v[212:215], a[188:191], a[0:3], 0
ds_read_b64_tr_b16 a[16:17], v26 offset:4096
v_mfma_f32_16x16x32_bf16 v[212:215], a[248:251], a[4:7], v[212:215]
s_add_u32 s43, s38, 27264
v_mfma_f32_16x16x32_bf16 v[228:231], a[188:191], a[48:51], 0
ds_read_b64_tr_b16 a[18:19], v26 offset:28672
buffer_load_dwordx4 v8, s[24:27], s43 offen offset:1024 lds
v_mfma_f32_16x16x32_bf16 v[228:231], a[248:251], a[52:55], v[228:231]
s_add_u32 s42, s38, 50816
buffer_load_dwordx4 v8, s[24:27], s42 offen offset:2048 lds
v_mfma_f32_16x16x32_bf16 v[72:75], a[188:191], a[96:99], 0
ds_read_b64_tr_b16 a[20:21], v26 offset:5120
v_cvt_pk_bf16_f32 v142, v192, v193
v_mfma_f32_16x16x32_bf16 v[72:75], a[248:251], a[100:103], v[72:75]
v_cvt_pk_bf16_f32 v143, v194, v195
v_mfma_f32_16x16x32_bf16 v[152:155], a[188:191], a[144:147], 0
ds_read_b64_tr_b16 a[22:23], v26 offset:29696
s_add_u32 s43, s38, 74368
v_mfma_f32_16x16x32_bf16 v[152:155], a[248:251], a[148:151], v[152:155]
buffer_load_dwordx4 v8, s[24:27], s43 offen offset:3072 lds
s_waitcnt lgkmcnt(4)
v_mfma_f32_16x16x32_bf16 v[212:215], a[156:159], a[8:11], v[212:215]
ds_read_b64_tr_b16 a[64:65], v28 offset:6144
v_cvt_pk_bf16_f32 v150, v48, v49
v_mfma_f32_16x16x32_bf16 v[212:215], a[252:255], a[192:195], v[212:215]
v_cvt_pk_bf16_f32 v151, v50, v51
v_mfma_f32_16x16x32_bf16 v[228:231], a[156:159], a[56:59], v[228:231]
ds_read_b64_tr_b16 a[66:67], v28 offset:30720
v_mfma_f32_16x16x32_bf16 v[228:231], a[252:255], a[196:199], v[228:231]
v_cvt_pk_bf16_f32 v38, v52, v53
v_mfma_f32_16x16x32_bf16 v[72:75], a[156:159], a[104:107], v[72:75]
ds_read_b64_tr_b16 a[68:69], v28 offset:7168
v_cvt_pk_bf16_f32 v39, v54, v55
v_mfma_f32_16x16x32_bf16 v[72:75], a[252:255], a[200:203], v[72:75]
v_cvt_pk_bf16_f32 v126, v224, v225
v_mfma_f32_16x16x32_bf16 v[152:155], a[156:159], a[152:155], v[152:155]
ds_read_b64_tr_b16 a[70:71], v28 offset:31744
v_mfma_f32_16x16x32_bf16 v[152:155], a[252:255], a[208:211], v[152:155]
s_waitcnt lgkmcnt(4)
v_mfma_f32_16x16x32_bf16 v[212:215], a[16:19], a[204:207], v[212:215]
ds_read_b64_tr_b16 a[112:113], v28 offset:8192
v_mfma_f32_16x16x32_bf16 v[212:215], a[20:23], a[228:231], v[212:215]
v_cvt_pk_bf16_f32 v127, v226, v227
v_mfma_f32_16x16x32_bf16 v[228:231], a[16:19], a[212:215], v[228:231]
ds_read_b64_tr_b16 a[114:115], v28 offset:32768
v_mfma_f32_16x16x32_bf16 v[228:231], a[20:23], a[240:243], v[228:231]
s_add_u32 m0, s39, 4096
v_mfma_f32_16x16x32_bf16 v[72:75], a[16:19], a[216:219], v[72:75]
ds_read_b64_tr_b16 a[116:117], v28 offset:9216
v_mfma_f32_16x16x32_bf16 v[72:75], a[20:23], v[120:123], v[72:75]
s_add_u32 s42, s38, 102016
v_mfma_f32_16x16x32_bf16 v[152:155], a[16:19], a[220:223], v[152:155]
ds_read_b64_tr_b16 a[118:119], v28 offset:33792
v_mfma_f32_16x16x32_bf16 v[152:155], a[20:23], v[92:95], v[152:155]
s_waitcnt lgkmcnt(4)
v_mfma_f32_16x16x32_bf16 v[212:215], a[64:67], v[172:175], v[212:215]
ds_read_b64_tr_b16 a[160:161], v28 offset:10240
v_mfma_f32_16x16x32_bf16 v[212:215], a[68:71], v[104:107], v[212:215]
buffer_load_dwordx4 v8, s[24:27], s42 offen offset:0 lds
v_mfma_f32_16x16x32_bf16 v[228:231], a[64:67], v[168:171], v[228:231]
ds_read_b64_tr_b16 a[162:163], v28 offset:34816
v_mfma_f32_16x16x32_bf16 v[228:231], a[68:71], v[164:167], v[228:231]
s_add_u32 s43, s38, 125568
v_mfma_f32_16x16x32_bf16 v[72:75], a[64:67], v[40:43], v[72:75]
ds_read_b64_tr_b16 a[224:225], v28 offset:11264
v_mfma_f32_16x16x32_bf16 v[72:75], a[68:71], v[188:191], v[72:75]
buffer_load_dwordx4 v8, s[24:27], s43 offen offset:1024 lds
v_mfma_f32_16x16x32_bf16 v[152:155], a[64:67], v[44:47], v[152:155]
ds_read_b64_tr_b16 a[226:227], v28 offset:35840
v_mfma_f32_16x16x32_bf16 v[152:155], a[68:71], v[88:91], v[152:155]
s_waitcnt lgkmcnt(4)
v_mfma_f32_16x16x32_bf16 v[212:215], a[112:115], v[84:87], v[212:215]
ds_read_b64_tr_b16 a[172:173], v26 offset:8
v_mfma_f32_16x16x32_bf16 v[212:215], a[116:119], v[68:71], v[212:215]
s_add_u32 m0, s39, 55296
v_mfma_f32_16x16x32_bf16 v[228:231], a[112:115], v[204:207], v[228:231]
ds_read_b64_tr_b16 a[174:175], v26 offset:24584
v_mfma_f32_16x16x32_bf16 v[228:231], a[116:119], v[240:243], v[228:231]
s_add_u32 s42, s38, 151168
v_mfma_f32_16x16x32_bf16 v[72:75], a[112:115], v[100:103], v[72:75]
ds_read_b64_tr_b16 a[164:165], v26 offset:1032
v_mfma_f32_16x16x32_bf16 v[72:75], a[116:119], v[136:139], v[72:75]
buffer_load_dwordx4 v8, s[24:27], s42 offen offset:0 lds
v_mfma_f32_16x16x32_bf16 v[152:155], a[112:115], v[232:235], v[152:155]
ds_read_b64_tr_b16 a[166:167], v26 offset:25608
v_mfma_f32_16x16x32_bf16 v[152:155], a[116:119], v[248:251], v[152:155]
s_waitcnt lgkmcnt(4)
v_mfma_f32_16x16x32_bf16 v[212:215], a[160:163], v[64:67], v[212:215]
ds_read_b64_tr_b16 a[232:233], v26 offset:2056
v_mfma_f32_16x16x32_bf16 v[212:215], a[224:227], v[80:83], v[212:215]
s_add_u32 s43, s38, 174720
v_mfma_f32_16x16x32_bf16 v[228:231], a[160:163], v[128:131], v[228:231]
ds_read_b64_tr_b16 a[234:235], v26 offset:26632
v_mfma_f32_16x16x32_bf16 v[228:231], a[224:227], v[132:135], v[228:231]
buffer_load_dwordx4 v8, s[24:27], s43 offen offset:1024 lds
v_mfma_f32_16x16x32_bf16 v[72:75], a[160:163], v[236:239], v[72:75]
ds_read_b64_tr_b16 a[32:33], v26 offset:3080
v_mfma_f32_16x16x32_bf16 v[72:75], a[224:227], v[160:163], v[72:75]
s_add_u32 s42, s38, 198272
v_mfma_f32_16x16x32_bf16 v[152:155], a[160:163], v[208:211], v[152:155]
ds_read_b64_tr_b16 a[34:35], v26 offset:27656
v_mfma_f32_16x16x32_bf16 v[152:155], a[224:227], v[108:111], v[152:155]
s_waitcnt lgkmcnt(4)
v_mfma_f32_16x16x32_bf16 v[216:219], a[172:175], a[0:3], 0
ds_read_b64_tr_b16 a[36:37], v26 offset:4104
v_mfma_f32_16x16x32_bf16 v[216:219], a[164:167], a[4:7], v[216:219]
buffer_load_dwordx4 v8, s[24:27], s42 offen offset:2048 lds
s_add_u32 s43, s38, 221824
v_mfma_f32_16x16x32_bf16 v[244:247], a[172:175], a[48:51], 0
ds_read_b64_tr_b16 a[38:39], v26 offset:28680
buffer_load_dwordx4 v8, s[24:27], s43 offen offset:3072 lds
v_mfma_f32_16x16x32_bf16 v[244:247], a[164:167], a[52:55], v[244:247]
s_add_u32 m0, s39, 59392
s_add_u32 s42, s38, 249472
v_mfma_f32_16x16x32_bf16 v[196:199], a[172:175], a[96:99], 0
ds_read_b64_tr_b16 a[24:25], v26 offset:5128
buffer_load_dwordx4 v8, s[24:27], s42 offen offset:0 lds
v_mfma_f32_16x16x32_bf16 v[196:199], a[164:167], a[100:103], v[196:199]
buffer_store_dwordx4 v[96:99], v22, s[32:35], 0 offen offset:384 sc1
v_cvt_pk_bf16_f32 v176, v212, v213
v_mfma_f32_16x16x32_bf16 v[32:35], a[172:175], a[144:147], 0
ds_read_b64_tr_b16 a[26:27], v26 offset:29704
s_add_u32 s43, s38, 273024
v_mfma_f32_16x16x32_bf16 v[32:35], a[164:167], a[148:151], v[32:35]
buffer_load_dwordx4 v8, s[24:27], s43 offen offset:1024 lds
s_waitcnt lgkmcnt(4)
v_mfma_f32_16x16x32_bf16 v[216:219], a[232:235], a[8:11], v[216:219]
ds_read_b64_tr_b16 a[28:29], v28 offset:6152
v_cvt_pk_bf16_f32 v177, v214, v215
v_mfma_f32_16x16x32_bf16 v[216:219], a[32:35], a[192:195], v[216:219]
v_cvt_pk_bf16_f32 v180, v228, v229
v_cvt_pk_bf16_f32 v181, v230, v231
v_mfma_f32_16x16x32_bf16 v[244:247], a[232:235], a[56:59], v[244:247]
ds_read_b64_tr_b16 a[30:31], v28 offset:30728
v_mfma_f32_16x16x32_bf16 v[244:247], a[32:35], a[196:199], v[244:247]
v_cvt_pk_bf16_f32 v184, v72, v73
v_mfma_f32_16x16x32_bf16 v[196:199], a[232:235], a[104:107], v[196:199]
ds_read_b64_tr_b16 a[84:85], v28 offset:7176
v_mfma_f32_16x16x32_bf16 v[196:199], a[32:35], a[200:203], v[196:199]
v_cvt_pk_bf16_f32 v185, v74, v75
v_mfma_f32_16x16x32_bf16 v[32:35], a[232:235], a[152:155], v[32:35]
ds_read_b64_tr_b16 a[86:87], v28 offset:31752
v_mfma_f32_16x16x32_bf16 v[32:35], a[32:35], a[208:211], v[32:35]
s_waitcnt lgkmcnt(4)
v_mfma_f32_16x16x32_bf16 v[216:219], a[36:39], a[204:207], v[216:219]
ds_read_b64_tr_b16 a[72:73], v28 offset:8200
v_mfma_f32_16x16x32_bf16 v[216:219], a[24:27], a[228:231], v[216:219]
v_cvt_pk_bf16_f32 v144, v152, v153
v_mfma_f32_16x16x32_bf16 v[244:247], a[36:39], a[212:215], v[244:247]
ds_read_b64_tr_b16 a[74:75], v28 offset:32776
v_mfma_f32_16x16x32_bf16 v[244:247], a[24:27], a[240:243], v[244:247]
v_cvt_pk_bf16_f32 v145, v154, v155
v_mfma_f32_16x16x32_bf16 v[196:199], a[36:39], a[216:219], v[196:199]
ds_read_b64_tr_b16 a[76:77], v28 offset:9224
v_mfma_f32_16x16x32_bf16 v[196:199], a[24:27], v[120:123], v[196:199]
buffer_store_dwordx4 v[140:143], v22, s[32:35], 0 offen offset:448 sc1
v_mfma_f32_16x16x32_bf16 v[32:35], a[36:39], a[220:223], v[32:35]
ds_read_b64_tr_b16 a[78:79], v28 offset:33800
v_mfma_f32_16x16x32_bf16 v[32:35], a[24:27], v[92:95], v[32:35]
s_waitcnt lgkmcnt(4)
v_mfma_f32_16x16x32_bf16 v[216:219], a[28:31], v[172:175], v[216:219]
ds_read_b64_tr_b16 a[40:41], v28 offset:10248
v_mfma_f32_16x16x32_bf16 v[216:219], a[84:87], v[104:107], v[216:219]
v_mfma_f32_16x16x32_bf16 v[244:247], a[28:31], v[168:171], v[244:247]
ds_read_b64_tr_b16 a[42:43], v28 offset:34824
v_mfma_f32_16x16x32_bf16 v[244:247], a[84:87], v[164:167], v[244:247]
v_mfma_f32_16x16x32_bf16 v[196:199], a[28:31], v[40:43], v[196:199]
ds_read_b64_tr_b16 a[120:121], v28 offset:11272
v_mfma_f32_16x16x32_bf16 v[196:199], a[84:87], v[188:191], v[196:199]
v_mfma_f32_16x16x32_bf16 v[32:35], a[28:31], v[44:47], v[32:35]
ds_read_b64_tr_b16 a[122:123], v28 offset:35848
v_mfma_f32_16x16x32_bf16 v[32:35], a[84:87], v[88:91], v[32:35]
s_waitcnt lgkmcnt(4)
v_mfma_f32_16x16x32_bf16 v[216:219], a[72:75], v[84:87], v[216:219]
ds_read_b64_tr_b16 a[88:89], v31 offset:0
v_mfma_f32_16x16x32_bf16 v[216:219], a[76:79], v[68:71], v[216:219]
v_mfma_f32_16x16x32_bf16 v[244:247], a[72:75], v[204:207], v[244:247]
ds_read_b64_tr_b16 a[90:91], v31 offset:24576
v_mfma_f32_16x16x32_bf16 v[244:247], a[76:79], v[240:243], v[244:247]
v_mfma_f32_16x16x32_bf16 v[196:199], a[72:75], v[100:103], v[196:199]
ds_read_b64_tr_b16 a[124:125], v31 offset:1024
v_mfma_f32_16x16x32_bf16 v[196:199], a[76:79], v[136:139], v[196:199]
buffer_store_dwordx4 v[220:223], v25, s[32:35], 0 offen offset:384 sc1
v_mfma_f32_16x16x32_bf16 v[32:35], a[72:75], v[232:235], v[32:35]
ds_read_b64_tr_b16 a[126:127], v31 offset:25600
v_mfma_f32_16x16x32_bf16 v[32:35], a[76:79], v[248:251], v[32:35]
s_waitcnt lgkmcnt(4)
v_mfma_f32_16x16x32_bf16 v[216:219], a[40:43], v[64:67], v[216:219]
ds_read_b64_tr_b16 a[92:93], v31 offset:2048
v_mfma_f32_16x16x32_bf16 v[216:219], a[120:123], v[80:83], v[216:219]
v_mfma_f32_16x16x32_bf16 v[244:247], a[40:43], v[128:131], v[244:247]
ds_read_b64_tr_b16 a[94:95], v31 offset:26624
v_mfma_f32_16x16x32_bf16 v[244:247], a[120:123], v[132:135], v[244:247]
v_mfma_f32_16x16x32_bf16 v[196:199], a[40:43], v[236:239], v[196:199]
ds_read_b64_tr_b16 a[140:141], v31 offset:3072
v_mfma_f32_16x16x32_bf16 v[196:199], a[120:123], v[160:163], v[196:199]
v_mfma_f32_16x16x32_bf16 v[32:35], a[40:43], v[208:211], v[32:35]
ds_read_b64_tr_b16 a[142:143], v31 offset:27648
v_mfma_f32_16x16x32_bf16 v[32:35], a[120:123], v[108:111], v[32:35]
s_waitcnt lgkmcnt(4)
v_mfma_f32_16x16x32_bf16 v[56:59], a[88:91], a[0:3], 0
ds_read_b64_tr_b16 a[168:169], v31 offset:4096
v_mfma_f32_16x16x32_bf16 v[56:59], a[124:127], a[4:7], v[56:59]
v_cvt_pk_bf16_f32 v178, v216, v217
v_mfma_f32_16x16x32_bf16 v[76:79], a[88:91], a[48:51], 0
ds_read_b64_tr_b16 a[170:171], v31 offset:28672
v_mfma_f32_16x16x32_bf16 v[76:79], a[124:127], a[52:55], v[76:79]
v_cvt_pk_bf16_f32 v179, v218, v219
v_mfma_f32_16x16x32_bf16 v[252:255], a[88:91], a[96:99], 0
ds_read_b64_tr_b16 a[236:237], v31 offset:5120
v_mfma_f32_16x16x32_bf16 v[252:255], a[124:127], a[100:103], v[252:255]
v_cvt_pk_bf16_f32 v182, v244, v245
v_mfma_f32_16x16x32_bf16 v[156:159], a[88:91], a[144:147], 0
ds_read_b64_tr_b16 a[238:239], v31 offset:29696
v_cvt_pk_bf16_f32 v183, v246, v247
v_mfma_f32_16x16x32_bf16 v[156:159], a[124:127], a[148:151], v[156:159]
buffer_store_dwordx4 v[148:151], v25, s[32:35], 0 offen offset:448 sc1
s_waitcnt lgkmcnt(4)
v_mfma_f32_16x16x32_bf16 v[56:59], a[92:95], a[8:11], v[56:59]
ds_read_b64_tr_b16 a[244:245], v24 offset:6144
v_mfma_f32_16x16x32_bf16 v[56:59], a[140:143], a[192:195], v[56:59]
v_cvt_pk_bf16_f32 v186, v196, v197
v_mfma_f32_16x16x32_bf16 v[76:79], a[92:95], a[56:59], v[76:79]
ds_read_b64_tr_b16 a[246:247], v24 offset:30720
v_mfma_f32_16x16x32_bf16 v[76:79], a[140:143], a[196:199], v[76:79]
v_cvt_pk_bf16_f32 v187, v198, v199
v_mfma_f32_16x16x32_bf16 v[252:255], a[92:95], a[104:107], v[252:255]
ds_read_b64_tr_b16 a[80:81], v24 offset:7168
v_mfma_f32_16x16x32_bf16 v[252:255], a[140:143], a[200:203], v[252:255]
v_cvt_pk_bf16_f32 v146, v32, v33
v_mfma_f32_16x16x32_bf16 v[156:159], a[92:95], a[152:155], v[156:159]
ds_read_b64_tr_b16 a[82:83], v24 offset:31744
v_mfma_f32_16x16x32_bf16 v[156:159], a[140:143], a[208:211], v[156:159]
s_waitcnt lgkmcnt(4)
v_mfma_f32_16x16x32_bf16 v[56:59], a[168:171], a[204:207], v[56:59]
ds_read_b64_tr_b16 a[128:129], v24 offset:8192
v_mfma_f32_16x16x32_bf16 v[56:59], a[236:239], a[228:231], v[56:59]
v_cvt_pk_bf16_f32 v147, v34, v35
v_mfma_f32_16x16x32_bf16 v[76:79], a[168:171], a[212:215], v[76:79]
ds_read_b64_tr_b16 a[130:131], v24 offset:32768
v_mfma_f32_16x16x32_bf16 v[76:79], a[236:239], a[240:243], v[76:79]
buffer_store_dwordx4 v[176:179], v22, s[32:35], 0 offen offset:512 sc1
v_mfma_f32_16x16x32_bf16 v[252:255], a[168:171], a[216:219], v[252:255]
ds_read_b64_tr_b16 a[132:133], v24 offset:9216
v_mfma_f32_16x16x32_bf16 v[252:255], a[236:239], v[120:123], v[252:255]
v_mfma_f32_16x16x32_bf16 v[156:159], a[168:171], a[220:223], v[156:159]
ds_read_b64_tr_b16 a[134:135], v24 offset:33792
v_mfma_f32_16x16x32_bf16 v[156:159], a[236:239], v[92:95], v[156:159]
s_waitcnt lgkmcnt(4)
v_mfma_f32_16x16x32_bf16 v[56:59], a[244:247], v[172:175], v[56:59]
ds_read_b64_tr_b16 a[176:177], v24 offset:10240
v_mfma_f32_16x16x32_bf16 v[56:59], a[80:83], v[104:107], v[56:59]
buffer_store_dwordx4 v[112:115], v10, s[32:35], 0 offen offset:384 sc1
v_mfma_f32_16x16x32_bf16 v[76:79], a[244:247], v[168:171], v[76:79]
ds_read_b64_tr_b16 a[178:179], v24 offset:34816
v_mfma_f32_16x16x32_bf16 v[76:79], a[80:83], v[164:167], v[76:79]
v_mfma_f32_16x16x32_bf16 v[252:255], a[244:247], v[40:43], v[252:255]
ds_read_b64_tr_b16 a[12:13], v24 offset:11264
v_mfma_f32_16x16x32_bf16 v[252:255], a[80:83], v[188:191], v[252:255]
v_mfma_f32_16x16x32_bf16 v[156:159], a[244:247], v[44:47], v[156:159]
ds_read_b64_tr_b16 a[14:15], v24 offset:35840
v_mfma_f32_16x16x32_bf16 v[156:159], a[80:83], v[88:91], v[156:159]
s_waitcnt lgkmcnt(4)
v_mfma_f32_16x16x32_bf16 v[56:59], a[128:131], v[84:87], v[56:59]
ds_read_b64_tr_b16 a[180:181], v31 offset:8
v_mfma_f32_16x16x32_bf16 v[56:59], a[132:135], v[68:71], v[56:59]
buffer_store_dwordx4 v[180:183], v25, s[32:35], 0 offen offset:512 sc1
v_mfma_f32_16x16x32_bf16 v[76:79], a[128:131], v[204:207], v[76:79]
ds_read_b64_tr_b16 a[182:183], v31 offset:24584
v_mfma_f32_16x16x32_bf16 v[76:79], a[132:135], v[240:243], v[76:79]
v_mfma_f32_16x16x32_bf16 v[252:255], a[128:131], v[100:103], v[252:255]
ds_read_b64_tr_b16 a[60:61], v31 offset:1032
v_mfma_f32_16x16x32_bf16 v[252:255], a[132:135], v[136:139], v[252:255]
v_mfma_f32_16x16x32_bf16 v[156:159], a[128:131], v[232:235], v[156:159]
ds_read_b64_tr_b16 a[62:63], v31 offset:25608
v_mfma_f32_16x16x32_bf16 v[156:159], a[132:135], v[248:251], v[156:159]
s_waitcnt lgkmcnt(4)
v_mfma_f32_16x16x32_bf16 v[56:59], a[176:179], v[64:67], v[56:59]
ds_read_b64_tr_b16 a[44:45], v31 offset:2056
v_mfma_f32_16x16x32_bf16 v[56:59], a[12:15], v[80:83], v[56:59]
v_mfma_f32_16x16x32_bf16 v[76:79], a[176:179], v[128:131], v[76:79]
ds_read_b64_tr_b16 a[46:47], v31 offset:26632
v_mfma_f32_16x16x32_bf16 v[76:79], a[12:15], v[132:135], v[76:79]
buffer_store_dwordx4 v[36:39], v10, s[32:35], 0 offen offset:448 sc1
v_mfma_f32_16x16x32_bf16 v[252:255], a[176:179], v[236:239], v[252:255]
ds_read_b64_tr_b16 a[136:137], v31 offset:3080
v_mfma_f32_16x16x32_bf16 v[252:255], a[12:15], v[160:163], v[252:255]
v_mfma_f32_16x16x32_bf16 v[156:159], a[176:179], v[208:211], v[156:159]
ds_read_b64_tr_b16 a[138:139], v31 offset:27656
v_mfma_f32_16x16x32_bf16 v[156:159], a[12:15], v[108:111], v[156:159]
s_waitcnt lgkmcnt(4)
v_mfma_f32_16x16x32_bf16 v[60:63], a[180:183], a[0:3], 0
ds_read_b64_tr_b16 a[184:185], v31 offset:4104
v_mfma_f32_16x16x32_bf16 v[60:63], a[60:63], a[4:7], v[60:63]
v_cvt_pk_bf16_f32 v116, v56, v57
v_mfma_f32_16x16x32_bf16 v[192:195], a[180:183], a[48:51], 0
ds_read_b64_tr_b16 a[186:187], v31 offset:28680
v_mfma_f32_16x16x32_bf16 v[192:195], a[60:63], a[52:55], v[192:195]
v_cvt_pk_bf16_f32 v117, v58, v59
v_mfma_f32_16x16x32_bf16 v[48:51], a[180:183], a[96:99], 0
ds_read_b64_tr_b16 a[108:109], v31 offset:5128
v_mfma_f32_16x16x32_bf16 v[48:51], a[60:63], a[100:103], v[48:51]
buffer_store_dwordx4 v[184:187], v10, s[32:35], 0 offen offset:512 sc1
v_mfma_f32_16x16x32_bf16 v[52:55], a[180:183], a[144:147], 0
ds_read_b64_tr_b16 a[110:111], v31 offset:29704
v_cvt_pk_bf16_f32 v224, v76, v77
v_mfma_f32_16x16x32_bf16 v[52:55], a[60:63], a[148:151], v[52:55]
v_cvt_pk_bf16_f32 v225, v78, v79
s_waitcnt lgkmcnt(4)
v_mfma_f32_16x16x32_bf16 v[60:63], a[44:47], a[8:11], v[60:63]
ds_read_b64_tr_b16 a[188:189], v24 offset:6152
v_mfma_f32_16x16x32_bf16 v[60:63], a[136:139], a[192:195], v[60:63]
v_cvt_pk_bf16_f32 v96, v252, v253
v_mfma_f32_16x16x32_bf16 v[192:195], a[44:47], a[56:59], v[192:195]
ds_read_b64_tr_b16 a[190:191], v24 offset:30728
v_mfma_f32_16x16x32_bf16 v[192:195], a[136:139], a[196:199], v[192:195]
v_cvt_pk_bf16_f32 v97, v254, v255
v_mfma_f32_16x16x32_bf16 v[48:51], a[44:47], a[104:107], v[48:51]
ds_read_b64_tr_b16 a[248:249], v24 offset:7176
v_mfma_f32_16x16x32_bf16 v[48:51], a[136:139], a[200:203], v[48:51]
v_cvt_pk_bf16_f32 v212, v156, v157
v_mfma_f32_16x16x32_bf16 v[52:55], a[44:47], a[152:155], v[52:55]
ds_read_b64_tr_b16 a[250:251], v24 offset:31752
v_mfma_f32_16x16x32_bf16 v[52:55], a[136:139], a[208:211], v[52:55]
s_waitcnt lgkmcnt(4)
v_mfma_f32_16x16x32_bf16 v[60:63], a[184:187], a[204:207], v[60:63]
ds_read_b64_tr_b16 a[156:157], v24 offset:8200
v_mfma_f32_16x16x32_bf16 v[60:63], a[108:111], a[228:231], v[60:63]
v_cvt_pk_bf16_f32 v213, v158, v159
v_mfma_f32_16x16x32_bf16 v[192:195], a[184:187], a[212:215], v[192:195]
ds_read_b64_tr_b16 a[158:159], v24 offset:32776
v_mfma_f32_16x16x32_bf16 v[192:195], a[108:111], a[240:243], v[192:195]
buffer_store_dwordx4 v[200:203], v21, s[32:35], 0 offen offset:384 sc1
v_mfma_f32_16x16x32_bf16 v[48:51], a[184:187], a[216:219], v[48:51]
ds_read_b64_tr_b16 a[252:253], v24 offset:9224
v_mfma_f32_16x16x32_bf16 v[48:51], a[108:111], v[120:123], v[48:51]
v_mfma_f32_16x16x32_bf16 v[52:55], a[184:187], a[220:223], v[52:55]
ds_read_b64_tr_b16 a[254:255], v24 offset:33800
v_mfma_f32_16x16x32_bf16 v[52:55], a[108:111], v[92:95], v[52:55]
s_waitcnt lgkmcnt(4)
v_mfma_f32_16x16x32_bf16 v[60:63], a[188:191], v[172:175], v[60:63]
ds_read_b64_tr_b16 a[16:17], v24 offset:10248
v_mfma_f32_16x16x32_bf16 v[60:63], a[248:251], v[104:107], v[60:63]
buffer_store_dwordx4 v[144:147], v21, s[32:35], 0 offen offset:512 sc1
v_mfma_f32_16x16x32_bf16 v[192:195], a[188:191], v[168:171], v[192:195]
ds_read_b64_tr_b16 a[18:19], v24 offset:34824
v_mfma_f32_16x16x32_bf16 v[192:195], a[248:251], v[164:167], v[192:195]
v_mfma_f32_16x16x32_bf16 v[48:51], a[188:191], v[40:43], v[48:51]
ds_read_b64_tr_b16 a[20:21], v24 offset:11272
v_mfma_f32_16x16x32_bf16 v[48:51], a[248:251], v[188:191], v[48:51]
v_mfma_f32_16x16x32_bf16 v[52:55], a[188:191], v[44:47], v[52:55]
ds_read_b64_tr_b16 a[22:23], v24 offset:35848
v_mfma_f32_16x16x32_bf16 v[52:55], a[248:251], v[88:91], v[52:55]
s_waitcnt lgkmcnt(4)
v_mfma_f32_16x16x32_bf16 v[60:63], a[156:159], v[84:87], v[60:63]
buffer_store_dwordx4 v[124:127], v21, s[32:35], 0 offen offset:448 sc1
v_mfma_f32_16x16x32_bf16 v[60:63], a[252:255], v[68:71], v[60:63]
v_mfma_f32_16x16x32_bf16 v[192:195], a[156:159], v[204:207], v[192:195]
v_mfma_f32_16x16x32_bf16 v[192:195], a[252:255], v[240:243], v[192:195]
s_waitcnt vmcnt(11) lgkmcnt(0)
s_barrier
v_mfma_f32_16x16x32_bf16 v[48:51], a[156:159], v[100:103], v[48:51]
ds_read_b64_tr_b16 a[64:65], v28 offset:0
v_mfma_f32_16x16x32_bf16 v[48:51], a[252:255], v[136:139], v[48:51]
ds_read_b64_tr_b16 a[66:67], v28 offset:24576
v_mfma_f32_16x16x32_bf16 v[52:55], a[156:159], v[232:235], v[52:55]
v_mfma_f32_16x16x32_bf16 v[52:55], a[252:255], v[248:251], v[52:55]
ds_read_b64_tr_b16 a[68:69], v28 offset:1024
v_mfma_f32_16x16x32_bf16 v[60:63], a[16:19], v[64:67], v[60:63]
ds_read_b64_tr_b16 a[112:113], v28 offset:2048
v_mfma_f32_16x16x32_bf16 v[60:63], a[20:23], v[80:83], v[60:63]
ds_read_b64_tr_b16 a[70:71], v28 offset:25600
v_mfma_f32_16x16x32_bf16 v[192:195], a[16:19], v[128:131], v[192:195]
ds_read_b64_tr_b16 a[114:115], v28 offset:26624
v_mfma_f32_16x16x32_bf16 v[192:195], a[20:23], v[132:135], v[192:195]
v_mfma_f32_16x16x32_bf16 v[48:51], a[16:19], v[236:239], v[48:51]
ds_read_b64_tr_b16 a[116:117], v28 offset:3072
v_mfma_f32_16x16x32_bf16 v[48:51], a[20:23], v[160:163], v[48:51]
v_mfma_f32_16x16x32_bf16 v[52:55], a[16:19], v[208:211], v[52:55]
ds_read_b64_tr_b16 a[118:119], v28 offset:27648
v_mfma_f32_16x16x32_bf16 v[52:55], a[20:23], v[108:111], v[52:55]
s_waitcnt lgkmcnt(3)
v_mfma_f32_16x16x32_bf16 v[228:231], a[64:67], a[0:3], 0
ds_read_b64_tr_b16 a[160:161], v28 offset:4096
v_mfma_f32_16x16x32_bf16 v[228:231], a[68:71], a[4:7], v[228:231]
v_cvt_pk_bf16_f32 v118, v60, v61
v_mfma_f32_16x16x32_bf16 v[72:75], a[64:67], a[48:51], 0
ds_read_b64_tr_b16 a[162:163], v28 offset:28672
v_mfma_f32_16x16x32_bf16 v[72:75], a[68:71], a[52:55], v[72:75]
v_cvt_pk_bf16_f32 v119, v62, v63
v_mfma_f32_16x16x32_bf16 v[152:155], a[64:67], a[96:99], 0
ds_read_b64_tr_b16 a[224:225], v28 offset:5120
v_mfma_f32_16x16x32_bf16 v[152:155], a[68:71], a[100:103], v[152:155]
v_cvt_pk_bf16_f32 v226, v192, v193
v_mfma_f32_16x16x32_bf16 v[140:143], a[64:67], a[144:147], 0
ds_read_b64_tr_b16 a[226:227], v28 offset:29696
v_cvt_pk_bf16_f32 v227, v194, v195
v_mfma_f32_16x16x32_bf16 v[140:143], a[68:71], a[148:151], v[140:143]
s_waitcnt lgkmcnt(4)
v_mfma_f32_16x16x32_bf16 v[228:231], a[112:115], a[8:11], v[228:231]
ds_read_b64_tr_b16 a[172:173], v26 offset:6144
v_mfma_f32_16x16x32_bf16 v[228:231], a[116:119], a[192:195], v[228:231]
v_cvt_pk_bf16_f32 v98, v48, v49
v_mfma_f32_16x16x32_bf16 v[72:75], a[112:115], a[56:59], v[72:75]
ds_read_b64_tr_b16 a[174:175], v26 offset:30720
v_mfma_f32_16x16x32_bf16 v[72:75], a[116:119], a[196:199], v[72:75]
v_cvt_pk_bf16_f32 v99, v50, v51
v_mfma_f32_16x16x32_bf16 v[152:155], a[112:115], a[104:107], v[152:155]
ds_read_b64_tr_b16 a[164:165], v26 offset:7168
v_mfma_f32_16x16x32_bf16 v[152:155], a[116:119], a[200:203], v[152:155]
v_cvt_pk_bf16_f32 v214, v52, v53
v_mfma_f32_16x16x32_bf16 v[140:143], a[112:115], a[152:155], v[140:143]
ds_read_b64_tr_b16 a[166:167], v26 offset:31744
v_mfma_f32_16x16x32_bf16 v[140:143], a[116:119], a[208:211], v[140:143]
s_waitcnt lgkmcnt(4)
v_mfma_f32_16x16x32_bf16 v[228:231], a[160:163], a[204:207], v[228:231]
ds_read_b64_tr_b16 a[232:233], v26 offset:8192
v_mfma_f32_16x16x32_bf16 v[228:231], a[224:227], a[228:231], v[228:231]
v_cvt_pk_bf16_f32 v215, v54, v55
v_mfma_f32_16x16x32_bf16 v[72:75], a[160:163], a[212:215], v[72:75]
ds_read_b64_tr_b16 a[234:235], v26 offset:32768
v_mfma_f32_16x16x32_bf16 v[72:75], a[224:227], a[240:243], v[72:75]
buffer_store_dwordx4 v[116:119], v22, s[32:35], 0 offen offset:576 sc1
v_mfma_f32_16x16x32_bf16 v[152:155], a[160:163], a[216:219], v[152:155]
ds_read_b64_tr_b16 a[32:33], v26 offset:9216
v_mfma_f32_16x16x32_bf16 v[152:155], a[224:227], v[120:123], v[152:155]
v_mfma_f32_16x16x32_bf16 v[140:143], a[160:163], a[220:223], v[140:143]
ds_read_b64_tr_b16 a[34:35], v26 offset:33792
v_mfma_f32_16x16x32_bf16 v[140:143], a[224:227], v[92:95], v[140:143]
s_waitcnt lgkmcnt(4)
v_mfma_f32_16x16x32_bf16 v[228:231], a[172:175], v[172:175], v[228:231]
ds_read_b64_tr_b16 a[36:37], v26 offset:10240
v_mfma_f32_16x16x32_bf16 v[228:231], a[164:167], v[104:107], v[228:231]
v_mfma_f32_16x16x32_bf16 v[72:75], a[172:175], v[168:171], v[72:75]
ds_read_b64_tr_b16 a[38:39], v26 offset:34816
v_mfma_f32_16x16x32_bf16 v[72:75], a[164:167], v[164:167], v[72:75]
v_mfma_f32_16x16x32_bf16 v[152:155], a[172:175], v[40:43], v[152:155]
ds_read_b64_tr_b16 a[24:25], v26 offset:11264
v_mfma_f32_16x16x32_bf16 v[152:155], a[164:167], v[188:191], v[152:155]
v_mfma_f32_16x16x32_bf16 v[140:143], a[172:175], v[44:47], v[140:143]
ds_read_b64_tr_b16 a[26:27], v26 offset:35840
v_mfma_f32_16x16x32_bf16 v[140:143], a[164:167], v[88:91], v[140:143]
s_waitcnt lgkmcnt(4)
v_mfma_f32_16x16x32_bf16 v[228:231], a[232:235], v[84:87], v[228:231]
ds_read_b64_tr_b16 a[28:29], v28 offset:8
v_mfma_f32_16x16x32_bf16 v[228:231], a[32:35], v[68:71], v[228:231]
buffer_store_dwordx4 v[224:227], v25, s[32:35], 0 offen offset:576 sc1
v_mfma_f32_16x16x32_bf16 v[72:75], a[232:235], v[204:207], v[72:75]
ds_read_b64_tr_b16 a[30:31], v28 offset:24584
v_mfma_f32_16x16x32_bf16 v[72:75], a[32:35], v[240:243], v[72:75]
v_mfma_f32_16x16x32_bf16 v[152:155], a[232:235], v[100:103], v[152:155]
ds_read_b64_tr_b16 a[84:85], v28 offset:1032
v_mfma_f32_16x16x32_bf16 v[152:155], a[32:35], v[136:139], v[152:155]
v_mfma_f32_16x16x32_bf16 v[140:143], a[232:235], v[232:235], v[140:143]
ds_read_b64_tr_b16 a[86:87], v28 offset:25608
v_mfma_f32_16x16x32_bf16 v[140:143], a[32:35], v[248:251], v[140:143]
s_waitcnt lgkmcnt(4)
v_mfma_f32_16x16x32_bf16 v[228:231], a[36:39], v[64:67], v[228:231]
ds_read_b64_tr_b16 a[72:73], v28 offset:2056
v_mfma_f32_16x16x32_bf16 v[228:231], a[24:27], v[80:83], v[228:231]
v_mfma_f32_16x16x32_bf16 v[72:75], a[36:39], v[128:131], v[72:75]
ds_read_b64_tr_b16 a[74:75], v28 offset:26632
v_mfma_f32_16x16x32_bf16 v[72:75], a[24:27], v[132:135], v[72:75]
v_mfma_f32_16x16x32_bf16 v[152:155], a[36:39], v[236:239], v[152:155]
ds_read_b64_tr_b16 a[76:77], v28 offset:3080
v_mfma_f32_16x16x32_bf16 v[152:155], a[24:27], v[160:163], v[152:155]
v_mfma_f32_16x16x32_bf16 v[140:143], a[36:39], v[208:211], v[140:143]
ds_read_b64_tr_b16 a[78:79], v28 offset:27656
v_mfma_f32_16x16x32_bf16 v[140:143], a[24:27], v[108:111], v[140:143]
s_waitcnt lgkmcnt(4)
v_mfma_f32_16x16x32_bf16 v[220:223], a[28:31], a[0:3], 0
ds_read_b64_tr_b16 a[40:41], v28 offset:4104
v_mfma_f32_16x16x32_bf16 v[220:223], a[84:87], a[4:7], v[220:223]
v_cvt_pk_bf16_f32 v216, v228, v229
v_mfma_f32_16x16x32_bf16 v[244:247], a[28:31], a[48:51], 0
ds_read_b64_tr_b16 a[42:43], v28 offset:28680
v_mfma_f32_16x16x32_bf16 v[244:247], a[84:87], a[52:55], v[244:247]
v_cvt_pk_bf16_f32 v217, v230, v231
v_mfma_f32_16x16x32_bf16 v[148:151], a[28:31], a[96:99], 0
ds_read_b64_tr_b16 a[120:121], v28 offset:5128
v_mfma_f32_16x16x32_bf16 v[148:151], a[84:87], a[100:103], v[148:151]
buffer_store_dwordx4 v[96:99], v10, s[32:35], 0 offen offset:576 sc1
v_mfma_f32_16x16x32_bf16 v[196:199], a[28:31], a[144:147], 0
ds_read_b64_tr_b16 a[122:123], v28 offset:29704
v_cvt_pk_bf16_f32 v32, v72, v73
v_mfma_f32_16x16x32_bf16 v[196:199], a[84:87], a[148:151], v[196:199]
v_cvt_pk_bf16_f32 v33, v74, v75
s_waitcnt lgkmcnt(4)
v_mfma_f32_16x16x32_bf16 v[220:223], a[72:75], a[8:11], v[220:223]
ds_read_b64_tr_b16 a[88:89], v26 offset:6152
v_mfma_f32_16x16x32_bf16 v[220:223], a[76:79], a[192:195], v[220:223]
v_cvt_pk_bf16_f32 v176, v152, v153
v_mfma_f32_16x16x32_bf16 v[244:247], a[72:75], a[56:59], v[244:247]
ds_read_b64_tr_b16 a[90:91], v26 offset:30728
v_mfma_f32_16x16x32_bf16 v[244:247], a[76:79], a[196:199], v[244:247]
v_cvt_pk_bf16_f32 v177, v154, v155
v_mfma_f32_16x16x32_bf16 v[148:151], a[72:75], a[104:107], v[148:151]
ds_read_b64_tr_b16 a[124:125], v26 offset:7176
v_mfma_f32_16x16x32_bf16 v[148:151], a[76:79], a[200:203], v[148:151]
v_cvt_pk_bf16_f32 v112, v140, v141
v_mfma_f32_16x16x32_bf16 v[196:199], a[72:75], a[152:155], v[196:199]
ds_read_b64_tr_b16 a[126:127], v26 offset:31752
v_mfma_f32_16x16x32_bf16 v[196:199], a[76:79], a[208:211], v[196:199]
s_waitcnt lgkmcnt(4)
v_mfma_f32_16x16x32_bf16 v[220:223], a[40:43], a[204:207], v[220:223]
ds_read_b64_tr_b16 a[92:93], v26 offset:8200
v_mfma_f32_16x16x32_bf16 v[220:223], a[120:123], a[228:231], v[220:223]
v_cvt_pk_bf16_f32 v113, v142, v143
v_mfma_f32_16x16x32_bf16 v[244:247], a[40:43], a[212:215], v[244:247]
ds_read_b64_tr_b16 a[94:95], v26 offset:32776
v_mfma_f32_16x16x32_bf16 v[244:247], a[120:123], a[240:243], v[244:247]
v_mfma_f32_16x16x32_bf16 v[148:151], a[40:43], a[216:219], v[148:151]
ds_read_b64_tr_b16 a[140:141], v26 offset:9224
v_mfma_f32_16x16x32_bf16 v[148:151], a[120:123], v[120:123], v[148:151]
v_mfma_f32_16x16x32_bf16 v[196:199], a[40:43], a[220:223], v[196:199]
ds_read_b64_tr_b16 a[142:143], v26 offset:33800
v_mfma_f32_16x16x32_bf16 v[196:199], a[120:123], v[92:95], v[196:199]
s_waitcnt lgkmcnt(4)
v_mfma_f32_16x16x32_bf16 v[220:223], a[88:91], v[172:175], v[220:223]
ds_read_b64_tr_b16 a[168:169], v26 offset:10248
v_mfma_f32_16x16x32_bf16 v[220:223], a[124:127], v[104:107], v[220:223]
buffer_store_dwordx4 v[212:215], v21, s[32:35], 0 offen offset:576 sc1
v_mfma_f32_16x16x32_bf16 v[244:247], a[88:91], v[168:171], v[244:247]
ds_read_b64_tr_b16 a[170:171], v26 offset:34824
v_mfma_f32_16x16x32_bf16 v[244:247], a[124:127], v[164:167], v[244:247]
v_mfma_f32_16x16x32_bf16 v[148:151], a[88:91], v[40:43], v[148:151]
ds_read_b64_tr_b16 a[236:237], v26 offset:11272
v_mfma_f32_16x16x32_bf16 v[148:151], a[124:127], v[188:191], v[148:151]
v_mfma_f32_16x16x32_bf16 v[196:199], a[88:91], v[44:47], v[196:199]
ds_read_b64_tr_b16 a[238:239], v26 offset:35848
v_mfma_f32_16x16x32_bf16 v[196:199], a[124:127], v[88:91], v[196:199]
s_waitcnt lgkmcnt(4)
v_mfma_f32_16x16x32_bf16 v[220:223], a[92:95], v[84:87], v[220:223]
ds_read_b64_tr_b16 a[244:245], v24 offset:0
v_mfma_f32_16x16x32_bf16 v[220:223], a[140:143], v[68:71], v[220:223]
v_mfma_f32_16x16x32_bf16 v[244:247], a[92:95], v[204:207], v[244:247]
ds_read_b64_tr_b16 a[246:247], v24 offset:24576
v_mfma_f32_16x16x32_bf16 v[244:247], a[140:143], v[240:243], v[244:247]
v_mfma_f32_16x16x32_bf16 v[148:151], a[92:95], v[100:103], v[148:151]
ds_read_b64_tr_b16 a[80:81], v24 offset:1024
v_mfma_f32_16x16x32_bf16 v[148:151], a[140:143], v[136:139], v[148:151]
v_mfma_f32_16x16x32_bf16 v[196:199], a[92:95], v[232:235], v[196:199]
ds_read_b64_tr_b16 a[82:83], v24 offset:25600
v_mfma_f32_16x16x32_bf16 v[196:199], a[140:143], v[248:251], v[196:199]
s_waitcnt lgkmcnt(4)
v_mfma_f32_16x16x32_bf16 v[220:223], a[168:171], v[64:67], v[220:223]
ds_read_b64_tr_b16 a[128:129], v24 offset:2048
v_mfma_f32_16x16x32_bf16 v[220:223], a[236:239], v[80:83], v[220:223]
v_mfma_f32_16x16x32_bf16 v[244:247], a[168:171], v[128:131], v[244:247]
ds_read_b64_tr_b16 a[130:131], v24 offset:26624
v_mfma_f32_16x16x32_bf16 v[244:247], a[236:239], v[132:135], v[244:247]
v_mfma_f32_16x16x32_bf16 v[148:151], a[168:171], v[236:239], v[148:151]
ds_read_b64_tr_b16 a[132:133], v24 offset:3072
v_mfma_f32_16x16x32_bf16 v[148:151], a[236:239], v[160:163], v[148:151]
v_mfma_f32_16x16x32_bf16 v[196:199], a[168:171], v[208:211], v[196:199]
ds_read_b64_tr_b16 a[134:135], v24 offset:27648
v_mfma_f32_16x16x32_bf16 v[196:199], a[236:239], v[108:111], v[196:199]
s_waitcnt lgkmcnt(4)
v_mfma_f32_16x16x32_bf16 v[180:183], a[244:247], a[0:3], 0
ds_read_b64_tr_b16 a[176:177], v24 offset:4096
v_mfma_f32_16x16x32_bf16 v[180:183], a[80:83], a[4:7], v[180:183]
v_cvt_pk_bf16_f32 v218, v220, v221
v_mfma_f32_16x16x32_bf16 v[36:39], a[244:247], a[48:51], 0
ds_read_b64_tr_b16 a[178:179], v24 offset:28672
v_mfma_f32_16x16x32_bf16 v[36:39], a[80:83], a[52:55], v[36:39]
v_cvt_pk_bf16_f32 v219, v222, v223
v_mfma_f32_16x16x32_bf16 v[56:59], a[244:247], a[96:99], 0
ds_read_b64_tr_b16 a[12:13], v24 offset:5120
v_mfma_f32_16x16x32_bf16 v[56:59], a[80:83], a[100:103], v[56:59]
v_cvt_pk_bf16_f32 v34, v244, v245
v_mfma_f32_16x16x32_bf16 v[184:187], a[244:247], a[144:147], 0
ds_read_b64_tr_b16 a[14:15], v24 offset:29696
v_cvt_pk_bf16_f32 v35, v246, v247
v_mfma_f32_16x16x32_bf16 v[184:187], a[80:83], a[148:151], v[184:187]
s_waitcnt lgkmcnt(4)
v_mfma_f32_16x16x32_bf16 v[180:183], a[128:131], a[8:11], v[180:183]
ds_read_b64_tr_b16 a[180:181], v31 offset:6144
v_mfma_f32_16x16x32_bf16 v[180:183], a[132:135], a[192:195], v[180:183]
v_cvt_pk_bf16_f32 v178, v148, v149
v_mfma_f32_16x16x32_bf16 v[36:39], a[128:131], a[56:59], v[36:39]
ds_read_b64_tr_b16 a[182:183], v31 offset:30720
v_mfma_f32_16x16x32_bf16 v[36:39], a[132:135], a[196:199], v[36:39]
v_cvt_pk_bf16_f32 v179, v150, v151
v_mfma_f32_16x16x32_bf16 v[56:59], a[128:131], a[104:107], v[56:59]
ds_read_b64_tr_b16 a[60:61], v31 offset:7168
v_mfma_f32_16x16x32_bf16 v[56:59], a[132:135], a[200:203], v[56:59]
v_cvt_pk_bf16_f32 v114, v196, v197
v_mfma_f32_16x16x32_bf16 v[184:187], a[128:131], a[152:155], v[184:187]
ds_read_b64_tr_b16 a[62:63], v31 offset:31744
v_mfma_f32_16x16x32_bf16 v[184:187], a[132:135], a[208:211], v[184:187]
s_waitcnt lgkmcnt(4)
v_mfma_f32_16x16x32_bf16 v[180:183], a[176:179], a[204:207], v[180:183]
ds_read_b64_tr_b16 a[44:45], v31 offset:8192
v_mfma_f32_16x16x32_bf16 v[180:183], a[12:15], a[228:231], v[180:183]
v_cvt_pk_bf16_f32 v115, v198, v199
v_mfma_f32_16x16x32_bf16 v[36:39], a[176:179], a[212:215], v[36:39]
ds_read_b64_tr_b16 a[46:47], v31 offset:32768
v_mfma_f32_16x16x32_bf16 v[36:39], a[12:15], a[240:243], v[36:39]
buffer_store_dwordx4 v[216:219], v22, s[32:35], 0 offen offset:640 sc1
v_mfma_f32_16x16x32_bf16 v[56:59], a[176:179], a[216:219], v[56:59]
ds_read_b64_tr_b16 a[136:137], v31 offset:9216
v_mfma_f32_16x16x32_bf16 v[56:59], a[12:15], v[120:123], v[56:59]
v_mfma_f32_16x16x32_bf16 v[184:187], a[176:179], a[220:223], v[184:187]
ds_read_b64_tr_b16 a[138:139], v31 offset:33792
v_mfma_f32_16x16x32_bf16 v[184:187], a[12:15], v[92:95], v[184:187]
s_waitcnt lgkmcnt(4)
v_mfma_f32_16x16x32_bf16 v[180:183], a[180:183], v[172:175], v[180:183]
ds_read_b64_tr_b16 a[184:185], v31 offset:10240
v_mfma_f32_16x16x32_bf16 v[180:183], a[60:63], v[104:107], v[180:183]
v_mfma_f32_16x16x32_bf16 v[36:39], a[180:183], v[168:171], v[36:39]
ds_read_b64_tr_b16 a[186:187], v31 offset:34816
v_mfma_f32_16x16x32_bf16 v[36:39], a[60:63], v[164:167], v[36:39]
v_mfma_f32_16x16x32_bf16 v[56:59], a[180:183], v[40:43], v[56:59]
ds_read_b64_tr_b16 a[108:109], v31 offset:11264
v_mfma_f32_16x16x32_bf16 v[56:59], a[60:63], v[188:191], v[56:59]
v_mfma_f32_16x16x32_bf16 v[184:187], a[180:183], v[44:47], v[184:187]
ds_read_b64_tr_b16 a[110:111], v31 offset:35840
v_mfma_f32_16x16x32_bf16 v[184:187], a[60:63], v[88:91], v[184:187]
s_waitcnt lgkmcnt(4)
v_mfma_f32_16x16x32_bf16 v[180:183], a[44:47], v[84:87], v[180:183]
ds_read_b64_tr_b16 a[188:189], v24 offset:8
v_mfma_f32_16x16x32_bf16 v[180:183], a[136:139], v[68:71], v[180:183]
buffer_store_dwordx4 v[32:35], v25, s[32:35], 0 offen offset:640 sc1
v_mfma_f32_16x16x32_bf16 v[36:39], a[44:47], v[204:207], v[36:39]
ds_read_b64_tr_b16 a[190:191], v24 offset:24584
v_mfma_f32_16x16x32_bf16 v[36:39], a[136:139], v[240:243], v[36:39]
v_mfma_f32_16x16x32_bf16 v[56:59], a[44:47], v[100:103], v[56:59]
ds_read_b64_tr_b16 a[248:249], v24 offset:1032
v_mfma_f32_16x16x32_bf16 v[56:59], a[136:139], v[136:139], v[56:59]
v_mfma_f32_16x16x32_bf16 v[184:187], a[44:47], v[232:235], v[184:187]
ds_read_b64_tr_b16 a[250:251], v24 offset:25608
v_mfma_f32_16x16x32_bf16 v[184:187], a[136:139], v[248:251], v[184:187]
s_waitcnt lgkmcnt(4)
v_mfma_f32_16x16x32_bf16 v[180:183], a[184:187], v[64:67], v[180:183]
ds_read_b64_tr_b16 a[156:157], v24 offset:2056
v_mfma_f32_16x16x32_bf16 v[180:183], a[108:111], v[80:83], v[180:183]
v_mfma_f32_16x16x32_bf16 v[36:39], a[184:187], v[128:131], v[36:39]
ds_read_b64_tr_b16 a[158:159], v24 offset:26632
v_mfma_f32_16x16x32_bf16 v[36:39], a[108:111], v[132:135], v[36:39]
v_mfma_f32_16x16x32_bf16 v[56:59], a[184:187], v[236:239], v[56:59]
ds_read_b64_tr_b16 a[252:253], v24 offset:3080
v_mfma_f32_16x16x32_bf16 v[56:59], a[108:111], v[160:163], v[56:59]
v_mfma_f32_16x16x32_bf16 v[184:187], a[184:187], v[208:211], v[184:187]
ds_read_b64_tr_b16 a[254:255], v24 offset:27656
v_mfma_f32_16x16x32_bf16 v[184:187], a[108:111], v[108:111], v[184:187]
s_waitcnt lgkmcnt(4)
v_mfma_f32_16x16x32_bf16 v[76:79], a[188:191], a[0:3], 0
ds_read_b64_tr_b16 a[16:17], v24 offset:4104
v_mfma_f32_16x16x32_bf16 v[76:79], a[248:251], a[4:7], v[76:79]
v_cvt_pk_bf16_f32 v252, v180, v181
v_mfma_f32_16x16x32_bf16 v[156:159], a[188:191], a[48:51], 0
ds_read_b64_tr_b16 a[18:19], v24 offset:28680
v_mfma_f32_16x16x32_bf16 v[156:159], a[248:251], a[52:55], v[156:159]
v_cvt_pk_bf16_f32 v253, v182, v183
v_mfma_f32_16x16x32_bf16 v[200:203], a[188:191], a[96:99], 0
ds_read_b64_tr_b16 a[20:21], v24 offset:5128
v_mfma_f32_16x16x32_bf16 v[200:203], a[248:251], a[100:103], v[200:203]
buffer_store_dwordx4 v[176:179], v10, s[32:35], 0 offen offset:640 sc1
v_mfma_f32_16x16x32_bf16 v[144:147], a[188:191], a[144:147], 0
ds_read_b64_tr_b16 a[22:23], v24 offset:29704
v_cvt_pk_bf16_f32 v124, v36, v37
v_mfma_f32_16x16x32_bf16 v[144:147], a[248:251], a[148:151], v[144:147]
v_cvt_pk_bf16_f32 v125, v38, v39
s_waitcnt lgkmcnt(4)
v_mfma_f32_16x16x32_bf16 v[76:79], a[156:159], a[8:11], v[76:79]
ds_read_b64_tr_b16 a[64:65], v31 offset:6152
v_mfma_f32_16x16x32_bf16 v[76:79], a[252:255], a[192:195], v[76:79]
v_cvt_pk_bf16_f32 v60, v56, v57
v_mfma_f32_16x16x32_bf16 v[156:159], a[156:159], a[56:59], v[156:159]
ds_read_b64_tr_b16 a[66:67], v31 offset:30728
v_mfma_f32_16x16x32_bf16 v[156:159], a[252:255], a[196:199], v[156:159]
v_cvt_pk_bf16_f32 v61, v58, v59
v_mfma_f32_16x16x32_bf16 v[200:203], a[156:159], a[104:107], v[200:203]
ds_read_b64_tr_b16 a[68:69], v31 offset:7176
v_mfma_f32_16x16x32_bf16 v[200:203], a[252:255], a[200:203], v[200:203]
v_cvt_pk_bf16_f32 v192, v184, v185
v_mfma_f32_16x16x32_bf16 v[144:147], a[156:159], a[152:155], v[144:147]
ds_read_b64_tr_b16 a[70:71], v31 offset:31752
v_mfma_f32_16x16x32_bf16 v[144:147], a[252:255], a[208:211], v[144:147]
s_waitcnt lgkmcnt(4)
v_mfma_f32_16x16x32_bf16 v[76:79], a[16:19], a[204:207], v[76:79]
ds_read_b64_tr_b16 a[112:113], v31 offset:8200
v_mfma_f32_16x16x32_bf16 v[76:79], a[20:23], a[228:231], v[76:79]
v_cvt_pk_bf16_f32 v193, v186, v187
v_mfma_f32_16x16x32_bf16 v[156:159], a[16:19], a[212:215], v[156:159]
ds_read_b64_tr_b16 a[114:115], v31 offset:32776
v_mfma_f32_16x16x32_bf16 v[156:159], a[20:23], a[240:243], v[156:159]
v_mfma_f32_16x16x32_bf16 v[200:203], a[16:19], a[216:219], v[200:203]
ds_read_b64_tr_b16 a[116:117], v31 offset:9224
v_mfma_f32_16x16x32_bf16 v[200:203], a[20:23], v[120:123], v[200:203]
v_mfma_f32_16x16x32_bf16 v[144:147], a[16:19], a[220:223], v[144:147]
ds_read_b64_tr_b16 a[118:119], v31 offset:33800
v_mfma_f32_16x16x32_bf16 v[144:147], a[20:23], v[92:95], v[144:147]
s_waitcnt lgkmcnt(4)
v_mfma_f32_16x16x32_bf16 v[76:79], a[64:67], v[172:175], v[76:79]
ds_read_b64_tr_b16 a[160:161], v31 offset:10248
v_mfma_f32_16x16x32_bf16 v[76:79], a[68:71], v[104:107], v[76:79]
buffer_store_dwordx4 v[112:115], v21, s[32:35], 0 offen offset:640 sc1
v_mfma_f32_16x16x32_bf16 v[156:159], a[64:67], v[168:171], v[156:159]
ds_read_b64_tr_b16 a[162:163], v31 offset:34824
v_mfma_f32_16x16x32_bf16 v[156:159], a[68:71], v[164:167], v[156:159]
v_mfma_f32_16x16x32_bf16 v[200:203], a[64:67], v[40:43], v[200:203]
ds_read_b64_tr_b16 a[224:225], v31 offset:11272
v_mfma_f32_16x16x32_bf16 v[200:203], a[68:71], v[188:191], v[200:203]
v_mfma_f32_16x16x32_bf16 v[144:147], a[64:67], v[44:47], v[144:147]
ds_read_b64_tr_b16 a[226:227], v31 offset:35848
v_mfma_f32_16x16x32_bf16 v[144:147], a[68:71], v[88:91], v[144:147]
s_waitcnt lgkmcnt(4)
v_mfma_f32_16x16x32_bf16 v[76:79], a[112:115], v[84:87], v[76:79]
v_mfma_f32_16x16x32_bf16 v[76:79], a[116:119], v[68:71], v[76:79]
v_mfma_f32_16x16x32_bf16 v[156:159], a[112:115], v[204:207], v[156:159]
v_mfma_f32_16x16x32_bf16 v[156:159], a[116:119], v[240:243], v[156:159]
v_mfma_f32_16x16x32_bf16 v[200:203], a[112:115], v[100:103], v[200:203]
v_mfma_f32_16x16x32_bf16 v[200:203], a[116:119], v[136:139], v[200:203]
v_mfma_f32_16x16x32_bf16 v[144:147], a[112:115], v[232:235], v[144:147]
v_mfma_f32_16x16x32_bf16 v[144:147], a[116:119], v[248:251], v[144:147]
s_waitcnt lgkmcnt(0)
v_mfma_f32_16x16x32_bf16 v[76:79], a[160:163], v[64:67], v[76:79]
v_mfma_f32_16x16x32_bf16 v[76:79], a[224:227], v[80:83], v[76:79]
v_mfma_f32_16x16x32_bf16 v[156:159], a[160:163], v[128:131], v[156:159]
v_mfma_f32_16x16x32_bf16 v[156:159], a[224:227], v[132:135], v[156:159]
v_mfma_f32_16x16x32_bf16 v[200:203], a[160:163], v[236:239], v[200:203]
v_mfma_f32_16x16x32_bf16 v[200:203], a[224:227], v[160:163], v[200:203]
v_mfma_f32_16x16x32_bf16 v[144:147], a[160:163], v[208:211], v[144:147]
v_mfma_f32_16x16x32_bf16 v[144:147], a[224:227], v[108:111], v[144:147]
s_nop 1
v_cvt_pk_bf16_f32 v254, v76, v77
v_cvt_pk_bf16_f32 v255, v78, v79
v_cvt_pk_bf16_f32 v126, v156, v157
v_cvt_pk_bf16_f32 v127, v158, v159
v_cvt_pk_bf16_f32 v62, v200, v201
v_cvt_pk_bf16_f32 v63, v202, v203
v_cvt_pk_bf16_f32 v194, v144, v145
v_cvt_pk_bf16_f32 v195, v146, v147
buffer_store_dwordx4 v[252:255], v22, s[32:35], 0 offen offset:704 sc1
buffer_store_dwordx4 v[124:127], v25, s[32:35], 0 offen offset:704 sc1
buffer_store_dwordx4 v[60:63], v10, s[32:35], 0 offen offset:704 sc1
buffer_store_dwordx4 v[192:195], v21, s[32:35], 0 offen offset:704 sc1
L_done:
s_endpgm
L_end:
.section .rodata,"a"
.p2align 6
.amdhsa_kernel standalone__window_attn_swin__vision_kernel
  .amdhsa_next_free_vgpr 512
  .amdhsa_next_free_sgpr 96
  .amdhsa_accum_offset 256
  .amdhsa_group_segment_fixed_size 0
  .amdhsa_kernarg_size 72
  .amdhsa_user_sgpr_count 2
  .amdhsa_user_sgpr_kernarg_segment_ptr 1
  .amdhsa_system_sgpr_workgroup_id_x 1
.end_amdhsa_kernel
```
